```python
import torch

def _softmax(x, axis=-1):
    return torch.softmax(x, dim=axis)
def _gelu(x):
    return torch.nn.functional.gelu(x, approximate="tanh")
def _silu(x):
    return torch.nn.functional.silu(x)
def _sigmoid(x):
    return torch.sigmoid(x)
def _layernorm(x, axis=-1, eps=1e-5):
    m = x.mean(dim=axis, keepdim=True)
    v = x.var(dim=axis, keepdim=True, unbiased=False)
    return (x - m) / torch.sqrt(v + eps)
def _scatter_add(tgt, idx, src, axis=0):
    return tgt.clone().index_add_(axis, idx, src)
def _segment_sum(src, seg, n):
    out = torch.zeros((n,) + src.shape[1:], dtype=src.dtype)
    return out.index_add_(0, seg, src)
def _pad(x, pw):
    flat = tuple(v for pair in reversed(pw) for v in pair)
    return torch.nn.functional.pad(x, flat)

kernel_name = 'recurrent_scan__gqa_block_cached__mixer_token_mlp__prompt'

def setup_inputs():

    _w = (lambda a: (lambda t: t.to(torch.bfloat16) if t.is_floating_point() else t)(torch.as_tensor(a)))
    def _A_setup():
        B, Sq, D = 1, 2048, 640
        Hq, Hkv, Sk, Dh = 32, 32, 2048, 128
        assert Hq % Hkv == 0, (Hq, Hkv)
        return {
            "x": _w((lambda *s: torch.randn(*s, dtype=torch.bfloat16) * 0.1)(B, Sq, D)),
            "k_cache": _w((lambda *s: torch.randn(*s, dtype=torch.bfloat16) * 0.8)(B, Hkv, Sk, Dh)),
            "v_cache": _w((lambda *s: torch.randn(*s, dtype=torch.bfloat16) * 3.2)(B, Hkv, Sk, Dh)),
            "wq": _w((lambda *s: torch.randn(*s, dtype=torch.bfloat16) * 0.8)(D, Hq * Dh) * (D ** -0.5)),
            "wo": _w((lambda *s: torch.randn(*s, dtype=torch.bfloat16) * 3.2)(Hq * Dh, D) * ((Hq * Dh) ** -0.5)),
        }
    _A_in = _A_setup()

    def _B_setup():
        B, S, D, F = 1, 2048, 640, 1728
        return {
            "x": _w((lambda *s: torch.randn(*s, dtype=torch.bfloat16) * 0.1)(B, S, D)),
            "w1": _w((lambda *s: torch.randn(*s, dtype=torch.bfloat16) * 3.2)(S, F) * (S ** -0.5)),
            "b1": _w((lambda *s: torch.randn(*s, dtype=torch.bfloat16) * 3.2)(F) * 0.02),
            "w2": _w((lambda *s: torch.randn(*s, dtype=torch.bfloat16) * 3.2)(F, S) * (F ** -0.5)),
            "b2": _w((lambda *s: torch.randn(*s, dtype=torch.bfloat16) * 3.2)(S) * 0.02),
        }
    _B_in = _B_setup()

    return {
        "A_x": _A_in["x"],
        "A_k_cache": _A_in["k_cache"],
        "A_v_cache": _A_in["v_cache"],
        "A_wq": _A_in["wq"],
        "A_wo": _A_in["wo"],
        "B_x": _B_in["x"],
        "B_w1": _B_in["w1"],
        "B_b1": _B_in["b1"],
        "B_w2": _B_in["w2"],
        "B_b2": _B_in["b2"],
    }

def reference(A_x, A_k_cache, A_v_cache, A_wq, A_wo, B_x, B_w1, B_b1, B_w2, B_b2):
    def _A_ref(x, k_cache, v_cache, wq, wo):
        B, Sq, D = x.shape
        Hq, Dh = 32, 128
        Hkv = k_cache.shape[1]
        rep = Hq // Hkv
        q = (lambda x, *d: x.permute(*d))((x @ wq).reshape(B, Sq, Hq, Dh), 0, 2, 1, 3)
        k = (lambda x, n, axis: torch.repeat_interleave(x, n, dim=axis))(k_cache, rep, axis=1)
        v = (lambda x, n, axis: torch.repeat_interleave(x, n, dim=axis))(v_cache, rep, axis=1)
        scores = torch.einsum("bhqd,bhkd->bhqk", q, k) * (Dh ** -0.5)
        p = _softmax(scores, axis=-1)
        o = torch.einsum("bhqk,bhkd->bhqd", p, v)
        return (lambda x, *d: x.permute(*d))(o, 0, 2, 1, 3).reshape(B, Sq, Hq * Dh) @ wo

    def _B_ref(x, w1, b1, w2, b2):
        B, S, D = x.shape
        h = _layernorm(x, axis=-1)
        u = torch.einsum("bsd,sf->bdf", h, w1) + b1
        u = _gelu(u)
        y = torch.einsum("bdf,fs->bds", u, w2) + b2
        return (lambda x, *d: x.permute(*d))(y, 0, 2, 1)

    x = A_x
    xn = _layernorm(x, axis=-1)
    s = _A_ref(xn, A_k_cache, A_v_cache, A_wq, A_wo)
    g = _silu(_B_ref(xn, B_w1, B_b1, B_w2, B_b2))
    return x + s * g
```

```asm
; @launch grid=(256,1,1) block=(256,1,1) lds=163840
.amdgcn_target "amdgcn-amd-amdhsa--gfx950"
.text
.text
.globl recurrent_scan__gqa_block_cached__mixer_token_mlp__prompt_kernel
.p2align 8
.type recurrent_scan__gqa_block_cached__mixer_token_mlp__prompt_kernel,@function
recurrent_scan__gqa_block_cached__mixer_token_mlp__prompt_kernel:
    s_cmp_ge_u32 s2, 256
    s_cbranch_scc1 L_end
    s_load_dwordx16 s[4:19], s[0:1], 0
    s_load_dwordx8 s[20:27], s[0:1], 64
    s_load_dwordx2 s[28:29], s[0:1], 96
    s_getpc_b64 s[30:31]
L_pc:
    v_and_b32 v1, 63, v0
    v_lshrrev_b32 v6, 6, v0
    v_and_b32 v2, 15, v0
    v_readfirstlane_b32 s76, v6
    v_lshrrev_b32 v3, 4, v1
    v_lshrrev_b32 v4, 2, v2
    v_and_b32 v5, 3, v0
    s_and_b32 s79, s2, 7
    s_lshr_b32 s80, s2, 3
    s_and_b32 s81, s80, 3
    s_lshl_b32 s77, s79, 2
    s_add_u32 s77, s77, s81
    s_lshr_b32 s78, s80, 2
    s_mov_b32 s94, 0
    s_lshl_b32 s81, s78, 8
    s_lshl_b32 s82, s76, 6
    s_add_u32 s81, s81, s82
    v_lshrrev_b32 v6, 3, v1
    v_add_u32 v6, s81, v6
    v_mul_u32_u24 v6, 1280, v6
    v_and_b32 v7, 7, v1
    v_xor_b32 v7, v7, v3
    v_lshl_add_u32 v8, v7, 4, v6
    v_xor_b32 v7, 4, v7
    v_lshl_add_u32 v9, v7, 4, v6
    v_add_u32 v9, 9216, v9
    v_add_u32 v10, 18432, v8
    v_add_u32 v11, 18432, v9
    v_add_u32 v12, 40960, v8
    v_add_u32 v13, 40960, v9
    v_add_u32 v14, 59392, v8
    v_add_u32 v15, 59392, v9
    s_lshl_b32 s81, s76, 4
    v_add_u32 v6, s81, v3
    v_lshlrev_b32 v6, 13, v6
    s_lshl_b32 s82, s77, 8
    v_add_u32 v6, s82, v6
    v_lshlrev_b32 v7, 1, v3
    v_xor_b32 v7, v7, v2
    v_lshl_add_u32 v16, v7, 4, v6
    v_add_u32 v17, 31744, v16
    v_xor_b32 v7, 8, v7
    v_lshl_add_u32 v18, v7, 4, v6
    v_add_u32 v18, 63488, v18
    v_add_u32 v19, 31744, v18
    s_and_b32 s81, s80, 3
    s_mul_i32 s81, s81, 0
    s_lshr_b32 s81, s81, 2
    s_mul_i32 s82, s78, 2
    s_lshr_b32 s82, s82, 2
    s_add_u32 s81, s81, s82
    s_lshl_b32 s91, s81, 7
    s_sub_u32 s81, s91, 1280
    s_cselect_b32 s91, s91, s81
    s_waitcnt lgkmcnt(0)
    s_mov_b32 s32, s4
    s_mov_b32 s33, s5
    s_mov_b32 s34, 2621440
    s_mov_b32 s35, 0x20000
    s_mov_b32 s44, s10
    s_mov_b32 s45, s11
    s_mov_b32 s46, 5242880
    s_mov_b32 s47, 0x20000
    s_lshl_b32 s84, s76, 13
    s_add_u32 m0, s84, 0
    s_nop 0
    buffer_load_dwordx4 v8, s[32:35], s91 offen offset:0 lds
    buffer_load_dwordx4 v9, s[32:35], s91 offen offset:1024 lds
    buffer_load_dwordx4 v10, s[32:35], s91 offen offset:2048 lds
    buffer_load_dwordx4 v11, s[32:35], s91 offen offset:3072 lds
    s_add_u32 m0, s84, 4096
    s_lshl_b32 s85, s91, 12
    buffer_load_dwordx4 v12, s[32:35], s91 offen offset:0 lds
    buffer_load_dwordx4 v13, s[32:35], s91 offen offset:1024 lds
    buffer_load_dwordx4 v14, s[32:35], s91 offen offset:2048 lds
    buffer_load_dwordx4 v15, s[32:35], s91 offen offset:3072 lds
    s_lshl_b32 s84, s76, 12
    s_add_u32 m0, s84, 32768
    s_add_u32 s91, s91, 128
    buffer_load_dwordx4 v16, s[44:47], s85 offen offset:0 lds
    buffer_load_dwordx4 v17, s[44:47], s85 offen offset:1024 lds
    buffer_load_dwordx4 v18, s[44:47], s85 offen offset:2048 lds
    buffer_load_dwordx4 v19, s[44:47], s85 offen offset:3072 lds
    s_cmp_eq_u32 s91, 1280
    s_cselect_b32 s91, 0, s91
    s_lshr_b32 s81, s2, 2
    s_lshl_b32 s81, s81, 5
    s_and_b32 s82, s2, 3
    s_lshl_b32 s82, s82, 2
    s_add_u32 s81, s81, s82
    s_lshr_b32 s82, s76, 1
    s_lshl_b32 s82, s82, 4
    s_add_u32 s81, s81, s82
    s_and_b32 s82, s76, 1
    s_lshl_b32 s82, s82, 1
    s_add_u32 s81, s81, s82
    v_lshrrev_b32 v6, 5, v1
    v_add_u32 v96, s81, v6
    v_mul_u32_u24 v6, 1280, v96
    v_and_b32 v7, 31, v1
    v_lshl_add_u32 v97, v7, 4, v6
    v_lshl_add_u32 v98, v7, 3, v6
    buffer_load_dwordx4 v[64:67], v97, s[32:35], 0 offen
    buffer_load_dwordx4 v[68:71], v97, s[32:35], 0 offen offset:512
    buffer_load_dwordx2 v[72:73], v98, s[32:35], 0 offen offset:1024
    s_lshl_b32 s81, s77, 19
    s_add_u32 s36, s6, s81
    s_addc_u32 s37, s7, 0
    s_mov_b32 s38, 0x80000
    s_mov_b32 s39, 0x20000
    s_add_u32 s40, s8, s81
    s_addc_u32 s41, s9, 0
    s_mov_b32 s42, 0x80000
    s_mov_b32 s43, 0x20000
    s_mov_b32 s48, s12
    s_mov_b32 s49, s13
    s_mov_b32 s50, 5242880
    s_mov_b32 s51, 0x20000
    s_mov_b32 s52, s16
    s_mov_b32 s53, s17
    s_mov_b32 s54, 7077888
    s_mov_b32 s55, 0x20000
    s_mov_b32 s56, s20
    s_mov_b32 s57, s21
    s_mov_b32 s58, 7077888
    s_mov_b32 s59, 0x20000
    s_mov_b32 s60, s18
    s_mov_b32 s61, s19
    s_mov_b32 s62, 3456
    s_mov_b32 s63, 0x20000
    s_mov_b32 s64, s22
    s_mov_b32 s65, s23
    s_mov_b32 s66, 4096
    s_mov_b32 s67, 0x20000
    s_mov_b32 s68, s24
    s_mov_b32 s69, s25
    s_mov_b32 s70, 2621440
    s_mov_b32 s71, 0x20000
    s_mov_b32 s72, s28
    s_mov_b32 s73, s29
    s_mov_b32 s74, 37748736
    s_mov_b32 s75, 0x20000
    s_mov_b32 s24, s26
    s_mov_b32 s25, s27
    s_mov_b32 s26, 256
    s_mov_b32 s27, 0x20000
    s_lshr_b32 s28, s80, 3
    s_lshr_b32 s81, s79, 0
    s_mul_i32 s81, s81, 4
    s_add_u32 s28, s28, s81
    s_and_b32 s29, s80, 7
    s_and_b32 s81, s79, 0
    s_lshl_b32 s81, s81, 3
    s_add_u32 s29, s29, s81
    s_lshr_b32 s81, s28, 1
    s_add_u32 s81, s81, 16
    v_mov_b32 v6, s81
    v_cmp_gt_u32 vcc, 13, v1
    s_nop 1
    v_cndmask_b32 v6, v6, v1, vcc
    v_add_u32 v7, 18, v1
    v_cmp_lt_u32 vcc, 13, v1
    s_nop 1
    v_cndmask_b32 v6, v6, v7, vcc
    v_lshlrev_b32 v6, 8, v6
    v_add_u32 v6, 35651584, v6
    buffer_load_dword a250, v6, s[72:75], 0 offen sc1
    s_lshl_b32 s84, s76, 13
    s_add_u32 m0, s84, 49152
    s_nop 0
    buffer_load_dwordx4 v8, s[32:35], s91 offen offset:0 lds
    buffer_load_dwordx4 v9, s[32:35], s91 offen offset:1024 lds
    buffer_load_dwordx4 v10, s[32:35], s91 offen offset:2048 lds
    buffer_load_dwordx4 v11, s[32:35], s91 offen offset:3072 lds
    s_add_u32 m0, s84, 53248
    s_lshl_b32 s85, s91, 12
    buffer_load_dwordx4 v12, s[32:35], s91 offen offset:0 lds
    buffer_load_dwordx4 v13, s[32:35], s91 offen offset:1024 lds
    buffer_load_dwordx4 v14, s[32:35], s91 offen offset:2048 lds
    buffer_load_dwordx4 v15, s[32:35], s91 offen offset:3072 lds
    s_lshl_b32 s84, s76, 12
    s_add_u32 m0, s84, 81920
    s_add_u32 s91, s91, 128
    buffer_load_dwordx4 v16, s[44:47], s85 offen offset:0 lds
    buffer_load_dwordx4 v17, s[44:47], s85 offen offset:1024 lds
    buffer_load_dwordx4 v18, s[44:47], s85 offen offset:2048 lds
    buffer_load_dwordx4 v19, s[44:47], s85 offen offset:3072 lds
    s_cmp_eq_u32 s91, 1280
    s_cselect_b32 s91, 0, s91
    s_lshl_b32 s81, s80, 2
    s_add_u32 s81, s81, s76
    s_lshl_b32 s81, s81, 10
    s_add_u32 s81, s81, L_pc-L_pc
    v_lshrrev_b32 v6, 3, v1
    v_lshlrev_b32 v6, 7, v6
    v_add_u32 v6, s81, v6
    v_min_u32 v6, L_codeend-L_pc-4, v6
    global_load_dword v63, v6, s[30:31]
    s_lshl_b32 s81, s76, 13
    v_lshlrev_b32 v6, 7, v2
    v_add_u32 v6, s81, v6
    v_lshrrev_b32 v7, 1, v2
    v_xor_b32 v7, v7, v3
    v_lshl_add_u32 v20, v7, 4, v6
    v_xor_b32 v21, 64, v20
    v_add_u32 v22, 0x10000, v20
    v_add_u32 v23, 0x10000, v21
    v_lshl_add_u32 v6, v3, 3, v4
    v_lshlrev_b32 v6, 8, v6
    v_add_u32 v6, 32768, v6
    v_and_b32 v7, 1, v3
    v_lshl_add_u32 v7, v7, 2, v4
    s_lshl_b32 s81, s76, 1
    v_xor_b32 v7, s81, v7
    v_lshrrev_b32 v32, 1, v5
    v_xor_b32 v7, v7, v32
    v_lshl_add_u32 v6, v7, 5, v6
    v_and_b32 v7, 1, v5
    v_lshl_add_u32 v24, v7, 4, v6
    v_xor_b32 v25, 8, v24
    v_xor_b32 v26, 64, v24
    v_xor_b32 v27, 72, v24
    v_xor_b32 v28, 128, v24
    v_xor_b32 v29, 136, v24
    v_xor_b32 v30, 192, v24
    v_xor_b32 v31, 200, v24
    v_add_u32 v32, 0x10000, v24
    v_add_u32 v33, 0x10000, v25
    v_add_u32 v34, 0x10000, v26
    v_add_u32 v35, 0x10000, v27
    v_add_u32 v36, 0x10000, v28
    v_add_u32 v37, 0x10000, v29
    v_add_u32 v38, 0x10000, v30
    v_add_u32 v39, 0x10000, v31
    v_mov_b32 v48, 0x3f803f80
    v_mov_b32 v49, 0x3f803f80
    v_mov_b32 v50, 0x3f803f80
    v_mov_b32 v51, 0x3f803f80
    v_and_b32 v6, 1, v1
    v_and_b32 v7, 6, v1
    v_lshlrev_b32 v7, 1, v7
    v_lshl_add_u32 v61, v6, 7, v7
    s_lshl_b32 s90, s76, 12
    v_lshlrev_b32 v6, 8, v3
    v_add_u32 v6, s90, v6
    v_xor_b32 v7, v2, v3
    v_lshl_add_u32 v52, v7, 4, v6
    v_xor_b32 v53, 64, v52
    v_xor_b32 v54, 128, v52
    v_xor_b32 v55, 192, v52
    v_lshlrev_b32 v7, 1, v3
    v_xor_b32 v7, v2, v7
    v_lshl_add_u32 v56, v7, 4, v6
    v_xor_b32 v57, 128, v56
    s_waitcnt vmcnt(14)
    s_barrier
    ds_read_b128 a[72:75], v20 offset:0
    ds_read_b128 a[76:79], v20 offset:2048
    ds_read_b128 a[80:83], v20 offset:4096
    ds_read_b128 a[84:87], v20 offset:6144
    ds_read_b128 a[88:91], v21 offset:0
    ds_read_b128 a[92:95], v21 offset:2048
    ds_read_b128 a[96:99], v21 offset:4096
    ds_read_b128 a[100:103], v21 offset:6144
    ds_read_b64_tr_b16 a[0:1], v24 offset:0
    ds_read_b64_tr_b16 a[2:3], v24 offset:1024
    ds_read_b64_tr_b16 a[4:5], v24 offset:8192
    ds_read_b64_tr_b16 a[6:7], v24 offset:9216
    ds_read_b64_tr_b16 a[8:9], v25 offset:0
    ds_read_b64_tr_b16 a[10:11], v25 offset:1024
    ds_read_b64_tr_b16 a[12:13], v25 offset:8192
    ds_read_b64_tr_b16 a[14:15], v25 offset:9216
    ds_read_b64_tr_b16 a[16:17], v26 offset:0
    ds_read_b64_tr_b16 a[18:19], v26 offset:1024
    ds_read_b64_tr_b16 a[20:21], v26 offset:8192
    ds_read_b64_tr_b16 a[22:23], v26 offset:9216
    ds_read_b64_tr_b16 a[24:25], v27 offset:0
    ds_read_b64_tr_b16 a[26:27], v27 offset:1024
    ds_read_b64_tr_b16 a[28:29], v27 offset:8192
    ds_read_b64_tr_b16 a[30:31], v27 offset:9216
    ds_read_b64_tr_b16 a[32:33], v28 offset:0
    ds_read_b64_tr_b16 a[34:35], v28 offset:1024
    ds_read_b64_tr_b16 a[36:37], v28 offset:8192
    ds_read_b64_tr_b16 a[38:39], v28 offset:9216
    ds_read_b64_tr_b16 a[40:41], v29 offset:0
    ds_read_b64_tr_b16 a[42:43], v29 offset:1024
    ds_read_b64_tr_b16 a[44:45], v29 offset:8192
    ds_read_b64_tr_b16 a[46:47], v29 offset:9216
    ds_read_b64_tr_b16 a[48:49], v30 offset:0
    ds_read_b64_tr_b16 a[50:51], v30 offset:1024
    ds_read_b64_tr_b16 a[52:53], v30 offset:8192
    ds_read_b64_tr_b16 a[54:55], v30 offset:9216
    ds_read_b64_tr_b16 a[56:57], v31 offset:0
    ds_read_b64_tr_b16 a[58:59], v31 offset:1024
    ds_read_b64_tr_b16 a[60:61], v31 offset:8192
    ds_read_b64_tr_b16 a[62:63], v31 offset:9216
    s_waitcnt vmcnt(1) lgkmcnt(0)
    s_barrier
    v_mfma_f32_16x16x32_bf16 v[128:131], a[0:3], a[72:75], 0
    ds_read_b128 a[104:107], v20 offset:49152
    v_lshlrev_b32 v99, 3, v96
    v_mfma_f32_16x16x32_bf16 v[128:131], a[4:7], a[88:91], v[128:131]
    ds_read_b128 a[108:111], v20 offset:51200
    s_lshl_b32 s84, s76, 13
    s_add_u32 m0, s84, 98304
    s_nop 0
    v_mfma_f32_16x16x32_bf16 v[132:135], a[0:3], a[76:79], 0
    ds_read_b128 a[112:115], v20 offset:53248
    v_lshlrev_b32 v76, 16, v64
    v_mfma_f32_16x16x32_bf16 v[132:135], a[4:7], a[92:95], v[132:135]
    ds_read_b128 a[116:119], v20 offset:55296
    buffer_load_dwordx4 v8, s[32:35], s91 offen offset:0 lds
    v_mfma_f32_16x16x32_bf16 v[136:139], a[0:3], a[80:83], 0
    ds_read_b128 a[120:123], v21 offset:49152
    v_and_b32 v77, 0xffff0000, v64
    v_mfma_f32_16x16x32_bf16 v[136:139], a[4:7], a[96:99], v[136:139]
    ds_read_b128 a[124:127], v21 offset:51200
    buffer_load_dwordx4 v9, s[32:35], s91 offen offset:1024 lds
    v_mfma_f32_16x16x32_bf16 v[140:143], a[0:3], a[84:87], 0
    ds_read_b128 a[128:131], v21 offset:53248
    v_lshlrev_b32 v78, 16, v65
    v_mfma_f32_16x16x32_bf16 v[140:143], a[4:7], a[100:103], v[140:143]
    ds_read_b128 a[132:135], v21 offset:55296
    buffer_load_dwordx4 v10, s[32:35], s91 offen offset:2048 lds
    v_mfma_f32_16x16x32_bf16 v[40:43], a[0:3], v[48:51], 0
    v_and_b32 v79, 0xffff0000, v65
    v_lshlrev_b32 v80, 16, v66
    v_mfma_f32_16x16x32_bf16 v[40:43], a[4:7], v[48:51], v[40:43]
    buffer_load_dwordx4 v11, s[32:35], s91 offen offset:3072 lds
    v_and_b32 v81, 0xffff0000, v66
    v_mfma_f32_16x16x32_bf16 v[144:147], a[8:11], a[72:75], 0
    ds_read_b64_tr_b16 a[0:1], v24 offset:49152
    v_lshlrev_b32 v82, 16, v67
    v_mfma_f32_16x16x32_bf16 v[144:147], a[12:15], a[88:91], v[144:147]
    ds_read_b64_tr_b16 a[2:3], v24 offset:50176
    s_add_u32 m0, s84, 102400
    s_lshl_b32 s85, s91, 12
    v_mfma_f32_16x16x32_bf16 v[148:151], a[8:11], a[76:79], 0
    ds_read_b64_tr_b16 a[4:5], v24 offset:57344
    v_and_b32 v83, 0xffff0000, v67
    v_mfma_f32_16x16x32_bf16 v[148:151], a[12:15], a[92:95], v[148:151]
    ds_read_b64_tr_b16 a[6:7], v24 offset:58368
    buffer_load_dwordx4 v12, s[32:35], s91 offen offset:0 lds
    v_mfma_f32_16x16x32_bf16 v[152:155], a[8:11], a[80:83], 0
    ds_read_b64_tr_b16 a[64:65], v31 offset:49152
    v_lshlrev_b32 v84, 16, v68
    v_mfma_f32_16x16x32_bf16 v[152:155], a[12:15], a[96:99], v[152:155]
    ds_read_b64_tr_b16 a[66:67], v31 offset:50176
    buffer_load_dwordx4 v13, s[32:35], s91 offen offset:1024 lds
    v_mfma_f32_16x16x32_bf16 v[156:159], a[8:11], a[84:87], 0
    ds_read_b64_tr_b16 a[68:69], v31 offset:57344
    v_and_b32 v85, 0xffff0000, v68
    v_mfma_f32_16x16x32_bf16 v[156:159], a[12:15], a[100:103], v[156:159]
    ds_read_b64_tr_b16 a[70:71], v31 offset:58368
    buffer_load_dwordx4 v14, s[32:35], s91 offen offset:2048 lds
    v_mfma_f32_16x16x32_bf16 v[44:47], a[8:11], v[48:51], 0
    v_lshlrev_b32 v86, 16, v69
    v_and_b32 v87, 0xffff0000, v69
    v_mfma_f32_16x16x32_bf16 v[44:47], a[12:15], v[48:51], v[44:47]
    buffer_load_dwordx4 v15, s[32:35], s91 offen offset:3072 lds
    v_lshlrev_b32 v88, 16, v70
    v_mfma_f32_16x16x32_bf16 v[160:163], a[16:19], a[72:75], 0
    ds_read_b64_tr_b16 a[8:9], v25 offset:49152
    v_and_b32 v89, 0xffff0000, v70
    v_mfma_f32_16x16x32_bf16 v[160:163], a[20:23], a[88:91], v[160:163]
    ds_read_b64_tr_b16 a[10:11], v25 offset:50176
    s_lshl_b32 s84, s76, 12
    s_add_u32 m0, s84, 131072
    s_add_u32 s91, s91, 128
    v_mfma_f32_16x16x32_bf16 v[164:167], a[16:19], a[76:79], 0
    ds_read_b64_tr_b16 a[12:13], v25 offset:57344
    v_lshlrev_b32 v90, 16, v71
    v_mfma_f32_16x16x32_bf16 v[164:167], a[20:23], a[92:95], v[164:167]
    ds_read_b64_tr_b16 a[14:15], v25 offset:58368
    buffer_load_dwordx4 v16, s[44:47], s85 offen offset:0 lds
    v_mfma_f32_16x16x32_bf16 v[168:171], a[16:19], a[80:83], 0
    v_and_b32 v91, 0xffff0000, v71
    v_lshlrev_b32 v92, 16, v72
    v_mfma_f32_16x16x32_bf16 v[168:171], a[20:23], a[96:99], v[168:171]
    buffer_load_dwordx4 v17, s[44:47], s85 offen offset:1024 lds
    v_and_b32 v93, 0xffff0000, v72
    v_mfma_f32_16x16x32_bf16 v[172:175], a[16:19], a[84:87], 0
    v_lshlrev_b32 v94, 16, v73
    v_and_b32 v95, 0xffff0000, v73
    v_mfma_f32_16x16x32_bf16 v[172:175], a[20:23], a[100:103], v[172:175]
    buffer_load_dwordx4 v18, s[44:47], s85 offen offset:2048 lds
    v_add_f32 v100, v76, v77
    v_mfma_f32_16x16x32_bf16 v[176:179], a[24:27], a[72:75], 0
    ds_read_b64_tr_b16 a[16:17], v26 offset:49152
    v_add_f32 v101, v78, v79
    v_mfma_f32_16x16x32_bf16 v[176:179], a[28:31], a[88:91], v[176:179]
    ds_read_b64_tr_b16 a[18:19], v26 offset:50176
    buffer_load_dwordx4 v19, s[44:47], s85 offen offset:3072 lds
    v_mfma_f32_16x16x32_bf16 v[180:183], a[24:27], a[76:79], 0
    ds_read_b64_tr_b16 a[20:21], v26 offset:57344
    v_add_f32 v100, v100, v80
    v_mfma_f32_16x16x32_bf16 v[180:183], a[28:31], a[92:95], v[180:183]
    ds_read_b64_tr_b16 a[22:23], v26 offset:58368
    s_cmp_eq_u32 s91, 1280
    s_cselect_b32 s91, 0, s91
    v_mfma_f32_16x16x32_bf16 v[184:187], a[24:27], a[80:83], 0
    v_add_f32 v101, v101, v81
    v_add_f32 v100, v100, v82
    v_mfma_f32_16x16x32_bf16 v[184:187], a[28:31], a[96:99], v[184:187]
    s_lshl_b32 s84, s76, 13
    s_add_u32 m0, s84, 0
    s_nop 0
    v_mfma_f32_16x16x32_bf16 v[188:191], a[24:27], a[84:87], 0
    v_add_f32 v101, v101, v83
    v_add_f32 v100, v100, v84
    v_mfma_f32_16x16x32_bf16 v[188:191], a[28:31], a[100:103], v[188:191]
    buffer_load_dwordx4 v8, s[32:35], s91 offen offset:0 lds
    v_add_f32 v101, v101, v85
    v_mfma_f32_16x16x32_bf16 v[192:195], a[32:35], a[72:75], 0
    ds_read_b64_tr_b16 a[24:25], v27 offset:49152
    v_add_f32 v100, v100, v86
    v_mfma_f32_16x16x32_bf16 v[192:195], a[36:39], a[88:91], v[192:195]
    ds_read_b64_tr_b16 a[26:27], v27 offset:50176
    buffer_load_dwordx4 v9, s[32:35], s91 offen offset:1024 lds
    v_mfma_f32_16x16x32_bf16 v[196:199], a[32:35], a[76:79], 0
    ds_read_b64_tr_b16 a[28:29], v27 offset:57344
    v_add_f32 v101, v101, v87
    v_mfma_f32_16x16x32_bf16 v[196:199], a[36:39], a[92:95], v[196:199]
    ds_read_b64_tr_b16 a[30:31], v27 offset:58368
    buffer_load_dwordx4 v10, s[32:35], s91 offen offset:2048 lds
    v_mfma_f32_16x16x32_bf16 v[200:203], a[32:35], a[80:83], 0
    v_add_f32 v100, v100, v88
    v_add_f32 v101, v101, v89
    v_mfma_f32_16x16x32_bf16 v[200:203], a[36:39], a[96:99], v[200:203]
    buffer_load_dwordx4 v11, s[32:35], s91 offen offset:3072 lds
    v_add_f32 v100, v100, v90
    v_mfma_f32_16x16x32_bf16 v[204:207], a[32:35], a[84:87], 0
    v_add_f32 v101, v101, v91
    v_add_f32 v100, v100, v92
    v_mfma_f32_16x16x32_bf16 v[204:207], a[36:39], a[100:103], v[204:207]
    s_add_u32 m0, s84, 4096
    s_lshl_b32 s85, s91, 12
    v_mfma_f32_16x16x32_bf16 v[208:211], a[40:43], a[72:75], 0
    ds_read_b64_tr_b16 a[32:33], v28 offset:49152
    v_add_f32 v101, v101, v93
    v_mfma_f32_16x16x32_bf16 v[208:211], a[44:47], a[88:91], v[208:211]
    ds_read_b64_tr_b16 a[34:35], v28 offset:50176
    buffer_load_dwordx4 v12, s[32:35], s91 offen offset:0 lds
    v_mfma_f32_16x16x32_bf16 v[212:215], a[40:43], a[76:79], 0
    ds_read_b64_tr_b16 a[36:37], v28 offset:57344
    v_add_f32 v100, v100, v94
    v_mfma_f32_16x16x32_bf16 v[212:215], a[44:47], a[92:95], v[212:215]
    ds_read_b64_tr_b16 a[38:39], v28 offset:58368
    buffer_load_dwordx4 v13, s[32:35], s91 offen offset:1024 lds
    v_mfma_f32_16x16x32_bf16 v[216:219], a[40:43], a[80:83], 0
    v_add_f32 v101, v101, v95
    v_add_f32 v100, v100, v101
    v_mfma_f32_16x16x32_bf16 v[216:219], a[44:47], a[96:99], v[216:219]
    buffer_load_dwordx4 v14, s[32:35], s91 offen offset:2048 lds
    v_mfma_f32_16x16x32_bf16 v[220:223], a[40:43], a[84:87], 0
    v_add_f32_dpp v100, v100, v100 quad_perm:[1,0,3,2] row_mask:0xf bank_mask:0xf
    v_mfma_f32_16x16x32_bf16 v[220:223], a[44:47], a[100:103], v[220:223]
    buffer_load_dwordx4 v15, s[32:35], s91 offen offset:3072 lds
    v_mfma_f32_16x16x32_bf16 v[224:227], a[48:51], a[72:75], 0
    ds_read_b64_tr_b16 a[40:41], v29 offset:49152
    v_add_f32_dpp v100, v100, v100 quad_perm:[2,3,0,1] row_mask:0xf bank_mask:0xf
    v_mfma_f32_16x16x32_bf16 v[224:227], a[52:55], a[88:91], v[224:227]
    ds_read_b64_tr_b16 a[42:43], v29 offset:50176
    s_lshl_b32 s84, s76, 12
    s_add_u32 m0, s84, 32768
    s_add_u32 s91, s91, 128
    v_mfma_f32_16x16x32_bf16 v[228:231], a[48:51], a[76:79], 0
    ds_read_b64_tr_b16 a[44:45], v29 offset:57344
    v_add_f32_dpp v100, v100, v100 row_half_mirror row_mask:0xf bank_mask:0xf
    v_mfma_f32_16x16x32_bf16 v[228:231], a[52:55], a[92:95], v[228:231]
    ds_read_b64_tr_b16 a[46:47], v29 offset:58368
    buffer_load_dwordx4 v16, s[44:47], s85 offen offset:0 lds
    v_mfma_f32_16x16x32_bf16 v[232:235], a[48:51], a[80:83], 0
    v_add_f32_dpp v100, v100, v100 row_mirror row_mask:0xf bank_mask:0xf
    v_mov_b32 v101, v100
    v_mfma_f32_16x16x32_bf16 v[232:235], a[52:55], a[96:99], v[232:235]
    buffer_load_dwordx4 v17, s[44:47], s85 offen offset:1024 lds
    v_mfma_f32_16x16x32_bf16 v[236:239], a[48:51], a[84:87], 0
    v_permlane16_swap_b32 v100, v101
    v_mfma_f32_16x16x32_bf16 v[236:239], a[52:55], a[100:103], v[236:239]
    buffer_load_dwordx4 v18, s[44:47], s85 offen offset:2048 lds
    v_add_f32 v100, v100, v101
    v_mfma_f32_16x16x32_bf16 v[240:243], a[56:59], a[72:75], 0
    ds_read_b64_tr_b16 a[48:49], v30 offset:49152
    v_mul_f32 v102, 0x3acccccd, v100
    v_mfma_f32_16x16x32_bf16 v[240:243], a[60:63], a[88:91], v[240:243]
    ds_read_b64_tr_b16 a[50:51], v30 offset:50176
    buffer_load_dwordx4 v19, s[44:47], s85 offen offset:3072 lds
    v_mfma_f32_16x16x32_bf16 v[244:247], a[56:59], a[76:79], 0
    ds_read_b64_tr_b16 a[52:53], v30 offset:57344
    v_sub_f32 v76, v76, v102
    v_mfma_f32_16x16x32_bf16 v[244:247], a[60:63], a[92:95], v[244:247]
    ds_read_b64_tr_b16 a[54:55], v30 offset:58368
    s_cmp_eq_u32 s91, 1280
    s_cselect_b32 s91, 0, s91
    v_mfma_f32_16x16x32_bf16 v[248:251], a[56:59], a[80:83], 0
    v_sub_f32 v77, v77, v102
    v_sub_f32 v78, v78, v102
    v_mfma_f32_16x16x32_bf16 v[248:251], a[60:63], a[96:99], v[248:251]
    v_sub_f32 v79, v79, v102
    v_sub_f32 v80, v80, v102
    v_mfma_f32_16x16x32_bf16 v[252:255], a[56:59], a[84:87], 0
    v_sub_f32 v81, v81, v102
    v_sub_f32 v82, v82, v102
    v_mfma_f32_16x16x32_bf16 v[252:255], a[60:63], a[100:103], v[252:255]
    v_sub_f32 v83, v83, v102
    v_sub_f32 v84, v84, v102
    s_waitcnt vmcnt(12) lgkmcnt(0)
    s_barrier
    v_mfma_f32_16x16x32_bf16 v[128:131], a[0:3], a[104:107], v[128:131]
    ds_read_b128 a[72:75], v22 offset:32768
    v_sub_f32 v85, v85, v102
    v_mfma_f32_16x16x32_bf16 v[128:131], a[4:7], a[120:123], v[128:131]
    ds_read_b128 a[76:79], v22 offset:34816
    s_lshl_b32 s84, s76, 13
    s_add_u32 m0, s84, 49152
    s_nop 0
    v_mfma_f32_16x16x32_bf16 v[132:135], a[0:3], a[108:111], v[132:135]
    ds_read_b128 a[80:83], v22 offset:36864
    v_sub_f32 v86, v86, v102
    v_mfma_f32_16x16x32_bf16 v[132:135], a[4:7], a[124:127], v[132:135]
    ds_read_b128 a[84:87], v22 offset:38912
    v_sub_f32 v87, v87, v102
    v_mfma_f32_16x16x32_bf16 v[136:139], a[0:3], a[112:115], v[136:139]
    ds_read_b128 a[88:91], v23 offset:32768
    v_sub_f32 v88, v88, v102
    v_mfma_f32_16x16x32_bf16 v[136:139], a[4:7], a[128:131], v[136:139]
    ds_read_b128 a[92:95], v23 offset:34816
    buffer_load_dwordx4 v8, s[32:35], s91 offen offset:0 lds
    v_mfma_f32_16x16x32_bf16 v[140:143], a[0:3], a[116:119], v[140:143]
    ds_read_b128 a[96:99], v23 offset:36864
    v_sub_f32 v89, v89, v102
    v_mfma_f32_16x16x32_bf16 v[140:143], a[4:7], a[132:135], v[140:143]
    ds_read_b128 a[100:103], v23 offset:38912
    v_sub_f32 v90, v90, v102
    v_mfma_f32_16x16x32_bf16 v[40:43], a[0:3], v[48:51], v[40:43]
    v_sub_f32 v91, v91, v102
    v_sub_f32 v92, v92, v102
    v_mfma_f32_16x16x32_bf16 v[40:43], a[4:7], v[48:51], v[40:43]
    buffer_load_dwordx4 v9, s[32:35], s91 offen offset:1024 lds
    v_sub_f32 v93, v93, v102
    v_mfma_f32_16x16x32_bf16 v[144:147], a[8:11], a[104:107], v[144:147]
    ds_read_b64_tr_b16 a[0:1], v32 offset:32768
    v_sub_f32 v94, v94, v102
    v_mfma_f32_16x16x32_bf16 v[144:147], a[12:15], a[120:123], v[144:147]
    ds_read_b64_tr_b16 a[2:3], v32 offset:33792
    v_sub_f32 v95, v95, v102
    v_mfma_f32_16x16x32_bf16 v[148:151], a[8:11], a[108:111], v[148:151]
    ds_read_b64_tr_b16 a[4:5], v32 offset:40960
    v_mul_f32 v100, v76, v76
    v_mfma_f32_16x16x32_bf16 v[148:151], a[12:15], a[124:127], v[148:151]
    ds_read_b64_tr_b16 a[6:7], v32 offset:41984
    buffer_load_dwordx4 v10, s[32:35], s91 offen offset:2048 lds
    v_mfma_f32_16x16x32_bf16 v[152:155], a[8:11], a[112:115], v[152:155]
    ds_read_b64_tr_b16 a[56:57], v39 offset:32768
    v_mul_f32 v101, v77, v77
    v_mfma_f32_16x16x32_bf16 v[152:155], a[12:15], a[128:131], v[152:155]
    ds_read_b64_tr_b16 a[58:59], v39 offset:33792
    v_fmac_f32 v100, v78, v78
    v_mfma_f32_16x16x32_bf16 v[156:159], a[8:11], a[116:119], v[156:159]
    ds_read_b64_tr_b16 a[60:61], v39 offset:40960
    v_fmac_f32 v101, v79, v79
    v_mfma_f32_16x16x32_bf16 v[156:159], a[12:15], a[132:135], v[156:159]
    ds_read_b64_tr_b16 a[62:63], v39 offset:41984
    buffer_load_dwordx4 v11, s[32:35], s91 offen offset:3072 lds
    v_mfma_f32_16x16x32_bf16 v[44:47], a[8:11], v[48:51], v[44:47]
    v_fmac_f32 v100, v80, v80
    v_fmac_f32 v101, v81, v81
    v_mfma_f32_16x16x32_bf16 v[44:47], a[12:15], v[48:51], v[44:47]
    v_fmac_f32 v100, v82, v82
    v_fmac_f32 v101, v83, v83
    v_mfma_f32_16x16x32_bf16 v[160:163], a[16:19], a[104:107], v[160:163]
    ds_read_b64_tr_b16 a[8:9], v33 offset:32768
    v_fmac_f32 v100, v84, v84
    v_mfma_f32_16x16x32_bf16 v[160:163], a[20:23], a[120:123], v[160:163]
    ds_read_b64_tr_b16 a[10:11], v33 offset:33792
    s_add_u32 m0, s84, 53248
    s_lshl_b32 s85, s91, 12
    v_mfma_f32_16x16x32_bf16 v[164:167], a[16:19], a[108:111], v[164:167]
    ds_read_b64_tr_b16 a[12:13], v33 offset:40960
    v_fmac_f32 v101, v85, v85
    v_mfma_f32_16x16x32_bf16 v[164:167], a[20:23], a[124:127], v[164:167]
    ds_read_b64_tr_b16 a[14:15], v33 offset:41984
    v_fmac_f32 v100, v86, v86
    v_mfma_f32_16x16x32_bf16 v[168:171], a[16:19], a[112:115], v[168:171]
    v_fmac_f32 v101, v87, v87
    v_fmac_f32 v100, v88, v88
    v_mfma_f32_16x16x32_bf16 v[168:171], a[20:23], a[128:131], v[168:171]
    buffer_load_dwordx4 v12, s[32:35], s91 offen offset:0 lds
    v_fmac_f32 v101, v89, v89
    v_mfma_f32_16x16x32_bf16 v[172:175], a[16:19], a[116:119], v[172:175]
    v_fmac_f32 v100, v90, v90
    v_fmac_f32 v101, v91, v91
    v_mfma_f32_16x16x32_bf16 v[172:175], a[20:23], a[132:135], v[172:175]
    v_fmac_f32 v100, v92, v92
    v_fmac_f32 v101, v93, v93
    v_mfma_f32_16x16x32_bf16 v[176:179], a[24:27], a[104:107], v[176:179]
    ds_read_b64_tr_b16 a[16:17], v34 offset:32768
    v_fmac_f32 v100, v94, v94
    v_mfma_f32_16x16x32_bf16 v[176:179], a[28:31], a[120:123], v[176:179]
    ds_read_b64_tr_b16 a[18:19], v34 offset:33792
    buffer_load_dwordx4 v13, s[32:35], s91 offen offset:1024 lds
    v_mfma_f32_16x16x32_bf16 v[180:183], a[24:27], a[108:111], v[180:183]
    ds_read_b64_tr_b16 a[20:21], v34 offset:40960
    v_fmac_f32 v101, v95, v95
    v_mfma_f32_16x16x32_bf16 v[180:183], a[28:31], a[124:127], v[180:183]
    ds_read_b64_tr_b16 a[22:23], v34 offset:41984
    v_add_f32 v100, v100, v101
    v_mfma_f32_16x16x32_bf16 v[184:187], a[24:27], a[112:115], v[184:187]
    v_mfma_f32_16x16x32_bf16 v[184:187], a[28:31], a[128:131], v[184:187]
    buffer_load_dwordx4 v14, s[32:35], s91 offen offset:2048 lds
    v_add_f32_dpp v100, v100, v100 quad_perm:[1,0,3,2] row_mask:0xf bank_mask:0xf
    v_mfma_f32_16x16x32_bf16 v[188:191], a[24:27], a[116:119], v[188:191]
    v_mfma_f32_16x16x32_bf16 v[188:191], a[28:31], a[132:135], v[188:191]
    v_add_f32_dpp v100, v100, v100 quad_perm:[2,3,0,1] row_mask:0xf bank_mask:0xf
    v_mfma_f32_16x16x32_bf16 v[192:195], a[32:35], a[104:107], v[192:195]
    ds_read_b64_tr_b16 a[24:25], v35 offset:32768
    v_mfma_f32_16x16x32_bf16 v[192:195], a[36:39], a[120:123], v[192:195]
    ds_read_b64_tr_b16 a[26:27], v35 offset:33792
    buffer_load_dwordx4 v15, s[32:35], s91 offen offset:3072 lds
    v_mfma_f32_16x16x32_bf16 v[196:199], a[32:35], a[108:111], v[196:199]
    ds_read_b64_tr_b16 a[28:29], v35 offset:40960
    v_add_f32_dpp v100, v100, v100 row_half_mirror row_mask:0xf bank_mask:0xf
    v_mfma_f32_16x16x32_bf16 v[196:199], a[36:39], a[124:127], v[196:199]
    ds_read_b64_tr_b16 a[30:31], v35 offset:41984
    v_mfma_f32_16x16x32_bf16 v[200:203], a[32:35], a[112:115], v[200:203]
    v_add_f32_dpp v100, v100, v100 row_mirror row_mask:0xf bank_mask:0xf
    v_mov_b32 v101, v100
    v_mfma_f32_16x16x32_bf16 v[200:203], a[36:39], a[128:131], v[200:203]
    s_lshl_b32 s84, s76, 12
    s_add_u32 m0, s84, 81920
    s_add_u32 s91, s91, 128
    v_mfma_f32_16x16x32_bf16 v[204:207], a[32:35], a[116:119], v[204:207]
    v_permlane16_swap_b32 v100, v101
    v_mfma_f32_16x16x32_bf16 v[204:207], a[36:39], a[132:135], v[204:207]
    v_add_f32 v100, v100, v101
    v_mov_b32 v101, 0x3727c5ac
    v_mfma_f32_16x16x32_bf16 v[208:211], a[40:43], a[104:107], v[208:211]
    ds_read_b64_tr_b16 a[32:33], v36 offset:32768
    v_fmac_f32 v101, 0x3acccccd, v100
    v_mfma_f32_16x16x32_bf16 v[208:211], a[44:47], a[120:123], v[208:211]
    ds_read_b64_tr_b16 a[34:35], v36 offset:33792
    buffer_load_dwordx4 v16, s[44:47], s85 offen offset:0 lds
    v_mfma_f32_16x16x32_bf16 v[212:215], a[40:43], a[108:111], v[212:215]
    ds_read_b64_tr_b16 a[36:37], v36 offset:40960
    v_rsq_f32 v103, v101
    v_mfma_f32_16x16x32_bf16 v[212:215], a[44:47], a[124:127], v[212:215]
    ds_read_b64_tr_b16 a[38:39], v36 offset:41984
    v_mul_f32 v76, v76, v103
    v_mfma_f32_16x16x32_bf16 v[216:219], a[40:43], a[112:115], v[216:219]
    s_mov_b32 exec_lo, 1
    s_mov_b32 exec_hi, 1
    buffer_store_dwordx2 v[102:103], v99, s[72:75], 0 offen sc1
    s_mov_b64 exec, -1
    v_mfma_f32_16x16x32_bf16 v[216:219], a[44:47], a[128:131], v[216:219]
    buffer_load_dwordx4 v17, s[44:47], s85 offen offset:1024 lds
    v_mul_f32 v77, v77, v103
    v_mfma_f32_16x16x32_bf16 v[220:223], a[40:43], a[116:119], v[220:223]
    v_mul_f32 v78, v78, v103
    v_mul_f32 v79, v79, v103
    v_mfma_f32_16x16x32_bf16 v[220:223], a[44:47], a[132:135], v[220:223]
    v_mul_f32 v80, v80, v103
    v_mul_f32 v81, v81, v103
    v_mfma_f32_16x16x32_bf16 v[224:227], a[48:51], a[104:107], v[224:227]
    ds_read_b64_tr_b16 a[40:41], v37 offset:32768
    v_mul_f32 v82, v82, v103
    v_mfma_f32_16x16x32_bf16 v[224:227], a[52:55], a[120:123], v[224:227]
    ds_read_b64_tr_b16 a[42:43], v37 offset:33792
    buffer_load_dwordx4 v18, s[44:47], s85 offen offset:2048 lds
    v_mfma_f32_16x16x32_bf16 v[228:231], a[48:51], a[108:111], v[228:231]
    ds_read_b64_tr_b16 a[44:45], v37 offset:40960
    v_mul_f32 v83, v83, v103
    v_mfma_f32_16x16x32_bf16 v[228:231], a[52:55], a[124:127], v[228:231]
    ds_read_b64_tr_b16 a[46:47], v37 offset:41984
    v_mul_f32 v84, v84, v103
    v_mfma_f32_16x16x32_bf16 v[232:235], a[48:51], a[112:115], v[232:235]
    v_mul_f32 v85, v85, v103
    v_mul_f32 v86, v86, v103
    v_mfma_f32_16x16x32_bf16 v[232:235], a[52:55], a[128:131], v[232:235]
    buffer_load_dwordx4 v19, s[44:47], s85 offen offset:3072 lds
    v_mul_f32 v87, v87, v103
    v_mfma_f32_16x16x32_bf16 v[236:239], a[48:51], a[116:119], v[236:239]
    v_mul_f32 v88, v88, v103
    v_mul_f32 v89, v89, v103
    v_mfma_f32_16x16x32_bf16 v[236:239], a[52:55], a[132:135], v[236:239]
    v_mul_f32 v90, v90, v103
    v_mul_f32 v91, v91, v103
    v_mfma_f32_16x16x32_bf16 v[240:243], a[64:67], a[104:107], v[240:243]
    ds_read_b64_tr_b16 a[48:49], v38 offset:32768
    v_mul_f32 v92, v92, v103
    v_mfma_f32_16x16x32_bf16 v[240:243], a[68:71], a[120:123], v[240:243]
    ds_read_b64_tr_b16 a[50:51], v38 offset:33792
    s_cmp_eq_u32 s91, 1280
    s_cselect_b32 s91, 0, s91
    v_mfma_f32_16x16x32_bf16 v[244:247], a[64:67], a[108:111], v[244:247]
    ds_read_b64_tr_b16 a[52:53], v38 offset:40960
    v_mul_f32 v93, v93, v103
    v_mfma_f32_16x16x32_bf16 v[244:247], a[68:71], a[124:127], v[244:247]
    ds_read_b64_tr_b16 a[54:55], v38 offset:41984
    v_mul_f32 v94, v94, v103
    v_mfma_f32_16x16x32_bf16 v[248:251], a[64:67], a[112:115], v[248:251]
    v_mul_f32 v95, v95, v103
    v_cvt_pk_bf16_f32 v64, v76, v77
    v_mfma_f32_16x16x32_bf16 v[248:251], a[68:71], a[128:131], v[248:251]
    v_cvt_pk_bf16_f32 v65, v78, v79
    v_cvt_pk_bf16_f32 v66, v80, v81
    v_mfma_f32_16x16x32_bf16 v[252:255], a[64:67], a[116:119], v[252:255]
    v_cvt_pk_bf16_f32 v67, v82, v83
    v_cvt_pk_bf16_f32 v68, v84, v85
    v_mfma_f32_16x16x32_bf16 v[252:255], a[68:71], a[132:135], v[252:255]
    v_cvt_pk_bf16_f32 v69, v86, v87
    v_cvt_pk_bf16_f32 v70, v88, v89
    s_waitcnt vmcnt(13) lgkmcnt(0)
    s_barrier
    v_mfma_f32_16x16x32_bf16 v[128:131], a[0:3], a[72:75], v[128:131]
    ds_read_b128 a[104:107], v20 offset:0
    v_cvt_pk_bf16_f32 v71, v90, v91
    v_mfma_f32_16x16x32_bf16 v[128:131], a[4:7], a[88:91], v[128:131]
    ds_read_b128 a[108:111], v20 offset:2048
    s_lshl_b32 s84, s76, 13
    s_add_u32 m0, s84, 98304
    s_nop 0
    v_mfma_f32_16x16x32_bf16 v[132:135], a[0:3], a[76:79], v[132:135]
    ds_read_b128 a[112:115], v20 offset:4096
    v_cvt_pk_bf16_f32 v72, v92, v93
    v_mfma_f32_16x16x32_bf16 v[132:135], a[4:7], a[92:95], v[132:135]
    ds_read_b128 a[116:119], v20 offset:6144
    v_cvt_pk_bf16_f32 v73, v94, v95
    v_mfma_f32_16x16x32_bf16 v[136:139], a[0:3], a[80:83], v[136:139]
    ds_read_b128 a[120:123], v21 offset:0
    v_lshrrev_b32 v104, 5, v1
    v_mfma_f32_16x16x32_bf16 v[136:139], a[4:7], a[96:99], v[136:139]
    ds_read_b128 a[124:127], v21 offset:2048
    buffer_load_dwordx4 v8, s[32:35], s91 offen offset:0 lds
    v_mfma_f32_16x16x32_bf16 v[140:143], a[0:3], a[84:87], v[140:143]
    ds_read_b128 a[128:131], v21 offset:4096
    s_lshl_b32 s82, s76, 1
    v_mfma_f32_16x16x32_bf16 v[140:143], a[4:7], a[100:103], v[140:143]
    ds_read_b128 a[132:135], v21 offset:6144
    v_add_u32 v104, s82, v104
    v_mfma_f32_16x16x32_bf16 v[40:43], a[0:3], v[48:51], v[40:43]
    v_mul_u32_u24 v104, 1280, v104
    v_add_u32 v104, 147456, v104
    v_mfma_f32_16x16x32_bf16 v[40:43], a[4:7], v[48:51], v[40:43]
    buffer_load_dwordx4 v9, s[32:35], s91 offen offset:1024 lds
    v_and_b32 v105, 31, v1
    v_mfma_f32_16x16x32_bf16 v[144:147], a[8:11], a[72:75], v[144:147]
    ds_read_b64_tr_b16 a[0:1], v24 offset:0
    v_lshl_add_u32 v97, v105, 4, v104
    v_mfma_f32_16x16x32_bf16 v[144:147], a[12:15], a[88:91], v[144:147]
    ds_read_b64_tr_b16 a[2:3], v24 offset:1024
    v_lshl_add_u32 v98, v105, 3, v104
    v_mfma_f32_16x16x32_bf16 v[148:151], a[8:11], a[76:79], v[148:151]
    ds_read_b64_tr_b16 a[4:5], v24 offset:8192
    v_mul_u32_u24 v104, 1280, v4
    v_mfma_f32_16x16x32_bf16 v[148:151], a[12:15], a[92:95], v[148:151]
    ds_read_b64_tr_b16 a[6:7], v24 offset:9216
    buffer_load_dwordx4 v10, s[32:35], s91 offen offset:2048 lds
    v_mfma_f32_16x16x32_bf16 v[152:155], a[8:11], a[80:83], v[152:155]
    ds_read_b64_tr_b16 a[64:65], v31 offset:0
    v_lshl_add_u32 v104, v3, 5, v104
    v_mfma_f32_16x16x32_bf16 v[152:155], a[12:15], a[96:99], v[152:155]
    ds_read_b64_tr_b16 a[66:67], v31 offset:1024
    v_lshl_add_u32 v104, v5, 3, v104
    v_mfma_f32_16x16x32_bf16 v[156:159], a[8:11], a[84:87], v[156:159]
    ds_read_b64_tr_b16 a[68:69], v31 offset:8192
    s_lshl_b32 s81, s76, 7
    v_mfma_f32_16x16x32_bf16 v[156:159], a[12:15], a[100:103], v[156:159]
    ds_read_b64_tr_b16 a[70:71], v31 offset:9216
    buffer_load_dwordx4 v11, s[32:35], s91 offen offset:3072 lds
    v_mfma_f32_16x16x32_bf16 v[44:47], a[8:11], v[48:51], v[44:47]
    s_add_u32 s81, s81, 147456
    v_add_u32 v106, s81, v104
    v_mfma_f32_16x16x32_bf16 v[44:47], a[12:15], v[48:51], v[44:47]
    v_lshlrev_b32 v104, 10, v3
    v_lshl_add_u32 v107, v2, 4, v104
    v_mfma_f32_16x16x32_bf16 v[160:163], a[16:19], a[72:75], v[160:163]
    ds_read_b64_tr_b16 a[8:9], v25 offset:0
    s_lshr_b32 s81, s2, 2
    v_mfma_f32_16x16x32_bf16 v[160:163], a[20:23], a[88:91], v[160:163]
    ds_read_b64_tr_b16 a[10:11], v25 offset:1024
    s_add_u32 m0, s84, 102400
    s_lshl_b32 s85, s91, 12
    v_mfma_f32_16x16x32_bf16 v[164:167], a[16:19], a[76:79], v[164:167]
    ds_read_b64_tr_b16 a[12:13], v25 offset:8192
    s_mul_i32 s81, s81, 40960
    v_mfma_f32_16x16x32_bf16 v[164:167], a[20:23], a[92:95], v[164:167]
    ds_read_b64_tr_b16 a[14:15], v25 offset:9216
    s_and_b32 s82, s2, 3
    v_mfma_f32_16x16x32_bf16 v[168:171], a[16:19], a[80:83], v[168:171]
    s_lshl_b32 s82, s82, 8
    s_add_u32 s81, s81, s82
    v_mfma_f32_16x16x32_bf16 v[168:171], a[20:23], a[96:99], v[168:171]
    buffer_load_dwordx4 v12, s[32:35], s91 offen offset:0 lds
    s_lshl_b32 s82, s76, 12
    v_mfma_f32_16x16x32_bf16 v[172:175], a[16:19], a[84:87], v[172:175]
    s_add_u32 s81, s81, s82
    s_add_u32 s88, s81, 65536
    v_mfma_f32_16x16x32_bf16 v[172:175], a[20:23], a[100:103], v[172:175]
    s_add_u32 s89, s88, 16384
    s_add_u32 s81, s88, 32768
    v_mfma_f32_16x16x32_bf16 v[176:179], a[24:27], a[72:75], v[176:179]
    ds_read_b64_tr_b16 a[16:17], v26 offset:0
    s_cmp_lt_u32 s76, 2
    s_cselect_b32 s87, s81, 37748736
    v_mfma_f32_16x16x32_bf16 v[176:179], a[28:31], a[88:91], v[176:179]
    ds_read_b64_tr_b16 a[18:19], v26 offset:1024
    buffer_load_dwordx4 v13, s[32:35], s91 offen offset:1024 lds
    v_mfma_f32_16x16x32_bf16 v[180:183], a[24:27], a[76:79], v[180:183]
    ds_read_b64_tr_b16 a[20:21], v26 offset:8192
    v_lshlrev_b32 v76, 16, v64
    v_mfma_f32_16x16x32_bf16 v[180:183], a[28:31], a[92:95], v[180:183]
    ds_read_b64_tr_b16 a[22:23], v26 offset:9216
    v_and_b32 v77, 0xffff0000, v64
    v_mfma_f32_16x16x32_bf16 v[184:187], a[24:27], a[80:83], v[184:187]
    v_lshlrev_b32 v78, 16, v65
    v_and_b32 v79, 0xffff0000, v65
    v_mfma_f32_16x16x32_bf16 v[184:187], a[28:31], a[96:99], v[184:187]
    buffer_load_dwordx4 v14, s[32:35], s91 offen offset:2048 lds
    v_lshlrev_b32 v80, 16, v66
    v_mfma_f32_16x16x32_bf16 v[188:191], a[24:27], a[84:87], v[188:191]
    v_and_b32 v81, 0xffff0000, v66
    v_lshlrev_b32 v82, 16, v67
    v_mfma_f32_16x16x32_bf16 v[188:191], a[28:31], a[100:103], v[188:191]
    v_and_b32 v83, 0xffff0000, v67
    v_lshlrev_b32 v84, 16, v68
    v_mfma_f32_16x16x32_bf16 v[192:195], a[32:35], a[72:75], v[192:195]
    ds_read_b64_tr_b16 a[24:25], v27 offset:0
    v_and_b32 v85, 0xffff0000, v68
    v_mfma_f32_16x16x32_bf16 v[192:195], a[36:39], a[88:91], v[192:195]
    ds_read_b64_tr_b16 a[26:27], v27 offset:1024
    buffer_load_dwordx4 v15, s[32:35], s91 offen offset:3072 lds
    v_mfma_f32_16x16x32_bf16 v[196:199], a[32:35], a[76:79], v[196:199]
    ds_read_b64_tr_b16 a[28:29], v27 offset:8192
    v_lshlrev_b32 v86, 16, v69
    v_mfma_f32_16x16x32_bf16 v[196:199], a[36:39], a[92:95], v[196:199]
    ds_read_b64_tr_b16 a[30:31], v27 offset:9216
    v_and_b32 v87, 0xffff0000, v69
    v_mfma_f32_16x16x32_bf16 v[200:203], a[32:35], a[80:83], v[200:203]
    v_lshlrev_b32 v88, 16, v70
    v_and_b32 v89, 0xffff0000, v70
    v_mfma_f32_16x16x32_bf16 v[200:203], a[36:39], a[96:99], v[200:203]
    s_lshl_b32 s84, s76, 12
    s_add_u32 m0, s84, 131072
    s_add_u32 s91, s91, 128
    v_mfma_f32_16x16x32_bf16 v[204:207], a[32:35], a[84:87], v[204:207]
    v_lshlrev_b32 v90, 16, v71
    v_and_b32 v91, 0xffff0000, v71
    v_mfma_f32_16x16x32_bf16 v[204:207], a[36:39], a[100:103], v[204:207]
    v_lshlrev_b32 v92, 16, v72
    v_and_b32 v93, 0xffff0000, v72
    v_mfma_f32_16x16x32_bf16 v[208:211], a[40:43], a[72:75], v[208:211]
    ds_read_b64_tr_b16 a[32:33], v28 offset:0
    v_lshlrev_b32 v94, 16, v73
    v_mfma_f32_16x16x32_bf16 v[208:211], a[44:47], a[88:91], v[208:211]
    ds_read_b64_tr_b16 a[34:35], v28 offset:1024
    buffer_load_dwordx4 v16, s[44:47], s85 offen offset:0 lds
    v_mfma_f32_16x16x32_bf16 v[212:215], a[40:43], a[76:79], v[212:215]
    ds_read_b64_tr_b16 a[36:37], v28 offset:8192
    v_and_b32 v95, 0xffff0000, v73
    v_mfma_f32_16x16x32_bf16 v[212:215], a[44:47], a[92:95], v[212:215]
    ds_read_b64_tr_b16 a[38:39], v28 offset:9216
    v_add_f32 v100, v76, v77
    v_mfma_f32_16x16x32_bf16 v[216:219], a[40:43], a[80:83], v[216:219]
    v_add_f32 v101, v78, v79
    v_add_f32 v100, v100, v80
    v_mfma_f32_16x16x32_bf16 v[216:219], a[44:47], a[96:99], v[216:219]
    buffer_load_dwordx4 v17, s[44:47], s85 offen offset:1024 lds
    v_add_f32 v101, v101, v81
    v_mfma_f32_16x16x32_bf16 v[220:223], a[40:43], a[84:87], v[220:223]
    v_add_f32 v100, v100, v82
    v_add_f32 v101, v101, v83
    v_mfma_f32_16x16x32_bf16 v[220:223], a[44:47], a[100:103], v[220:223]
    v_add_f32 v100, v100, v84
    v_add_f32 v101, v101, v85
    v_mfma_f32_16x16x32_bf16 v[224:227], a[48:51], a[72:75], v[224:227]
    ds_read_b64_tr_b16 a[40:41], v29 offset:0
    v_add_f32 v100, v100, v86
    v_mfma_f32_16x16x32_bf16 v[224:227], a[52:55], a[88:91], v[224:227]
    ds_read_b64_tr_b16 a[42:43], v29 offset:1024
    buffer_load_dwordx4 v18, s[44:47], s85 offen offset:2048 lds
    v_mfma_f32_16x16x32_bf16 v[228:231], a[48:51], a[76:79], v[228:231]
    ds_read_b64_tr_b16 a[44:45], v29 offset:8192
    v_add_f32 v101, v101, v87
    v_mfma_f32_16x16x32_bf16 v[228:231], a[52:55], a[92:95], v[228:231]
    ds_read_b64_tr_b16 a[46:47], v29 offset:9216
    v_add_f32 v100, v100, v88
    v_mfma_f32_16x16x32_bf16 v[232:235], a[48:51], a[80:83], v[232:235]
    v_add_f32 v101, v101, v89
    v_add_f32 v100, v100, v90
    v_mfma_f32_16x16x32_bf16 v[232:235], a[52:55], a[96:99], v[232:235]
    buffer_load_dwordx4 v19, s[44:47], s85 offen offset:3072 lds
    v_add_f32 v101, v101, v91
    v_mfma_f32_16x16x32_bf16 v[236:239], a[48:51], a[84:87], v[236:239]
    v_add_f32 v100, v100, v92
    v_add_f32 v101, v101, v93
    v_mfma_f32_16x16x32_bf16 v[236:239], a[52:55], a[100:103], v[236:239]
    v_add_f32 v100, v100, v94
    v_add_f32 v101, v101, v95
    v_mfma_f32_16x16x32_bf16 v[240:243], a[56:59], a[72:75], v[240:243]
    ds_read_b64_tr_b16 a[48:49], v30 offset:0
    v_add_f32 v100, v100, v101
    v_mfma_f32_16x16x32_bf16 v[240:243], a[60:63], a[88:91], v[240:243]
    ds_read_b64_tr_b16 a[50:51], v30 offset:1024
    s_cmp_eq_u32 s91, 1280
    s_cselect_b32 s91, 0, s91
    v_mfma_f32_16x16x32_bf16 v[244:247], a[56:59], a[76:79], v[244:247]
    ds_read_b64_tr_b16 a[52:53], v30 offset:8192
    v_add_f32_dpp v100, v100, v100 quad_perm:[1,0,3,2] row_mask:0xf bank_mask:0xf
    v_mfma_f32_16x16x32_bf16 v[244:247], a[60:63], a[92:95], v[244:247]
    ds_read_b64_tr_b16 a[54:55], v30 offset:9216
    v_mfma_f32_16x16x32_bf16 v[248:251], a[56:59], a[80:83], v[248:251]
    v_add_f32_dpp v100, v100, v100 quad_perm:[2,3,0,1] row_mask:0xf bank_mask:0xf
    v_mfma_f32_16x16x32_bf16 v[248:251], a[60:63], a[96:99], v[248:251]
    v_mfma_f32_16x16x32_bf16 v[252:255], a[56:59], a[84:87], v[252:255]
    v_add_f32_dpp v100, v100, v100 row_half_mirror row_mask:0xf bank_mask:0xf
    v_mfma_f32_16x16x32_bf16 v[252:255], a[60:63], a[100:103], v[252:255]
    s_waitcnt vmcnt(12) lgkmcnt(0)
    s_barrier
    s_lshr_b32 s83, s2, 6
    s_lshl_b32 s83, s83, 2
    s_and_b32 s86, s2, 32
    s_lshl_b32 s86, s86, 2
    s_add_u32 s83, s83, s86
    s_cmp_eq_u32 s76, 0
    s_cselect_b32 s83, s83, 0x40000000
    v_mov_b32 v7, 1
    s_mov_b64 exec, 1
    buffer_atomic_add v7, off, s[24:27], s83
    s_mov_b64 exec, -1
    v_mfma_f32_16x16x32_bf16 v[128:131], a[0:3], a[104:107], v[128:131]
    ds_read_b128 a[72:75], v20 offset:49152
    v_mfma_f32_16x16x32_bf16 v[128:131], a[4:7], a[120:123], v[128:131]
    ds_read_b128 a[76:79], v20 offset:51200
    s_lshl_b32 s84, s76, 13
    s_add_u32 m0, s84, 0
    s_nop 0
    v_mfma_f32_16x16x32_bf16 v[132:135], a[0:3], a[108:111], v[132:135]
    ds_read_b128 a[80:83], v20 offset:53248
    v_add_f32_dpp v100, v100, v100 row_mirror row_mask:0xf bank_mask:0xf
    v_mfma_f32_16x16x32_bf16 v[132:135], a[4:7], a[124:127], v[132:135]
    ds_read_b128 a[84:87], v20 offset:55296
    v_mov_b32 v101, v100
    v_mfma_f32_16x16x32_bf16 v[136:139], a[0:3], a[112:115], v[136:139]
    ds_read_b128 a[88:91], v21 offset:49152
    v_mfma_f32_16x16x32_bf16 v[136:139], a[4:7], a[128:131], v[136:139]
    ds_read_b128 a[92:95], v21 offset:51200
    buffer_load_dwordx4 v8, s[32:35], s91 offen offset:0 lds
    v_mfma_f32_16x16x32_bf16 v[140:143], a[0:3], a[116:119], v[140:143]
    ds_read_b128 a[96:99], v21 offset:53248
    v_permlane16_swap_b32 v100, v101
    v_mfma_f32_16x16x32_bf16 v[140:143], a[4:7], a[132:135], v[140:143]
    ds_read_b128 a[100:103], v21 offset:55296
    v_add_f32 v100, v100, v101
    v_mfma_f32_16x16x32_bf16 v[40:43], a[0:3], v[48:51], v[40:43]
    v_mul_f32 v102, 0x3acccccd, v100
    v_sub_f32 v76, v76, v102
    v_mfma_f32_16x16x32_bf16 v[40:43], a[4:7], v[48:51], v[40:43]
    buffer_load_dwordx4 v9, s[32:35], s91 offen offset:1024 lds
    v_sub_f32 v77, v77, v102
    v_mfma_f32_16x16x32_bf16 v[144:147], a[8:11], a[104:107], v[144:147]
    ds_read_b64_tr_b16 a[0:1], v24 offset:49152
    v_sub_f32 v78, v78, v102
    v_mfma_f32_16x16x32_bf16 v[144:147], a[12:15], a[120:123], v[144:147]
    ds_read_b64_tr_b16 a[2:3], v24 offset:50176
    v_sub_f32 v79, v79, v102
    v_mfma_f32_16x16x32_bf16 v[148:151], a[8:11], a[108:111], v[148:151]
    ds_read_b64_tr_b16 a[4:5], v24 offset:57344
    v_sub_f32 v80, v80, v102
    v_mfma_f32_16x16x32_bf16 v[148:151], a[12:15], a[124:127], v[148:151]
    ds_read_b64_tr_b16 a[6:7], v24 offset:58368
    buffer_load_dwordx4 v10, s[32:35], s91 offen offset:2048 lds
    v_mfma_f32_16x16x32_bf16 v[152:155], a[8:11], a[112:115], v[152:155]
    ds_read_b64_tr_b16 a[56:57], v31 offset:49152
    v_sub_f32 v81, v81, v102
    v_mfma_f32_16x16x32_bf16 v[152:155], a[12:15], a[128:131], v[152:155]
    ds_read_b64_tr_b16 a[58:59], v31 offset:50176
    v_sub_f32 v82, v82, v102
    v_mfma_f32_16x16x32_bf16 v[156:159], a[8:11], a[116:119], v[156:159]
    ds_read_b64_tr_b16 a[60:61], v31 offset:57344
    v_sub_f32 v83, v83, v102
    v_mfma_f32_16x16x32_bf16 v[156:159], a[12:15], a[132:135], v[156:159]
    ds_read_b64_tr_b16 a[62:63], v31 offset:58368
    buffer_load_dwordx4 v11, s[32:35], s91 offen offset:3072 lds
    v_mfma_f32_16x16x32_bf16 v[44:47], a[8:11], v[48:51], v[44:47]
    v_sub_f32 v84, v84, v102
    v_sub_f32 v85, v85, v102
    v_mfma_f32_16x16x32_bf16 v[44:47], a[12:15], v[48:51], v[44:47]
    v_sub_f32 v86, v86, v102
    v_sub_f32 v87, v87, v102
    v_mfma_f32_16x16x32_bf16 v[160:163], a[16:19], a[104:107], v[160:163]
    ds_read_b64_tr_b16 a[8:9], v25 offset:49152
    v_sub_f32 v88, v88, v102
    v_mfma_f32_16x16x32_bf16 v[160:163], a[20:23], a[120:123], v[160:163]
    ds_read_b64_tr_b16 a[10:11], v25 offset:50176
    s_add_u32 m0, s84, 4096
    s_lshl_b32 s85, s91, 12
    v_mfma_f32_16x16x32_bf16 v[164:167], a[16:19], a[108:111], v[164:167]
    ds_read_b64_tr_b16 a[12:13], v25 offset:57344
    v_sub_f32 v89, v89, v102
    v_mfma_f32_16x16x32_bf16 v[164:167], a[20:23], a[124:127], v[164:167]
    ds_read_b64_tr_b16 a[14:15], v25 offset:58368
    v_sub_f32 v90, v90, v102
    v_mfma_f32_16x16x32_bf16 v[168:171], a[16:19], a[112:115], v[168:171]
    v_sub_f32 v91, v91, v102
    v_sub_f32 v92, v92, v102
    v_mfma_f32_16x16x32_bf16 v[168:171], a[20:23], a[128:131], v[168:171]
    buffer_load_dwordx4 v12, s[32:35], s91 offen offset:0 lds
    v_sub_f32 v93, v93, v102
    v_mfma_f32_16x16x32_bf16 v[172:175], a[16:19], a[116:119], v[172:175]
    v_sub_f32 v94, v94, v102
    v_sub_f32 v95, v95, v102
    v_mfma_f32_16x16x32_bf16 v[172:175], a[20:23], a[132:135], v[172:175]
    v_mul_f32 v100, v76, v76
    v_mul_f32 v101, v77, v77
    v_mfma_f32_16x16x32_bf16 v[176:179], a[24:27], a[104:107], v[176:179]
    ds_read_b64_tr_b16 a[16:17], v26 offset:49152
    v_fmac_f32 v100, v78, v78
    v_mfma_f32_16x16x32_bf16 v[176:179], a[28:31], a[120:123], v[176:179]
    ds_read_b64_tr_b16 a[18:19], v26 offset:50176
    buffer_load_dwordx4 v13, s[32:35], s91 offen offset:1024 lds
    v_mfma_f32_16x16x32_bf16 v[180:183], a[24:27], a[108:111], v[180:183]
    ds_read_b64_tr_b16 a[20:21], v26 offset:57344
    v_fmac_f32 v101, v79, v79
    v_mfma_f32_16x16x32_bf16 v[180:183], a[28:31], a[124:127], v[180:183]
    ds_read_b64_tr_b16 a[22:23], v26 offset:58368
    v_fmac_f32 v100, v80, v80
    v_mfma_f32_16x16x32_bf16 v[184:187], a[24:27], a[112:115], v[184:187]
    v_fmac_f32 v101, v81, v81
    v_fmac_f32 v100, v82, v82
    v_mfma_f32_16x16x32_bf16 v[184:187], a[28:31], a[128:131], v[184:187]
    buffer_load_dwordx4 v14, s[32:35], s91 offen offset:2048 lds
    v_fmac_f32 v101, v83, v83
    v_mfma_f32_16x16x32_bf16 v[188:191], a[24:27], a[116:119], v[188:191]
    v_fmac_f32 v100, v84, v84
    v_fmac_f32 v101, v85, v85
    v_mfma_f32_16x16x32_bf16 v[188:191], a[28:31], a[132:135], v[188:191]
    v_fmac_f32 v100, v86, v86
    v_fmac_f32 v101, v87, v87
    v_mfma_f32_16x16x32_bf16 v[192:195], a[32:35], a[104:107], v[192:195]
    ds_read_b64_tr_b16 a[24:25], v27 offset:49152
    v_fmac_f32 v100, v88, v88
    v_mfma_f32_16x16x32_bf16 v[192:195], a[36:39], a[120:123], v[192:195]
    ds_read_b64_tr_b16 a[26:27], v27 offset:50176
    buffer_load_dwordx4 v15, s[32:35], s91 offen offset:3072 lds
    v_mfma_f32_16x16x32_bf16 v[196:199], a[32:35], a[108:111], v[196:199]
    ds_read_b64_tr_b16 a[28:29], v27 offset:57344
    v_fmac_f32 v101, v89, v89
    v_mfma_f32_16x16x32_bf16 v[196:199], a[36:39], a[124:127], v[196:199]
    ds_read_b64_tr_b16 a[30:31], v27 offset:58368
    v_fmac_f32 v100, v90, v90
    v_mfma_f32_16x16x32_bf16 v[200:203], a[32:35], a[112:115], v[200:203]
    v_fmac_f32 v101, v91, v91
    v_fmac_f32 v100, v92, v92
    v_mfma_f32_16x16x32_bf16 v[200:203], a[36:39], a[128:131], v[200:203]
    s_lshl_b32 s84, s76, 12
    s_add_u32 m0, s84, 32768
    s_add_u32 s91, s91, 128
    v_mfma_f32_16x16x32_bf16 v[204:207], a[32:35], a[116:119], v[204:207]
    v_fmac_f32 v101, v93, v93
    v_fmac_f32 v100, v94, v94
    v_mfma_f32_16x16x32_bf16 v[204:207], a[36:39], a[132:135], v[204:207]
    v_fmac_f32 v101, v95, v95
    v_add_f32 v100, v100, v101
    v_mfma_f32_16x16x32_bf16 v[208:211], a[40:43], a[104:107], v[208:211]
    ds_read_b64_tr_b16 a[32:33], v28 offset:49152
    v_mfma_f32_16x16x32_bf16 v[208:211], a[44:47], a[120:123], v[208:211]
    ds_read_b64_tr_b16 a[34:35], v28 offset:50176
    buffer_load_dwordx4 v16, s[44:47], s85 offen offset:0 lds
    v_mfma_f32_16x16x32_bf16 v[212:215], a[40:43], a[108:111], v[212:215]
    ds_read_b64_tr_b16 a[36:37], v28 offset:57344
    v_add_f32_dpp v100, v100, v100 quad_perm:[1,0,3,2] row_mask:0xf bank_mask:0xf
    v_mfma_f32_16x16x32_bf16 v[212:215], a[44:47], a[124:127], v[212:215]
    ds_read_b64_tr_b16 a[38:39], v28 offset:58368
    v_mfma_f32_16x16x32_bf16 v[216:219], a[40:43], a[112:115], v[216:219]
    v_add_f32_dpp v100, v100, v100 quad_perm:[2,3,0,1] row_mask:0xf bank_mask:0xf
    v_mfma_f32_16x16x32_bf16 v[216:219], a[44:47], a[128:131], v[216:219]
    buffer_load_dwordx4 v17, s[44:47], s85 offen offset:1024 lds
    v_mfma_f32_16x16x32_bf16 v[220:223], a[40:43], a[116:119], v[220:223]
    v_add_f32_dpp v100, v100, v100 row_half_mirror row_mask:0xf bank_mask:0xf
    v_mfma_f32_16x16x32_bf16 v[220:223], a[44:47], a[132:135], v[220:223]
    v_mfma_f32_16x16x32_bf16 v[224:227], a[48:51], a[104:107], v[224:227]
    ds_read_b64_tr_b16 a[40:41], v29 offset:49152
    v_add_f32_dpp v100, v100, v100 row_mirror row_mask:0xf bank_mask:0xf
    v_mfma_f32_16x16x32_bf16 v[224:227], a[52:55], a[120:123], v[224:227]
    ds_read_b64_tr_b16 a[42:43], v29 offset:50176
    buffer_load_dwordx4 v18, s[44:47], s85 offen offset:2048 lds
    v_mfma_f32_16x16x32_bf16 v[228:231], a[48:51], a[108:111], v[228:231]
    ds_read_b64_tr_b16 a[44:45], v29 offset:57344
    v_mov_b32 v101, v100
    v_mfma_f32_16x16x32_bf16 v[228:231], a[52:55], a[124:127], v[228:231]
    ds_read_b64_tr_b16 a[46:47], v29 offset:58368
    v_mfma_f32_16x16x32_bf16 v[232:235], a[48:51], a[112:115], v[232:235]
    v_permlane16_swap_b32 v100, v101
    v_mfma_f32_16x16x32_bf16 v[232:235], a[52:55], a[128:131], v[232:235]
    buffer_load_dwordx4 v19, s[44:47], s85 offen offset:3072 lds
    v_add_f32 v100, v100, v101
    v_mfma_f32_16x16x32_bf16 v[236:239], a[48:51], a[116:119], v[236:239]
    v_mov_b32 v101, 0x3727c5ac
    v_fmac_f32 v101, 0x3acccccd, v100
    v_mfma_f32_16x16x32_bf16 v[236:239], a[52:55], a[132:135], v[236:239]
    v_rsq_f32 v103, v101
    v_mfma_f32_16x16x32_bf16 v[240:243], a[64:67], a[104:107], v[240:243]
    ds_read_b64_tr_b16 a[48:49], v30 offset:49152
    v_mul_f32 v76, v76, v103
    v_mfma_f32_16x16x32_bf16 v[240:243], a[68:71], a[120:123], v[240:243]
    ds_read_b64_tr_b16 a[50:51], v30 offset:50176
    s_cmp_eq_u32 s91, 1280
    s_cselect_b32 s91, 0, s91
    v_mfma_f32_16x16x32_bf16 v[244:247], a[64:67], a[108:111], v[244:247]
    ds_read_b64_tr_b16 a[52:53], v30 offset:57344
    v_mul_f32 v77, v77, v103
    v_mfma_f32_16x16x32_bf16 v[244:247], a[68:71], a[124:127], v[244:247]
    ds_read_b64_tr_b16 a[54:55], v30 offset:58368
    v_mul_f32 v78, v78, v103
    v_mfma_f32_16x16x32_bf16 v[248:251], a[64:67], a[112:115], v[248:251]
    v_mul_f32 v79, v79, v103
    v_mul_f32 v80, v80, v103
    v_mfma_f32_16x16x32_bf16 v[248:251], a[68:71], a[128:131], v[248:251]
    v_mul_f32 v81, v81, v103
    v_mul_f32 v82, v82, v103
    v_mfma_f32_16x16x32_bf16 v[252:255], a[64:67], a[116:119], v[252:255]
    v_mul_f32 v83, v83, v103
    v_mul_f32 v84, v84, v103
    v_mfma_f32_16x16x32_bf16 v[252:255], a[68:71], a[132:135], v[252:255]
    v_mul_f32 v85, v85, v103
    v_mul_f32 v86, v86, v103
    s_waitcnt vmcnt(13) lgkmcnt(0)
    s_barrier
    v_mfma_f32_16x16x32_bf16 v[128:131], a[0:3], a[72:75], v[128:131]
    ds_read_b128 a[104:107], v22 offset:32768
    v_mul_f32 v87, v87, v103
    v_mfma_f32_16x16x32_bf16 v[128:131], a[4:7], a[88:91], v[128:131]
    ds_read_b128 a[108:111], v22 offset:34816
    s_lshl_b32 s84, s76, 13
    s_add_u32 m0, s84, 49152
    s_nop 0
    v_mfma_f32_16x16x32_bf16 v[132:135], a[0:3], a[76:79], v[132:135]
    ds_read_b128 a[112:115], v22 offset:36864
    v_mul_f32 v88, v88, v103
    v_mfma_f32_16x16x32_bf16 v[132:135], a[4:7], a[92:95], v[132:135]
    ds_read_b128 a[116:119], v22 offset:38912
    v_mul_f32 v89, v89, v103
    v_mfma_f32_16x16x32_bf16 v[136:139], a[0:3], a[80:83], v[136:139]
    ds_read_b128 a[120:123], v23 offset:32768
    v_mul_f32 v90, v90, v103
    v_mfma_f32_16x16x32_bf16 v[136:139], a[4:7], a[96:99], v[136:139]
    ds_read_b128 a[124:127], v23 offset:34816
    buffer_load_dwordx4 v8, s[32:35], s91 offen offset:0 lds
    v_mfma_f32_16x16x32_bf16 v[140:143], a[0:3], a[84:87], v[140:143]
    ds_read_b128 a[128:131], v23 offset:36864
    v_mul_f32 v91, v91, v103
    v_mfma_f32_16x16x32_bf16 v[140:143], a[4:7], a[100:103], v[140:143]
    ds_read_b128 a[132:135], v23 offset:38912
    v_mul_f32 v92, v92, v103
    v_mfma_f32_16x16x32_bf16 v[40:43], a[0:3], v[48:51], v[40:43]
    v_mul_f32 v93, v93, v103
    v_mul_f32 v94, v94, v103
    v_mfma_f32_16x16x32_bf16 v[40:43], a[4:7], v[48:51], v[40:43]
    buffer_load_dwordx4 v9, s[32:35], s91 offen offset:1024 lds
    v_mul_f32 v95, v95, v103
    v_mfma_f32_16x16x32_bf16 v[144:147], a[8:11], a[72:75], v[144:147]
    ds_read_b64_tr_b16 a[0:1], v32 offset:32768
    v_cvt_pk_bf16_f32 v64, v76, v77
    v_mfma_f32_16x16x32_bf16 v[144:147], a[12:15], a[88:91], v[144:147]
    ds_read_b64_tr_b16 a[2:3], v32 offset:33792
    v_cvt_pk_bf16_f32 v65, v78, v79
    v_mfma_f32_16x16x32_bf16 v[148:151], a[8:11], a[76:79], v[148:151]
    ds_read_b64_tr_b16 a[4:5], v32 offset:40960
    v_cvt_pk_bf16_f32 v66, v80, v81
    v_mfma_f32_16x16x32_bf16 v[148:151], a[12:15], a[92:95], v[148:151]
    ds_read_b64_tr_b16 a[6:7], v32 offset:41984
    buffer_load_dwordx4 v10, s[32:35], s91 offen offset:2048 lds
    v_mfma_f32_16x16x32_bf16 v[152:155], a[8:11], a[80:83], v[152:155]
    ds_read_b64_tr_b16 a[64:65], v39 offset:32768
    v_cvt_pk_bf16_f32 v67, v82, v83
    v_mfma_f32_16x16x32_bf16 v[152:155], a[12:15], a[96:99], v[152:155]
    ds_read_b64_tr_b16 a[66:67], v39 offset:33792
    v_cvt_pk_bf16_f32 v68, v84, v85
    v_mfma_f32_16x16x32_bf16 v[156:159], a[8:11], a[84:87], v[156:159]
    ds_read_b64_tr_b16 a[68:69], v39 offset:40960
    v_cvt_pk_bf16_f32 v69, v86, v87
    v_mfma_f32_16x16x32_bf16 v[156:159], a[12:15], a[100:103], v[156:159]
    ds_read_b64_tr_b16 a[70:71], v39 offset:41984
    buffer_load_dwordx4 v11, s[32:35], s91 offen offset:3072 lds
    v_mfma_f32_16x16x32_bf16 v[44:47], a[8:11], v[48:51], v[44:47]
    v_cvt_pk_bf16_f32 v70, v88, v89
    v_cvt_pk_bf16_f32 v71, v90, v91
    v_mfma_f32_16x16x32_bf16 v[44:47], a[12:15], v[48:51], v[44:47]
    v_cvt_pk_bf16_f32 v72, v92, v93
    v_cvt_pk_bf16_f32 v73, v94, v95
    v_mfma_f32_16x16x32_bf16 v[160:163], a[16:19], a[72:75], v[160:163]
    ds_read_b64_tr_b16 a[8:9], v33 offset:32768
    v_mfma_f32_16x16x32_bf16 v[160:163], a[20:23], a[88:91], v[160:163]
    ds_read_b64_tr_b16 a[10:11], v33 offset:33792
    s_add_u32 m0, s84, 53248
    s_lshl_b32 s85, s91, 12
    v_mfma_f32_16x16x32_bf16 v[164:167], a[16:19], a[76:79], v[164:167]
    ds_read_b64_tr_b16 a[12:13], v33 offset:40960
    v_mfma_f32_16x16x32_bf16 v[164:167], a[20:23], a[92:95], v[164:167]
    ds_read_b64_tr_b16 a[14:15], v33 offset:41984
    v_mfma_f32_16x16x32_bf16 v[168:171], a[16:19], a[80:83], v[168:171]
    v_mfma_f32_16x16x32_bf16 v[168:171], a[20:23], a[96:99], v[168:171]
    buffer_load_dwordx4 v12, s[32:35], s91 offen offset:0 lds
    v_mfma_f32_16x16x32_bf16 v[172:175], a[16:19], a[84:87], v[172:175]
    v_mfma_f32_16x16x32_bf16 v[172:175], a[20:23], a[100:103], v[172:175]
    v_mfma_f32_16x16x32_bf16 v[176:179], a[24:27], a[72:75], v[176:179]
    ds_read_b64_tr_b16 a[16:17], v34 offset:32768
    v_mfma_f32_16x16x32_bf16 v[176:179], a[28:31], a[88:91], v[176:179]
    ds_read_b64_tr_b16 a[18:19], v34 offset:33792
    buffer_load_dwordx4 v13, s[32:35], s91 offen offset:1024 lds
    v_mfma_f32_16x16x32_bf16 v[180:183], a[24:27], a[76:79], v[180:183]
    ds_read_b64_tr_b16 a[20:21], v34 offset:40960
    v_mfma_f32_16x16x32_bf16 v[180:183], a[28:31], a[92:95], v[180:183]
    ds_read_b64_tr_b16 a[22:23], v34 offset:41984
    v_mfma_f32_16x16x32_bf16 v[184:187], a[24:27], a[80:83], v[184:187]
    v_mfma_f32_16x16x32_bf16 v[184:187], a[28:31], a[96:99], v[184:187]
    buffer_load_dwordx4 v14, s[32:35], s91 offen offset:2048 lds
    v_mfma_f32_16x16x32_bf16 v[188:191], a[24:27], a[84:87], v[188:191]
    v_mfma_f32_16x16x32_bf16 v[188:191], a[28:31], a[100:103], v[188:191]
    v_mfma_f32_16x16x32_bf16 v[192:195], a[32:35], a[72:75], v[192:195]
    ds_read_b64_tr_b16 a[24:25], v35 offset:32768
    v_mfma_f32_16x16x32_bf16 v[192:195], a[36:39], a[88:91], v[192:195]
    ds_read_b64_tr_b16 a[26:27], v35 offset:33792
    buffer_load_dwordx4 v15, s[32:35], s91 offen offset:3072 lds
    v_mfma_f32_16x16x32_bf16 v[196:199], a[32:35], a[76:79], v[196:199]
    ds_read_b64_tr_b16 a[28:29], v35 offset:40960
    v_mfma_f32_16x16x32_bf16 v[196:199], a[36:39], a[92:95], v[196:199]
    ds_read_b64_tr_b16 a[30:31], v35 offset:41984
    v_mfma_f32_16x16x32_bf16 v[200:203], a[32:35], a[80:83], v[200:203]
    v_mfma_f32_16x16x32_bf16 v[200:203], a[36:39], a[96:99], v[200:203]
    s_lshl_b32 s84, s76, 12
    s_add_u32 m0, s84, 81920
    s_add_u32 s91, s91, 128
    v_mfma_f32_16x16x32_bf16 v[204:207], a[32:35], a[84:87], v[204:207]
    v_mfma_f32_16x16x32_bf16 v[204:207], a[36:39], a[100:103], v[204:207]
    v_mfma_f32_16x16x32_bf16 v[208:211], a[40:43], a[72:75], v[208:211]
    ds_read_b64_tr_b16 a[32:33], v36 offset:32768
    v_mfma_f32_16x16x32_bf16 v[208:211], a[44:47], a[88:91], v[208:211]
    ds_read_b64_tr_b16 a[34:35], v36 offset:33792
    buffer_load_dwordx4 v16, s[44:47], s85 offen offset:0 lds
    v_mfma_f32_16x16x32_bf16 v[212:215], a[40:43], a[76:79], v[212:215]
    ds_read_b64_tr_b16 a[36:37], v36 offset:40960
    v_mfma_f32_16x16x32_bf16 v[212:215], a[44:47], a[92:95], v[212:215]
    ds_read_b64_tr_b16 a[38:39], v36 offset:41984
    v_mfma_f32_16x16x32_bf16 v[216:219], a[40:43], a[80:83], v[216:219]
    v_mfma_f32_16x16x32_bf16 v[216:219], a[44:47], a[96:99], v[216:219]
    buffer_load_dwordx4 v17, s[44:47], s85 offen offset:1024 lds
    v_mfma_f32_16x16x32_bf16 v[220:223], a[40:43], a[84:87], v[220:223]
    v_mfma_f32_16x16x32_bf16 v[220:223], a[44:47], a[100:103], v[220:223]
    v_mfma_f32_16x16x32_bf16 v[224:227], a[48:51], a[72:75], v[224:227]
    ds_read_b64_tr_b16 a[40:41], v37 offset:32768
    v_mfma_f32_16x16x32_bf16 v[224:227], a[52:55], a[88:91], v[224:227]
    ds_read_b64_tr_b16 a[42:43], v37 offset:33792
    buffer_load_dwordx4 v18, s[44:47], s85 offen offset:2048 lds
    v_mfma_f32_16x16x32_bf16 v[228:231], a[48:51], a[76:79], v[228:231]
    ds_read_b64_tr_b16 a[44:45], v37 offset:40960
    v_mfma_f32_16x16x32_bf16 v[228:231], a[52:55], a[92:95], v[228:231]
    ds_read_b64_tr_b16 a[46:47], v37 offset:41984
    v_mfma_f32_16x16x32_bf16 v[232:235], a[48:51], a[80:83], v[232:235]
    v_mfma_f32_16x16x32_bf16 v[232:235], a[52:55], a[96:99], v[232:235]
    buffer_load_dwordx4 v19, s[44:47], s85 offen offset:3072 lds
    v_mfma_f32_16x16x32_bf16 v[236:239], a[48:51], a[84:87], v[236:239]
    v_mfma_f32_16x16x32_bf16 v[236:239], a[52:55], a[100:103], v[236:239]
    v_mfma_f32_16x16x32_bf16 v[240:243], a[56:59], a[72:75], v[240:243]
    ds_read_b64_tr_b16 a[48:49], v38 offset:32768
    v_mfma_f32_16x16x32_bf16 v[240:243], a[60:63], a[88:91], v[240:243]
    ds_read_b64_tr_b16 a[50:51], v38 offset:33792
    s_cmp_eq_u32 s91, 1280
    s_cselect_b32 s91, 0, s91
    v_mfma_f32_16x16x32_bf16 v[244:247], a[56:59], a[76:79], v[244:247]
    ds_read_b64_tr_b16 a[52:53], v38 offset:40960
    v_mfma_f32_16x16x32_bf16 v[244:247], a[60:63], a[92:95], v[244:247]
    ds_read_b64_tr_b16 a[54:55], v38 offset:41984
    v_mfma_f32_16x16x32_bf16 v[248:251], a[56:59], a[80:83], v[248:251]
    v_mfma_f32_16x16x32_bf16 v[248:251], a[60:63], a[96:99], v[248:251]
    v_mfma_f32_16x16x32_bf16 v[252:255], a[56:59], a[84:87], v[252:255]
    v_mfma_f32_16x16x32_bf16 v[252:255], a[60:63], a[100:103], v[252:255]
    s_waitcnt vmcnt(12) lgkmcnt(0)
    s_barrier
    v_mfma_f32_16x16x32_bf16 v[128:131], a[0:3], a[104:107], v[128:131]
    ds_read_b128 a[72:75], v20 offset:0
    v_mfma_f32_16x16x32_bf16 v[128:131], a[4:7], a[120:123], v[128:131]
    ds_read_b128 a[76:79], v20 offset:2048
    s_lshl_b32 s84, s76, 13
    s_add_u32 m0, s84, 98304
    s_nop 0
    v_mfma_f32_16x16x32_bf16 v[132:135], a[0:3], a[108:111], v[132:135]
    ds_read_b128 a[80:83], v20 offset:4096
    v_mfma_f32_16x16x32_bf16 v[132:135], a[4:7], a[124:127], v[132:135]
    ds_read_b128 a[84:87], v20 offset:6144
    v_mfma_f32_16x16x32_bf16 v[136:139], a[0:3], a[112:115], v[136:139]
    ds_read_b128 a[88:91], v21 offset:0
    v_mfma_f32_16x16x32_bf16 v[136:139], a[4:7], a[128:131], v[136:139]
    ds_read_b128 a[92:95], v21 offset:2048
    buffer_load_dwordx4 v8, s[32:35], s91 offen offset:0 lds
    v_mfma_f32_16x16x32_bf16 v[140:143], a[0:3], a[116:119], v[140:143]
    ds_read_b128 a[96:99], v21 offset:4096
    v_mfma_f32_16x16x32_bf16 v[140:143], a[4:7], a[132:135], v[140:143]
    ds_read_b128 a[100:103], v21 offset:6144
    v_mfma_f32_16x16x32_bf16 v[40:43], a[0:3], v[48:51], v[40:43]
    ds_write_b128 v97, v[64:67]
    v_mfma_f32_16x16x32_bf16 v[40:43], a[4:7], v[48:51], v[40:43]
    ds_write_b128 v97, v[68:71] offset:512
    buffer_load_dwordx4 v9, s[32:35], s91 offen offset:1024 lds
    v_mfma_f32_16x16x32_bf16 v[144:147], a[8:11], a[104:107], v[144:147]
    ds_read_b64_tr_b16 a[0:1], v24 offset:0
    v_mfma_f32_16x16x32_bf16 v[144:147], a[12:15], a[120:123], v[144:147]
    ds_read_b64_tr_b16 a[2:3], v24 offset:1024
    v_mfma_f32_16x16x32_bf16 v[148:151], a[8:11], a[108:111], v[148:151]
    ds_read_b64_tr_b16 a[4:5], v24 offset:8192
    v_mfma_f32_16x16x32_bf16 v[148:151], a[12:15], a[124:127], v[148:151]
    ds_read_b64_tr_b16 a[6:7], v24 offset:9216
    buffer_load_dwordx4 v10, s[32:35], s91 offen offset:2048 lds
    v_mfma_f32_16x16x32_bf16 v[152:155], a[8:11], a[112:115], v[152:155]
    ds_read_b64_tr_b16 a[56:57], v31 offset:0
    v_mfma_f32_16x16x32_bf16 v[152:155], a[12:15], a[128:131], v[152:155]
    ds_read_b64_tr_b16 a[58:59], v31 offset:1024
    v_mfma_f32_16x16x32_bf16 v[156:159], a[8:11], a[116:119], v[156:159]
    ds_read_b64_tr_b16 a[60:61], v31 offset:8192
    v_mfma_f32_16x16x32_bf16 v[156:159], a[12:15], a[132:135], v[156:159]
    ds_read_b64_tr_b16 a[62:63], v31 offset:9216
    buffer_load_dwordx4 v11, s[32:35], s91 offen offset:3072 lds
    v_mfma_f32_16x16x32_bf16 v[44:47], a[8:11], v[48:51], v[44:47]
    ds_write_b64 v98, v[72:73] offset:1024
    v_mfma_f32_16x16x32_bf16 v[44:47], a[12:15], v[48:51], v[44:47]
    v_mfma_f32_16x16x32_bf16 v[160:163], a[16:19], a[104:107], v[160:163]
    ds_read_b64_tr_b16 a[8:9], v25 offset:0
    v_mfma_f32_16x16x32_bf16 v[160:163], a[20:23], a[120:123], v[160:163]
    ds_read_b64_tr_b16 a[10:11], v25 offset:1024
    s_add_u32 m0, s84, 102400
    s_lshl_b32 s85, s91, 12
    v_mfma_f32_16x16x32_bf16 v[164:167], a[16:19], a[108:111], v[164:167]
    ds_read_b64_tr_b16 a[12:13], v25 offset:8192
    v_mfma_f32_16x16x32_bf16 v[164:167], a[20:23], a[124:127], v[164:167]
    ds_read_b64_tr_b16 a[14:15], v25 offset:9216
    v_mfma_f32_16x16x32_bf16 v[168:171], a[16:19], a[112:115], v[168:171]
    v_mfma_f32_16x16x32_bf16 v[168:171], a[20:23], a[128:131], v[168:171]
    buffer_load_dwordx4 v12, s[32:35], s91 offen offset:0 lds
    v_mfma_f32_16x16x32_bf16 v[172:175], a[16:19], a[116:119], v[172:175]
    v_mfma_f32_16x16x32_bf16 v[172:175], a[20:23], a[132:135], v[172:175]
    v_mfma_f32_16x16x32_bf16 v[176:179], a[24:27], a[104:107], v[176:179]
    ds_read_b64_tr_b16 a[16:17], v26 offset:0
    v_mfma_f32_16x16x32_bf16 v[176:179], a[28:31], a[120:123], v[176:179]
    ds_read_b64_tr_b16 a[18:19], v26 offset:1024
    buffer_load_dwordx4 v13, s[32:35], s91 offen offset:1024 lds
    v_mfma_f32_16x16x32_bf16 v[180:183], a[24:27], a[108:111], v[180:183]
    ds_read_b64_tr_b16 a[20:21], v26 offset:8192
    v_mfma_f32_16x16x32_bf16 v[180:183], a[28:31], a[124:127], v[180:183]
    ds_read_b64_tr_b16 a[22:23], v26 offset:9216
    v_mfma_f32_16x16x32_bf16 v[184:187], a[24:27], a[112:115], v[184:187]
    v_mfma_f32_16x16x32_bf16 v[184:187], a[28:31], a[128:131], v[184:187]
    buffer_load_dwordx4 v14, s[32:35], s91 offen offset:2048 lds
    v_mfma_f32_16x16x32_bf16 v[188:191], a[24:27], a[116:119], v[188:191]
    v_mfma_f32_16x16x32_bf16 v[188:191], a[28:31], a[132:135], v[188:191]
    v_mfma_f32_16x16x32_bf16 v[192:195], a[32:35], a[104:107], v[192:195]
    ds_read_b64_tr_b16 a[24:25], v27 offset:0
    v_mfma_f32_16x16x32_bf16 v[192:195], a[36:39], a[120:123], v[192:195]
    ds_read_b64_tr_b16 a[26:27], v27 offset:1024
    buffer_load_dwordx4 v15, s[32:35], s91 offen offset:3072 lds
    v_mfma_f32_16x16x32_bf16 v[196:199], a[32:35], a[108:111], v[196:199]
    ds_read_b64_tr_b16 a[28:29], v27 offset:8192
    v_mfma_f32_16x16x32_bf16 v[196:199], a[36:39], a[124:127], v[196:199]
    ds_read_b64_tr_b16 a[30:31], v27 offset:9216
    v_mfma_f32_16x16x32_bf16 v[200:203], a[32:35], a[112:115], v[200:203]
    v_mfma_f32_16x16x32_bf16 v[200:203], a[36:39], a[128:131], v[200:203]
    s_lshl_b32 s84, s76, 12
    s_add_u32 m0, s84, 131072
    s_add_u32 s91, s91, 128
    v_mfma_f32_16x16x32_bf16 v[204:207], a[32:35], a[116:119], v[204:207]
    v_mfma_f32_16x16x32_bf16 v[204:207], a[36:39], a[132:135], v[204:207]
    v_mfma_f32_16x16x32_bf16 v[208:211], a[40:43], a[104:107], v[208:211]
    ds_read_b64_tr_b16 a[32:33], v28 offset:0
    v_mfma_f32_16x16x32_bf16 v[208:211], a[44:47], a[120:123], v[208:211]
    ds_read_b64_tr_b16 a[34:35], v28 offset:1024
    buffer_load_dwordx4 v16, s[44:47], s85 offen offset:0 lds
    v_mfma_f32_16x16x32_bf16 v[212:215], a[40:43], a[108:111], v[212:215]
    ds_read_b64_tr_b16 a[36:37], v28 offset:8192
    v_mfma_f32_16x16x32_bf16 v[212:215], a[44:47], a[124:127], v[212:215]
    ds_read_b64_tr_b16 a[38:39], v28 offset:9216
    v_mfma_f32_16x16x32_bf16 v[216:219], a[40:43], a[112:115], v[216:219]
    v_mfma_f32_16x16x32_bf16 v[216:219], a[44:47], a[128:131], v[216:219]
    buffer_load_dwordx4 v17, s[44:47], s85 offen offset:1024 lds
    v_mfma_f32_16x16x32_bf16 v[220:223], a[40:43], a[116:119], v[220:223]
    v_mfma_f32_16x16x32_bf16 v[220:223], a[44:47], a[132:135], v[220:223]
    v_mfma_f32_16x16x32_bf16 v[224:227], a[48:51], a[104:107], v[224:227]
    ds_read_b64_tr_b16 a[40:41], v29 offset:0
    v_mfma_f32_16x16x32_bf16 v[224:227], a[52:55], a[120:123], v[224:227]
    ds_read_b64_tr_b16 a[42:43], v29 offset:1024
    buffer_load_dwordx4 v18, s[44:47], s85 offen offset:2048 lds
    v_mfma_f32_16x16x32_bf16 v[228:231], a[48:51], a[108:111], v[228:231]
    ds_read_b64_tr_b16 a[44:45], v29 offset:8192
    v_mfma_f32_16x16x32_bf16 v[228:231], a[52:55], a[124:127], v[228:231]
    ds_read_b64_tr_b16 a[46:47], v29 offset:9216
    v_mfma_f32_16x16x32_bf16 v[232:235], a[48:51], a[112:115], v[232:235]
    v_mfma_f32_16x16x32_bf16 v[232:235], a[52:55], a[128:131], v[232:235]
    buffer_load_dwordx4 v19, s[44:47], s85 offen offset:3072 lds
    v_mfma_f32_16x16x32_bf16 v[236:239], a[48:51], a[116:119], v[236:239]
    v_mfma_f32_16x16x32_bf16 v[236:239], a[52:55], a[132:135], v[236:239]
    v_mfma_f32_16x16x32_bf16 v[240:243], a[64:67], a[104:107], v[240:243]
    ds_read_b64_tr_b16 a[48:49], v30 offset:0
    v_mfma_f32_16x16x32_bf16 v[240:243], a[68:71], a[120:123], v[240:243]
    ds_read_b64_tr_b16 a[50:51], v30 offset:1024
    s_cmp_eq_u32 s91, 1280
    s_cselect_b32 s91, 0, s91
    v_mfma_f32_16x16x32_bf16 v[244:247], a[64:67], a[108:111], v[244:247]
    ds_read_b64_tr_b16 a[52:53], v30 offset:8192
    v_mfma_f32_16x16x32_bf16 v[244:247], a[68:71], a[124:127], v[244:247]
    ds_read_b64_tr_b16 a[54:55], v30 offset:9216
    v_mfma_f32_16x16x32_bf16 v[248:251], a[64:67], a[112:115], v[248:251]
    v_mfma_f32_16x16x32_bf16 v[248:251], a[68:71], a[128:131], v[248:251]
    v_mfma_f32_16x16x32_bf16 v[252:255], a[64:67], a[116:119], v[252:255]
    v_mfma_f32_16x16x32_bf16 v[252:255], a[68:71], a[132:135], v[252:255]
    s_waitcnt vmcnt(12) lgkmcnt(0)
    s_barrier
    v_mfma_f32_16x16x32_bf16 v[128:131], a[0:3], a[72:75], v[128:131]
    ds_read_b128 a[104:107], v20 offset:49152
    v_mfma_f32_16x16x32_bf16 v[128:131], a[4:7], a[88:91], v[128:131]
    ds_read_b128 a[108:111], v20 offset:51200
    global_load_dword v60, v61, s[24:25] sc1
    v_mfma_f32_16x16x32_bf16 v[132:135], a[0:3], a[76:79], v[132:135]
    ds_read_b128 a[112:115], v20 offset:53248
    v_mfma_f32_16x16x32_bf16 v[132:135], a[4:7], a[92:95], v[132:135]
    ds_read_b128 a[116:119], v20 offset:55296
    v_mfma_f32_16x16x32_bf16 v[136:139], a[0:3], a[80:83], v[136:139]
    ds_read_b128 a[120:123], v21 offset:49152
    s_lshl_b32 s84, s76, 13
    s_add_u32 m0, s84, 0
    s_nop 0
    v_mfma_f32_16x16x32_bf16 v[136:139], a[4:7], a[96:99], v[136:139]
    ds_read_b128 a[124:127], v21 offset:51200
    v_mfma_f32_16x16x32_bf16 v[140:143], a[0:3], a[84:87], v[140:143]
    ds_read_b128 a[128:131], v21 offset:53248
    v_mfma_f32_16x16x32_bf16 v[140:143], a[4:7], a[100:103], v[140:143]
    ds_read_b128 a[132:135], v21 offset:55296
    v_mfma_f32_16x16x32_bf16 v[40:43], a[0:3], v[48:51], v[40:43]
    ds_read_b64_tr_b16 v[76:77], v106 offset:0
    buffer_load_dwordx4 v8, s[32:35], s91 offen offset:0 lds
    v_mfma_f32_16x16x32_bf16 v[40:43], a[4:7], v[48:51], v[40:43]
    ds_read_b64_tr_b16 v[78:79], v106 offset:5120
    v_mfma_f32_16x16x32_bf16 v[144:147], a[8:11], a[72:75], v[144:147]
    ds_read_b64_tr_b16 a[0:1], v24 offset:49152
    v_mfma_f32_16x16x32_bf16 v[144:147], a[12:15], a[88:91], v[144:147]
    ds_read_b64_tr_b16 a[2:3], v24 offset:50176
    v_mfma_f32_16x16x32_bf16 v[148:151], a[8:11], a[76:79], v[148:151]
    ds_read_b64_tr_b16 a[4:5], v24 offset:57344
    buffer_load_dwordx4 v9, s[32:35], s91 offen offset:1024 lds
    v_mfma_f32_16x16x32_bf16 v[148:151], a[12:15], a[92:95], v[148:151]
    ds_read_b64_tr_b16 a[6:7], v24 offset:58368
    v_mfma_f32_16x16x32_bf16 v[152:155], a[8:11], a[80:83], v[152:155]
    ds_read_b64_tr_b16 a[64:65], v31 offset:49152
    v_mfma_f32_16x16x32_bf16 v[152:155], a[12:15], a[96:99], v[152:155]
    ds_read_b64_tr_b16 a[66:67], v31 offset:50176
    v_mfma_f32_16x16x32_bf16 v[156:159], a[8:11], a[84:87], v[156:159]
    ds_read_b64_tr_b16 a[68:69], v31 offset:57344
    buffer_load_dwordx4 v10, s[32:35], s91 offen offset:2048 lds
    v_mfma_f32_16x16x32_bf16 v[156:159], a[12:15], a[100:103], v[156:159]
    ds_read_b64_tr_b16 a[70:71], v31 offset:58368
    v_mfma_f32_16x16x32_bf16 v[44:47], a[8:11], v[48:51], v[44:47]
    ds_read_b64_tr_b16 v[80:81], v106 offset:512
    v_mfma_f32_16x16x32_bf16 v[44:47], a[12:15], v[48:51], v[44:47]
    ds_read_b64_tr_b16 v[82:83], v106 offset:5632
    v_mfma_f32_16x16x32_bf16 v[160:163], a[16:19], a[72:75], v[160:163]
    ds_read_b64_tr_b16 a[8:9], v25 offset:49152
    buffer_load_dwordx4 v11, s[32:35], s91 offen offset:3072 lds
    v_mfma_f32_16x16x32_bf16 v[160:163], a[20:23], a[88:91], v[160:163]
    ds_read_b64_tr_b16 a[10:11], v25 offset:50176
    v_mfma_f32_16x16x32_bf16 v[164:167], a[16:19], a[76:79], v[164:167]
    ds_read_b64_tr_b16 a[12:13], v25 offset:57344
    v_mfma_f32_16x16x32_bf16 v[164:167], a[20:23], a[92:95], v[164:167]
    ds_read_b64_tr_b16 a[14:15], v25 offset:58368
    s_add_u32 m0, s84, 4096
    s_lshl_b32 s85, s91, 12
    v_mfma_f32_16x16x32_bf16 v[168:171], a[16:19], a[80:83], v[168:171]
    ds_read_b64_tr_b16 v[84:85], v106 offset:1024
    v_mfma_f32_16x16x32_bf16 v[168:171], a[20:23], a[96:99], v[168:171]
    ds_read_b64_tr_b16 v[86:87], v106 offset:6144
    v_mfma_f32_16x16x32_bf16 v[172:175], a[16:19], a[84:87], v[172:175]
    v_mfma_f32_16x16x32_bf16 v[172:175], a[20:23], a[100:103], v[172:175]
    buffer_load_dwordx4 v12, s[32:35], s91 offen offset:0 lds
    v_mfma_f32_16x16x32_bf16 v[176:179], a[24:27], a[72:75], v[176:179]
    ds_read_b64_tr_b16 a[16:17], v26 offset:49152
    v_mfma_f32_16x16x32_bf16 v[176:179], a[28:31], a[88:91], v[176:179]
    ds_read_b64_tr_b16 a[18:19], v26 offset:50176
    v_mfma_f32_16x16x32_bf16 v[180:183], a[24:27], a[76:79], v[180:183]
    ds_read_b64_tr_b16 a[20:21], v26 offset:57344
    v_mfma_f32_16x16x32_bf16 v[180:183], a[28:31], a[92:95], v[180:183]
    ds_read_b64_tr_b16 a[22:23], v26 offset:58368
    buffer_load_dwordx4 v13, s[32:35], s91 offen offset:1024 lds
    v_mfma_f32_16x16x32_bf16 v[184:187], a[24:27], a[80:83], v[184:187]
    v_mfma_f32_16x16x32_bf16 v[184:187], a[28:31], a[96:99], v[184:187]
    v_mfma_f32_16x16x32_bf16 v[188:191], a[24:27], a[84:87], v[188:191]
    v_mfma_f32_16x16x32_bf16 v[188:191], a[28:31], a[100:103], v[188:191]
    buffer_load_dwordx4 v14, s[32:35], s91 offen offset:2048 lds
    v_mfma_f32_16x16x32_bf16 v[192:195], a[32:35], a[72:75], v[192:195]
    ds_read_b64_tr_b16 a[24:25], v27 offset:49152
    v_mfma_f32_16x16x32_bf16 v[192:195], a[36:39], a[88:91], v[192:195]
    ds_read_b64_tr_b16 a[26:27], v27 offset:50176
    v_mfma_f32_16x16x32_bf16 v[196:199], a[32:35], a[76:79], v[196:199]
    ds_read_b64_tr_b16 a[28:29], v27 offset:57344
    v_mfma_f32_16x16x32_bf16 v[196:199], a[36:39], a[92:95], v[196:199]
    ds_read_b64_tr_b16 a[30:31], v27 offset:58368
    buffer_load_dwordx4 v15, s[32:35], s91 offen offset:3072 lds
    v_mfma_f32_16x16x32_bf16 v[200:203], a[32:35], a[80:83], v[200:203]
    v_mfma_f32_16x16x32_bf16 v[200:203], a[36:39], a[96:99], v[200:203]
    v_mfma_f32_16x16x32_bf16 v[204:207], a[32:35], a[84:87], v[204:207]
    v_mfma_f32_16x16x32_bf16 v[204:207], a[36:39], a[100:103], v[204:207]
    s_lshl_b32 s84, s76, 12
    s_add_u32 m0, s84, 32768
    s_add_u32 s91, s91, 128
    v_mfma_f32_16x16x32_bf16 v[208:211], a[40:43], a[72:75], v[208:211]
    ds_read_b64_tr_b16 a[32:33], v28 offset:49152
    v_mfma_f32_16x16x32_bf16 v[208:211], a[44:47], a[88:91], v[208:211]
    ds_read_b64_tr_b16 a[34:35], v28 offset:50176
    v_mfma_f32_16x16x32_bf16 v[212:215], a[40:43], a[76:79], v[212:215]
    ds_read_b64_tr_b16 a[36:37], v28 offset:57344
    buffer_load_dwordx4 v16, s[44:47], s85 offen offset:0 lds
    v_mfma_f32_16x16x32_bf16 v[212:215], a[44:47], a[92:95], v[212:215]
    ds_read_b64_tr_b16 a[38:39], v28 offset:58368
    v_mfma_f32_16x16x32_bf16 v[216:219], a[40:43], a[80:83], v[216:219]
    v_mfma_f32_16x16x32_bf16 v[216:219], a[44:47], a[96:99], v[216:219]
    v_mfma_f32_16x16x32_bf16 v[220:223], a[40:43], a[84:87], v[220:223]
    buffer_load_dwordx4 v17, s[44:47], s85 offen offset:1024 lds
    v_mfma_f32_16x16x32_bf16 v[220:223], a[44:47], a[100:103], v[220:223]
    v_mfma_f32_16x16x32_bf16 v[224:227], a[48:51], a[72:75], v[224:227]
    ds_read_b64_tr_b16 a[40:41], v29 offset:49152
    v_mfma_f32_16x16x32_bf16 v[224:227], a[52:55], a[88:91], v[224:227]
    ds_read_b64_tr_b16 a[42:43], v29 offset:50176
    v_mfma_f32_16x16x32_bf16 v[228:231], a[48:51], a[76:79], v[228:231]
    ds_read_b64_tr_b16 a[44:45], v29 offset:57344
    buffer_load_dwordx4 v18, s[44:47], s85 offen offset:2048 lds
    v_mfma_f32_16x16x32_bf16 v[228:231], a[52:55], a[92:95], v[228:231]
    ds_read_b64_tr_b16 a[46:47], v29 offset:58368
    v_mfma_f32_16x16x32_bf16 v[232:235], a[48:51], a[80:83], v[232:235]
    v_mfma_f32_16x16x32_bf16 v[232:235], a[52:55], a[96:99], v[232:235]
    v_mfma_f32_16x16x32_bf16 v[236:239], a[48:51], a[84:87], v[236:239]
    buffer_load_dwordx4 v19, s[44:47], s85 offen offset:3072 lds
    v_mfma_f32_16x16x32_bf16 v[236:239], a[52:55], a[100:103], v[236:239]
    v_mfma_f32_16x16x32_bf16 v[240:243], a[56:59], a[72:75], v[240:243]
    ds_read_b64_tr_b16 a[48:49], v30 offset:49152
    v_mfma_f32_16x16x32_bf16 v[240:243], a[60:63], a[88:91], v[240:243]
    ds_read_b64_tr_b16 a[50:51], v30 offset:50176
    v_mfma_f32_16x16x32_bf16 v[244:247], a[56:59], a[76:79], v[244:247]
    ds_read_b64_tr_b16 a[52:53], v30 offset:57344
    s_cmp_eq_u32 s91, 1280
    s_cselect_b32 s91, 0, s91
    v_mfma_f32_16x16x32_bf16 v[244:247], a[60:63], a[92:95], v[244:247]
    ds_read_b64_tr_b16 a[54:55], v30 offset:58368
    v_mfma_f32_16x16x32_bf16 v[248:251], a[56:59], a[80:83], v[248:251]
    v_mfma_f32_16x16x32_bf16 v[248:251], a[60:63], a[96:99], v[248:251]
    v_mfma_f32_16x16x32_bf16 v[252:255], a[56:59], a[84:87], v[252:255]
    v_mfma_f32_16x16x32_bf16 v[252:255], a[60:63], a[100:103], v[252:255]
    s_waitcnt vmcnt(12) lgkmcnt(0)
    s_barrier
    s_mov_b32 s93, 0xff
    s_mov_b32 s92, 0x40000
L_poll0:
    v_cmp_gt_u32 vcc, 32, v60
    s_nop 1
    s_and_b32 s86, vcc_lo, s93
    s_cbranch_scc0 L_polld0
    s_sub_u32 s92, s92, 1
    s_cbranch_scc1 L_polld0
    s_sleep 6
    global_load_dword v60, v61, s[24:25] sc1
    s_waitcnt vmcnt(0)
    s_branch L_poll0
L_polld0:
    s_lshl_b32 s81, s78, 8
    s_lshl_b32 s82, s76, 6
    s_add_u32 s81, s81, s82
    v_add_u32 v6, s81, v2
    v_lshlrev_b32 v6, 3, v6
    buffer_load_dwordx2 v[8:9], v6, s[72:75], 0 offen offset:0 sc1
    buffer_load_dwordx2 v[10:11], v6, s[72:75], 0 offen offset:128 sc1
    buffer_load_dwordx2 v[12:13], v6, s[72:75], 0 offen offset:256 sc1
    buffer_load_dwordx2 v[14:15], v6, s[72:75], 0 offen offset:384 sc1
    v_mfma_f32_16x16x32_bf16 v[128:131], a[0:3], a[104:107], v[128:131]
    ds_read_b128 a[72:75], v22 offset:32768
    v_mfma_f32_16x16x32_bf16 v[128:131], a[4:7], a[120:123], v[128:131]
    ds_read_b128 a[76:79], v22 offset:34816
    buffer_store_dwordx4 v[76:79], v107, s[72:75], s88 offen sc1
    v_mfma_f32_16x16x32_bf16 v[132:135], a[0:3], a[108:111], v[132:135]
    ds_read_b128 a[80:83], v22 offset:36864
    v_mfma_f32_16x16x32_bf16 v[132:135], a[4:7], a[124:127], v[132:135]
    ds_read_b128 a[84:87], v22 offset:38912
    v_mfma_f32_16x16x32_bf16 v[136:139], a[0:3], a[112:115], v[136:139]
    ds_read_b128 a[88:91], v23 offset:32768
    buffer_store_dwordx4 v[80:83], v107, s[72:75], s89 offen sc1
    v_mfma_f32_16x16x32_bf16 v[136:139], a[4:7], a[128:131], v[136:139]
    ds_read_b128 a[92:95], v23 offset:34816
    v_mfma_f32_16x16x32_bf16 v[140:143], a[0:3], a[116:119], v[140:143]
    ds_read_b128 a[96:99], v23 offset:36864
    v_mfma_f32_16x16x32_bf16 v[140:143], a[4:7], a[132:135], v[140:143]
    ds_read_b128 a[100:103], v23 offset:38912
    v_mfma_f32_16x16x32_bf16 v[40:43], a[0:3], v[48:51], v[40:43]
    buffer_store_dwordx4 v[84:87], v107, s[72:75], s87 offen sc1
    v_mfma_f32_16x16x32_bf16 v[40:43], a[4:7], v[48:51], v[40:43]
    v_mfma_f32_16x16x32_bf16 v[144:147], a[8:11], a[104:107], v[144:147]
    ds_read_b64_tr_b16 a[0:1], v32 offset:32768
    v_mfma_f32_16x16x32_bf16 v[144:147], a[12:15], a[120:123], v[144:147]
    ds_read_b64_tr_b16 a[2:3], v32 offset:33792
    s_add_u32 m0, s90, 49152
    s_mov_b32 s85, 0
    v_mfma_f32_16x16x32_bf16 v[148:151], a[8:11], a[108:111], v[148:151]
    ds_read_b64_tr_b16 a[4:5], v32 offset:40960
    v_mfma_f32_16x16x32_bf16 v[148:151], a[12:15], a[124:127], v[148:151]
    ds_read_b64_tr_b16 a[6:7], v32 offset:41984
    v_mfma_f32_16x16x32_bf16 v[152:155], a[8:11], a[112:115], v[152:155]
    ds_read_b64_tr_b16 a[56:57], v39 offset:32768
    v_mfma_f32_16x16x32_bf16 v[152:155], a[12:15], a[128:131], v[152:155]
    ds_read_b64_tr_b16 a[58:59], v39 offset:33792
    buffer_load_dwordx4 v52, s[36:39], s85 offen offset:0 nt lds
    v_mfma_f32_16x16x32_bf16 v[156:159], a[8:11], a[116:119], v[156:159]
    ds_read_b64_tr_b16 a[60:61], v39 offset:40960
    v_mfma_f32_16x16x32_bf16 v[156:159], a[12:15], a[132:135], v[156:159]
    ds_read_b64_tr_b16 a[62:63], v39 offset:41984
    v_mfma_f32_16x16x32_bf16 v[44:47], a[8:11], v[48:51], v[44:47]
    v_mfma_f32_16x16x32_bf16 v[44:47], a[12:15], v[48:51], v[44:47]
    buffer_load_dwordx4 v53, s[36:39], s85 offen offset:1024 nt lds
    v_mfma_f32_16x16x32_bf16 v[160:163], a[16:19], a[104:107], v[160:163]
    ds_read_b64_tr_b16 a[8:9], v33 offset:32768
    v_mfma_f32_16x16x32_bf16 v[160:163], a[20:23], a[120:123], v[160:163]
    ds_read_b64_tr_b16 a[10:11], v33 offset:33792
    v_mfma_f32_16x16x32_bf16 v[164:167], a[16:19], a[108:111], v[164:167]
    ds_read_b64_tr_b16 a[12:13], v33 offset:40960
    buffer_load_dwordx4 v54, s[36:39], s85 offen offset:2048 nt lds
    v_mfma_f32_16x16x32_bf16 v[164:167], a[20:23], a[124:127], v[164:167]
    ds_read_b64_tr_b16 a[14:15], v33 offset:41984
    v_mfma_f32_16x16x32_bf16 v[168:171], a[16:19], a[112:115], v[168:171]
    v_mfma_f32_16x16x32_bf16 v[168:171], a[20:23], a[128:131], v[168:171]
    v_mfma_f32_16x16x32_bf16 v[172:175], a[16:19], a[116:119], v[172:175]
    buffer_load_dwordx4 v55, s[36:39], s85 offen offset:3072 nt lds
    v_mfma_f32_16x16x32_bf16 v[172:175], a[20:23], a[132:135], v[172:175]
    v_mfma_f32_16x16x32_bf16 v[176:179], a[24:27], a[104:107], v[176:179]
    ds_read_b64_tr_b16 a[16:17], v34 offset:32768
    v_mfma_f32_16x16x32_bf16 v[176:179], a[28:31], a[120:123], v[176:179]
    ds_read_b64_tr_b16 a[18:19], v34 offset:33792
    s_add_u32 m0, s90, 65536
    s_mov_b32 s85, 0
    v_mfma_f32_16x16x32_bf16 v[180:183], a[24:27], a[108:111], v[180:183]
    ds_read_b64_tr_b16 a[20:21], v34 offset:40960
    v_mfma_f32_16x16x32_bf16 v[180:183], a[28:31], a[124:127], v[180:183]
    ds_read_b64_tr_b16 a[22:23], v34 offset:41984
    v_mfma_f32_16x16x32_bf16 v[184:187], a[24:27], a[112:115], v[184:187]
    v_mfma_f32_16x16x32_bf16 v[184:187], a[28:31], a[128:131], v[184:187]
    buffer_load_dwordx4 v56, s[40:43], s85 offen offset:0 nt lds
    v_mfma_f32_16x16x32_bf16 v[188:191], a[24:27], a[116:119], v[188:191]
    v_mfma_f32_16x16x32_bf16 v[188:191], a[28:31], a[132:135], v[188:191]
    v_mfma_f32_16x16x32_bf16 v[192:195], a[32:35], a[104:107], v[192:195]
    ds_read_b64_tr_b16 a[24:25], v35 offset:32768
    v_mfma_f32_16x16x32_bf16 v[192:195], a[36:39], a[120:123], v[192:195]
    ds_read_b64_tr_b16 a[26:27], v35 offset:33792
    buffer_load_dwordx4 v57, s[40:43], s85 offen offset:1024 nt lds
    v_mfma_f32_16x16x32_bf16 v[196:199], a[32:35], a[108:111], v[196:199]
    ds_read_b64_tr_b16 a[28:29], v35 offset:40960
    v_mfma_f32_16x16x32_bf16 v[196:199], a[36:39], a[124:127], v[196:199]
    ds_read_b64_tr_b16 a[30:31], v35 offset:41984
    v_mfma_f32_16x16x32_bf16 v[200:203], a[32:35], a[112:115], v[200:203]
    buffer_load_dwordx4 v56, s[40:43], s85 offen offset:2048 nt lds
    v_mfma_f32_16x16x32_bf16 v[200:203], a[36:39], a[128:131], v[200:203]
    v_mfma_f32_16x16x32_bf16 v[204:207], a[32:35], a[116:119], v[204:207]
    v_mfma_f32_16x16x32_bf16 v[204:207], a[36:39], a[132:135], v[204:207]
    v_mfma_f32_16x16x32_bf16 v[208:211], a[40:43], a[104:107], v[208:211]
    ds_read_b64_tr_b16 a[32:33], v36 offset:32768
    buffer_load_dwordx4 v57, s[40:43], s85 offen offset:3072 nt lds
    v_mfma_f32_16x16x32_bf16 v[208:211], a[44:47], a[120:123], v[208:211]
    ds_read_b64_tr_b16 a[34:35], v36 offset:33792
    v_mfma_f32_16x16x32_bf16 v[212:215], a[40:43], a[108:111], v[212:215]
    ds_read_b64_tr_b16 a[36:37], v36 offset:40960
    v_mfma_f32_16x16x32_bf16 v[212:215], a[44:47], a[124:127], v[212:215]
    ds_read_b64_tr_b16 a[38:39], v36 offset:41984
    s_add_u32 m0, s90, 81920
    s_mov_b32 s85, 16384
    v_mfma_f32_16x16x32_bf16 v[216:219], a[40:43], a[112:115], v[216:219]
    v_mfma_f32_16x16x32_bf16 v[216:219], a[44:47], a[128:131], v[216:219]
    v_mfma_f32_16x16x32_bf16 v[220:223], a[40:43], a[116:119], v[220:223]
    v_mfma_f32_16x16x32_bf16 v[220:223], a[44:47], a[132:135], v[220:223]
    buffer_load_dwordx4 v56, s[40:43], s85 offen offset:0 nt lds
    v_mfma_f32_16x16x32_bf16 v[224:227], a[48:51], a[104:107], v[224:227]
    ds_read_b64_tr_b16 a[40:41], v37 offset:32768
    v_mfma_f32_16x16x32_bf16 v[224:227], a[52:55], a[120:123], v[224:227]
    ds_read_b64_tr_b16 a[42:43], v37 offset:33792
    v_mfma_f32_16x16x32_bf16 v[228:231], a[48:51], a[108:111], v[228:231]
    ds_read_b64_tr_b16 a[44:45], v37 offset:40960
    v_mfma_f32_16x16x32_bf16 v[228:231], a[52:55], a[124:127], v[228:231]
    ds_read_b64_tr_b16 a[46:47], v37 offset:41984
    buffer_load_dwordx4 v57, s[40:43], s85 offen offset:1024 nt lds
    v_mfma_f32_16x16x32_bf16 v[232:235], a[48:51], a[112:115], v[232:235]
    v_mfma_f32_16x16x32_bf16 v[232:235], a[52:55], a[128:131], v[232:235]
    v_mfma_f32_16x16x32_bf16 v[236:239], a[48:51], a[116:119], v[236:239]
    buffer_load_dwordx4 v56, s[40:43], s85 offen offset:2048 nt lds
    v_mfma_f32_16x16x32_bf16 v[236:239], a[52:55], a[132:135], v[236:239]
    v_mfma_f32_16x16x32_bf16 v[240:243], a[64:67], a[104:107], v[240:243]
    ds_read_b64_tr_b16 a[48:49], v38 offset:32768
    v_mfma_f32_16x16x32_bf16 v[240:243], a[68:71], a[120:123], v[240:243]
    ds_read_b64_tr_b16 a[50:51], v38 offset:33792
    v_mfma_f32_16x16x32_bf16 v[244:247], a[64:67], a[108:111], v[244:247]
    ds_read_b64_tr_b16 a[52:53], v38 offset:40960
    buffer_load_dwordx4 v57, s[40:43], s85 offen offset:3072 nt lds
    v_mfma_f32_16x16x32_bf16 v[244:247], a[68:71], a[124:127], v[244:247]
    ds_read_b64_tr_b16 a[54:55], v38 offset:41984
    v_mfma_f32_16x16x32_bf16 v[248:251], a[64:67], a[112:115], v[248:251]
    v_mfma_f32_16x16x32_bf16 v[248:251], a[68:71], a[128:131], v[248:251]
    v_mfma_f32_16x16x32_bf16 v[252:255], a[64:67], a[116:119], v[252:255]
    v_mfma_f32_16x16x32_bf16 v[252:255], a[68:71], a[132:135], v[252:255]
    s_waitcnt vmcnt(19) lgkmcnt(0)
    s_barrier
    v_mfma_f32_16x16x32_bf16 v[128:131], a[0:3], a[72:75], v[128:131]
    ds_read_b128 a[104:107], v20 offset:0
    v_mfma_f32_16x16x32_bf16 v[128:131], a[4:7], a[88:91], v[128:131]
    ds_read_b128 a[108:111], v20 offset:2048
    v_mfma_f32_16x16x32_bf16 v[132:135], a[0:3], a[76:79], v[132:135]
    ds_read_b128 a[112:115], v20 offset:4096
    v_mfma_f32_16x16x32_bf16 v[132:135], a[4:7], a[92:95], v[132:135]
    ds_read_b128 a[116:119], v20 offset:6144
    v_mfma_f32_16x16x32_bf16 v[136:139], a[0:3], a[80:83], v[136:139]
    ds_read_b128 a[120:123], v21 offset:0
    v_mfma_f32_16x16x32_bf16 v[136:139], a[4:7], a[96:99], v[136:139]
    ds_read_b128 a[124:127], v21 offset:2048
    v_mfma_f32_16x16x32_bf16 v[140:143], a[0:3], a[84:87], v[140:143]
    ds_read_b128 a[128:131], v21 offset:4096
    v_mfma_f32_16x16x32_bf16 v[140:143], a[4:7], a[100:103], v[140:143]
    ds_read_b128 a[132:135], v21 offset:6144
    v_mfma_f32_16x16x32_bf16 v[40:43], a[0:3], v[48:51], v[40:43]
    v_mfma_f32_16x16x32_bf16 v[40:43], a[4:7], v[48:51], v[40:43]
    v_mfma_f32_16x16x32_bf16 v[144:147], a[8:11], a[72:75], v[144:147]
    ds_read_b64_tr_b16 a[0:1], v24 offset:0
    v_mfma_f32_16x16x32_bf16 v[144:147], a[12:15], a[88:91], v[144:147]
    ds_read_b64_tr_b16 a[2:3], v24 offset:1024
    v_mfma_f32_16x16x32_bf16 v[148:151], a[8:11], a[76:79], v[148:151]
    ds_read_b64_tr_b16 a[4:5], v24 offset:8192
    v_mfma_f32_16x16x32_bf16 v[148:151], a[12:15], a[92:95], v[148:151]
    ds_read_b64_tr_b16 a[6:7], v24 offset:9216
    v_mfma_f32_16x16x32_bf16 v[152:155], a[8:11], a[80:83], v[152:155]
    ds_read_b64_tr_b16 a[64:65], v31 offset:0
    v_mfma_f32_16x16x32_bf16 v[152:155], a[12:15], a[96:99], v[152:155]
    ds_read_b64_tr_b16 a[66:67], v31 offset:1024
    v_mfma_f32_16x16x32_bf16 v[156:159], a[8:11], a[84:87], v[156:159]
    ds_read_b64_tr_b16 a[68:69], v31 offset:8192
    v_mfma_f32_16x16x32_bf16 v[156:159], a[12:15], a[100:103], v[156:159]
    ds_read_b64_tr_b16 a[70:71], v31 offset:9216
    v_mfma_f32_16x16x32_bf16 v[44:47], a[8:11], v[48:51], v[44:47]
    v_mfma_f32_16x16x32_bf16 v[44:47], a[12:15], v[48:51], v[44:47]
    v_mfma_f32_16x16x32_bf16 v[160:163], a[16:19], a[72:75], v[160:163]
    ds_read_b64_tr_b16 a[8:9], v25 offset:0
    v_mfma_f32_16x16x32_bf16 v[160:163], a[20:23], a[88:91], v[160:163]
    ds_read_b64_tr_b16 a[10:11], v25 offset:1024
    v_mfma_f32_16x16x32_bf16 v[164:167], a[16:19], a[76:79], v[164:167]
    ds_read_b64_tr_b16 a[12:13], v25 offset:8192
    v_mfma_f32_16x16x32_bf16 v[164:167], a[20:23], a[92:95], v[164:167]
    ds_read_b64_tr_b16 a[14:15], v25 offset:9216
    v_mfma_f32_16x16x32_bf16 v[168:171], a[16:19], a[80:83], v[168:171]
    v_mfma_f32_16x16x32_bf16 v[168:171], a[20:23], a[96:99], v[168:171]
    v_mfma_f32_16x16x32_bf16 v[172:175], a[16:19], a[84:87], v[172:175]
    v_mfma_f32_16x16x32_bf16 v[172:175], a[20:23], a[100:103], v[172:175]
    v_mfma_f32_16x16x32_bf16 v[176:179], a[24:27], a[72:75], v[176:179]
    ds_read_b64_tr_b16 a[16:17], v26 offset:0
    v_mfma_f32_16x16x32_bf16 v[176:179], a[28:31], a[88:91], v[176:179]
    ds_read_b64_tr_b16 a[18:19], v26 offset:1024
    v_mfma_f32_16x16x32_bf16 v[180:183], a[24:27], a[76:79], v[180:183]
    ds_read_b64_tr_b16 a[20:21], v26 offset:8192
    v_mfma_f32_16x16x32_bf16 v[180:183], a[28:31], a[92:95], v[180:183]
    ds_read_b64_tr_b16 a[22:23], v26 offset:9216
    v_mfma_f32_16x16x32_bf16 v[184:187], a[24:27], a[80:83], v[184:187]
    v_mfma_f32_16x16x32_bf16 v[184:187], a[28:31], a[96:99], v[184:187]
    v_mfma_f32_16x16x32_bf16 v[188:191], a[24:27], a[84:87], v[188:191]
    v_mfma_f32_16x16x32_bf16 v[188:191], a[28:31], a[100:103], v[188:191]
    v_mfma_f32_16x16x32_bf16 v[192:195], a[32:35], a[72:75], v[192:195]
    ds_read_b64_tr_b16 a[24:25], v27 offset:0
    v_mfma_f32_16x16x32_bf16 v[192:195], a[36:39], a[88:91], v[192:195]
    ds_read_b64_tr_b16 a[26:27], v27 offset:1024
    v_mfma_f32_16x16x32_bf16 v[196:199], a[32:35], a[76:79], v[196:199]
    ds_read_b64_tr_b16 a[28:29], v27 offset:8192
    v_mfma_f32_16x16x32_bf16 v[196:199], a[36:39], a[92:95], v[196:199]
    ds_read_b64_tr_b16 a[30:31], v27 offset:9216
    v_mfma_f32_16x16x32_bf16 v[200:203], a[32:35], a[80:83], v[200:203]
    v_mfma_f32_16x16x32_bf16 v[200:203], a[36:39], a[96:99], v[200:203]
    v_mfma_f32_16x16x32_bf16 v[204:207], a[32:35], a[84:87], v[204:207]
    v_mfma_f32_16x16x32_bf16 v[204:207], a[36:39], a[100:103], v[204:207]
    v_mfma_f32_16x16x32_bf16 v[208:211], a[40:43], a[72:75], v[208:211]
    ds_read_b64_tr_b16 a[32:33], v28 offset:0
    v_mfma_f32_16x16x32_bf16 v[208:211], a[44:47], a[88:91], v[208:211]
    ds_read_b64_tr_b16 a[34:35], v28 offset:1024
    v_mfma_f32_16x16x32_bf16 v[212:215], a[40:43], a[76:79], v[212:215]
    ds_read_b64_tr_b16 a[36:37], v28 offset:8192
    v_mfma_f32_16x16x32_bf16 v[212:215], a[44:47], a[92:95], v[212:215]
    ds_read_b64_tr_b16 a[38:39], v28 offset:9216
    v_mfma_f32_16x16x32_bf16 v[216:219], a[40:43], a[80:83], v[216:219]
    v_mfma_f32_16x16x32_bf16 v[216:219], a[44:47], a[96:99], v[216:219]
    v_mfma_f32_16x16x32_bf16 v[220:223], a[40:43], a[84:87], v[220:223]
    v_mfma_f32_16x16x32_bf16 v[220:223], a[44:47], a[100:103], v[220:223]
    v_mfma_f32_16x16x32_bf16 v[224:227], a[48:51], a[72:75], v[224:227]
    ds_read_b64_tr_b16 a[40:41], v29 offset:0
    v_mfma_f32_16x16x32_bf16 v[224:227], a[52:55], a[88:91], v[224:227]
    ds_read_b64_tr_b16 a[42:43], v29 offset:1024
    v_mfma_f32_16x16x32_bf16 v[228:231], a[48:51], a[76:79], v[228:231]
    ds_read_b64_tr_b16 a[44:45], v29 offset:8192
    v_mfma_f32_16x16x32_bf16 v[228:231], a[52:55], a[92:95], v[228:231]
    ds_read_b64_tr_b16 a[46:47], v29 offset:9216
    v_mfma_f32_16x16x32_bf16 v[232:235], a[48:51], a[80:83], v[232:235]
    v_mfma_f32_16x16x32_bf16 v[232:235], a[52:55], a[96:99], v[232:235]
    v_mfma_f32_16x16x32_bf16 v[236:239], a[48:51], a[84:87], v[236:239]
    v_mfma_f32_16x16x32_bf16 v[236:239], a[52:55], a[100:103], v[236:239]
    v_mfma_f32_16x16x32_bf16 v[240:243], a[56:59], a[72:75], v[240:243]
    ds_read_b64_tr_b16 a[48:49], v30 offset:0
    v_mfma_f32_16x16x32_bf16 v[240:243], a[60:63], a[88:91], v[240:243]
    ds_read_b64_tr_b16 a[50:51], v30 offset:1024
    v_mfma_f32_16x16x32_bf16 v[244:247], a[56:59], a[76:79], v[244:247]
    ds_read_b64_tr_b16 a[52:53], v30 offset:8192
    v_mfma_f32_16x16x32_bf16 v[244:247], a[60:63], a[92:95], v[244:247]
    ds_read_b64_tr_b16 a[54:55], v30 offset:9216
    v_mfma_f32_16x16x32_bf16 v[248:251], a[56:59], a[80:83], v[248:251]
    v_mfma_f32_16x16x32_bf16 v[248:251], a[60:63], a[96:99], v[248:251]
    v_mfma_f32_16x16x32_bf16 v[252:255], a[56:59], a[84:87], v[252:255]
    v_mfma_f32_16x16x32_bf16 v[252:255], a[60:63], a[100:103], v[252:255]
    s_waitcnt vmcnt(12) lgkmcnt(0)
    s_barrier
    s_lshl_b32 s83, s79, 8
    s_add_u32 s83, s83, 35659776
    s_cmp_eq_u32 s76, 0
    s_cselect_b32 s83, s83, 0x40000000
    v_mov_b32 v7, 1
    s_mov_b64 exec, 1
    buffer_atomic_add v7, off, s[72:75], s83
    s_mov_b64 exec, -1
    v_mfma_f32_16x16x32_bf16 v[128:131], a[0:3], a[104:107], v[128:131]
    v_mfma_f32_16x16x32_bf16 v[128:131], a[4:7], a[120:123], v[128:131]
    s_add_u32 m0, s90, 0
    s_mov_b32 s85, 16384
    v_mfma_f32_16x16x32_bf16 v[132:135], a[0:3], a[108:111], v[132:135]
    v_mfma_f32_16x16x32_bf16 v[132:135], a[4:7], a[124:127], v[132:135]
    v_mfma_f32_16x16x32_bf16 v[136:139], a[0:3], a[112:115], v[136:139]
    v_mfma_f32_16x16x32_bf16 v[136:139], a[4:7], a[128:131], v[136:139]
    v_mfma_f32_16x16x32_bf16 v[140:143], a[0:3], a[116:119], v[140:143]
    v_mfma_f32_16x16x32_bf16 v[140:143], a[4:7], a[132:135], v[140:143]
    buffer_load_dwordx4 v52, s[36:39], s85 offen offset:0 nt lds
    v_mfma_f32_16x16x32_bf16 v[40:43], a[0:3], v[48:51], v[40:43]
    v_mfma_f32_16x16x32_bf16 v[40:43], a[4:7], v[48:51], v[40:43]
    v_mfma_f32_16x16x32_bf16 v[144:147], a[8:11], a[104:107], v[144:147]
    v_mfma_f32_16x16x32_bf16 v[144:147], a[12:15], a[120:123], v[144:147]
    v_mfma_f32_16x16x32_bf16 v[148:151], a[8:11], a[108:111], v[148:151]
    v_mfma_f32_16x16x32_bf16 v[148:151], a[12:15], a[124:127], v[148:151]
    v_mfma_f32_16x16x32_bf16 v[152:155], a[8:11], a[112:115], v[152:155]
    buffer_load_dwordx4 v53, s[36:39], s85 offen offset:1024 nt lds
    v_mfma_f32_16x16x32_bf16 v[152:155], a[12:15], a[128:131], v[152:155]
    v_mfma_f32_16x16x32_bf16 v[156:159], a[8:11], a[116:119], v[156:159]
    v_mfma_f32_16x16x32_bf16 v[156:159], a[12:15], a[132:135], v[156:159]
    v_mfma_f32_16x16x32_bf16 v[44:47], a[8:11], v[48:51], v[44:47]
    v_mfma_f32_16x16x32_bf16 v[44:47], a[12:15], v[48:51], v[44:47]
    v_mfma_f32_16x16x32_bf16 v[160:163], a[16:19], a[104:107], v[160:163]
    buffer_load_dwordx4 v54, s[36:39], s85 offen offset:2048 nt lds
    v_mfma_f32_16x16x32_bf16 v[160:163], a[20:23], a[120:123], v[160:163]
    v_mfma_f32_16x16x32_bf16 v[164:167], a[16:19], a[108:111], v[164:167]
    v_mfma_f32_16x16x32_bf16 v[164:167], a[20:23], a[124:127], v[164:167]
    v_mfma_f32_16x16x32_bf16 v[168:171], a[16:19], a[112:115], v[168:171]
    v_mfma_f32_16x16x32_bf16 v[168:171], a[20:23], a[128:131], v[168:171]
    v_mfma_f32_16x16x32_bf16 v[172:175], a[16:19], a[116:119], v[172:175]
    v_mfma_f32_16x16x32_bf16 v[172:175], a[20:23], a[132:135], v[172:175]
    buffer_load_dwordx4 v55, s[36:39], s85 offen offset:3072 nt lds
    v_mfma_f32_16x16x32_bf16 v[176:179], a[24:27], a[104:107], v[176:179]
    v_mfma_f32_16x16x32_bf16 v[176:179], a[28:31], a[120:123], v[176:179]
    v_mfma_f32_16x16x32_bf16 v[180:183], a[24:27], a[108:111], v[180:183]
    v_mfma_f32_16x16x32_bf16 v[180:183], a[28:31], a[124:127], v[180:183]
    v_mfma_f32_16x16x32_bf16 v[184:187], a[24:27], a[112:115], v[184:187]
    v_mfma_f32_16x16x32_bf16 v[184:187], a[28:31], a[128:131], v[184:187]
    s_add_u32 m0, s90, 16384
    s_mov_b32 s85, 32768
    v_mfma_f32_16x16x32_bf16 v[188:191], a[24:27], a[116:119], v[188:191]
    v_mfma_f32_16x16x32_bf16 v[188:191], a[28:31], a[132:135], v[188:191]
    v_mfma_f32_16x16x32_bf16 v[192:195], a[32:35], a[104:107], v[192:195]
    v_mfma_f32_16x16x32_bf16 v[192:195], a[36:39], a[120:123], v[192:195]
    v_mfma_f32_16x16x32_bf16 v[196:199], a[32:35], a[108:111], v[196:199]
    v_mfma_f32_16x16x32_bf16 v[196:199], a[36:39], a[124:127], v[196:199]
    v_mfma_f32_16x16x32_bf16 v[200:203], a[32:35], a[112:115], v[200:203]
    buffer_load_dwordx4 v52, s[36:39], s85 offen offset:0 nt lds
    v_mfma_f32_16x16x32_bf16 v[200:203], a[36:39], a[128:131], v[200:203]
    v_mfma_f32_16x16x32_bf16 v[204:207], a[32:35], a[116:119], v[204:207]
    v_mfma_f32_16x16x32_bf16 v[204:207], a[36:39], a[132:135], v[204:207]
    v_mfma_f32_16x16x32_bf16 v[208:211], a[40:43], a[104:107], v[208:211]
    v_mfma_f32_16x16x32_bf16 v[208:211], a[44:47], a[120:123], v[208:211]
    v_mfma_f32_16x16x32_bf16 v[212:215], a[40:43], a[108:111], v[212:215]
    buffer_load_dwordx4 v53, s[36:39], s85 offen offset:1024 nt lds
    v_mfma_f32_16x16x32_bf16 v[212:215], a[44:47], a[124:127], v[212:215]
    v_mfma_f32_16x16x32_bf16 v[216:219], a[40:43], a[112:115], v[216:219]
    v_mfma_f32_16x16x32_bf16 v[216:219], a[44:47], a[128:131], v[216:219]
    v_mfma_f32_16x16x32_bf16 v[220:223], a[40:43], a[116:119], v[220:223]
    v_mfma_f32_16x16x32_bf16 v[220:223], a[44:47], a[132:135], v[220:223]
    v_mfma_f32_16x16x32_bf16 v[224:227], a[48:51], a[104:107], v[224:227]
    v_mfma_f32_16x16x32_bf16 v[224:227], a[52:55], a[120:123], v[224:227]
    buffer_load_dwordx4 v54, s[36:39], s85 offen offset:2048 nt lds
    v_mfma_f32_16x16x32_bf16 v[228:231], a[48:51], a[108:111], v[228:231]
    v_mfma_f32_16x16x32_bf16 v[228:231], a[52:55], a[124:127], v[228:231]
    v_mfma_f32_16x16x32_bf16 v[232:235], a[48:51], a[112:115], v[232:235]
    v_mfma_f32_16x16x32_bf16 v[232:235], a[52:55], a[128:131], v[232:235]
    v_mfma_f32_16x16x32_bf16 v[236:239], a[48:51], a[116:119], v[236:239]
    v_mfma_f32_16x16x32_bf16 v[236:239], a[52:55], a[132:135], v[236:239]
    buffer_load_dwordx4 v55, s[36:39], s85 offen offset:3072 nt lds
    v_mfma_f32_16x16x32_bf16 v[240:243], a[64:67], a[104:107], v[240:243]
    v_mfma_f32_16x16x32_bf16 v[240:243], a[68:71], a[120:123], v[240:243]
    v_mfma_f32_16x16x32_bf16 v[244:247], a[64:67], a[108:111], v[244:247]
    v_mfma_f32_16x16x32_bf16 v[244:247], a[68:71], a[124:127], v[244:247]
    v_mfma_f32_16x16x32_bf16 v[248:251], a[64:67], a[112:115], v[248:251]
    v_mfma_f32_16x16x32_bf16 v[248:251], a[68:71], a[128:131], v[248:251]
    v_mfma_f32_16x16x32_bf16 v[252:255], a[64:67], a[116:119], v[252:255]
    v_mfma_f32_16x16x32_bf16 v[252:255], a[68:71], a[132:135], v[252:255]
    s_lshl_b32 s81, s76, 7
    v_lshlrev_b32 v6, 4, v3
    v_add_u32 v6, s81, v6
    v_add_u32 v6, 157696, v6
    s_mov_b32 exec_lo, 0x00010001
    s_mov_b32 exec_hi, 0x00010001
    ds_write_b128 v6, v[40:43]
    ds_write_b128 v6, v[44:47] offset:64
    s_mov_b64 exec, -1
    s_waitcnt lgkmcnt(0)
    s_barrier
    v_xor_b32 v7, 0, v6
    ds_read_b128 v[16:19], v7
    v_xor_b32 v7, 64, v6
    ds_read_b128 v[20:23], v7
    v_xor_b32 v7, 128, v6
    ds_read_b128 v[24:27], v7
    v_xor_b32 v7, 192, v6
    ds_read_b128 v[28:31], v7
    v_xor_b32 v7, 256, v6
    ds_read_b128 v[32:35], v7
    v_xor_b32 v7, 320, v6
    ds_read_b128 v[36:39], v7
    v_xor_b32 v7, 384, v6
    ds_read_b128 v[40:43], v7
    v_xor_b32 v7, 448, v6
    ds_read_b128 v[44:47], v7
    s_waitcnt vmcnt(21)
    v_mul_f32 v9, 0x3e0293ee, v9
    v_mul_f32 v11, 0x3e0293ee, v11
    v_mul_f32 v13, 0x3e0293ee, v13
    v_mul_f32 v15, 0x3e0293ee, v15
    s_waitcnt lgkmcnt(0)
    v_pk_fma_f32 v[128:129], v[16:17], v[8:9], v[128:129] op_sel_hi:[1,0,1] neg_lo:[1,0,0] neg_hi:[1,0,0]
    v_pk_fma_f32 v[130:131], v[18:19], v[8:9], v[130:131] op_sel_hi:[1,0,1] neg_lo:[1,0,0] neg_hi:[1,0,0]
    v_pk_mul_f32 v[128:129], v[128:129], v[8:9] op_sel:[0,1] op_sel_hi:[1,1]
    v_pk_mul_f32 v[130:131], v[130:131], v[8:9] op_sel:[0,1] op_sel_hi:[1,1]
    v_pk_fma_f32 v[144:145], v[20:21], v[8:9], v[144:145] op_sel_hi:[1,0,1] neg_lo:[1,0,0] neg_hi:[1,0,0]
    v_pk_fma_f32 v[146:147], v[22:23], v[8:9], v[146:147] op_sel_hi:[1,0,1] neg_lo:[1,0,0] neg_hi:[1,0,0]
    v_pk_mul_f32 v[144:145], v[144:145], v[8:9] op_sel:[0,1] op_sel_hi:[1,1]
    v_pk_mul_f32 v[146:147], v[146:147], v[8:9] op_sel:[0,1] op_sel_hi:[1,1]
    v_cvt_pk_bf16_f32 v64, v128, v129
    v_cvt_pk_bf16_f32 v65, v130, v131
    v_cvt_pk_bf16_f32 v66, v144, v145
    v_cvt_pk_bf16_f32 v67, v146, v147
    v_pk_fma_f32 v[160:161], v[24:25], v[8:9], v[160:161] op_sel_hi:[1,0,1] neg_lo:[1,0,0] neg_hi:[1,0,0]
    v_pk_fma_f32 v[162:163], v[26:27], v[8:9], v[162:163] op_sel_hi:[1,0,1] neg_lo:[1,0,0] neg_hi:[1,0,0]
    v_pk_mul_f32 v[160:161], v[160:161], v[8:9] op_sel:[0,1] op_sel_hi:[1,1]
    v_pk_mul_f32 v[162:163], v[162:163], v[8:9] op_sel:[0,1] op_sel_hi:[1,1]
    v_pk_fma_f32 v[176:177], v[28:29], v[8:9], v[176:177] op_sel_hi:[1,0,1] neg_lo:[1,0,0] neg_hi:[1,0,0]
    v_pk_fma_f32 v[178:179], v[30:31], v[8:9], v[178:179] op_sel_hi:[1,0,1] neg_lo:[1,0,0] neg_hi:[1,0,0]
    v_pk_mul_f32 v[176:177], v[176:177], v[8:9] op_sel:[0,1] op_sel_hi:[1,1]
    v_pk_mul_f32 v[178:179], v[178:179], v[8:9] op_sel:[0,1] op_sel_hi:[1,1]
    v_cvt_pk_bf16_f32 v68, v160, v161
    v_cvt_pk_bf16_f32 v69, v162, v163
    v_cvt_pk_bf16_f32 v70, v176, v177
    v_cvt_pk_bf16_f32 v71, v178, v179
    v_pk_fma_f32 v[192:193], v[32:33], v[8:9], v[192:193] op_sel_hi:[1,0,1] neg_lo:[1,0,0] neg_hi:[1,0,0]
    v_pk_fma_f32 v[194:195], v[34:35], v[8:9], v[194:195] op_sel_hi:[1,0,1] neg_lo:[1,0,0] neg_hi:[1,0,0]
    v_pk_mul_f32 v[192:193], v[192:193], v[8:9] op_sel:[0,1] op_sel_hi:[1,1]
    v_pk_mul_f32 v[194:195], v[194:195], v[8:9] op_sel:[0,1] op_sel_hi:[1,1]
    v_pk_fma_f32 v[208:209], v[36:37], v[8:9], v[208:209] op_sel_hi:[1,0,1] neg_lo:[1,0,0] neg_hi:[1,0,0]
    v_pk_fma_f32 v[210:211], v[38:39], v[8:9], v[210:211] op_sel_hi:[1,0,1] neg_lo:[1,0,0] neg_hi:[1,0,0]
    v_pk_mul_f32 v[208:209], v[208:209], v[8:9] op_sel:[0,1] op_sel_hi:[1,1]
    v_pk_mul_f32 v[210:211], v[210:211], v[8:9] op_sel:[0,1] op_sel_hi:[1,1]
    v_cvt_pk_bf16_f32 v72, v192, v193
    v_cvt_pk_bf16_f32 v73, v194, v195
    v_cvt_pk_bf16_f32 v74, v208, v209
    v_cvt_pk_bf16_f32 v75, v210, v211
    v_pk_fma_f32 v[224:225], v[40:41], v[8:9], v[224:225] op_sel_hi:[1,0,1] neg_lo:[1,0,0] neg_hi:[1,0,0]
    v_pk_fma_f32 v[226:227], v[42:43], v[8:9], v[226:227] op_sel_hi:[1,0,1] neg_lo:[1,0,0] neg_hi:[1,0,0]
    v_pk_mul_f32 v[224:225], v[224:225], v[8:9] op_sel:[0,1] op_sel_hi:[1,1]
    v_pk_mul_f32 v[226:227], v[226:227], v[8:9] op_sel:[0,1] op_sel_hi:[1,1]
    v_pk_fma_f32 v[240:241], v[44:45], v[8:9], v[240:241] op_sel_hi:[1,0,1] neg_lo:[1,0,0] neg_hi:[1,0,0]
    v_pk_fma_f32 v[242:243], v[46:47], v[8:9], v[242:243] op_sel_hi:[1,0,1] neg_lo:[1,0,0] neg_hi:[1,0,0]
    v_pk_mul_f32 v[240:241], v[240:241], v[8:9] op_sel:[0,1] op_sel_hi:[1,1]
    v_pk_mul_f32 v[242:243], v[242:243], v[8:9] op_sel:[0,1] op_sel_hi:[1,1]
    v_cvt_pk_bf16_f32 v76, v224, v225
    v_cvt_pk_bf16_f32 v77, v226, v227
    v_cvt_pk_bf16_f32 v78, v240, v241
    v_cvt_pk_bf16_f32 v79, v242, v243
    v_pk_fma_f32 v[132:133], v[16:17], v[10:11], v[132:133] op_sel_hi:[1,0,1] neg_lo:[1,0,0] neg_hi:[1,0,0]
    v_pk_fma_f32 v[134:135], v[18:19], v[10:11], v[134:135] op_sel_hi:[1,0,1] neg_lo:[1,0,0] neg_hi:[1,0,0]
    v_pk_mul_f32 v[132:133], v[132:133], v[10:11] op_sel:[0,1] op_sel_hi:[1,1]
    v_pk_mul_f32 v[134:135], v[134:135], v[10:11] op_sel:[0,1] op_sel_hi:[1,1]
    v_pk_fma_f32 v[148:149], v[20:21], v[10:11], v[148:149] op_sel_hi:[1,0,1] neg_lo:[1,0,0] neg_hi:[1,0,0]
    v_pk_fma_f32 v[150:151], v[22:23], v[10:11], v[150:151] op_sel_hi:[1,0,1] neg_lo:[1,0,0] neg_hi:[1,0,0]
    v_pk_mul_f32 v[148:149], v[148:149], v[10:11] op_sel:[0,1] op_sel_hi:[1,1]
    v_pk_mul_f32 v[150:151], v[150:151], v[10:11] op_sel:[0,1] op_sel_hi:[1,1]
    v_cvt_pk_bf16_f32 v80, v132, v133
    v_cvt_pk_bf16_f32 v81, v134, v135
    v_cvt_pk_bf16_f32 v82, v148, v149
    v_cvt_pk_bf16_f32 v83, v150, v151
    v_pk_fma_f32 v[164:165], v[24:25], v[10:11], v[164:165] op_sel_hi:[1,0,1] neg_lo:[1,0,0] neg_hi:[1,0,0]
    v_pk_fma_f32 v[166:167], v[26:27], v[10:11], v[166:167] op_sel_hi:[1,0,1] neg_lo:[1,0,0] neg_hi:[1,0,0]
    v_pk_mul_f32 v[164:165], v[164:165], v[10:11] op_sel:[0,1] op_sel_hi:[1,1]
    v_pk_mul_f32 v[166:167], v[166:167], v[10:11] op_sel:[0,1] op_sel_hi:[1,1]
    v_pk_fma_f32 v[180:181], v[28:29], v[10:11], v[180:181] op_sel_hi:[1,0,1] neg_lo:[1,0,0] neg_hi:[1,0,0]
    v_pk_fma_f32 v[182:183], v[30:31], v[10:11], v[182:183] op_sel_hi:[1,0,1] neg_lo:[1,0,0] neg_hi:[1,0,0]
    v_pk_mul_f32 v[180:181], v[180:181], v[10:11] op_sel:[0,1] op_sel_hi:[1,1]
    v_pk_mul_f32 v[182:183], v[182:183], v[10:11] op_sel:[0,1] op_sel_hi:[1,1]
    v_cvt_pk_bf16_f32 v84, v164, v165
    v_cvt_pk_bf16_f32 v85, v166, v167
    v_cvt_pk_bf16_f32 v86, v180, v181
    v_cvt_pk_bf16_f32 v87, v182, v183
    v_pk_fma_f32 v[196:197], v[32:33], v[10:11], v[196:197] op_sel_hi:[1,0,1] neg_lo:[1,0,0] neg_hi:[1,0,0]
    v_pk_fma_f32 v[198:199], v[34:35], v[10:11], v[198:199] op_sel_hi:[1,0,1] neg_lo:[1,0,0] neg_hi:[1,0,0]
    v_pk_mul_f32 v[196:197], v[196:197], v[10:11] op_sel:[0,1] op_sel_hi:[1,1]
    v_pk_mul_f32 v[198:199], v[198:199], v[10:11] op_sel:[0,1] op_sel_hi:[1,1]
    v_pk_fma_f32 v[212:213], v[36:37], v[10:11], v[212:213] op_sel_hi:[1,0,1] neg_lo:[1,0,0] neg_hi:[1,0,0]
    v_pk_fma_f32 v[214:215], v[38:39], v[10:11], v[214:215] op_sel_hi:[1,0,1] neg_lo:[1,0,0] neg_hi:[1,0,0]
    v_pk_mul_f32 v[212:213], v[212:213], v[10:11] op_sel:[0,1] op_sel_hi:[1,1]
    v_pk_mul_f32 v[214:215], v[214:215], v[10:11] op_sel:[0,1] op_sel_hi:[1,1]
    v_cvt_pk_bf16_f32 v88, v196, v197
    v_cvt_pk_bf16_f32 v89, v198, v199
    v_cvt_pk_bf16_f32 v90, v212, v213
    v_cvt_pk_bf16_f32 v91, v214, v215
    v_pk_fma_f32 v[228:229], v[40:41], v[10:11], v[228:229] op_sel_hi:[1,0,1] neg_lo:[1,0,0] neg_hi:[1,0,0]
    v_pk_fma_f32 v[230:231], v[42:43], v[10:11], v[230:231] op_sel_hi:[1,0,1] neg_lo:[1,0,0] neg_hi:[1,0,0]
    v_pk_mul_f32 v[228:229], v[228:229], v[10:11] op_sel:[0,1] op_sel_hi:[1,1]
    v_pk_mul_f32 v[230:231], v[230:231], v[10:11] op_sel:[0,1] op_sel_hi:[1,1]
    v_pk_fma_f32 v[244:245], v[44:45], v[10:11], v[244:245] op_sel_hi:[1,0,1] neg_lo:[1,0,0] neg_hi:[1,0,0]
    v_pk_fma_f32 v[246:247], v[46:47], v[10:11], v[246:247] op_sel_hi:[1,0,1] neg_lo:[1,0,0] neg_hi:[1,0,0]
    v_pk_mul_f32 v[244:245], v[244:245], v[10:11] op_sel:[0,1] op_sel_hi:[1,1]
    v_pk_mul_f32 v[246:247], v[246:247], v[10:11] op_sel:[0,1] op_sel_hi:[1,1]
    v_cvt_pk_bf16_f32 v92, v228, v229
    v_cvt_pk_bf16_f32 v93, v230, v231
    v_cvt_pk_bf16_f32 v94, v244, v245
    v_cvt_pk_bf16_f32 v95, v246, v247
    v_pk_fma_f32 v[136:137], v[16:17], v[12:13], v[136:137] op_sel_hi:[1,0,1] neg_lo:[1,0,0] neg_hi:[1,0,0]
    v_pk_fma_f32 v[138:139], v[18:19], v[12:13], v[138:139] op_sel_hi:[1,0,1] neg_lo:[1,0,0] neg_hi:[1,0,0]
    v_pk_mul_f32 v[136:137], v[136:137], v[12:13] op_sel:[0,1] op_sel_hi:[1,1]
    v_pk_mul_f32 v[138:139], v[138:139], v[12:13] op_sel:[0,1] op_sel_hi:[1,1]
    v_pk_fma_f32 v[152:153], v[20:21], v[12:13], v[152:153] op_sel_hi:[1,0,1] neg_lo:[1,0,0] neg_hi:[1,0,0]
    v_pk_fma_f32 v[154:155], v[22:23], v[12:13], v[154:155] op_sel_hi:[1,0,1] neg_lo:[1,0,0] neg_hi:[1,0,0]
    v_pk_mul_f32 v[152:153], v[152:153], v[12:13] op_sel:[0,1] op_sel_hi:[1,1]
    v_pk_mul_f32 v[154:155], v[154:155], v[12:13] op_sel:[0,1] op_sel_hi:[1,1]
    v_cvt_pk_bf16_f32 v96, v136, v137
    v_cvt_pk_bf16_f32 v97, v138, v139
    v_cvt_pk_bf16_f32 v98, v152, v153
    v_cvt_pk_bf16_f32 v99, v154, v155
    v_pk_fma_f32 v[168:169], v[24:25], v[12:13], v[168:169] op_sel_hi:[1,0,1] neg_lo:[1,0,0] neg_hi:[1,0,0]
    v_pk_fma_f32 v[170:171], v[26:27], v[12:13], v[170:171] op_sel_hi:[1,0,1] neg_lo:[1,0,0] neg_hi:[1,0,0]
    v_pk_mul_f32 v[168:169], v[168:169], v[12:13] op_sel:[0,1] op_sel_hi:[1,1]
    v_pk_mul_f32 v[170:171], v[170:171], v[12:13] op_sel:[0,1] op_sel_hi:[1,1]
    v_pk_fma_f32 v[184:185], v[28:29], v[12:13], v[184:185] op_sel_hi:[1,0,1] neg_lo:[1,0,0] neg_hi:[1,0,0]
    v_pk_fma_f32 v[186:187], v[30:31], v[12:13], v[186:187] op_sel_hi:[1,0,1] neg_lo:[1,0,0] neg_hi:[1,0,0]
    v_pk_mul_f32 v[184:185], v[184:185], v[12:13] op_sel:[0,1] op_sel_hi:[1,1]
    v_pk_mul_f32 v[186:187], v[186:187], v[12:13] op_sel:[0,1] op_sel_hi:[1,1]
    v_cvt_pk_bf16_f32 v100, v168, v169
    v_cvt_pk_bf16_f32 v101, v170, v171
    v_cvt_pk_bf16_f32 v102, v184, v185
    v_cvt_pk_bf16_f32 v103, v186, v187
    v_pk_fma_f32 v[200:201], v[32:33], v[12:13], v[200:201] op_sel_hi:[1,0,1] neg_lo:[1,0,0] neg_hi:[1,0,0]
    v_pk_fma_f32 v[202:203], v[34:35], v[12:13], v[202:203] op_sel_hi:[1,0,1] neg_lo:[1,0,0] neg_hi:[1,0,0]
    v_pk_mul_f32 v[200:201], v[200:201], v[12:13] op_sel:[0,1] op_sel_hi:[1,1]
    v_pk_mul_f32 v[202:203], v[202:203], v[12:13] op_sel:[0,1] op_sel_hi:[1,1]
    v_pk_fma_f32 v[216:217], v[36:37], v[12:13], v[216:217] op_sel_hi:[1,0,1] neg_lo:[1,0,0] neg_hi:[1,0,0]
    v_pk_fma_f32 v[218:219], v[38:39], v[12:13], v[218:219] op_sel_hi:[1,0,1] neg_lo:[1,0,0] neg_hi:[1,0,0]
    v_pk_mul_f32 v[216:217], v[216:217], v[12:13] op_sel:[0,1] op_sel_hi:[1,1]
    v_pk_mul_f32 v[218:219], v[218:219], v[12:13] op_sel:[0,1] op_sel_hi:[1,1]
    v_cvt_pk_bf16_f32 v104, v200, v201
    v_cvt_pk_bf16_f32 v105, v202, v203
    v_cvt_pk_bf16_f32 v106, v216, v217
    v_cvt_pk_bf16_f32 v107, v218, v219
    v_pk_fma_f32 v[232:233], v[40:41], v[12:13], v[232:233] op_sel_hi:[1,0,1] neg_lo:[1,0,0] neg_hi:[1,0,0]
    v_pk_fma_f32 v[234:235], v[42:43], v[12:13], v[234:235] op_sel_hi:[1,0,1] neg_lo:[1,0,0] neg_hi:[1,0,0]
    v_pk_mul_f32 v[232:233], v[232:233], v[12:13] op_sel:[0,1] op_sel_hi:[1,1]
    v_pk_mul_f32 v[234:235], v[234:235], v[12:13] op_sel:[0,1] op_sel_hi:[1,1]
    v_pk_fma_f32 v[248:249], v[44:45], v[12:13], v[248:249] op_sel_hi:[1,0,1] neg_lo:[1,0,0] neg_hi:[1,0,0]
    v_pk_fma_f32 v[250:251], v[46:47], v[12:13], v[250:251] op_sel_hi:[1,0,1] neg_lo:[1,0,0] neg_hi:[1,0,0]
    v_pk_mul_f32 v[248:249], v[248:249], v[12:13] op_sel:[0,1] op_sel_hi:[1,1]
    v_pk_mul_f32 v[250:251], v[250:251], v[12:13] op_sel:[0,1] op_sel_hi:[1,1]
    v_cvt_pk_bf16_f32 v108, v232, v233
    v_cvt_pk_bf16_f32 v109, v234, v235
    v_cvt_pk_bf16_f32 v110, v248, v249
    v_cvt_pk_bf16_f32 v111, v250, v251
    v_pk_fma_f32 v[140:141], v[16:17], v[14:15], v[140:141] op_sel_hi:[1,0,1] neg_lo:[1,0,0] neg_hi:[1,0,0]
    v_pk_fma_f32 v[142:143], v[18:19], v[14:15], v[142:143] op_sel_hi:[1,0,1] neg_lo:[1,0,0] neg_hi:[1,0,0]
    v_pk_mul_f32 v[140:141], v[140:141], v[14:15] op_sel:[0,1] op_sel_hi:[1,1]
    v_pk_mul_f32 v[142:143], v[142:143], v[14:15] op_sel:[0,1] op_sel_hi:[1,1]
    v_pk_fma_f32 v[156:157], v[20:21], v[14:15], v[156:157] op_sel_hi:[1,0,1] neg_lo:[1,0,0] neg_hi:[1,0,0]
    v_pk_fma_f32 v[158:159], v[22:23], v[14:15], v[158:159] op_sel_hi:[1,0,1] neg_lo:[1,0,0] neg_hi:[1,0,0]
    v_pk_mul_f32 v[156:157], v[156:157], v[14:15] op_sel:[0,1] op_sel_hi:[1,1]
    v_pk_mul_f32 v[158:159], v[158:159], v[14:15] op_sel:[0,1] op_sel_hi:[1,1]
    v_cvt_pk_bf16_f32 v112, v140, v141
    v_cvt_pk_bf16_f32 v113, v142, v143
    v_cvt_pk_bf16_f32 v114, v156, v157
    v_cvt_pk_bf16_f32 v115, v158, v159
    v_pk_fma_f32 v[172:173], v[24:25], v[14:15], v[172:173] op_sel_hi:[1,0,1] neg_lo:[1,0,0] neg_hi:[1,0,0]
    v_pk_fma_f32 v[174:175], v[26:27], v[14:15], v[174:175] op_sel_hi:[1,0,1] neg_lo:[1,0,0] neg_hi:[1,0,0]
    v_pk_mul_f32 v[172:173], v[172:173], v[14:15] op_sel:[0,1] op_sel_hi:[1,1]
    v_pk_mul_f32 v[174:175], v[174:175], v[14:15] op_sel:[0,1] op_sel_hi:[1,1]
    v_pk_fma_f32 v[188:189], v[28:29], v[14:15], v[188:189] op_sel_hi:[1,0,1] neg_lo:[1,0,0] neg_hi:[1,0,0]
    v_pk_fma_f32 v[190:191], v[30:31], v[14:15], v[190:191] op_sel_hi:[1,0,1] neg_lo:[1,0,0] neg_hi:[1,0,0]
    v_pk_mul_f32 v[188:189], v[188:189], v[14:15] op_sel:[0,1] op_sel_hi:[1,1]
    v_pk_mul_f32 v[190:191], v[190:191], v[14:15] op_sel:[0,1] op_sel_hi:[1,1]
    v_cvt_pk_bf16_f32 v116, v172, v173
    v_cvt_pk_bf16_f32 v117, v174, v175
    v_cvt_pk_bf16_f32 v118, v188, v189
    v_cvt_pk_bf16_f32 v119, v190, v191
    v_pk_fma_f32 v[204:205], v[32:33], v[14:15], v[204:205] op_sel_hi:[1,0,1] neg_lo:[1,0,0] neg_hi:[1,0,0]
    v_pk_fma_f32 v[206:207], v[34:35], v[14:15], v[206:207] op_sel_hi:[1,0,1] neg_lo:[1,0,0] neg_hi:[1,0,0]
    v_pk_mul_f32 v[204:205], v[204:205], v[14:15] op_sel:[0,1] op_sel_hi:[1,1]
    v_pk_mul_f32 v[206:207], v[206:207], v[14:15] op_sel:[0,1] op_sel_hi:[1,1]
    v_pk_fma_f32 v[220:221], v[36:37], v[14:15], v[220:221] op_sel_hi:[1,0,1] neg_lo:[1,0,0] neg_hi:[1,0,0]
    v_pk_fma_f32 v[222:223], v[38:39], v[14:15], v[222:223] op_sel_hi:[1,0,1] neg_lo:[1,0,0] neg_hi:[1,0,0]
    v_pk_mul_f32 v[220:221], v[220:221], v[14:15] op_sel:[0,1] op_sel_hi:[1,1]
    v_pk_mul_f32 v[222:223], v[222:223], v[14:15] op_sel:[0,1] op_sel_hi:[1,1]
    v_cvt_pk_bf16_f32 v120, v204, v205
    v_cvt_pk_bf16_f32 v121, v206, v207
    v_cvt_pk_bf16_f32 v122, v220, v221
    v_cvt_pk_bf16_f32 v123, v222, v223
    v_pk_fma_f32 v[236:237], v[40:41], v[14:15], v[236:237] op_sel_hi:[1,0,1] neg_lo:[1,0,0] neg_hi:[1,0,0]
    v_pk_fma_f32 v[238:239], v[42:43], v[14:15], v[238:239] op_sel_hi:[1,0,1] neg_lo:[1,0,0] neg_hi:[1,0,0]
    v_pk_mul_f32 v[236:237], v[236:237], v[14:15] op_sel:[0,1] op_sel_hi:[1,1]
    v_pk_mul_f32 v[238:239], v[238:239], v[14:15] op_sel:[0,1] op_sel_hi:[1,1]
    v_pk_fma_f32 v[252:253], v[44:45], v[14:15], v[252:253] op_sel_hi:[1,0,1] neg_lo:[1,0,0] neg_hi:[1,0,0]
    v_pk_fma_f32 v[254:255], v[46:47], v[14:15], v[254:255] op_sel_hi:[1,0,1] neg_lo:[1,0,0] neg_hi:[1,0,0]
    v_pk_mul_f32 v[252:253], v[252:253], v[14:15] op_sel:[0,1] op_sel_hi:[1,1]
    v_pk_mul_f32 v[254:255], v[254:255], v[14:15] op_sel:[0,1] op_sel_hi:[1,1]
    v_cvt_pk_bf16_f32 v124, v236, v237
    v_cvt_pk_bf16_f32 v125, v238, v239
    v_cvt_pk_bf16_f32 v126, v252, v253
    v_cvt_pk_bf16_f32 v127, v254, v255
    v_lshlrev_b32 v6, 8, v2
    v_xor_b32 v7, v2, v3
    s_lshl_b32 s81, s76, 2
    v_xor_b32 v7, s81, v7
    v_lshl_add_u32 v20, v7, 4, v6
    v_xor_b32 v21, 64, v20
    v_xor_b32 v22, 128, v20
    v_xor_b32 v23, 192, v20
    v_lshlrev_b32 v18, 2, v1
    v_add_u32 v18, 158272, v18
    v_mov_b32 v19, 0
    ds_write_b32 v18, v19
    v_mov_b32 v19, 1
    s_mov_b32 s98, 4
    s_waitcnt vmcnt(13) lgkmcnt(0)
    s_barrier
    ds_read_b128 a[160:163], v20 offset:49152
    ds_read_b128 a[164:167], v21 offset:49152
    ds_read_b128 a[168:171], v22 offset:49152
    ds_read_b128 a[172:175], v23 offset:49152
    ds_read_b128 a[176:179], v20 offset:53248
    ds_read_b128 a[180:183], v21 offset:53248
    ds_read_b128 a[184:187], v22 offset:53248
    ds_read_b128 a[188:191], v23 offset:53248
    s_add_u32 m0, s90, 32768
    s_mov_b32 s85, 49152
    buffer_load_dwordx4 v52, s[36:39], s85 offen offset:0 nt lds
    buffer_load_dwordx4 v53, s[36:39], s85 offen offset:1024 nt lds
    buffer_load_dwordx4 v54, s[36:39], s85 offen offset:2048 nt lds
    buffer_load_dwordx4 v55, s[36:39], s85 offen offset:3072 nt lds
    s_waitcnt lgkmcnt(0)
    v_mfma_f32_16x16x32_bf16 v[128:131], a[160:163], v[64:67], 0
    v_lshl_add_u32 v6, v3, 2, v4
    v_and_b32 v7, 7, v6
    v_lshlrev_b32 v6, 8, v6
    v_mfma_f32_16x16x32_bf16 v[128:131], a[164:167], v[68:71], v[128:131]
    v_lshl_add_u32 v6, v5, 3, v6
    v_add_u32 v6, 0x10000, v6
    v_mfma_f32_16x16x32_bf16 v[128:131], a[168:171], v[72:75], v[128:131]
    v_lshl_add_u32 v32, v7, 5, v6
    v_xor_b32 v33, 32, v32
    v_xor_b32 v34, 64, v32
    v_mfma_f32_16x16x32_bf16 v[128:131], a[172:175], v[76:79], v[128:131]
    v_xor_b32 v35, 96, v32
    v_xor_b32 v36, 128, v32
    v_mfma_f32_16x16x32_bf16 v[144:147], a[160:163], v[80:83], 0
    v_xor_b32 v37, 160, v32
    v_xor_b32 v38, 192, v32
    v_xor_b32 v39, 224, v32
    v_mfma_f32_16x16x32_bf16 v[144:147], a[164:167], v[84:87], v[144:147]
    v_mov_b32 v6, 0x3f803f80
    v_accvgpr_write_b32 a208, v6
    v_mfma_f32_16x16x32_bf16 v[144:147], a[168:171], v[88:91], v[144:147]
    v_accvgpr_write_b32 a209, v6
    v_accvgpr_write_b32 a210, v6
    v_mfma_f32_16x16x32_bf16 v[144:147], a[172:175], v[92:95], v[144:147]
    v_accvgpr_write_b32 a211, v6
    v_accvgpr_write_b32 a192, 0
    v_accvgpr_write_b32 a193, 0
    v_mfma_f32_16x16x32_bf16 v[160:163], a[160:163], v[96:99], 0
    v_accvgpr_write_b32 a194, 0
    v_accvgpr_write_b32 a195, 0
    v_mfma_f32_16x16x32_bf16 v[160:163], a[164:167], v[100:103], v[160:163]
    v_accvgpr_write_b32 a196, 0
    v_accvgpr_write_b32 a197, 0
    v_accvgpr_write_b32 a198, 0
    v_mfma_f32_16x16x32_bf16 v[160:163], a[168:171], v[104:107], v[160:163]
    v_accvgpr_write_b32 a199, 0
    v_accvgpr_write_b32 a200, 0
    v_mfma_f32_16x16x32_bf16 v[160:163], a[172:175], v[108:111], v[160:163]
    v_accvgpr_write_b32 a201, 0
    v_accvgpr_write_b32 a202, 0
    v_mfma_f32_16x16x32_bf16 v[176:179], a[160:163], v[112:115], 0
    v_accvgpr_write_b32 a203, 0
    v_accvgpr_write_b32 a204, 0
    v_accvgpr_write_b32 a205, 0
    v_mfma_f32_16x16x32_bf16 v[176:179], a[164:167], v[116:119], v[176:179]
    v_accvgpr_write_b32 a206, 0
    v_accvgpr_write_b32 a207, 0
    v_mfma_f32_16x16x32_bf16 v[176:179], a[168:171], v[120:123], v[176:179]
    s_lshl_b32 s81, s2, 2
    s_add_u32 s81, s81, s76
    s_mul_i32 s81, s81, 56
    v_mfma_f32_16x16x32_bf16 v[176:179], a[172:175], v[124:127], v[176:179]
    v_lshrrev_b32 v6, 3, v1
    v_add_u32 v6, s81, v6
    v_mfma_f32_16x16x32_bf16 v[132:135], a[176:179], v[64:67], 0
    ds_read_b128 a[160:163], v20 offset:57344
    v_lshlrev_b32 v16, 7, v6
    s_mov_b32 s3, 0
    v_mfma_f32_16x16x32_bf16 v[132:135], a[180:183], v[68:71], v[132:135]
    ds_read_b128 a[164:167], v21 offset:57344
    v_lshlrev_b32 v50, 4, v1
    s_lshr_b32 s81, s76, 1
    s_lshl_b32 s81, s81, 12
    v_mfma_f32_16x16x32_bf16 v[132:135], a[184:187], v[72:75], v[132:135]
    ds_read_b128 a[168:171], v22 offset:57344
    v_add_u32 v45, s81, v50
    v_lshl_add_u32 v6, v3, 2, v4
    v_mfma_f32_16x16x32_bf16 v[132:135], a[188:191], v[76:79], v[132:135]
    ds_read_b128 a[172:175], v23 offset:57344
    v_and_b32 v7, 7, v6
    v_lshlrev_b32 v6, 8, v6
    v_lshl_add_u32 v6, v5, 3, v6
    v_mfma_f32_16x16x32_bf16 v[148:151], a[176:179], v[80:83], 0
    v_add_u32 v6, 0x10000, v6
    s_and_b32 s81, s76, 1
    v_mfma_f32_16x16x32_bf16 v[148:151], a[180:183], v[84:87], v[148:151]
    s_lshl_b32 s81, s81, 2
    v_xor_b32 v7, s81, v7
    v_mfma_f32_16x16x32_bf16 v[148:151], a[184:187], v[88:91], v[148:151]
    v_lshl_add_u32 v46, v7, 5, v6
    v_xor_b32 v47, 32, v46
    v_xor_b32 v48, 64, v46
    v_mfma_f32_16x16x32_bf16 v[148:151], a[188:191], v[92:95], v[148:151]
    v_xor_b32 v49, 96, v46
    v_mov_b32 v61, 158224
    v_mfma_f32_16x16x32_bf16 v[164:167], a[176:179], v[96:99], 0
    s_and_b32 s81, s76, 1
    s_lshl_b32 s81, s81, 7
    v_lshlrev_b32 v6, 3, v3
    v_mfma_f32_16x16x32_bf16 v[164:167], a[180:183], v[100:103], v[164:167]
    v_add_u32 v51, s81, v6
    s_lshr_b32 s81, s28, 1
    v_mfma_f32_16x16x32_bf16 v[164:167], a[184:187], v[104:107], v[164:167]
    s_add_u32 s81, s81, 16
    v_mov_b32 v59, s81
    v_mfma_f32_16x16x32_bf16 v[164:167], a[188:191], v[108:111], v[164:167]
    v_cmp_gt_u32 vcc, 13, v1
    s_nop 1
    v_cndmask_b32 v59, v59, v1, vcc
    v_mfma_f32_16x16x32_bf16 v[180:183], a[176:179], v[112:115], 0
    v_add_u32 v7, 18, v1
    v_cmp_lt_u32 vcc, 13, v1
    v_mfma_f32_16x16x32_bf16 v[180:183], a[180:183], v[116:119], v[180:183]
    s_nop 1
    v_cndmask_b32 v59, v59, v7, vcc
    v_lshlrev_b32 v59, 8, v59
    v_mfma_f32_16x16x32_bf16 v[180:183], a[184:187], v[120:123], v[180:183]
    v_add_u32 v59, 35651584, v59
    s_or_b32 s81, s80, s76
    v_mfma_f32_16x16x32_bf16 v[180:183], a[188:191], v[124:127], v[180:183]
    s_cmp_eq_u32 s81, 0
    s_cselect_b32 s99, 2, -1
    ds_read_b128 a[176:179], v20 offset:61440
    ds_read_b128 a[180:183], v21 offset:61440
    ds_read_b128 a[184:187], v22 offset:61440
    ds_read_b128 a[188:191], v23 offset:61440
    v_max3_f32 v8, v128, v129, v130
    v_max3_f32 v9, v131, v132, v133
    v_max3_f32 v8, v8, v134, v135
    v_max_f32 v8, v8, v9
    v_mov_b32 v9, v8
    v_max3_f32 v12, v144, v145, v146
    v_max3_f32 v13, v147, v148, v149
    v_max3_f32 v12, v12, v150, v151
    v_max_f32 v12, v12, v13
    v_mov_b32 v13, v12
    v_max3_f32 v24, v160, v161, v162
    v_max3_f32 v25, v163, v164, v165
    v_max3_f32 v24, v24, v166, v167
    v_max_f32 v24, v24, v25
    v_mov_b32 v25, v24
    v_max3_f32 v28, v176, v177, v178
    v_max3_f32 v29, v179, v180, v181
    v_max3_f32 v28, v28, v182, v183
    v_max_f32 v28, v28, v29
    v_mov_b32 v29, v28
    v_permlane16_swap_b32 v8, v9
    v_permlane16_swap_b32 v12, v13
    v_permlane16_swap_b32 v24, v25
    v_permlane16_swap_b32 v28, v29
    v_max_f32 v8, v8, v9
    v_mov_b32 v9, v8
    v_max_f32 v12, v12, v13
    v_mov_b32 v13, v12
    v_max_f32 v24, v24, v25
    v_mov_b32 v25, v24
    v_max_f32 v28, v28, v29
    v_mov_b32 v29, v28
    v_permlane32_swap_b32 v8, v9
    v_permlane32_swap_b32 v12, v13
    v_permlane32_swap_b32 v24, v25
    v_permlane32_swap_b32 v28, v29
    v_max_f32 v8, v8, v9
    v_mov_b32 v9, v8
    v_max_f32 v12, v12, v13
    v_mov_b32 v13, v12
    v_max_f32 v24, v24, v25
    v_mov_b32 v25, v24
    v_max_f32 v28, v28, v29
    v_mov_b32 v29, v28
    v_sub_f32 v8, 0, v8
    v_mov_b32 v9, v8
    v_mov_b32 v10, v8
    v_mov_b32 v11, v8
    v_sub_f32 v12, 0, v12
    v_mov_b32 v13, v12
    v_mov_b32 v14, v12
    v_mov_b32 v15, v12
    v_sub_f32 v24, 0, v24
    v_mov_b32 v25, v24
    v_mov_b32 v26, v24
    v_mov_b32 v27, v24
    v_sub_f32 v28, 0, v28
    v_mov_b32 v29, v28
    v_mov_b32 v30, v28
    v_mov_b32 v31, v28
    s_waitcnt vmcnt(8) lgkmcnt(0)
    s_barrier
    v_mfma_f32_16x16x32_bf16 v[136:139], a[160:163], v[64:67], v[8:11]
    v_add_f32 v128, v128, v8
    v_add_f32 v129, v129, v8
    v_mfma_f32_16x16x32_bf16 v[136:139], a[164:167], v[68:71], v[136:139]
    v_add_f32 v130, v130, v8
    v_add_f32 v131, v131, v8
    v_mfma_f32_16x16x32_bf16 v[136:139], a[168:171], v[72:75], v[136:139]
    v_add_f32 v132, v132, v8
    v_add_f32 v133, v133, v8
    v_mfma_f32_16x16x32_bf16 v[136:139], a[172:175], v[76:79], v[136:139]
    v_add_f32 v134, v134, v8
    v_add_f32 v135, v135, v8
    v_mfma_f32_16x16x32_bf16 v[152:155], a[160:163], v[80:83], v[12:15]
    v_add_f32 v144, v144, v12
    v_add_f32 v145, v145, v12
    v_mfma_f32_16x16x32_bf16 v[152:155], a[164:167], v[84:87], v[152:155]
    v_add_f32 v146, v146, v12
    v_add_f32 v147, v147, v12
    v_mfma_f32_16x16x32_bf16 v[152:155], a[168:171], v[88:91], v[152:155]
    v_add_f32 v148, v148, v12
    v_add_f32 v149, v149, v12
    v_mfma_f32_16x16x32_bf16 v[152:155], a[172:175], v[92:95], v[152:155]
    v_add_f32 v150, v150, v12
    v_add_f32 v151, v151, v12
    v_mfma_f32_16x16x32_bf16 v[168:171], a[160:163], v[96:99], v[24:27]
    v_add_f32 v160, v160, v24
    v_add_f32 v161, v161, v24
    v_mfma_f32_16x16x32_bf16 v[168:171], a[164:167], v[100:103], v[168:171]
    v_add_f32 v162, v162, v24
    v_add_f32 v163, v163, v24
    v_mfma_f32_16x16x32_bf16 v[168:171], a[168:171], v[104:107], v[168:171]
    v_add_f32 v164, v164, v24
    v_add_f32 v165, v165, v24
    v_mfma_f32_16x16x32_bf16 v[168:171], a[172:175], v[108:111], v[168:171]
    v_add_f32 v166, v166, v24
    v_add_f32 v167, v167, v24
    v_mfma_f32_16x16x32_bf16 v[184:187], a[160:163], v[112:115], v[28:31]
    v_add_f32 v176, v176, v28
    v_add_f32 v177, v177, v28
    v_mfma_f32_16x16x32_bf16 v[184:187], a[164:167], v[116:119], v[184:187]
    v_add_f32 v178, v178, v28
    v_add_f32 v179, v179, v28
    v_mfma_f32_16x16x32_bf16 v[184:187], a[168:171], v[120:123], v[184:187]
    v_add_f32 v180, v180, v28
    v_add_f32 v181, v181, v28
    v_mfma_f32_16x16x32_bf16 v[184:187], a[172:175], v[124:127], v[184:187]
    v_add_f32 v182, v182, v28
    v_add_f32 v183, v183, v28
    v_mfma_f32_16x16x32_bf16 v[140:143], a[176:179], v[64:67], v[8:11]
    v_exp_f32 v128, v128
    v_mfma_f32_16x16x32_bf16 v[140:143], a[180:183], v[68:71], v[140:143]
    ds_read_b128 a[160:163], v20 offset:0
    ds_read_b128 a[164:167], v21 offset:0
    v_mfma_f32_16x16x32_bf16 v[140:143], a[184:187], v[72:75], v[140:143]
    v_exp_f32 v129, v129
    v_mfma_f32_16x16x32_bf16 v[140:143], a[188:191], v[76:79], v[140:143]
    ds_read_b128 a[168:171], v22 offset:0
    ds_read_b128 a[172:175], v23 offset:0
    v_mfma_f32_16x16x32_bf16 v[156:159], a[176:179], v[80:83], v[12:15]
    v_exp_f32 v130, v130
    v_mfma_f32_16x16x32_bf16 v[156:159], a[180:183], v[84:87], v[156:159]
    v_cvt_pk_bf16_f32 v128, v128, v129
    v_mfma_f32_16x16x32_bf16 v[156:159], a[184:187], v[88:91], v[156:159]
    v_exp_f32 v131, v131
    v_mfma_f32_16x16x32_bf16 v[156:159], a[188:191], v[92:95], v[156:159]
    v_mfma_f32_16x16x32_bf16 v[172:175], a[176:179], v[96:99], v[24:27]
    v_exp_f32 v132, v132
    v_mfma_f32_16x16x32_bf16 v[172:175], a[180:183], v[100:103], v[172:175]
    v_cvt_pk_bf16_f32 v129, v130, v131
    v_mfma_f32_16x16x32_bf16 v[172:175], a[184:187], v[104:107], v[172:175]
    v_exp_f32 v133, v133
    v_mfma_f32_16x16x32_bf16 v[172:175], a[188:191], v[108:111], v[172:175]
    v_mfma_f32_16x16x32_bf16 v[188:191], a[176:179], v[112:115], v[28:31]
    v_exp_f32 v134, v134
    v_mfma_f32_16x16x32_bf16 v[188:191], a[180:183], v[116:119], v[188:191]
    v_cvt_pk_bf16_f32 v130, v132, v133
    v_mfma_f32_16x16x32_bf16 v[188:191], a[184:187], v[120:123], v[188:191]
    v_exp_f32 v135, v135
    v_mfma_f32_16x16x32_bf16 v[188:191], a[188:191], v[124:127], v[188:191]
    s_nop 0
    v_cvt_pk_bf16_f32 v131, v134, v135
    ds_read_b128 a[176:179], v20 offset:4096
    ds_read_b128 a[180:183], v21 offset:4096
    ds_read_b128 a[184:187], v22 offset:4096
    ds_read_b128 a[188:191], v23 offset:4096
    s_waitcnt lgkmcnt(4)
    v_mfma_f32_16x16x32_bf16 v[192:195], a[160:163], v[64:67], v[8:11]
    s_add_u32 m0, s90, 98304
    s_mov_b32 s85, 32768
    v_exp_f32 v144, v144
    v_mfma_f32_16x16x32_bf16 v[192:195], a[164:167], v[68:71], v[192:195]
    v_exp_f32 v145, v145
    v_mfma_f32_16x16x32_bf16 v[192:195], a[168:171], v[72:75], v[192:195]
    v_exp_f32 v146, v146
    v_cvt_pk_bf16_f32 v144, v144, v145
    v_mfma_f32_16x16x32_bf16 v[192:195], a[172:175], v[76:79], v[192:195]
    v_exp_f32 v147, v147
    v_mfma_f32_16x16x32_bf16 v[208:211], a[160:163], v[80:83], v[12:15]
    v_exp_f32 v148, v148
    v_cvt_pk_bf16_f32 v145, v146, v147
    v_mfma_f32_16x16x32_bf16 v[208:211], a[164:167], v[84:87], v[208:211]
    v_exp_f32 v149, v149
    v_mfma_f32_16x16x32_bf16 v[208:211], a[168:171], v[88:91], v[208:211]
    v_exp_f32 v150, v150
    v_mfma_f32_16x16x32_bf16 v[208:211], a[172:175], v[92:95], v[208:211]
    buffer_load_dwordx4 v56, s[40:43], s85 offen offset:0 nt lds
    v_cvt_pk_bf16_f32 v146, v148, v149
    v_mfma_f32_16x16x32_bf16 v[224:227], a[160:163], v[96:99], v[24:27]
    buffer_load_dwordx4 v57, s[40:43], s85 offen offset:1024 nt lds
    v_exp_f32 v151, v151
    v_mfma_f32_16x16x32_bf16 v[224:227], a[164:167], v[100:103], v[224:227]
    v_exp_f32 v160, v160
    v_cvt_pk_bf16_f32 v147, v150, v151
    v_mfma_f32_16x16x32_bf16 v[224:227], a[168:171], v[104:107], v[224:227]
    v_exp_f32 v161, v161
    v_mfma_f32_16x16x32_bf16 v[224:227], a[172:175], v[108:111], v[224:227]
    v_exp_f32 v162, v162
    v_cvt_pk_bf16_f32 v160, v160, v161
    v_mfma_f32_16x16x32_bf16 v[240:243], a[160:163], v[112:115], v[28:31]
    buffer_load_dwordx4 v56, s[40:43], s85 offen offset:2048 nt lds
    v_exp_f32 v163, v163
    v_mfma_f32_16x16x32_bf16 v[240:243], a[164:167], v[116:119], v[240:243]
    v_exp_f32 v164, v164
    v_mfma_f32_16x16x32_bf16 v[240:243], a[168:171], v[120:123], v[240:243]
    v_exp_f32 v165, v165
    s_waitcnt lgkmcnt(0)
    v_mfma_f32_16x16x32_bf16 v[240:243], a[172:175], v[124:127], v[240:243]
    v_cvt_pk_bf16_f32 v161, v162, v163
    v_cvt_pk_bf16_f32 v162, v164, v165
    v_mfma_f32_16x16x32_bf16 v[196:199], a[176:179], v[64:67], v[8:11]
    ds_read_b64_tr_b16 a[128:129], v32 offset:0
    v_exp_f32 v166, v166
    v_mfma_f32_16x16x32_bf16 v[196:199], a[180:183], v[68:71], v[196:199]
    buffer_load_dwordx4 v57, s[40:43], s85 offen offset:3072 nt lds
    v_exp_f32 v167, v167
    v_mfma_f32_16x16x32_bf16 v[196:199], a[184:187], v[72:75], v[196:199]
    v_exp_f32 v176, v176
    v_cvt_pk_bf16_f32 v163, v166, v167
    v_mfma_f32_16x16x32_bf16 v[196:199], a[188:191], v[76:79], v[196:199]
    ds_read_b64_tr_b16 a[130:131], v32 offset:4096
    v_exp_f32 v177, v177
    v_mfma_f32_16x16x32_bf16 v[212:215], a[176:179], v[80:83], v[12:15]
    v_exp_f32 v178, v178
    v_cvt_pk_bf16_f32 v176, v176, v177
    v_mfma_f32_16x16x32_bf16 v[212:215], a[180:183], v[84:87], v[212:215]
    ds_read_b64_tr_b16 a[132:133], v32 offset:8192
    v_exp_f32 v179, v179
    v_mfma_f32_16x16x32_bf16 v[212:215], a[184:187], v[88:91], v[212:215]
    s_add_u32 m0, s90, 49152
    s_mov_b32 s85, 65536
    v_exp_f32 v180, v180
    v_mfma_f32_16x16x32_bf16 v[212:215], a[188:191], v[92:95], v[212:215]
    ds_read_b128 a[160:163], v20 offset:8192
    ds_read_b128 a[164:167], v21 offset:8192
    v_cvt_pk_bf16_f32 v177, v178, v179
    v_mfma_f32_16x16x32_bf16 v[228:231], a[176:179], v[96:99], v[24:27]
    ds_read_b128 a[168:171], v22 offset:8192
    ds_read_b128 a[172:175], v23 offset:8192
    v_exp_f32 v181, v181
    v_mfma_f32_16x16x32_bf16 v[228:231], a[180:183], v[100:103], v[228:231]
    buffer_load_dwordx4 v52, s[36:39], s85 offen offset:0 nt lds
    v_exp_f32 v182, v182
    v_cvt_pk_bf16_f32 v178, v180, v181
    v_mfma_f32_16x16x32_bf16 v[228:231], a[184:187], v[104:107], v[228:231]
    ds_read_b64_tr_b16 a[134:135], v32 offset:12288
    v_exp_f32 v183, v183
    v_mfma_f32_16x16x32_bf16 v[228:231], a[188:191], v[108:111], v[228:231]
    v_exp_f32 v136, v136
    v_cvt_pk_bf16_f32 v179, v182, v183
    v_mfma_f32_16x16x32_bf16 v[244:247], a[176:179], v[112:115], v[28:31]
    ds_read_b64_tr_b16 a[136:137], v33 offset:0
    buffer_load_dwordx4 v53, s[36:39], s85 offen offset:1024 nt lds
    v_exp_f32 v137, v137
    v_mfma_f32_16x16x32_bf16 v[244:247], a[180:183], v[116:119], v[244:247]
    ds_read_b64_tr_b16 a[138:139], v33 offset:4096
    v_exp_f32 v138, v138
    v_mfma_f32_16x16x32_bf16 v[244:247], a[184:187], v[120:123], v[244:247]
    v_exp_f32 v139, v139
    s_waitcnt lgkmcnt(3)
    v_mfma_f32_16x16x32_bf16 v[244:247], a[188:191], v[124:127], v[244:247]
    ds_read_b64_tr_b16 a[140:141], v33 offset:8192
    v_cvt_pk_bf16_f32 v136, v136, v137
    v_cvt_pk_bf16_f32 v137, v138, v139
    v_mfma_f32_16x16x32_bf16 v[200:203], a[160:163], v[64:67], v[8:11]
    buffer_load_dwordx4 v54, s[36:39], s85 offen offset:2048 nt lds
    v_exp_f32 v140, v140
    v_mfma_f32_16x16x32_bf16 v[200:203], a[164:167], v[68:71], v[200:203]
    v_exp_f32 v141, v141
    v_mfma_f32_16x16x32_bf16 v[200:203], a[168:171], v[72:75], v[200:203]
    v_exp_f32 v142, v142
    v_cvt_pk_bf16_f32 v138, v140, v141
    v_mfma_f32_16x16x32_bf16 v[200:203], a[172:175], v[76:79], v[200:203]
    ds_read_b64_tr_b16 a[142:143], v33 offset:12288
    v_exp_f32 v143, v143
    v_mfma_f32_16x16x32_bf16 v[216:219], a[160:163], v[80:83], v[12:15]
    v_exp_f32 v152, v152
    v_cvt_pk_bf16_f32 v139, v142, v143
    v_mfma_f32_16x16x32_bf16 v[216:219], a[164:167], v[84:87], v[216:219]
    ds_read_b64_tr_b16 a[144:145], v34 offset:0
    v_exp_f32 v153, v153
    v_mfma_f32_16x16x32_bf16 v[216:219], a[168:171], v[88:91], v[216:219]
    buffer_load_dwordx4 v55, s[36:39], s85 offen offset:3072 nt lds
    v_exp_f32 v154, v154
    v_mfma_f32_16x16x32_bf16 v[216:219], a[172:175], v[92:95], v[216:219]
    ds_read_b128 a[176:179], v20 offset:12288
    ds_read_b128 a[180:183], v21 offset:12288
    v_cvt_pk_bf16_f32 v152, v152, v153
    v_mfma_f32_16x16x32_bf16 v[232:235], a[160:163], v[96:99], v[24:27]
    ds_read_b128 a[184:187], v22 offset:12288
    ds_read_b128 a[188:191], v23 offset:12288
    v_exp_f32 v155, v155
    v_mfma_f32_16x16x32_bf16 v[232:235], a[164:167], v[100:103], v[232:235]
    v_exp_f32 v156, v156
    v_cvt_pk_bf16_f32 v153, v154, v155
    v_mfma_f32_16x16x32_bf16 v[232:235], a[168:171], v[104:107], v[232:235]
    ds_read_b64_tr_b16 a[146:147], v34 offset:4096
    v_exp_f32 v157, v157
    v_mfma_f32_16x16x32_bf16 v[232:235], a[172:175], v[108:111], v[232:235]
    v_exp_f32 v158, v158
    v_cvt_pk_bf16_f32 v154, v156, v157
    v_mfma_f32_16x16x32_bf16 v[248:251], a[160:163], v[112:115], v[28:31]
    ds_read_b64_tr_b16 a[148:149], v34 offset:8192
    v_exp_f32 v159, v159
    v_mfma_f32_16x16x32_bf16 v[248:251], a[164:167], v[116:119], v[248:251]
    ds_read_b64_tr_b16 a[150:151], v34 offset:12288
    v_exp_f32 v168, v168
    v_mfma_f32_16x16x32_bf16 v[248:251], a[168:171], v[120:123], v[248:251]
    v_exp_f32 v169, v169
    s_waitcnt vmcnt(12) lgkmcnt(3)
    v_mfma_f32_16x16x32_bf16 v[248:251], a[172:175], v[124:127], v[248:251]
    ds_read_b64_tr_b16 a[152:153], v35 offset:0
    v_cvt_pk_bf16_f32 v155, v158, v159
    v_cvt_pk_bf16_f32 v168, v168, v169
    v_mfma_f32_16x16x32_bf16 v[204:207], a[176:179], v[64:67], v[8:11]
    ds_add_u32 v18, v19
    v_exp_f32 v170, v170
    v_mfma_f32_16x16x32_bf16 v[204:207], a[180:183], v[68:71], v[204:207]
    v_exp_f32 v171, v171
    v_mfma_f32_16x16x32_bf16 v[204:207], a[184:187], v[72:75], v[204:207]
    v_exp_f32 v172, v172
    v_cvt_pk_bf16_f32 v169, v170, v171
    v_mfma_f32_16x16x32_bf16 v[204:207], a[188:191], v[76:79], v[204:207]
    ds_read_b64_tr_b16 a[154:155], v35 offset:4096
    v_exp_f32 v173, v173
    v_mfma_f32_16x16x32_bf16 v[220:223], a[176:179], v[80:83], v[12:15]
    v_exp_f32 v174, v174
    v_cvt_pk_bf16_f32 v170, v172, v173
    v_mfma_f32_16x16x32_bf16 v[220:223], a[180:183], v[84:87], v[220:223]
    v_exp_f32 v175, v175
    v_mfma_f32_16x16x32_bf16 v[220:223], a[184:187], v[88:91], v[220:223]
    v_exp_f32 v184, v184
    v_mfma_f32_16x16x32_bf16 v[220:223], a[188:191], v[92:95], v[220:223]
    ds_read_b64_tr_b16 a[156:157], v35 offset:8192
    v_cvt_pk_bf16_f32 v171, v174, v175
    v_mfma_f32_16x16x32_bf16 v[236:239], a[176:179], v[96:99], v[24:27]
    ds_read_b64_tr_b16 a[158:159], v35 offset:12288
    v_exp_f32 v185, v185
    v_mfma_f32_16x16x32_bf16 v[236:239], a[180:183], v[100:103], v[236:239]
    v_exp_f32 v186, v186
    v_cvt_pk_bf16_f32 v184, v184, v185
    v_mfma_f32_16x16x32_bf16 v[236:239], a[184:187], v[104:107], v[236:239]
    v_exp_f32 v187, v187
    v_mfma_f32_16x16x32_bf16 v[236:239], a[188:191], v[108:111], v[236:239]
    v_exp_f32 v188, v188
    v_cvt_pk_bf16_f32 v185, v186, v187
    v_mfma_f32_16x16x32_bf16 v[252:255], a[176:179], v[112:115], v[28:31]
    ds_read_b32 v17, v18
    v_exp_f32 v189, v189
    v_mfma_f32_16x16x32_bf16 v[252:255], a[180:183], v[116:119], v[252:255]
    v_exp_f32 v190, v190
    v_mfma_f32_16x16x32_bf16 v[252:255], a[184:187], v[120:123], v[252:255]
    v_exp_f32 v191, v191
    v_mfma_f32_16x16x32_bf16 v[252:255], a[188:191], v[124:127], v[252:255]
    v_cvt_pk_bf16_f32 v186, v188, v189
    v_cvt_pk_bf16_f32 v187, v190, v191
    s_waitcnt lgkmcnt(0)
    s_mov_b32 s89, 49152
    s_mov_b32 s88, 81920
    v_mfma_f32_16x16x32_bf16 a[0:3], a[128:131], v[128:131], 0
    v_exp_f32 v192, v192
    v_mfma_f32_16x16x32_bf16 a[0:3], a[132:135], v[136:139], a[0:3]
    v_cmp_gt_u32 vcc, s98, v17
    v_mfma_f32_16x16x32_bf16 a[4:7], a[128:131], v[144:147], 0
    v_exp_f32 v193, v193
    v_mfma_f32_16x16x32_bf16 a[4:7], a[132:135], v[152:155], a[4:7]
    s_cbranch_vccnz L_spinh
L_spunh:
    v_mfma_f32_16x16x32_bf16 a[8:11], a[128:131], v[160:163], 0
    s_add_u32 m0, s90, 114688
    v_exp_f32 v194, v194
    v_mfma_f32_16x16x32_bf16 a[8:11], a[132:135], v[168:171], a[8:11]
    s_add_u32 s98, s98, 4
    v_cvt_pk_bf16_f32 v192, v192, v193
    v_mfma_f32_16x16x32_bf16 a[12:15], a[128:131], v[176:179], 0
    v_exp_f32 v195, v195
    v_mfma_f32_16x16x32_bf16 a[12:15], a[132:135], v[184:187], a[12:15]
    ds_read_b128 a[160:163], v20 offset:16384
    ds_read_b128 a[164:167], v21 offset:16384
    v_mfma_f32_16x16x32_bf16 a[16:19], a[136:139], v[128:131], 0
    v_exp_f32 v196, v196
    v_mfma_f32_16x16x32_bf16 a[16:19], a[140:143], v[136:139], a[16:19]
    ds_read_b64_tr_b16 a[128:129], v36 offset:0
    v_cvt_pk_bf16_f32 v193, v194, v195
    v_mfma_f32_16x16x32_bf16 a[20:23], a[136:139], v[144:147], 0
    v_exp_f32 v197, v197
    v_mfma_f32_16x16x32_bf16 a[20:23], a[140:143], v[152:155], a[20:23]
    ds_read_b64_tr_b16 a[130:131], v36 offset:4096
    ds_read_b64_tr_b16 a[132:133], v36 offset:8192
    v_mfma_f32_16x16x32_bf16 a[24:27], a[136:139], v[160:163], 0
    v_exp_f32 v198, v198
    v_mfma_f32_16x16x32_bf16 a[24:27], a[140:143], v[168:171], a[24:27]
    ds_read_b64_tr_b16 a[134:135], v36 offset:12288
    v_cvt_pk_bf16_f32 v194, v196, v197
    v_mfma_f32_16x16x32_bf16 a[28:31], a[136:139], v[176:179], 0
    v_exp_f32 v199, v199
    v_mfma_f32_16x16x32_bf16 a[28:31], a[140:143], v[184:187], a[28:31]
    ds_read_b128 a[168:171], v22 offset:16384
    ds_read_b128 a[172:175], v23 offset:16384
    v_mfma_f32_16x16x32_bf16 a[192:195], a[208:211], v[128:131], a[192:195]
    ds_read_b64_tr_b16 a[136:137], v37 offset:0
    ds_read_b64_tr_b16 a[138:139], v37 offset:4096
    v_mfma_f32_16x16x32_bf16 a[192:195], a[208:211], v[136:139], a[192:195]
    v_exp_f32 v208, v208
    v_mfma_f32_16x16x32_bf16 a[32:35], a[144:147], v[128:131], 0
    ds_read_b64_tr_b16 a[140:141], v37 offset:8192
    v_cvt_pk_bf16_f32 v195, v198, v199
    v_mfma_f32_16x16x32_bf16 a[32:35], a[148:151], v[136:139], a[32:35]
    v_exp_f32 v209, v209
    v_mfma_f32_16x16x32_bf16 a[36:39], a[144:147], v[144:147], 0
    ds_read_b64_tr_b16 a[142:143], v37 offset:12288
    buffer_load_dwordx4 v56, s[40:43], s89 offen offset:0 nt lds
    v_mfma_f32_16x16x32_bf16 a[36:39], a[148:151], v[152:155], a[36:39]
    v_exp_f32 v210, v210
    v_mfma_f32_16x16x32_bf16 a[40:43], a[144:147], v[160:163], 0
    buffer_load_dwordx4 v57, s[40:43], s89 offen offset:1024 nt lds
    v_cvt_pk_bf16_f32 v208, v208, v209
    v_mfma_f32_16x16x32_bf16 a[40:43], a[148:151], v[168:171], a[40:43]
    v_exp_f32 v211, v211
    v_mfma_f32_16x16x32_bf16 a[44:47], a[144:147], v[176:179], 0
    v_mfma_f32_16x16x32_bf16 a[44:47], a[148:151], v[184:187], a[44:47]
    v_exp_f32 v212, v212
    v_mfma_f32_16x16x32_bf16 a[48:51], a[152:155], v[128:131], 0
    ds_read_b64_tr_b16 a[144:145], v38 offset:0
    v_cvt_pk_bf16_f32 v209, v210, v211
    v_mfma_f32_16x16x32_bf16 a[48:51], a[156:159], v[136:139], a[48:51]
    v_exp_f32 v213, v213
    v_mfma_f32_16x16x32_bf16 a[52:55], a[152:155], v[144:147], 0
    ds_read_b64_tr_b16 a[146:147], v38 offset:4096
    ds_read_b64_tr_b16 a[148:149], v38 offset:8192
    v_mfma_f32_16x16x32_bf16 a[52:55], a[156:159], v[152:155], a[52:55]
    v_exp_f32 v214, v214
    v_mfma_f32_16x16x32_bf16 a[56:59], a[152:155], v[160:163], 0
    ds_read_b64_tr_b16 a[150:151], v38 offset:12288
    v_cvt_pk_bf16_f32 v210, v212, v213
    v_mfma_f32_16x16x32_bf16 a[56:59], a[156:159], v[168:171], a[56:59]
    v_exp_f32 v215, v215
    v_mfma_f32_16x16x32_bf16 a[60:63], a[152:155], v[176:179], 0
    buffer_load_dwordx4 v56, s[40:43], s89 offen offset:2048 nt lds
    v_mfma_f32_16x16x32_bf16 a[60:63], a[156:159], v[184:187], a[60:63]
    v_mfma_f32_16x16x32_bf16 a[196:199], a[208:211], v[144:147], a[196:199]
    v_exp_f32 v224, v224
    v_mfma_f32_16x16x32_bf16 a[196:199], a[208:211], v[152:155], a[196:199]
    v_cvt_pk_bf16_f32 v211, v214, v215
    s_waitcnt lgkmcnt(10)
    v_mfma_f32_16x16x32_bf16 a[64:67], a[128:131], v[128:131], 0
    v_exp_f32 v225, v225
    v_mfma_f32_16x16x32_bf16 a[64:67], a[132:135], v[136:139], a[64:67]
    ds_read_b64_tr_b16 a[152:153], v39 offset:0
    ds_read_b64_tr_b16 a[154:155], v39 offset:4096
    v_mfma_f32_16x16x32_bf16 a[68:71], a[128:131], v[144:147], 0
    v_exp_f32 v226, v226
    v_mfma_f32_16x16x32_bf16 a[68:71], a[132:135], v[152:155], a[68:71]
    ds_read_b64_tr_b16 a[156:157], v39 offset:8192
    v_cvt_pk_bf16_f32 v224, v224, v225
    v_mfma_f32_16x16x32_bf16 a[72:75], a[128:131], v[160:163], 0
    v_exp_f32 v227, v227
    v_mfma_f32_16x16x32_bf16 a[72:75], a[132:135], v[168:171], a[72:75]
    ds_read_b64_tr_b16 a[158:159], v39 offset:12288
    ds_read_b128 a[176:179], v20 offset:20480
    v_mfma_f32_16x16x32_bf16 a[76:79], a[128:131], v[176:179], 0
    v_exp_f32 v228, v228
    v_mfma_f32_16x16x32_bf16 a[76:79], a[132:135], v[184:187], a[76:79]
    v_cvt_pk_bf16_f32 v225, v226, v227
    s_waitcnt lgkmcnt(9)
    v_mfma_f32_16x16x32_bf16 a[80:83], a[136:139], v[128:131], 0
    v_exp_f32 v229, v229
    v_mfma_f32_16x16x32_bf16 a[80:83], a[140:143], v[136:139], a[80:83]
    ds_read_b128 a[180:183], v21 offset:20480
    ds_read_b128 a[184:187], v22 offset:20480
    v_mfma_f32_16x16x32_bf16 a[84:87], a[136:139], v[144:147], 0
    v_exp_f32 v230, v230
    v_mfma_f32_16x16x32_bf16 a[84:87], a[140:143], v[152:155], a[84:87]
    ds_read_b128 a[188:191], v23 offset:20480
    v_cvt_pk_bf16_f32 v226, v228, v229
    v_mfma_f32_16x16x32_bf16 a[88:91], a[136:139], v[160:163], 0
    v_exp_f32 v231, v231
    v_mfma_f32_16x16x32_bf16 a[88:91], a[140:143], v[168:171], a[88:91]
    buffer_load_dwordx4 v57, s[40:43], s89 offen offset:3072 nt lds
    v_mfma_f32_16x16x32_bf16 a[92:95], a[136:139], v[176:179], 0
    s_add_u32 s89, s89, 16384
    v_mfma_f32_16x16x32_bf16 a[92:95], a[140:143], v[184:187], a[92:95]
    v_exp_f32 v240, v240
    v_mfma_f32_16x16x32_bf16 a[200:203], a[208:211], v[160:163], a[200:203]
    v_cvt_pk_bf16_f32 v227, v230, v231
    s_waitcnt lgkmcnt(8)
    v_mfma_f32_16x16x32_bf16 a[200:203], a[208:211], v[168:171], a[200:203]
    v_exp_f32 v241, v241
    v_mfma_f32_16x16x32_bf16 a[96:99], a[144:147], v[128:131], 0
    v_mfma_f32_16x16x32_bf16 a[96:99], a[148:151], v[136:139], a[96:99]
    v_exp_f32 v242, v242
    v_mfma_f32_16x16x32_bf16 a[100:103], a[144:147], v[144:147], 0
    v_cvt_pk_bf16_f32 v240, v240, v241
    v_mfma_f32_16x16x32_bf16 a[100:103], a[148:151], v[152:155], a[100:103]
    v_exp_f32 v243, v243
    v_mfma_f32_16x16x32_bf16 a[104:107], a[144:147], v[160:163], 0
    s_add_u32 m0, s90, 0
    v_mfma_f32_16x16x32_bf16 a[104:107], a[148:151], v[168:171], a[104:107]
    v_exp_f32 v244, v244
    v_mfma_f32_16x16x32_bf16 a[108:111], a[144:147], v[176:179], 0
    v_cvt_pk_bf16_f32 v241, v242, v243
    s_waitcnt lgkmcnt(4)
    v_mfma_f32_16x16x32_bf16 a[108:111], a[148:151], v[184:187], a[108:111]
    v_exp_f32 v245, v245
    v_mfma_f32_16x16x32_bf16 a[112:115], a[152:155], v[128:131], 0
    v_mfma_f32_16x16x32_bf16 a[112:115], a[156:159], v[136:139], a[112:115]
    v_exp_f32 v246, v246
    v_mfma_f32_16x16x32_bf16 a[116:119], a[152:155], v[144:147], 0
    v_cvt_pk_bf16_f32 v242, v244, v245
    v_mfma_f32_16x16x32_bf16 a[116:119], a[156:159], v[152:155], a[116:119]
    v_exp_f32 v247, v247
    v_mfma_f32_16x16x32_bf16 a[120:123], a[152:155], v[160:163], 0
    v_mfma_f32_16x16x32_bf16 a[120:123], a[156:159], v[168:171], a[120:123]
    buffer_load_dwordx4 v52, s[36:39], s88 offen offset:0 nt lds
    v_mfma_f32_16x16x32_bf16 a[124:127], a[152:155], v[176:179], 0
    v_exp_f32 v200, v200
    v_mfma_f32_16x16x32_bf16 a[124:127], a[156:159], v[184:187], a[124:127]
    v_cvt_pk_bf16_f32 v243, v246, v247
    v_mfma_f32_16x16x32_bf16 a[204:207], a[208:211], v[176:179], a[204:207]
    v_exp_f32 v201, v201
    v_mfma_f32_16x16x32_bf16 a[204:207], a[208:211], v[184:187], a[204:207]
    s_waitcnt lgkmcnt(0)
    v_mfma_f32_16x16x32_bf16 v[128:131], a[160:163], v[64:67], v[8:11]
    v_exp_f32 v202, v202
    v_mfma_f32_16x16x32_bf16 v[128:131], a[164:167], v[68:71], v[128:131]
    ds_read_b64_tr_b16 a[128:129], v32 offset:16384
    v_cvt_pk_bf16_f32 v200, v200, v201
    v_mfma_f32_16x16x32_bf16 v[128:131], a[168:171], v[72:75], v[128:131]
    v_exp_f32 v203, v203
    v_mfma_f32_16x16x32_bf16 v[128:131], a[172:175], v[76:79], v[128:131]
    ds_read_b64_tr_b16 a[130:131], v32 offset:20480
    v_mfma_f32_16x16x32_bf16 v[144:147], a[160:163], v[80:83], v[12:15]
    v_exp_f32 v204, v204
    v_mfma_f32_16x16x32_bf16 v[144:147], a[164:167], v[84:87], v[144:147]
    buffer_load_dwordx4 v53, s[36:39], s88 offen offset:1024 nt lds
    v_cvt_pk_bf16_f32 v201, v202, v203
    v_mfma_f32_16x16x32_bf16 v[144:147], a[168:171], v[88:91], v[144:147]
    v_exp_f32 v205, v205
    v_mfma_f32_16x16x32_bf16 v[144:147], a[172:175], v[92:95], v[144:147]
    ds_read_b64_tr_b16 a[132:133], v32 offset:24576
    v_mfma_f32_16x16x32_bf16 v[160:163], a[160:163], v[96:99], v[24:27]
    v_exp_f32 v206, v206
    v_mfma_f32_16x16x32_bf16 v[160:163], a[164:167], v[100:103], v[160:163]
    v_cvt_pk_bf16_f32 v202, v204, v205
    v_mfma_f32_16x16x32_bf16 v[160:163], a[168:171], v[104:107], v[160:163]
    v_exp_f32 v207, v207
    v_mfma_f32_16x16x32_bf16 v[160:163], a[172:175], v[108:111], v[160:163]
    ds_read_b64_tr_b16 a[134:135], v32 offset:28672
    v_mfma_f32_16x16x32_bf16 v[176:179], a[160:163], v[112:115], v[28:31]
    v_mfma_f32_16x16x32_bf16 v[176:179], a[164:167], v[116:119], v[176:179]
    buffer_load_dwordx4 v54, s[36:39], s88 offen offset:2048 nt lds
    v_exp_f32 v216, v216
    v_mfma_f32_16x16x32_bf16 v[176:179], a[168:171], v[120:123], v[176:179]
    ds_read_b64_tr_b16 a[136:137], v33 offset:16384
    v_cvt_pk_bf16_f32 v203, v206, v207
    v_mfma_f32_16x16x32_bf16 v[176:179], a[172:175], v[124:127], v[176:179]
    v_exp_f32 v217, v217
    v_mfma_f32_16x16x32_bf16 v[132:135], a[176:179], v[64:67], v[8:11]
    ds_read_b128 a[160:163], v20 offset:24576
    ds_read_b128 a[164:167], v21 offset:24576
    v_mfma_f32_16x16x32_bf16 v[132:135], a[180:183], v[68:71], v[132:135]
    v_exp_f32 v218, v218
    v_mfma_f32_16x16x32_bf16 v[132:135], a[184:187], v[72:75], v[132:135]
    ds_read_b128 a[168:171], v22 offset:24576
    v_cvt_pk_bf16_f32 v216, v216, v217
    v_mfma_f32_16x16x32_bf16 v[132:135], a[188:191], v[76:79], v[132:135]
    v_exp_f32 v219, v219
    v_mfma_f32_16x16x32_bf16 v[148:151], a[176:179], v[80:83], v[12:15]
    ds_read_b128 a[172:175], v23 offset:24576
    ds_read_b64_tr_b16 a[138:139], v33 offset:20480
    v_mfma_f32_16x16x32_bf16 v[148:151], a[180:183], v[84:87], v[148:151]
    v_exp_f32 v220, v220
    v_mfma_f32_16x16x32_bf16 v[148:151], a[184:187], v[88:91], v[148:151]
    ds_read_b64_tr_b16 a[140:141], v33 offset:24576
    v_cvt_pk_bf16_f32 v217, v218, v219
    v_mfma_f32_16x16x32_bf16 v[148:151], a[188:191], v[92:95], v[148:151]
    v_exp_f32 v221, v221
    v_mfma_f32_16x16x32_bf16 v[164:167], a[176:179], v[96:99], v[24:27]
    buffer_load_dwordx4 v55, s[36:39], s88 offen offset:3072 nt lds
    v_mfma_f32_16x16x32_bf16 v[164:167], a[180:183], v[100:103], v[164:167]
    v_exp_f32 v222, v222
    v_mfma_f32_16x16x32_bf16 v[164:167], a[184:187], v[104:107], v[164:167]
    ds_read_b64_tr_b16 a[142:143], v33 offset:28672
    v_cvt_pk_bf16_f32 v218, v220, v221
    v_mfma_f32_16x16x32_bf16 v[164:167], a[188:191], v[108:111], v[164:167]
    v_exp_f32 v223, v223
    v_mfma_f32_16x16x32_bf16 v[180:183], a[176:179], v[112:115], v[28:31]
    v_mfma_f32_16x16x32_bf16 v[180:183], a[180:183], v[116:119], v[180:183]
    ds_read_b64_tr_b16 a[144:145], v34 offset:16384
    v_mfma_f32_16x16x32_bf16 v[180:183], a[184:187], v[120:123], v[180:183]
    v_exp_f32 v232, v232
    v_mfma_f32_16x16x32_bf16 v[180:183], a[188:191], v[124:127], v[180:183]
    v_cvt_pk_bf16_f32 v219, v222, v223
    s_waitcnt lgkmcnt(4)
    s_add_u32 s88, s88, 16384
    v_mfma_f32_16x16x32_bf16 v[136:139], a[160:163], v[64:67], v[8:11]
    ds_read_b64_tr_b16 a[146:147], v34 offset:20480
    v_exp_f32 v233, v233
    v_mfma_f32_16x16x32_bf16 v[136:139], a[164:167], v[68:71], v[136:139]
    ds_read_b128 a[176:179], v20 offset:28672
    ds_read_b128 a[180:183], v21 offset:28672
    v_mfma_f32_16x16x32_bf16 v[136:139], a[168:171], v[72:75], v[136:139]
    v_exp_f32 v234, v234
    v_mfma_f32_16x16x32_bf16 v[136:139], a[172:175], v[76:79], v[136:139]
    ds_read_b128 a[184:187], v22 offset:28672
    v_cvt_pk_bf16_f32 v232, v232, v233
    v_mfma_f32_16x16x32_bf16 v[152:155], a[160:163], v[80:83], v[12:15]
    v_exp_f32 v235, v235
    v_mfma_f32_16x16x32_bf16 v[152:155], a[164:167], v[84:87], v[152:155]
    ds_read_b128 a[188:191], v23 offset:28672
    ds_read_b64_tr_b16 a[148:149], v34 offset:24576
    v_mfma_f32_16x16x32_bf16 v[152:155], a[168:171], v[88:91], v[152:155]
    v_exp_f32 v236, v236
    v_mfma_f32_16x16x32_bf16 v[152:155], a[172:175], v[92:95], v[152:155]
    ds_read_b64_tr_b16 a[150:151], v34 offset:28672
    v_cvt_pk_bf16_f32 v233, v234, v235
    v_mfma_f32_16x16x32_bf16 v[168:171], a[160:163], v[96:99], v[24:27]
    v_exp_f32 v237, v237
    v_mfma_f32_16x16x32_bf16 v[168:171], a[164:167], v[100:103], v[168:171]
    v_mfma_f32_16x16x32_bf16 v[168:171], a[168:171], v[104:107], v[168:171]
    v_exp_f32 v238, v238
    v_mfma_f32_16x16x32_bf16 v[168:171], a[172:175], v[108:111], v[168:171]
    ds_read_b64_tr_b16 a[152:153], v35 offset:16384
    v_cvt_pk_bf16_f32 v234, v236, v237
    v_mfma_f32_16x16x32_bf16 v[184:187], a[160:163], v[112:115], v[28:31]
    v_exp_f32 v239, v239
    v_mfma_f32_16x16x32_bf16 v[184:187], a[164:167], v[116:119], v[184:187]
    v_mfma_f32_16x16x32_bf16 v[184:187], a[168:171], v[120:123], v[184:187]
    s_waitcnt vmcnt(12) lgkmcnt(3)
    ds_add_u32 v18, v19
    v_mfma_f32_16x16x32_bf16 v[184:187], a[172:175], v[124:127], v[184:187]
    v_exp_f32 v248, v248
    v_mfma_f32_16x16x32_bf16 v[140:143], a[176:179], v[64:67], v[8:11]
    ds_read_b64_tr_b16 a[154:155], v35 offset:20480
    v_cvt_pk_bf16_f32 v235, v238, v239
    v_mfma_f32_16x16x32_bf16 v[140:143], a[180:183], v[68:71], v[140:143]
    v_exp_f32 v249, v249
    v_mfma_f32_16x16x32_bf16 v[140:143], a[184:187], v[72:75], v[140:143]
    ds_read_b64_tr_b16 a[156:157], v35 offset:24576
    v_mfma_f32_16x16x32_bf16 v[140:143], a[188:191], v[76:79], v[140:143]
    v_exp_f32 v250, v250
    v_mfma_f32_16x16x32_bf16 v[156:159], a[176:179], v[80:83], v[12:15]
    v_cvt_pk_bf16_f32 v248, v248, v249
    v_mfma_f32_16x16x32_bf16 v[156:159], a[180:183], v[84:87], v[156:159]
    v_exp_f32 v251, v251
    v_mfma_f32_16x16x32_bf16 v[156:159], a[184:187], v[88:91], v[156:159]
    ds_read_b64_tr_b16 a[158:159], v35 offset:28672
    v_mfma_f32_16x16x32_bf16 v[156:159], a[188:191], v[92:95], v[156:159]
    v_exp_f32 v252, v252
    v_mfma_f32_16x16x32_bf16 v[172:175], a[176:179], v[96:99], v[24:27]
    v_cvt_pk_bf16_f32 v249, v250, v251
    v_mfma_f32_16x16x32_bf16 v[172:175], a[180:183], v[100:103], v[172:175]
    v_exp_f32 v253, v253
    v_mfma_f32_16x16x32_bf16 v[172:175], a[184:187], v[104:107], v[172:175]
    v_mfma_f32_16x16x32_bf16 v[172:175], a[188:191], v[108:111], v[172:175]
    v_exp_f32 v254, v254
    v_mfma_f32_16x16x32_bf16 v[188:191], a[176:179], v[112:115], v[28:31]
    ds_read_b32 v17, v18
    v_cvt_pk_bf16_f32 v250, v252, v253
    v_mfma_f32_16x16x32_bf16 v[188:191], a[180:183], v[116:119], v[188:191]
    v_exp_f32 v255, v255
    v_mfma_f32_16x16x32_bf16 v[188:191], a[184:187], v[120:123], v[188:191]
    v_mfma_f32_16x16x32_bf16 v[188:191], a[188:191], v[124:127], v[188:191]
    s_nop 0
    v_cvt_pk_bf16_f32 v251, v254, v255
    s_waitcnt lgkmcnt(0)
    s_mov_b32 s87, 7
.p2align 6
L_att:
    v_mfma_f32_16x16x32_bf16 a[0:3], a[128:131], v[192:195], a[0:3]
    v_exp_f32 v128, v128
    v_mfma_f32_16x16x32_bf16 a[0:3], a[132:135], v[200:203], a[0:3]
    v_cmp_gt_u32 vcc, s98, v17
    v_mfma_f32_16x16x32_bf16 a[4:7], a[128:131], v[208:211], a[4:7]
    v_exp_f32 v129, v129
    v_mfma_f32_16x16x32_bf16 a[4:7], a[132:135], v[216:219], a[4:7]
    s_cbranch_vccnz L_spin0
L_spun0:
    v_mfma_f32_16x16x32_bf16 a[8:11], a[128:131], v[224:227], a[8:11]
    v_exp_f32 v130, v130
    v_mfma_f32_16x16x32_bf16 a[8:11], a[132:135], v[232:235], a[8:11]
    s_add_u32 s98, s98, 4
    v_cvt_pk_bf16_f32 v128, v128, v129
    v_mfma_f32_16x16x32_bf16 a[12:15], a[128:131], v[240:243], a[12:15]
    v_exp_f32 v131, v131
    v_mfma_f32_16x16x32_bf16 a[12:15], a[132:135], v[248:251], a[12:15]
    ds_read_b128 a[160:163], v20 offset:32768
    ds_read_b128 a[164:167], v21 offset:32768
    v_mfma_f32_16x16x32_bf16 a[16:19], a[136:139], v[192:195], a[16:19]
    v_exp_f32 v132, v132
    v_mfma_f32_16x16x32_bf16 a[16:19], a[140:143], v[200:203], a[16:19]
    ds_read_b64_tr_b16 a[128:129], v36 offset:16384
    v_cvt_pk_bf16_f32 v129, v130, v131
    v_mfma_f32_16x16x32_bf16 a[20:23], a[136:139], v[208:211], a[20:23]
    v_exp_f32 v133, v133
    v_mfma_f32_16x16x32_bf16 a[20:23], a[140:143], v[216:219], a[20:23]
    ds_read_b64_tr_b16 a[130:131], v36 offset:20480
    ds_read_b64_tr_b16 a[132:133], v36 offset:24576
    v_mfma_f32_16x16x32_bf16 a[24:27], a[136:139], v[224:227], a[24:27]
    v_exp_f32 v134, v134
    v_mfma_f32_16x16x32_bf16 a[24:27], a[140:143], v[232:235], a[24:27]
    ds_read_b64_tr_b16 a[134:135], v36 offset:28672
    v_cvt_pk_bf16_f32 v130, v132, v133
    v_mfma_f32_16x16x32_bf16 a[28:31], a[136:139], v[240:243], a[28:31]
    v_exp_f32 v135, v135
    v_mfma_f32_16x16x32_bf16 a[28:31], a[140:143], v[248:251], a[28:31]
    ds_read_b128 a[168:171], v22 offset:32768
    ds_read_b128 a[172:175], v23 offset:32768
    v_mfma_f32_16x16x32_bf16 a[192:195], a[208:211], v[192:195], a[192:195]
    ds_read_b64_tr_b16 a[136:137], v37 offset:16384
    ds_read_b64_tr_b16 a[138:139], v37 offset:20480
    v_mfma_f32_16x16x32_bf16 a[192:195], a[208:211], v[200:203], a[192:195]
    v_exp_f32 v144, v144
    v_mfma_f32_16x16x32_bf16 a[32:35], a[144:147], v[192:195], a[32:35]
    ds_read_b64_tr_b16 a[140:141], v37 offset:24576
    v_cvt_pk_bf16_f32 v131, v134, v135
    v_mfma_f32_16x16x32_bf16 a[32:35], a[148:151], v[200:203], a[32:35]
    v_exp_f32 v145, v145
    v_mfma_f32_16x16x32_bf16 a[36:39], a[144:147], v[208:211], a[36:39]
    ds_read_b64_tr_b16 a[142:143], v37 offset:28672
    buffer_load_dword v63, v16, s[52:55], s3 offen
    v_mfma_f32_16x16x32_bf16 a[36:39], a[148:151], v[216:219], a[36:39]
    v_exp_f32 v146, v146
    v_mfma_f32_16x16x32_bf16 a[40:43], a[144:147], v[224:227], a[40:43]
    s_add_u32 m0, s90, 65536
    v_cvt_pk_bf16_f32 v144, v144, v145
    v_mfma_f32_16x16x32_bf16 a[40:43], a[148:151], v[232:235], a[40:43]
    v_exp_f32 v147, v147
    v_mfma_f32_16x16x32_bf16 a[44:47], a[144:147], v[240:243], a[44:47]
    v_mfma_f32_16x16x32_bf16 a[44:47], a[148:151], v[248:251], a[44:47]
    v_exp_f32 v148, v148
    v_mfma_f32_16x16x32_bf16 a[48:51], a[152:155], v[192:195], a[48:51]
    ds_read_b64_tr_b16 a[144:145], v38 offset:16384
    v_cvt_pk_bf16_f32 v145, v146, v147
    v_mfma_f32_16x16x32_bf16 a[48:51], a[156:159], v[200:203], a[48:51]
    v_exp_f32 v149, v149
    v_mfma_f32_16x16x32_bf16 a[52:55], a[152:155], v[208:211], a[52:55]
    ds_read_b64_tr_b16 a[146:147], v38 offset:20480
    ds_read_b64_tr_b16 a[148:149], v38 offset:24576
    v_mfma_f32_16x16x32_bf16 a[52:55], a[156:159], v[216:219], a[52:55]
    v_exp_f32 v150, v150
    v_mfma_f32_16x16x32_bf16 a[56:59], a[152:155], v[224:227], a[56:59]
    ds_read_b64_tr_b16 a[150:151], v38 offset:28672
    v_cvt_pk_bf16_f32 v146, v148, v149
    v_mfma_f32_16x16x32_bf16 a[56:59], a[156:159], v[232:235], a[56:59]
    v_exp_f32 v151, v151
    v_mfma_f32_16x16x32_bf16 a[60:63], a[152:155], v[240:243], a[60:63]
    buffer_load_dwordx4 v56, s[40:43], s89 offen offset:0 nt lds
    v_mfma_f32_16x16x32_bf16 a[60:63], a[156:159], v[248:251], a[60:63]
    v_mfma_f32_16x16x32_bf16 a[196:199], a[208:211], v[208:211], a[196:199]
    v_exp_f32 v160, v160
    v_mfma_f32_16x16x32_bf16 a[196:199], a[208:211], v[216:219], a[196:199]
    v_cvt_pk_bf16_f32 v147, v150, v151
    s_waitcnt lgkmcnt(10)
    v_mfma_f32_16x16x32_bf16 a[64:67], a[128:131], v[192:195], a[64:67]
    buffer_load_dwordx4 v57, s[40:43], s89 offen offset:1024 nt lds
    v_exp_f32 v161, v161
    v_mfma_f32_16x16x32_bf16 a[64:67], a[132:135], v[200:203], a[64:67]
    ds_read_b64_tr_b16 a[152:153], v39 offset:16384
    ds_read_b64_tr_b16 a[154:155], v39 offset:20480
    v_mfma_f32_16x16x32_bf16 a[68:71], a[128:131], v[208:211], a[68:71]
    v_exp_f32 v162, v162
    v_mfma_f32_16x16x32_bf16 a[68:71], a[132:135], v[216:219], a[68:71]
    ds_read_b64_tr_b16 a[156:157], v39 offset:24576
    v_cvt_pk_bf16_f32 v160, v160, v161
    v_mfma_f32_16x16x32_bf16 a[72:75], a[128:131], v[224:227], a[72:75]
    v_exp_f32 v163, v163
    v_mfma_f32_16x16x32_bf16 a[72:75], a[132:135], v[232:235], a[72:75]
    ds_read_b64_tr_b16 a[158:159], v39 offset:28672
    ds_read_b128 a[176:179], v20 offset:36864
    v_mfma_f32_16x16x32_bf16 a[76:79], a[128:131], v[240:243], a[76:79]
    v_exp_f32 v164, v164
    v_mfma_f32_16x16x32_bf16 a[76:79], a[132:135], v[248:251], a[76:79]
    v_cvt_pk_bf16_f32 v161, v162, v163
    s_waitcnt lgkmcnt(9)
    v_mfma_f32_16x16x32_bf16 a[80:83], a[136:139], v[192:195], a[80:83]
    v_exp_f32 v165, v165
    v_mfma_f32_16x16x32_bf16 a[80:83], a[140:143], v[200:203], a[80:83]
    ds_read_b128 a[180:183], v21 offset:36864
    ds_read_b128 a[184:187], v22 offset:36864
    v_mfma_f32_16x16x32_bf16 a[84:87], a[136:139], v[208:211], a[84:87]
    v_exp_f32 v166, v166
    v_mfma_f32_16x16x32_bf16 a[84:87], a[140:143], v[216:219], a[84:87]
    ds_read_b128 a[188:191], v23 offset:36864
    v_cvt_pk_bf16_f32 v162, v164, v165
    v_mfma_f32_16x16x32_bf16 a[88:91], a[136:139], v[224:227], a[88:91]
    v_exp_f32 v167, v167
    v_mfma_f32_16x16x32_bf16 a[88:91], a[140:143], v[232:235], a[88:91]
    buffer_load_dwordx4 v56, s[40:43], s89 offen offset:2048 nt lds
    v_mfma_f32_16x16x32_bf16 a[92:95], a[136:139], v[240:243], a[92:95]
    v_mfma_f32_16x16x32_bf16 a[92:95], a[140:143], v[248:251], a[92:95]
    v_exp_f32 v176, v176
    v_mfma_f32_16x16x32_bf16 a[200:203], a[208:211], v[224:227], a[200:203]
    v_cvt_pk_bf16_f32 v163, v166, v167
    s_waitcnt lgkmcnt(8)
    v_mfma_f32_16x16x32_bf16 a[200:203], a[208:211], v[232:235], a[200:203]
    v_exp_f32 v177, v177
    v_mfma_f32_16x16x32_bf16 a[96:99], a[144:147], v[192:195], a[96:99]
    buffer_load_dwordx4 v57, s[40:43], s89 offen offset:3072 nt lds
    v_mfma_f32_16x16x32_bf16 a[96:99], a[148:151], v[200:203], a[96:99]
    v_exp_f32 v178, v178
    v_mfma_f32_16x16x32_bf16 a[100:103], a[144:147], v[208:211], a[100:103]
    v_cvt_pk_bf16_f32 v176, v176, v177
    v_mfma_f32_16x16x32_bf16 a[100:103], a[148:151], v[216:219], a[100:103]
    v_exp_f32 v179, v179
    v_mfma_f32_16x16x32_bf16 a[104:107], a[144:147], v[224:227], a[104:107]
    s_add_u32 s89, s89, 16384
    v_mfma_f32_16x16x32_bf16 a[104:107], a[148:151], v[232:235], a[104:107]
    v_exp_f32 v180, v180
    v_mfma_f32_16x16x32_bf16 a[108:111], a[144:147], v[240:243], a[108:111]
    v_cvt_pk_bf16_f32 v177, v178, v179
    s_waitcnt lgkmcnt(4)
    v_mfma_f32_16x16x32_bf16 a[108:111], a[148:151], v[248:251], a[108:111]
    v_exp_f32 v181, v181
    v_mfma_f32_16x16x32_bf16 a[112:115], a[152:155], v[192:195], a[112:115]
    v_mfma_f32_16x16x32_bf16 a[112:115], a[156:159], v[200:203], a[112:115]
    v_exp_f32 v182, v182
    v_mfma_f32_16x16x32_bf16 a[116:119], a[152:155], v[208:211], a[116:119]
    v_cvt_pk_bf16_f32 v178, v180, v181
    v_mfma_f32_16x16x32_bf16 a[116:119], a[156:159], v[216:219], a[116:119]
    v_exp_f32 v183, v183
    v_mfma_f32_16x16x32_bf16 a[120:123], a[152:155], v[224:227], a[120:123]
    s_add_u32 m0, s90, 16384
    v_mfma_f32_16x16x32_bf16 a[120:123], a[156:159], v[232:235], a[120:123]
    v_mfma_f32_16x16x32_bf16 a[124:127], a[152:155], v[240:243], a[124:127]
    v_exp_f32 v136, v136
    v_mfma_f32_16x16x32_bf16 a[124:127], a[156:159], v[248:251], a[124:127]
    v_cvt_pk_bf16_f32 v179, v182, v183
    v_mfma_f32_16x16x32_bf16 a[204:207], a[208:211], v[240:243], a[204:207]
    v_exp_f32 v137, v137
    v_mfma_f32_16x16x32_bf16 a[204:207], a[208:211], v[248:251], a[204:207]
    s_waitcnt lgkmcnt(0)
    v_mfma_f32_16x16x32_bf16 v[192:195], a[160:163], v[64:67], v[8:11]
    v_exp_f32 v138, v138
    v_mfma_f32_16x16x32_bf16 v[192:195], a[164:167], v[68:71], v[192:195]
    ds_read_b64_tr_b16 a[128:129], v32 offset:32768
    v_cvt_pk_bf16_f32 v136, v136, v137
    v_mfma_f32_16x16x32_bf16 v[192:195], a[168:171], v[72:75], v[192:195]
    v_exp_f32 v139, v139
    v_mfma_f32_16x16x32_bf16 v[192:195], a[172:175], v[76:79], v[192:195]
    ds_read_b64_tr_b16 a[130:131], v32 offset:36864
    buffer_load_dwordx4 v52, s[36:39], s88 offen offset:0 nt lds
    v_mfma_f32_16x16x32_bf16 v[208:211], a[160:163], v[80:83], v[12:15]
    v_exp_f32 v140, v140
    v_mfma_f32_16x16x32_bf16 v[208:211], a[164:167], v[84:87], v[208:211]
    v_cvt_pk_bf16_f32 v137, v138, v139
    v_mfma_f32_16x16x32_bf16 v[208:211], a[168:171], v[88:91], v[208:211]
    v_exp_f32 v141, v141
    v_mfma_f32_16x16x32_bf16 v[208:211], a[172:175], v[92:95], v[208:211]
    ds_read_b64_tr_b16 a[132:133], v32 offset:40960
    v_mfma_f32_16x16x32_bf16 v[224:227], a[160:163], v[96:99], v[24:27]
    v_exp_f32 v142, v142
    v_mfma_f32_16x16x32_bf16 v[224:227], a[164:167], v[100:103], v[224:227]
    buffer_load_dwordx4 v53, s[36:39], s88 offen offset:1024 nt lds
    v_cvt_pk_bf16_f32 v138, v140, v141
    v_mfma_f32_16x16x32_bf16 v[224:227], a[168:171], v[104:107], v[224:227]
    v_exp_f32 v143, v143
    v_mfma_f32_16x16x32_bf16 v[224:227], a[172:175], v[108:111], v[224:227]
    ds_read_b64_tr_b16 a[134:135], v32 offset:45056
    v_mfma_f32_16x16x32_bf16 v[240:243], a[160:163], v[112:115], v[28:31]
    v_mfma_f32_16x16x32_bf16 v[240:243], a[164:167], v[116:119], v[240:243]
    v_exp_f32 v152, v152
    v_mfma_f32_16x16x32_bf16 v[240:243], a[168:171], v[120:123], v[240:243]
    ds_read_b64_tr_b16 a[136:137], v33 offset:32768
    v_cvt_pk_bf16_f32 v139, v142, v143
    v_mfma_f32_16x16x32_bf16 v[240:243], a[172:175], v[124:127], v[240:243]
    v_exp_f32 v153, v153
    v_mfma_f32_16x16x32_bf16 v[196:199], a[176:179], v[64:67], v[8:11]
    ds_read_b128 a[160:163], v20 offset:40960
    ds_read_b128 a[164:167], v21 offset:40960
    v_mfma_f32_16x16x32_bf16 v[196:199], a[180:183], v[68:71], v[196:199]
    v_exp_f32 v154, v154
    v_mfma_f32_16x16x32_bf16 v[196:199], a[184:187], v[72:75], v[196:199]
    ds_read_b128 a[168:171], v22 offset:40960
    v_cvt_pk_bf16_f32 v152, v152, v153
    v_mfma_f32_16x16x32_bf16 v[196:199], a[188:191], v[76:79], v[196:199]
    v_exp_f32 v155, v155
    v_mfma_f32_16x16x32_bf16 v[212:215], a[176:179], v[80:83], v[12:15]
    ds_read_b128 a[172:175], v23 offset:40960
    ds_read_b64_tr_b16 a[138:139], v33 offset:36864
    v_mfma_f32_16x16x32_bf16 v[212:215], a[180:183], v[84:87], v[212:215]
    v_exp_f32 v156, v156
    v_mfma_f32_16x16x32_bf16 v[212:215], a[184:187], v[88:91], v[212:215]
    ds_read_b64_tr_b16 a[140:141], v33 offset:40960
    v_cvt_pk_bf16_f32 v153, v154, v155
    v_mfma_f32_16x16x32_bf16 v[212:215], a[188:191], v[92:95], v[212:215]
    v_exp_f32 v157, v157
    v_mfma_f32_16x16x32_bf16 v[228:231], a[176:179], v[96:99], v[24:27]
    buffer_load_dwordx4 v54, s[36:39], s88 offen offset:2048 nt lds
    v_mfma_f32_16x16x32_bf16 v[228:231], a[180:183], v[100:103], v[228:231]
    v_exp_f32 v158, v158
    v_mfma_f32_16x16x32_bf16 v[228:231], a[184:187], v[104:107], v[228:231]
    ds_read_b64_tr_b16 a[142:143], v33 offset:45056
    v_cvt_pk_bf16_f32 v154, v156, v157
    v_mfma_f32_16x16x32_bf16 v[228:231], a[188:191], v[108:111], v[228:231]
    v_exp_f32 v159, v159
    v_mfma_f32_16x16x32_bf16 v[244:247], a[176:179], v[112:115], v[28:31]
    buffer_load_dwordx4 v55, s[36:39], s88 offen offset:3072 nt lds
    v_mfma_f32_16x16x32_bf16 v[244:247], a[180:183], v[116:119], v[244:247]
    ds_read_b64_tr_b16 a[144:145], v34 offset:32768
    v_mfma_f32_16x16x32_bf16 v[244:247], a[184:187], v[120:123], v[244:247]
    v_exp_f32 v168, v168
    v_mfma_f32_16x16x32_bf16 v[244:247], a[188:191], v[124:127], v[244:247]
    v_cvt_pk_bf16_f32 v155, v158, v159
    s_waitcnt lgkmcnt(4)
    v_mfma_f32_16x16x32_bf16 v[200:203], a[160:163], v[64:67], v[8:11]
    ds_read_b64_tr_b16 a[146:147], v34 offset:36864
    v_exp_f32 v169, v169
    v_mfma_f32_16x16x32_bf16 v[200:203], a[164:167], v[68:71], v[200:203]
    ds_read_b128 a[176:179], v20 offset:45056
    ds_read_b128 a[180:183], v21 offset:45056
    s_add_u32 s88, s88, 16384
    v_mfma_f32_16x16x32_bf16 v[200:203], a[168:171], v[72:75], v[200:203]
    v_exp_f32 v170, v170
    v_mfma_f32_16x16x32_bf16 v[200:203], a[172:175], v[76:79], v[200:203]
    ds_read_b128 a[184:187], v22 offset:45056
    v_cvt_pk_bf16_f32 v168, v168, v169
    v_mfma_f32_16x16x32_bf16 v[216:219], a[160:163], v[80:83], v[12:15]
    v_exp_f32 v171, v171
    v_mfma_f32_16x16x32_bf16 v[216:219], a[164:167], v[84:87], v[216:219]
    ds_read_b128 a[188:191], v23 offset:45056
    ds_read_b64_tr_b16 a[148:149], v34 offset:40960
    v_mfma_f32_16x16x32_bf16 v[216:219], a[168:171], v[88:91], v[216:219]
    v_exp_f32 v172, v172
    v_mfma_f32_16x16x32_bf16 v[216:219], a[172:175], v[92:95], v[216:219]
    ds_read_b64_tr_b16 a[150:151], v34 offset:45056
    v_cvt_pk_bf16_f32 v169, v170, v171
    v_mfma_f32_16x16x32_bf16 v[232:235], a[160:163], v[96:99], v[24:27]
    v_exp_f32 v173, v173
    v_mfma_f32_16x16x32_bf16 v[232:235], a[164:167], v[100:103], v[232:235]
    v_mfma_f32_16x16x32_bf16 v[232:235], a[168:171], v[104:107], v[232:235]
    v_exp_f32 v174, v174
    v_mfma_f32_16x16x32_bf16 v[232:235], a[172:175], v[108:111], v[232:235]
    ds_read_b64_tr_b16 a[152:153], v35 offset:32768
    v_cvt_pk_bf16_f32 v170, v172, v173
    v_mfma_f32_16x16x32_bf16 v[248:251], a[160:163], v[112:115], v[28:31]
    v_exp_f32 v175, v175
    v_mfma_f32_16x16x32_bf16 v[248:251], a[164:167], v[116:119], v[248:251]
    v_mfma_f32_16x16x32_bf16 v[248:251], a[168:171], v[120:123], v[248:251]
    s_waitcnt vmcnt(13) lgkmcnt(3)
    ds_add_u32 v18, v19
    v_mfma_f32_16x16x32_bf16 v[248:251], a[172:175], v[124:127], v[248:251]
    v_exp_f32 v184, v184
    v_mfma_f32_16x16x32_bf16 v[204:207], a[176:179], v[64:67], v[8:11]
    ds_read_b64_tr_b16 a[154:155], v35 offset:36864
    v_cvt_pk_bf16_f32 v171, v174, v175
    v_mfma_f32_16x16x32_bf16 v[204:207], a[180:183], v[68:71], v[204:207]
    v_exp_f32 v185, v185
    v_mfma_f32_16x16x32_bf16 v[204:207], a[184:187], v[72:75], v[204:207]
    ds_read_b64_tr_b16 a[156:157], v35 offset:40960
    v_mfma_f32_16x16x32_bf16 v[204:207], a[188:191], v[76:79], v[204:207]
    v_exp_f32 v186, v186
    v_mfma_f32_16x16x32_bf16 v[220:223], a[176:179], v[80:83], v[12:15]
    v_cvt_pk_bf16_f32 v184, v184, v185
    v_mfma_f32_16x16x32_bf16 v[220:223], a[180:183], v[84:87], v[220:223]
    v_exp_f32 v187, v187
    v_mfma_f32_16x16x32_bf16 v[220:223], a[184:187], v[88:91], v[220:223]
    ds_read_b64_tr_b16 a[158:159], v35 offset:45056
    v_mfma_f32_16x16x32_bf16 v[220:223], a[188:191], v[92:95], v[220:223]
    v_exp_f32 v188, v188
    v_mfma_f32_16x16x32_bf16 v[236:239], a[176:179], v[96:99], v[24:27]
    v_cvt_pk_bf16_f32 v185, v186, v187
    v_mfma_f32_16x16x32_bf16 v[236:239], a[180:183], v[100:103], v[236:239]
    v_exp_f32 v189, v189
    v_mfma_f32_16x16x32_bf16 v[236:239], a[184:187], v[104:107], v[236:239]
    v_mfma_f32_16x16x32_bf16 v[236:239], a[188:191], v[108:111], v[236:239]
    v_exp_f32 v190, v190
    v_mfma_f32_16x16x32_bf16 v[252:255], a[176:179], v[112:115], v[28:31]
    ds_read_b32 v17, v18
    v_cvt_pk_bf16_f32 v186, v188, v189
    v_mfma_f32_16x16x32_bf16 v[252:255], a[180:183], v[116:119], v[252:255]
    v_exp_f32 v191, v191
    v_mfma_f32_16x16x32_bf16 v[252:255], a[184:187], v[120:123], v[252:255]
    v_mfma_f32_16x16x32_bf16 v[252:255], a[188:191], v[124:127], v[252:255]
    s_nop 0
    v_cvt_pk_bf16_f32 v187, v190, v191
    s_waitcnt lgkmcnt(0)
    s_cmp_eq_u32 s87, s99
    s_cbranch_scc1 L_rkA
L_rkAb:
    v_mfma_f32_16x16x32_bf16 a[0:3], a[128:131], v[128:131], a[0:3]
    v_exp_f32 v192, v192
    v_mfma_f32_16x16x32_bf16 a[0:3], a[132:135], v[136:139], a[0:3]
    v_cmp_gt_u32 vcc, s98, v17
    v_mfma_f32_16x16x32_bf16 a[4:7], a[128:131], v[144:147], a[4:7]
    v_exp_f32 v193, v193
    v_mfma_f32_16x16x32_bf16 a[4:7], a[132:135], v[152:155], a[4:7]
    s_cbranch_vccnz L_spin1
L_spun1:
    v_mfma_f32_16x16x32_bf16 a[8:11], a[128:131], v[160:163], a[8:11]
    v_exp_f32 v194, v194
    v_mfma_f32_16x16x32_bf16 a[8:11], a[132:135], v[168:171], a[8:11]
    s_add_u32 s98, s98, 4
    v_cvt_pk_bf16_f32 v192, v192, v193
    v_mfma_f32_16x16x32_bf16 a[12:15], a[128:131], v[176:179], a[12:15]
    v_exp_f32 v195, v195
    v_mfma_f32_16x16x32_bf16 a[12:15], a[132:135], v[184:187], a[12:15]
    ds_read_b128 a[160:163], v20 offset:49152
    ds_read_b128 a[164:167], v21 offset:49152
    v_mfma_f32_16x16x32_bf16 a[16:19], a[136:139], v[128:131], a[16:19]
    v_exp_f32 v196, v196
    v_mfma_f32_16x16x32_bf16 a[16:19], a[140:143], v[136:139], a[16:19]
    ds_read_b64_tr_b16 a[128:129], v36 offset:32768
    v_cvt_pk_bf16_f32 v193, v194, v195
    v_mfma_f32_16x16x32_bf16 a[20:23], a[136:139], v[144:147], a[20:23]
    v_exp_f32 v197, v197
    v_mfma_f32_16x16x32_bf16 a[20:23], a[140:143], v[152:155], a[20:23]
    ds_read_b64_tr_b16 a[130:131], v36 offset:36864
    ds_read_b64_tr_b16 a[132:133], v36 offset:40960
    v_mfma_f32_16x16x32_bf16 a[24:27], a[136:139], v[160:163], a[24:27]
    v_exp_f32 v198, v198
    v_mfma_f32_16x16x32_bf16 a[24:27], a[140:143], v[168:171], a[24:27]
    ds_read_b64_tr_b16 a[134:135], v36 offset:45056
    v_cvt_pk_bf16_f32 v194, v196, v197
    v_mfma_f32_16x16x32_bf16 a[28:31], a[136:139], v[176:179], a[28:31]
    v_exp_f32 v199, v199
    v_mfma_f32_16x16x32_bf16 a[28:31], a[140:143], v[184:187], a[28:31]
    ds_read_b128 a[168:171], v22 offset:49152
    ds_read_b128 a[172:175], v23 offset:49152
    v_mfma_f32_16x16x32_bf16 a[192:195], a[208:211], v[128:131], a[192:195]
    ds_read_b64_tr_b16 a[136:137], v37 offset:32768
    ds_read_b64_tr_b16 a[138:139], v37 offset:36864
    v_mfma_f32_16x16x32_bf16 a[192:195], a[208:211], v[136:139], a[192:195]
    v_exp_f32 v208, v208
    v_mfma_f32_16x16x32_bf16 a[32:35], a[144:147], v[128:131], a[32:35]
    ds_read_b64_tr_b16 a[140:141], v37 offset:40960
    v_cvt_pk_bf16_f32 v195, v198, v199
    v_mfma_f32_16x16x32_bf16 a[32:35], a[148:151], v[136:139], a[32:35]
    v_exp_f32 v209, v209
    v_mfma_f32_16x16x32_bf16 a[36:39], a[144:147], v[144:147], a[36:39]
    ds_read_b64_tr_b16 a[142:143], v37 offset:45056
    buffer_load_dword v63, v16, s[48:51], s3 offen
    v_mfma_f32_16x16x32_bf16 a[36:39], a[148:151], v[152:155], a[36:39]
    v_exp_f32 v210, v210
    v_mfma_f32_16x16x32_bf16 a[40:43], a[144:147], v[160:163], a[40:43]
    s_add_u32 m0, s90, 81920
    v_cvt_pk_bf16_f32 v208, v208, v209
    v_mfma_f32_16x16x32_bf16 a[40:43], a[148:151], v[168:171], a[40:43]
    v_exp_f32 v211, v211
    v_mfma_f32_16x16x32_bf16 a[44:47], a[144:147], v[176:179], a[44:47]
    v_mfma_f32_16x16x32_bf16 a[44:47], a[148:151], v[184:187], a[44:47]
    v_exp_f32 v212, v212
    v_mfma_f32_16x16x32_bf16 a[48:51], a[152:155], v[128:131], a[48:51]
    ds_read_b64_tr_b16 a[144:145], v38 offset:32768
    v_cvt_pk_bf16_f32 v209, v210, v211
    v_mfma_f32_16x16x32_bf16 a[48:51], a[156:159], v[136:139], a[48:51]
    v_exp_f32 v213, v213
    v_mfma_f32_16x16x32_bf16 a[52:55], a[152:155], v[144:147], a[52:55]
    ds_read_b64_tr_b16 a[146:147], v38 offset:36864
    ds_read_b64_tr_b16 a[148:149], v38 offset:40960
    v_mfma_f32_16x16x32_bf16 a[52:55], a[156:159], v[152:155], a[52:55]
    v_exp_f32 v214, v214
    v_mfma_f32_16x16x32_bf16 a[56:59], a[152:155], v[160:163], a[56:59]
    ds_read_b64_tr_b16 a[150:151], v38 offset:45056
    v_cvt_pk_bf16_f32 v210, v212, v213
    v_mfma_f32_16x16x32_bf16 a[56:59], a[156:159], v[168:171], a[56:59]
    v_exp_f32 v215, v215
    v_mfma_f32_16x16x32_bf16 a[60:63], a[152:155], v[176:179], a[60:63]
    buffer_load_dwordx4 v56, s[40:43], s89 offen offset:0 nt lds
    v_mfma_f32_16x16x32_bf16 a[60:63], a[156:159], v[184:187], a[60:63]
    v_mfma_f32_16x16x32_bf16 a[196:199], a[208:211], v[144:147], a[196:199]
    v_exp_f32 v224, v224
    v_mfma_f32_16x16x32_bf16 a[196:199], a[208:211], v[152:155], a[196:199]
    v_cvt_pk_bf16_f32 v211, v214, v215
    s_waitcnt lgkmcnt(10)
    v_mfma_f32_16x16x32_bf16 a[64:67], a[128:131], v[128:131], a[64:67]
    buffer_load_dwordx4 v57, s[40:43], s89 offen offset:1024 nt lds
    v_exp_f32 v225, v225
    v_mfma_f32_16x16x32_bf16 a[64:67], a[132:135], v[136:139], a[64:67]
    ds_read_b64_tr_b16 a[152:153], v39 offset:32768
    ds_read_b64_tr_b16 a[154:155], v39 offset:36864
    v_mfma_f32_16x16x32_bf16 a[68:71], a[128:131], v[144:147], a[68:71]
    v_exp_f32 v226, v226
    v_mfma_f32_16x16x32_bf16 a[68:71], a[132:135], v[152:155], a[68:71]
    ds_read_b64_tr_b16 a[156:157], v39 offset:40960
    v_cvt_pk_bf16_f32 v224, v224, v225
    v_mfma_f32_16x16x32_bf16 a[72:75], a[128:131], v[160:163], a[72:75]
    v_exp_f32 v227, v227
    v_mfma_f32_16x16x32_bf16 a[72:75], a[132:135], v[168:171], a[72:75]
    ds_read_b64_tr_b16 a[158:159], v39 offset:45056
    ds_read_b128 a[176:179], v20 offset:53248
    v_mfma_f32_16x16x32_bf16 a[76:79], a[128:131], v[176:179], a[76:79]
    v_exp_f32 v228, v228
    v_mfma_f32_16x16x32_bf16 a[76:79], a[132:135], v[184:187], a[76:79]
    v_cvt_pk_bf16_f32 v225, v226, v227
    s_waitcnt lgkmcnt(9)
    v_mfma_f32_16x16x32_bf16 a[80:83], a[136:139], v[128:131], a[80:83]
    v_exp_f32 v229, v229
    v_mfma_f32_16x16x32_bf16 a[80:83], a[140:143], v[136:139], a[80:83]
    ds_read_b128 a[180:183], v21 offset:53248
    ds_read_b128 a[184:187], v22 offset:53248
    v_mfma_f32_16x16x32_bf16 a[84:87], a[136:139], v[144:147], a[84:87]
    v_exp_f32 v230, v230
    v_mfma_f32_16x16x32_bf16 a[84:87], a[140:143], v[152:155], a[84:87]
    ds_read_b128 a[188:191], v23 offset:53248
    v_cvt_pk_bf16_f32 v226, v228, v229
    v_mfma_f32_16x16x32_bf16 a[88:91], a[136:139], v[160:163], a[88:91]
    v_exp_f32 v231, v231
    v_mfma_f32_16x16x32_bf16 a[88:91], a[140:143], v[168:171], a[88:91]
    buffer_load_dwordx4 v56, s[40:43], s89 offen offset:2048 nt lds
    v_mfma_f32_16x16x32_bf16 a[92:95], a[136:139], v[176:179], a[92:95]
    v_mfma_f32_16x16x32_bf16 a[92:95], a[140:143], v[184:187], a[92:95]
    v_exp_f32 v240, v240
    v_mfma_f32_16x16x32_bf16 a[200:203], a[208:211], v[160:163], a[200:203]
    v_cvt_pk_bf16_f32 v227, v230, v231
    s_waitcnt lgkmcnt(8)
    v_mfma_f32_16x16x32_bf16 a[200:203], a[208:211], v[168:171], a[200:203]
    v_exp_f32 v241, v241
    v_mfma_f32_16x16x32_bf16 a[96:99], a[144:147], v[128:131], a[96:99]
    buffer_load_dwordx4 v57, s[40:43], s89 offen offset:3072 nt lds
    v_mfma_f32_16x16x32_bf16 a[96:99], a[148:151], v[136:139], a[96:99]
    v_exp_f32 v242, v242
    v_mfma_f32_16x16x32_bf16 a[100:103], a[144:147], v[144:147], a[100:103]
    v_cvt_pk_bf16_f32 v240, v240, v241
    v_mfma_f32_16x16x32_bf16 a[100:103], a[148:151], v[152:155], a[100:103]
    v_exp_f32 v243, v243
    v_mfma_f32_16x16x32_bf16 a[104:107], a[144:147], v[160:163], a[104:107]
    s_add_u32 s89, s89, 16384
    v_mfma_f32_16x16x32_bf16 a[104:107], a[148:151], v[168:171], a[104:107]
    v_exp_f32 v244, v244
    v_mfma_f32_16x16x32_bf16 a[108:111], a[144:147], v[176:179], a[108:111]
    v_cvt_pk_bf16_f32 v241, v242, v243
    s_waitcnt lgkmcnt(4)
    v_mfma_f32_16x16x32_bf16 a[108:111], a[148:151], v[184:187], a[108:111]
    v_exp_f32 v245, v245
    v_mfma_f32_16x16x32_bf16 a[112:115], a[152:155], v[128:131], a[112:115]
    v_mfma_f32_16x16x32_bf16 a[112:115], a[156:159], v[136:139], a[112:115]
    v_exp_f32 v246, v246
    v_mfma_f32_16x16x32_bf16 a[116:119], a[152:155], v[144:147], a[116:119]
    v_cvt_pk_bf16_f32 v242, v244, v245
    v_mfma_f32_16x16x32_bf16 a[116:119], a[156:159], v[152:155], a[116:119]
    v_exp_f32 v247, v247
    v_mfma_f32_16x16x32_bf16 a[120:123], a[152:155], v[160:163], a[120:123]
    s_add_u32 m0, s90, 32768
    v_mfma_f32_16x16x32_bf16 a[120:123], a[156:159], v[168:171], a[120:123]
    v_mfma_f32_16x16x32_bf16 a[124:127], a[152:155], v[176:179], a[124:127]
    v_exp_f32 v200, v200
    v_mfma_f32_16x16x32_bf16 a[124:127], a[156:159], v[184:187], a[124:127]
    v_cvt_pk_bf16_f32 v243, v246, v247
    v_mfma_f32_16x16x32_bf16 a[204:207], a[208:211], v[176:179], a[204:207]
    v_exp_f32 v201, v201
    v_mfma_f32_16x16x32_bf16 a[204:207], a[208:211], v[184:187], a[204:207]
    s_waitcnt lgkmcnt(0)
    v_mfma_f32_16x16x32_bf16 v[128:131], a[160:163], v[64:67], v[8:11]
    v_exp_f32 v202, v202
    v_mfma_f32_16x16x32_bf16 v[128:131], a[164:167], v[68:71], v[128:131]
    ds_read_b64_tr_b16 a[128:129], v32 offset:49152
    v_cvt_pk_bf16_f32 v200, v200, v201
    v_mfma_f32_16x16x32_bf16 v[128:131], a[168:171], v[72:75], v[128:131]
    v_exp_f32 v203, v203
    v_mfma_f32_16x16x32_bf16 v[128:131], a[172:175], v[76:79], v[128:131]
    ds_read_b64_tr_b16 a[130:131], v32 offset:53248
    buffer_load_dwordx4 v52, s[36:39], s88 offen offset:0 nt lds
    v_mfma_f32_16x16x32_bf16 v[144:147], a[160:163], v[80:83], v[12:15]
    v_exp_f32 v204, v204
    v_mfma_f32_16x16x32_bf16 v[144:147], a[164:167], v[84:87], v[144:147]
    v_cvt_pk_bf16_f32 v201, v202, v203
    v_mfma_f32_16x16x32_bf16 v[144:147], a[168:171], v[88:91], v[144:147]
    v_exp_f32 v205, v205
    v_mfma_f32_16x16x32_bf16 v[144:147], a[172:175], v[92:95], v[144:147]
    ds_read_b64_tr_b16 a[132:133], v32 offset:57344
    v_mfma_f32_16x16x32_bf16 v[160:163], a[160:163], v[96:99], v[24:27]
    v_exp_f32 v206, v206
    v_mfma_f32_16x16x32_bf16 v[160:163], a[164:167], v[100:103], v[160:163]
    buffer_load_dwordx4 v53, s[36:39], s88 offen offset:1024 nt lds
    v_cvt_pk_bf16_f32 v202, v204, v205
    v_mfma_f32_16x16x32_bf16 v[160:163], a[168:171], v[104:107], v[160:163]
    v_exp_f32 v207, v207
    v_mfma_f32_16x16x32_bf16 v[160:163], a[172:175], v[108:111], v[160:163]
    ds_read_b64_tr_b16 a[134:135], v32 offset:61440
    v_mfma_f32_16x16x32_bf16 v[176:179], a[160:163], v[112:115], v[28:31]
    v_mfma_f32_16x16x32_bf16 v[176:179], a[164:167], v[116:119], v[176:179]
    v_exp_f32 v216, v216
    v_mfma_f32_16x16x32_bf16 v[176:179], a[168:171], v[120:123], v[176:179]
    ds_read_b64_tr_b16 a[136:137], v33 offset:49152
    v_cvt_pk_bf16_f32 v203, v206, v207
    v_mfma_f32_16x16x32_bf16 v[176:179], a[172:175], v[124:127], v[176:179]
    v_exp_f32 v217, v217
    v_mfma_f32_16x16x32_bf16 v[132:135], a[176:179], v[64:67], v[8:11]
    ds_read_b128 a[160:163], v20 offset:57344
    ds_read_b128 a[164:167], v21 offset:57344
    v_mfma_f32_16x16x32_bf16 v[132:135], a[180:183], v[68:71], v[132:135]
    v_exp_f32 v218, v218
    v_mfma_f32_16x16x32_bf16 v[132:135], a[184:187], v[72:75], v[132:135]
    ds_read_b128 a[168:171], v22 offset:57344
    v_cvt_pk_bf16_f32 v216, v216, v217
    v_mfma_f32_16x16x32_bf16 v[132:135], a[188:191], v[76:79], v[132:135]
    v_exp_f32 v219, v219
    v_mfma_f32_16x16x32_bf16 v[148:151], a[176:179], v[80:83], v[12:15]
    ds_read_b128 a[172:175], v23 offset:57344
    ds_read_b64_tr_b16 a[138:139], v33 offset:53248
    v_mfma_f32_16x16x32_bf16 v[148:151], a[180:183], v[84:87], v[148:151]
    v_exp_f32 v220, v220
    v_mfma_f32_16x16x32_bf16 v[148:151], a[184:187], v[88:91], v[148:151]
    ds_read_b64_tr_b16 a[140:141], v33 offset:57344
    v_cvt_pk_bf16_f32 v217, v218, v219
    v_mfma_f32_16x16x32_bf16 v[148:151], a[188:191], v[92:95], v[148:151]
    v_exp_f32 v221, v221
    v_mfma_f32_16x16x32_bf16 v[164:167], a[176:179], v[96:99], v[24:27]
    buffer_load_dwordx4 v54, s[36:39], s88 offen offset:2048 nt lds
    v_mfma_f32_16x16x32_bf16 v[164:167], a[180:183], v[100:103], v[164:167]
    v_exp_f32 v222, v222
    v_mfma_f32_16x16x32_bf16 v[164:167], a[184:187], v[104:107], v[164:167]
    ds_read_b64_tr_b16 a[142:143], v33 offset:61440
    v_cvt_pk_bf16_f32 v218, v220, v221
    v_mfma_f32_16x16x32_bf16 v[164:167], a[188:191], v[108:111], v[164:167]
    v_exp_f32 v223, v223
    v_mfma_f32_16x16x32_bf16 v[180:183], a[176:179], v[112:115], v[28:31]
    buffer_load_dwordx4 v55, s[36:39], s88 offen offset:3072 nt lds
    v_mfma_f32_16x16x32_bf16 v[180:183], a[180:183], v[116:119], v[180:183]
    ds_read_b64_tr_b16 a[144:145], v34 offset:49152
    v_mfma_f32_16x16x32_bf16 v[180:183], a[184:187], v[120:123], v[180:183]
    v_exp_f32 v232, v232
    v_mfma_f32_16x16x32_bf16 v[180:183], a[188:191], v[124:127], v[180:183]
    v_cvt_pk_bf16_f32 v219, v222, v223
    s_waitcnt lgkmcnt(4)
    v_mfma_f32_16x16x32_bf16 v[136:139], a[160:163], v[64:67], v[8:11]
    ds_read_b64_tr_b16 a[146:147], v34 offset:53248
    v_exp_f32 v233, v233
    v_mfma_f32_16x16x32_bf16 v[136:139], a[164:167], v[68:71], v[136:139]
    ds_read_b128 a[176:179], v20 offset:61440
    ds_read_b128 a[180:183], v21 offset:61440
    s_add_u32 s88, s88, 16384
    v_mfma_f32_16x16x32_bf16 v[136:139], a[168:171], v[72:75], v[136:139]
    v_exp_f32 v234, v234
    v_mfma_f32_16x16x32_bf16 v[136:139], a[172:175], v[76:79], v[136:139]
    ds_read_b128 a[184:187], v22 offset:61440
    v_cvt_pk_bf16_f32 v232, v232, v233
    v_mfma_f32_16x16x32_bf16 v[152:155], a[160:163], v[80:83], v[12:15]
    v_exp_f32 v235, v235
    v_mfma_f32_16x16x32_bf16 v[152:155], a[164:167], v[84:87], v[152:155]
    ds_read_b128 a[188:191], v23 offset:61440
    ds_read_b64_tr_b16 a[148:149], v34 offset:57344
    v_mfma_f32_16x16x32_bf16 v[152:155], a[168:171], v[88:91], v[152:155]
    v_exp_f32 v236, v236
    v_mfma_f32_16x16x32_bf16 v[152:155], a[172:175], v[92:95], v[152:155]
    ds_read_b64_tr_b16 a[150:151], v34 offset:61440
    v_cvt_pk_bf16_f32 v233, v234, v235
    v_mfma_f32_16x16x32_bf16 v[168:171], a[160:163], v[96:99], v[24:27]
    v_exp_f32 v237, v237
    v_mfma_f32_16x16x32_bf16 v[168:171], a[164:167], v[100:103], v[168:171]
    v_mfma_f32_16x16x32_bf16 v[168:171], a[168:171], v[104:107], v[168:171]
    v_exp_f32 v238, v238
    v_mfma_f32_16x16x32_bf16 v[168:171], a[172:175], v[108:111], v[168:171]
    ds_read_b64_tr_b16 a[152:153], v35 offset:49152
    v_cvt_pk_bf16_f32 v234, v236, v237
    v_mfma_f32_16x16x32_bf16 v[184:187], a[160:163], v[112:115], v[28:31]
    v_exp_f32 v239, v239
    v_mfma_f32_16x16x32_bf16 v[184:187], a[164:167], v[116:119], v[184:187]
    v_mfma_f32_16x16x32_bf16 v[184:187], a[168:171], v[120:123], v[184:187]
    s_waitcnt vmcnt(13) lgkmcnt(3)
    ds_add_u32 v18, v19
    v_mfma_f32_16x16x32_bf16 v[184:187], a[172:175], v[124:127], v[184:187]
    v_exp_f32 v248, v248
    v_mfma_f32_16x16x32_bf16 v[140:143], a[176:179], v[64:67], v[8:11]
    ds_read_b64_tr_b16 a[154:155], v35 offset:53248
    v_cvt_pk_bf16_f32 v235, v238, v239
    v_mfma_f32_16x16x32_bf16 v[140:143], a[180:183], v[68:71], v[140:143]
    v_exp_f32 v249, v249
    v_mfma_f32_16x16x32_bf16 v[140:143], a[184:187], v[72:75], v[140:143]
    ds_read_b64_tr_b16 a[156:157], v35 offset:57344
    v_mfma_f32_16x16x32_bf16 v[140:143], a[188:191], v[76:79], v[140:143]
    v_exp_f32 v250, v250
    v_mfma_f32_16x16x32_bf16 v[156:159], a[176:179], v[80:83], v[12:15]
    v_cvt_pk_bf16_f32 v248, v248, v249
    v_mfma_f32_16x16x32_bf16 v[156:159], a[180:183], v[84:87], v[156:159]
    v_exp_f32 v251, v251
    v_mfma_f32_16x16x32_bf16 v[156:159], a[184:187], v[88:91], v[156:159]
    ds_read_b64_tr_b16 a[158:159], v35 offset:61440
    v_mfma_f32_16x16x32_bf16 v[156:159], a[188:191], v[92:95], v[156:159]
    v_exp_f32 v252, v252
    v_mfma_f32_16x16x32_bf16 v[172:175], a[176:179], v[96:99], v[24:27]
    v_cvt_pk_bf16_f32 v249, v250, v251
    v_mfma_f32_16x16x32_bf16 v[172:175], a[180:183], v[100:103], v[172:175]
    v_exp_f32 v253, v253
    v_mfma_f32_16x16x32_bf16 v[172:175], a[184:187], v[104:107], v[172:175]
    v_mfma_f32_16x16x32_bf16 v[172:175], a[188:191], v[108:111], v[172:175]
    v_exp_f32 v254, v254
    v_mfma_f32_16x16x32_bf16 v[188:191], a[176:179], v[112:115], v[28:31]
    ds_read_b32 v17, v18
    v_cvt_pk_bf16_f32 v250, v252, v253
    v_mfma_f32_16x16x32_bf16 v[188:191], a[180:183], v[116:119], v[188:191]
    v_exp_f32 v255, v255
    v_mfma_f32_16x16x32_bf16 v[188:191], a[184:187], v[120:123], v[188:191]
    v_mfma_f32_16x16x32_bf16 v[188:191], a[188:191], v[124:127], v[188:191]
    s_nop 0
    v_cvt_pk_bf16_f32 v251, v254, v255
    s_waitcnt lgkmcnt(0)
    v_mfma_f32_16x16x32_bf16 a[0:3], a[128:131], v[192:195], a[0:3]
    v_exp_f32 v128, v128
    v_mfma_f32_16x16x32_bf16 a[0:3], a[132:135], v[200:203], a[0:3]
    v_cmp_gt_u32 vcc, s98, v17
    v_mfma_f32_16x16x32_bf16 a[4:7], a[128:131], v[208:211], a[4:7]
    v_exp_f32 v129, v129
    v_mfma_f32_16x16x32_bf16 a[4:7], a[132:135], v[216:219], a[4:7]
    s_cbranch_vccnz L_spin2
L_spun2:
    v_mfma_f32_16x16x32_bf16 a[8:11], a[128:131], v[224:227], a[8:11]
    v_exp_f32 v130, v130
    v_mfma_f32_16x16x32_bf16 a[8:11], a[132:135], v[232:235], a[8:11]
    s_add_u32 s98, s98, 4
    v_cvt_pk_bf16_f32 v128, v128, v129
    v_mfma_f32_16x16x32_bf16 a[12:15], a[128:131], v[240:243], a[12:15]
    v_exp_f32 v131, v131
    v_mfma_f32_16x16x32_bf16 a[12:15], a[132:135], v[248:251], a[12:15]
    ds_read_b128 a[160:163], v20 offset:0
    ds_read_b128 a[164:167], v21 offset:0
    v_mfma_f32_16x16x32_bf16 a[16:19], a[136:139], v[192:195], a[16:19]
    v_exp_f32 v132, v132
    v_mfma_f32_16x16x32_bf16 a[16:19], a[140:143], v[200:203], a[16:19]
    ds_read_b64_tr_b16 a[128:129], v36 offset:49152
    v_cvt_pk_bf16_f32 v129, v130, v131
    v_mfma_f32_16x16x32_bf16 a[20:23], a[136:139], v[208:211], a[20:23]
    v_exp_f32 v133, v133
    v_mfma_f32_16x16x32_bf16 a[20:23], a[140:143], v[216:219], a[20:23]
    ds_read_b64_tr_b16 a[130:131], v36 offset:53248
    ds_read_b64_tr_b16 a[132:133], v36 offset:57344
    v_mfma_f32_16x16x32_bf16 a[24:27], a[136:139], v[224:227], a[24:27]
    v_exp_f32 v134, v134
    v_mfma_f32_16x16x32_bf16 a[24:27], a[140:143], v[232:235], a[24:27]
    ds_read_b64_tr_b16 a[134:135], v36 offset:61440
    v_cvt_pk_bf16_f32 v130, v132, v133
    v_mfma_f32_16x16x32_bf16 a[28:31], a[136:139], v[240:243], a[28:31]
    v_exp_f32 v135, v135
    v_mfma_f32_16x16x32_bf16 a[28:31], a[140:143], v[248:251], a[28:31]
    ds_read_b128 a[168:171], v22 offset:0
    ds_read_b128 a[172:175], v23 offset:0
    v_mfma_f32_16x16x32_bf16 a[192:195], a[208:211], v[192:195], a[192:195]
    ds_read_b64_tr_b16 a[136:137], v37 offset:49152
    ds_read_b64_tr_b16 a[138:139], v37 offset:53248
    v_mfma_f32_16x16x32_bf16 a[192:195], a[208:211], v[200:203], a[192:195]
    v_exp_f32 v144, v144
    v_mfma_f32_16x16x32_bf16 a[32:35], a[144:147], v[192:195], a[32:35]
    ds_read_b64_tr_b16 a[140:141], v37 offset:57344
    v_cvt_pk_bf16_f32 v131, v134, v135
    v_mfma_f32_16x16x32_bf16 a[32:35], a[148:151], v[200:203], a[32:35]
    v_exp_f32 v145, v145
    v_mfma_f32_16x16x32_bf16 a[36:39], a[144:147], v[208:211], a[36:39]
    ds_read_b64_tr_b16 a[142:143], v37 offset:61440
    buffer_load_dword v63, v16, s[56:59], s3 offen
    v_mfma_f32_16x16x32_bf16 a[36:39], a[148:151], v[216:219], a[36:39]
    v_exp_f32 v146, v146
    v_mfma_f32_16x16x32_bf16 a[40:43], a[144:147], v[224:227], a[40:43]
    s_add_u32 m0, s90, 98304
    v_cvt_pk_bf16_f32 v144, v144, v145
    v_mfma_f32_16x16x32_bf16 a[40:43], a[148:151], v[232:235], a[40:43]
    v_exp_f32 v147, v147
    v_mfma_f32_16x16x32_bf16 a[44:47], a[144:147], v[240:243], a[44:47]
    v_mfma_f32_16x16x32_bf16 a[44:47], a[148:151], v[248:251], a[44:47]
    v_exp_f32 v148, v148
    v_mfma_f32_16x16x32_bf16 a[48:51], a[152:155], v[192:195], a[48:51]
    ds_read_b64_tr_b16 a[144:145], v38 offset:49152
    v_cvt_pk_bf16_f32 v145, v146, v147
    v_mfma_f32_16x16x32_bf16 a[48:51], a[156:159], v[200:203], a[48:51]
    v_exp_f32 v149, v149
    v_mfma_f32_16x16x32_bf16 a[52:55], a[152:155], v[208:211], a[52:55]
    ds_read_b64_tr_b16 a[146:147], v38 offset:53248
    ds_read_b64_tr_b16 a[148:149], v38 offset:57344
    v_mfma_f32_16x16x32_bf16 a[52:55], a[156:159], v[216:219], a[52:55]
    v_exp_f32 v150, v150
    v_mfma_f32_16x16x32_bf16 a[56:59], a[152:155], v[224:227], a[56:59]
    ds_read_b64_tr_b16 a[150:151], v38 offset:61440
    v_cvt_pk_bf16_f32 v146, v148, v149
    v_mfma_f32_16x16x32_bf16 a[56:59], a[156:159], v[232:235], a[56:59]
    v_exp_f32 v151, v151
    v_mfma_f32_16x16x32_bf16 a[60:63], a[152:155], v[240:243], a[60:63]
    buffer_load_dwordx4 v56, s[40:43], s89 offen offset:0 nt lds
    v_mfma_f32_16x16x32_bf16 a[60:63], a[156:159], v[248:251], a[60:63]
    v_mfma_f32_16x16x32_bf16 a[196:199], a[208:211], v[208:211], a[196:199]
    v_exp_f32 v160, v160
    v_mfma_f32_16x16x32_bf16 a[196:199], a[208:211], v[216:219], a[196:199]
    v_cvt_pk_bf16_f32 v147, v150, v151
    s_waitcnt lgkmcnt(10)
    v_mfma_f32_16x16x32_bf16 a[64:67], a[128:131], v[192:195], a[64:67]
    buffer_load_dwordx4 v57, s[40:43], s89 offen offset:1024 nt lds
    v_exp_f32 v161, v161
    v_mfma_f32_16x16x32_bf16 a[64:67], a[132:135], v[200:203], a[64:67]
    ds_read_b64_tr_b16 a[152:153], v39 offset:49152
    ds_read_b64_tr_b16 a[154:155], v39 offset:53248
    v_mfma_f32_16x16x32_bf16 a[68:71], a[128:131], v[208:211], a[68:71]
    v_exp_f32 v162, v162
    v_mfma_f32_16x16x32_bf16 a[68:71], a[132:135], v[216:219], a[68:71]
    ds_read_b64_tr_b16 a[156:157], v39 offset:57344
    v_cvt_pk_bf16_f32 v160, v160, v161
    v_mfma_f32_16x16x32_bf16 a[72:75], a[128:131], v[224:227], a[72:75]
    v_exp_f32 v163, v163
    v_mfma_f32_16x16x32_bf16 a[72:75], a[132:135], v[232:235], a[72:75]
    ds_read_b64_tr_b16 a[158:159], v39 offset:61440
    ds_read_b128 a[176:179], v20 offset:4096
    v_mfma_f32_16x16x32_bf16 a[76:79], a[128:131], v[240:243], a[76:79]
    v_exp_f32 v164, v164
    v_mfma_f32_16x16x32_bf16 a[76:79], a[132:135], v[248:251], a[76:79]
    v_cvt_pk_bf16_f32 v161, v162, v163
    s_waitcnt lgkmcnt(9)
    v_mfma_f32_16x16x32_bf16 a[80:83], a[136:139], v[192:195], a[80:83]
    v_exp_f32 v165, v165
    v_mfma_f32_16x16x32_bf16 a[80:83], a[140:143], v[200:203], a[80:83]
    ds_read_b128 a[180:183], v21 offset:4096
    ds_read_b128 a[184:187], v22 offset:4096
    v_mfma_f32_16x16x32_bf16 a[84:87], a[136:139], v[208:211], a[84:87]
    v_exp_f32 v166, v166
    v_mfma_f32_16x16x32_bf16 a[84:87], a[140:143], v[216:219], a[84:87]
    ds_read_b128 a[188:191], v23 offset:4096
    v_cvt_pk_bf16_f32 v162, v164, v165
    v_mfma_f32_16x16x32_bf16 a[88:91], a[136:139], v[224:227], a[88:91]
    v_exp_f32 v167, v167
    v_mfma_f32_16x16x32_bf16 a[88:91], a[140:143], v[232:235], a[88:91]
    buffer_load_dwordx4 v56, s[40:43], s89 offen offset:2048 nt lds
    v_mfma_f32_16x16x32_bf16 a[92:95], a[136:139], v[240:243], a[92:95]
    v_mfma_f32_16x16x32_bf16 a[92:95], a[140:143], v[248:251], a[92:95]
    v_exp_f32 v176, v176
    v_mfma_f32_16x16x32_bf16 a[200:203], a[208:211], v[224:227], a[200:203]
    v_cvt_pk_bf16_f32 v163, v166, v167
    s_waitcnt lgkmcnt(8)
    v_mfma_f32_16x16x32_bf16 a[200:203], a[208:211], v[232:235], a[200:203]
    v_exp_f32 v177, v177
    v_mfma_f32_16x16x32_bf16 a[96:99], a[144:147], v[192:195], a[96:99]
    buffer_load_dwordx4 v57, s[40:43], s89 offen offset:3072 nt lds
    v_mfma_f32_16x16x32_bf16 a[96:99], a[148:151], v[200:203], a[96:99]
    v_exp_f32 v178, v178
    v_mfma_f32_16x16x32_bf16 a[100:103], a[144:147], v[208:211], a[100:103]
    v_cvt_pk_bf16_f32 v176, v176, v177
    v_mfma_f32_16x16x32_bf16 a[100:103], a[148:151], v[216:219], a[100:103]
    v_exp_f32 v179, v179
    v_mfma_f32_16x16x32_bf16 a[104:107], a[144:147], v[224:227], a[104:107]
    s_add_u32 s89, s89, 16384
    v_mfma_f32_16x16x32_bf16 a[104:107], a[148:151], v[232:235], a[104:107]
    v_exp_f32 v180, v180
    v_mfma_f32_16x16x32_bf16 a[108:111], a[144:147], v[240:243], a[108:111]
    v_cvt_pk_bf16_f32 v177, v178, v179
    s_waitcnt lgkmcnt(4)
    v_mfma_f32_16x16x32_bf16 a[108:111], a[148:151], v[248:251], a[108:111]
    v_exp_f32 v181, v181
    v_mfma_f32_16x16x32_bf16 a[112:115], a[152:155], v[192:195], a[112:115]
    v_mfma_f32_16x16x32_bf16 a[112:115], a[156:159], v[200:203], a[112:115]
    v_exp_f32 v182, v182
    v_mfma_f32_16x16x32_bf16 a[116:119], a[152:155], v[208:211], a[116:119]
    v_cvt_pk_bf16_f32 v178, v180, v181
    v_mfma_f32_16x16x32_bf16 a[116:119], a[156:159], v[216:219], a[116:119]
    v_exp_f32 v183, v183
    v_mfma_f32_16x16x32_bf16 a[120:123], a[152:155], v[224:227], a[120:123]
    s_add_u32 m0, s90, 49152
    v_mfma_f32_16x16x32_bf16 a[120:123], a[156:159], v[232:235], a[120:123]
    v_mfma_f32_16x16x32_bf16 a[124:127], a[152:155], v[240:243], a[124:127]
    v_exp_f32 v136, v136
    v_mfma_f32_16x16x32_bf16 a[124:127], a[156:159], v[248:251], a[124:127]
    v_cvt_pk_bf16_f32 v179, v182, v183
    v_mfma_f32_16x16x32_bf16 a[204:207], a[208:211], v[240:243], a[204:207]
    v_exp_f32 v137, v137
    v_mfma_f32_16x16x32_bf16 a[204:207], a[208:211], v[248:251], a[204:207]
    s_waitcnt lgkmcnt(0)
    v_mfma_f32_16x16x32_bf16 v[192:195], a[160:163], v[64:67], v[8:11]
    v_exp_f32 v138, v138
    v_mfma_f32_16x16x32_bf16 v[192:195], a[164:167], v[68:71], v[192:195]
    ds_read_b64_tr_b16 a[128:129], v32 offset:0
    v_cvt_pk_bf16_f32 v136, v136, v137
    v_mfma_f32_16x16x32_bf16 v[192:195], a[168:171], v[72:75], v[192:195]
    v_exp_f32 v139, v139
    v_mfma_f32_16x16x32_bf16 v[192:195], a[172:175], v[76:79], v[192:195]
    ds_read_b64_tr_b16 a[130:131], v32 offset:4096
    buffer_load_dwordx4 v52, s[36:39], s88 offen offset:0 nt lds
    v_mfma_f32_16x16x32_bf16 v[208:211], a[160:163], v[80:83], v[12:15]
    v_exp_f32 v140, v140
    v_mfma_f32_16x16x32_bf16 v[208:211], a[164:167], v[84:87], v[208:211]
    v_cvt_pk_bf16_f32 v137, v138, v139
    v_mfma_f32_16x16x32_bf16 v[208:211], a[168:171], v[88:91], v[208:211]
    v_exp_f32 v141, v141
    v_mfma_f32_16x16x32_bf16 v[208:211], a[172:175], v[92:95], v[208:211]
    ds_read_b64_tr_b16 a[132:133], v32 offset:8192
    v_mfma_f32_16x16x32_bf16 v[224:227], a[160:163], v[96:99], v[24:27]
    v_exp_f32 v142, v142
    v_mfma_f32_16x16x32_bf16 v[224:227], a[164:167], v[100:103], v[224:227]
    buffer_load_dwordx4 v53, s[36:39], s88 offen offset:1024 nt lds
    v_cvt_pk_bf16_f32 v138, v140, v141
    v_mfma_f32_16x16x32_bf16 v[224:227], a[168:171], v[104:107], v[224:227]
    v_exp_f32 v143, v143
    v_mfma_f32_16x16x32_bf16 v[224:227], a[172:175], v[108:111], v[224:227]
    ds_read_b64_tr_b16 a[134:135], v32 offset:12288
    v_mfma_f32_16x16x32_bf16 v[240:243], a[160:163], v[112:115], v[28:31]
    v_mfma_f32_16x16x32_bf16 v[240:243], a[164:167], v[116:119], v[240:243]
    v_exp_f32 v152, v152
    v_mfma_f32_16x16x32_bf16 v[240:243], a[168:171], v[120:123], v[240:243]
    ds_read_b64_tr_b16 a[136:137], v33 offset:0
    v_cvt_pk_bf16_f32 v139, v142, v143
    v_mfma_f32_16x16x32_bf16 v[240:243], a[172:175], v[124:127], v[240:243]
    v_exp_f32 v153, v153
    v_mfma_f32_16x16x32_bf16 v[196:199], a[176:179], v[64:67], v[8:11]
    ds_read_b128 a[160:163], v20 offset:8192
    ds_read_b128 a[164:167], v21 offset:8192
    v_mfma_f32_16x16x32_bf16 v[196:199], a[180:183], v[68:71], v[196:199]
    v_exp_f32 v154, v154
    v_mfma_f32_16x16x32_bf16 v[196:199], a[184:187], v[72:75], v[196:199]
    ds_read_b128 a[168:171], v22 offset:8192
    v_cvt_pk_bf16_f32 v152, v152, v153
    v_mfma_f32_16x16x32_bf16 v[196:199], a[188:191], v[76:79], v[196:199]
    v_exp_f32 v155, v155
    v_mfma_f32_16x16x32_bf16 v[212:215], a[176:179], v[80:83], v[12:15]
    ds_read_b128 a[172:175], v23 offset:8192
    ds_read_b64_tr_b16 a[138:139], v33 offset:4096
    v_mfma_f32_16x16x32_bf16 v[212:215], a[180:183], v[84:87], v[212:215]
    v_exp_f32 v156, v156
    v_mfma_f32_16x16x32_bf16 v[212:215], a[184:187], v[88:91], v[212:215]
    ds_read_b64_tr_b16 a[140:141], v33 offset:8192
    v_cvt_pk_bf16_f32 v153, v154, v155
    v_mfma_f32_16x16x32_bf16 v[212:215], a[188:191], v[92:95], v[212:215]
    v_exp_f32 v157, v157
    v_mfma_f32_16x16x32_bf16 v[228:231], a[176:179], v[96:99], v[24:27]
    buffer_load_dwordx4 v54, s[36:39], s88 offen offset:2048 nt lds
    v_mfma_f32_16x16x32_bf16 v[228:231], a[180:183], v[100:103], v[228:231]
    v_exp_f32 v158, v158
    v_mfma_f32_16x16x32_bf16 v[228:231], a[184:187], v[104:107], v[228:231]
    ds_read_b64_tr_b16 a[142:143], v33 offset:12288
    v_cvt_pk_bf16_f32 v154, v156, v157
    v_mfma_f32_16x16x32_bf16 v[228:231], a[188:191], v[108:111], v[228:231]
    v_exp_f32 v159, v159
    v_mfma_f32_16x16x32_bf16 v[244:247], a[176:179], v[112:115], v[28:31]
    buffer_load_dwordx4 v55, s[36:39], s88 offen offset:3072 nt lds
    v_mfma_f32_16x16x32_bf16 v[244:247], a[180:183], v[116:119], v[244:247]
    ds_read_b64_tr_b16 a[144:145], v34 offset:0
    v_mfma_f32_16x16x32_bf16 v[244:247], a[184:187], v[120:123], v[244:247]
    v_exp_f32 v168, v168
    v_mfma_f32_16x16x32_bf16 v[244:247], a[188:191], v[124:127], v[244:247]
    v_cvt_pk_bf16_f32 v155, v158, v159
    s_waitcnt lgkmcnt(4)
    v_mfma_f32_16x16x32_bf16 v[200:203], a[160:163], v[64:67], v[8:11]
    ds_read_b64_tr_b16 a[146:147], v34 offset:4096
    v_exp_f32 v169, v169
    v_mfma_f32_16x16x32_bf16 v[200:203], a[164:167], v[68:71], v[200:203]
    ds_read_b128 a[176:179], v20 offset:12288
    ds_read_b128 a[180:183], v21 offset:12288
    s_add_u32 s88, s88, 16384
    v_mfma_f32_16x16x32_bf16 v[200:203], a[168:171], v[72:75], v[200:203]
    v_exp_f32 v170, v170
    v_mfma_f32_16x16x32_bf16 v[200:203], a[172:175], v[76:79], v[200:203]
    ds_read_b128 a[184:187], v22 offset:12288
    v_cvt_pk_bf16_f32 v168, v168, v169
    v_mfma_f32_16x16x32_bf16 v[216:219], a[160:163], v[80:83], v[12:15]
    v_exp_f32 v171, v171
    v_mfma_f32_16x16x32_bf16 v[216:219], a[164:167], v[84:87], v[216:219]
    ds_read_b128 a[188:191], v23 offset:12288
    ds_read_b64_tr_b16 a[148:149], v34 offset:8192
    v_mfma_f32_16x16x32_bf16 v[216:219], a[168:171], v[88:91], v[216:219]
    v_exp_f32 v172, v172
    v_mfma_f32_16x16x32_bf16 v[216:219], a[172:175], v[92:95], v[216:219]
    ds_read_b64_tr_b16 a[150:151], v34 offset:12288
    v_cvt_pk_bf16_f32 v169, v170, v171
    v_mfma_f32_16x16x32_bf16 v[232:235], a[160:163], v[96:99], v[24:27]
    v_exp_f32 v173, v173
    v_mfma_f32_16x16x32_bf16 v[232:235], a[164:167], v[100:103], v[232:235]
    v_mfma_f32_16x16x32_bf16 v[232:235], a[168:171], v[104:107], v[232:235]
    v_exp_f32 v174, v174
    v_mfma_f32_16x16x32_bf16 v[232:235], a[172:175], v[108:111], v[232:235]
    ds_read_b64_tr_b16 a[152:153], v35 offset:0
    v_cvt_pk_bf16_f32 v170, v172, v173
    v_mfma_f32_16x16x32_bf16 v[248:251], a[160:163], v[112:115], v[28:31]
    v_exp_f32 v175, v175
    v_mfma_f32_16x16x32_bf16 v[248:251], a[164:167], v[116:119], v[248:251]
    v_mfma_f32_16x16x32_bf16 v[248:251], a[168:171], v[120:123], v[248:251]
    s_waitcnt vmcnt(13) lgkmcnt(3)
    ds_add_u32 v18, v19
    v_mfma_f32_16x16x32_bf16 v[248:251], a[172:175], v[124:127], v[248:251]
    v_exp_f32 v184, v184
    v_mfma_f32_16x16x32_bf16 v[204:207], a[176:179], v[64:67], v[8:11]
    ds_read_b64_tr_b16 a[154:155], v35 offset:4096
    v_cvt_pk_bf16_f32 v171, v174, v175
    v_mfma_f32_16x16x32_bf16 v[204:207], a[180:183], v[68:71], v[204:207]
    v_exp_f32 v185, v185
    v_mfma_f32_16x16x32_bf16 v[204:207], a[184:187], v[72:75], v[204:207]
    ds_read_b64_tr_b16 a[156:157], v35 offset:8192
    v_mfma_f32_16x16x32_bf16 v[204:207], a[188:191], v[76:79], v[204:207]
    v_exp_f32 v186, v186
    v_mfma_f32_16x16x32_bf16 v[220:223], a[176:179], v[80:83], v[12:15]
    v_cvt_pk_bf16_f32 v184, v184, v185
    v_mfma_f32_16x16x32_bf16 v[220:223], a[180:183], v[84:87], v[220:223]
    v_exp_f32 v187, v187
    v_mfma_f32_16x16x32_bf16 v[220:223], a[184:187], v[88:91], v[220:223]
    ds_read_b64_tr_b16 a[158:159], v35 offset:12288
    v_mfma_f32_16x16x32_bf16 v[220:223], a[188:191], v[92:95], v[220:223]
    v_exp_f32 v188, v188
    v_mfma_f32_16x16x32_bf16 v[236:239], a[176:179], v[96:99], v[24:27]
    v_cvt_pk_bf16_f32 v185, v186, v187
    v_mfma_f32_16x16x32_bf16 v[236:239], a[180:183], v[100:103], v[236:239]
    v_exp_f32 v189, v189
    v_mfma_f32_16x16x32_bf16 v[236:239], a[184:187], v[104:107], v[236:239]
    v_mfma_f32_16x16x32_bf16 v[236:239], a[188:191], v[108:111], v[236:239]
    v_exp_f32 v190, v190
    v_mfma_f32_16x16x32_bf16 v[252:255], a[176:179], v[112:115], v[28:31]
    ds_read_b32 v17, v18
    v_cvt_pk_bf16_f32 v186, v188, v189
    v_mfma_f32_16x16x32_bf16 v[252:255], a[180:183], v[116:119], v[252:255]
    v_exp_f32 v191, v191
    v_mfma_f32_16x16x32_bf16 v[252:255], a[184:187], v[120:123], v[252:255]
    v_mfma_f32_16x16x32_bf16 v[252:255], a[188:191], v[124:127], v[252:255]
    s_nop 0
    v_cvt_pk_bf16_f32 v187, v190, v191
    s_waitcnt lgkmcnt(0)
    v_mfma_f32_16x16x32_bf16 a[0:3], a[128:131], v[128:131], a[0:3]
    v_exp_f32 v192, v192
    v_mfma_f32_16x16x32_bf16 a[0:3], a[132:135], v[136:139], a[0:3]
    v_cmp_gt_u32 vcc, s98, v17
    v_mfma_f32_16x16x32_bf16 a[4:7], a[128:131], v[144:147], a[4:7]
    v_exp_f32 v193, v193
    v_mfma_f32_16x16x32_bf16 a[4:7], a[132:135], v[152:155], a[4:7]
    s_cbranch_vccnz L_spin3
L_spun3:
    v_mfma_f32_16x16x32_bf16 a[8:11], a[128:131], v[160:163], a[8:11]
    v_exp_f32 v194, v194
    v_mfma_f32_16x16x32_bf16 a[8:11], a[132:135], v[168:171], a[8:11]
    s_add_u32 s98, s98, 4
    v_cvt_pk_bf16_f32 v192, v192, v193
    v_mfma_f32_16x16x32_bf16 a[12:15], a[128:131], v[176:179], a[12:15]
    v_exp_f32 v195, v195
    v_mfma_f32_16x16x32_bf16 a[12:15], a[132:135], v[184:187], a[12:15]
    ds_read_b128 a[160:163], v20 offset:16384
    ds_read_b128 a[164:167], v21 offset:16384
    v_mfma_f32_16x16x32_bf16 a[16:19], a[136:139], v[128:131], a[16:19]
    v_exp_f32 v196, v196
    v_mfma_f32_16x16x32_bf16 a[16:19], a[140:143], v[136:139], a[16:19]
    ds_read_b64_tr_b16 a[128:129], v36 offset:0
    v_cvt_pk_bf16_f32 v193, v194, v195
    v_mfma_f32_16x16x32_bf16 a[20:23], a[136:139], v[144:147], a[20:23]
    v_exp_f32 v197, v197
    v_mfma_f32_16x16x32_bf16 a[20:23], a[140:143], v[152:155], a[20:23]
    ds_read_b64_tr_b16 a[130:131], v36 offset:4096
    ds_read_b64_tr_b16 a[132:133], v36 offset:8192
    v_mfma_f32_16x16x32_bf16 a[24:27], a[136:139], v[160:163], a[24:27]
    v_exp_f32 v198, v198
    v_mfma_f32_16x16x32_bf16 a[24:27], a[140:143], v[168:171], a[24:27]
    ds_read_b64_tr_b16 a[134:135], v36 offset:12288
    v_cvt_pk_bf16_f32 v194, v196, v197
    v_mfma_f32_16x16x32_bf16 a[28:31], a[136:139], v[176:179], a[28:31]
    v_exp_f32 v199, v199
    v_mfma_f32_16x16x32_bf16 a[28:31], a[140:143], v[184:187], a[28:31]
    ds_read_b128 a[168:171], v22 offset:16384
    ds_read_b128 a[172:175], v23 offset:16384
    v_mfma_f32_16x16x32_bf16 a[192:195], a[208:211], v[128:131], a[192:195]
    ds_read_b64_tr_b16 a[136:137], v37 offset:0
    ds_read_b64_tr_b16 a[138:139], v37 offset:4096
    v_mfma_f32_16x16x32_bf16 a[192:195], a[208:211], v[136:139], a[192:195]
    v_exp_f32 v208, v208
    v_mfma_f32_16x16x32_bf16 a[32:35], a[144:147], v[128:131], a[32:35]
    ds_read_b64_tr_b16 a[140:141], v37 offset:8192
    v_cvt_pk_bf16_f32 v195, v198, v199
    v_mfma_f32_16x16x32_bf16 a[32:35], a[148:151], v[136:139], a[32:35]
    v_exp_f32 v209, v209
    v_mfma_f32_16x16x32_bf16 a[36:39], a[144:147], v[144:147], a[36:39]
    ds_read_b64_tr_b16 a[142:143], v37 offset:12288
    s_add_u32 s3, s3, 1024
    v_mfma_f32_16x16x32_bf16 a[36:39], a[148:151], v[152:155], a[36:39]
    v_exp_f32 v210, v210
    v_mfma_f32_16x16x32_bf16 a[40:43], a[144:147], v[160:163], a[40:43]
    s_add_u32 m0, s90, 114688
    v_cvt_pk_bf16_f32 v208, v208, v209
    v_mfma_f32_16x16x32_bf16 a[40:43], a[148:151], v[168:171], a[40:43]
    v_exp_f32 v211, v211
    v_mfma_f32_16x16x32_bf16 a[44:47], a[144:147], v[176:179], a[44:47]
    v_mfma_f32_16x16x32_bf16 a[44:47], a[148:151], v[184:187], a[44:47]
    v_exp_f32 v212, v212
    v_mfma_f32_16x16x32_bf16 a[48:51], a[152:155], v[128:131], a[48:51]
    ds_read_b64_tr_b16 a[144:145], v38 offset:0
    v_cvt_pk_bf16_f32 v209, v210, v211
    v_mfma_f32_16x16x32_bf16 a[48:51], a[156:159], v[136:139], a[48:51]
    v_exp_f32 v213, v213
    v_mfma_f32_16x16x32_bf16 a[52:55], a[152:155], v[144:147], a[52:55]
    ds_read_b64_tr_b16 a[146:147], v38 offset:4096
    ds_read_b64_tr_b16 a[148:149], v38 offset:8192
    v_mfma_f32_16x16x32_bf16 a[52:55], a[156:159], v[152:155], a[52:55]
    v_exp_f32 v214, v214
    v_mfma_f32_16x16x32_bf16 a[56:59], a[152:155], v[160:163], a[56:59]
    ds_read_b64_tr_b16 a[150:151], v38 offset:12288
    v_cvt_pk_bf16_f32 v210, v212, v213
    v_mfma_f32_16x16x32_bf16 a[56:59], a[156:159], v[168:171], a[56:59]
    v_exp_f32 v215, v215
    v_mfma_f32_16x16x32_bf16 a[60:63], a[152:155], v[176:179], a[60:63]
    buffer_load_dwordx4 v56, s[40:43], s89 offen offset:0 nt lds
    v_mfma_f32_16x16x32_bf16 a[60:63], a[156:159], v[184:187], a[60:63]
    v_mfma_f32_16x16x32_bf16 a[196:199], a[208:211], v[144:147], a[196:199]
    v_exp_f32 v224, v224
    v_mfma_f32_16x16x32_bf16 a[196:199], a[208:211], v[152:155], a[196:199]
    v_cvt_pk_bf16_f32 v211, v214, v215
    s_waitcnt lgkmcnt(10)
    v_mfma_f32_16x16x32_bf16 a[64:67], a[128:131], v[128:131], a[64:67]
    buffer_load_dwordx4 v57, s[40:43], s89 offen offset:1024 nt lds
    v_exp_f32 v225, v225
    v_mfma_f32_16x16x32_bf16 a[64:67], a[132:135], v[136:139], a[64:67]
    ds_read_b64_tr_b16 a[152:153], v39 offset:0
    ds_read_b64_tr_b16 a[154:155], v39 offset:4096
    v_mfma_f32_16x16x32_bf16 a[68:71], a[128:131], v[144:147], a[68:71]
    v_exp_f32 v226, v226
    v_mfma_f32_16x16x32_bf16 a[68:71], a[132:135], v[152:155], a[68:71]
    ds_read_b64_tr_b16 a[156:157], v39 offset:8192
    v_cvt_pk_bf16_f32 v224, v224, v225
    v_mfma_f32_16x16x32_bf16 a[72:75], a[128:131], v[160:163], a[72:75]
    v_exp_f32 v227, v227
    v_mfma_f32_16x16x32_bf16 a[72:75], a[132:135], v[168:171], a[72:75]
    ds_read_b64_tr_b16 a[158:159], v39 offset:12288
    ds_read_b128 a[176:179], v20 offset:20480
    v_mfma_f32_16x16x32_bf16 a[76:79], a[128:131], v[176:179], a[76:79]
    v_exp_f32 v228, v228
    v_mfma_f32_16x16x32_bf16 a[76:79], a[132:135], v[184:187], a[76:79]
    v_cvt_pk_bf16_f32 v225, v226, v227
    s_waitcnt lgkmcnt(9)
    v_mfma_f32_16x16x32_bf16 a[80:83], a[136:139], v[128:131], a[80:83]
    v_exp_f32 v229, v229
    v_mfma_f32_16x16x32_bf16 a[80:83], a[140:143], v[136:139], a[80:83]
    ds_read_b128 a[180:183], v21 offset:20480
    ds_read_b128 a[184:187], v22 offset:20480
    v_mfma_f32_16x16x32_bf16 a[84:87], a[136:139], v[144:147], a[84:87]
    v_exp_f32 v230, v230
    v_mfma_f32_16x16x32_bf16 a[84:87], a[140:143], v[152:155], a[84:87]
    ds_read_b128 a[188:191], v23 offset:20480
    v_cvt_pk_bf16_f32 v226, v228, v229
    v_mfma_f32_16x16x32_bf16 a[88:91], a[136:139], v[160:163], a[88:91]
    v_exp_f32 v231, v231
    v_mfma_f32_16x16x32_bf16 a[88:91], a[140:143], v[168:171], a[88:91]
    buffer_load_dwordx4 v56, s[40:43], s89 offen offset:2048 nt lds
    v_mfma_f32_16x16x32_bf16 a[92:95], a[136:139], v[176:179], a[92:95]
    v_mfma_f32_16x16x32_bf16 a[92:95], a[140:143], v[184:187], a[92:95]
    v_exp_f32 v240, v240
    v_mfma_f32_16x16x32_bf16 a[200:203], a[208:211], v[160:163], a[200:203]
    v_cvt_pk_bf16_f32 v227, v230, v231
    s_waitcnt lgkmcnt(8)
    v_mfma_f32_16x16x32_bf16 a[200:203], a[208:211], v[168:171], a[200:203]
    v_exp_f32 v241, v241
    v_mfma_f32_16x16x32_bf16 a[96:99], a[144:147], v[128:131], a[96:99]
    buffer_load_dwordx4 v57, s[40:43], s89 offen offset:3072 nt lds
    v_mfma_f32_16x16x32_bf16 a[96:99], a[148:151], v[136:139], a[96:99]
    v_exp_f32 v242, v242
    v_mfma_f32_16x16x32_bf16 a[100:103], a[144:147], v[144:147], a[100:103]
    v_cvt_pk_bf16_f32 v240, v240, v241
    v_mfma_f32_16x16x32_bf16 a[100:103], a[148:151], v[152:155], a[100:103]
    v_exp_f32 v243, v243
    v_mfma_f32_16x16x32_bf16 a[104:107], a[144:147], v[160:163], a[104:107]
    s_add_u32 s89, s89, 16384
    v_mfma_f32_16x16x32_bf16 a[104:107], a[148:151], v[168:171], a[104:107]
    v_exp_f32 v244, v244
    v_mfma_f32_16x16x32_bf16 a[108:111], a[144:147], v[176:179], a[108:111]
    v_cvt_pk_bf16_f32 v241, v242, v243
    s_waitcnt lgkmcnt(4)
    v_mfma_f32_16x16x32_bf16 a[108:111], a[148:151], v[184:187], a[108:111]
    v_exp_f32 v245, v245
    v_mfma_f32_16x16x32_bf16 a[112:115], a[152:155], v[128:131], a[112:115]
    v_mfma_f32_16x16x32_bf16 a[112:115], a[156:159], v[136:139], a[112:115]
    v_exp_f32 v246, v246
    v_mfma_f32_16x16x32_bf16 a[116:119], a[152:155], v[144:147], a[116:119]
    v_cvt_pk_bf16_f32 v242, v244, v245
    v_mfma_f32_16x16x32_bf16 a[116:119], a[156:159], v[152:155], a[116:119]
    v_exp_f32 v247, v247
    v_mfma_f32_16x16x32_bf16 a[120:123], a[152:155], v[160:163], a[120:123]
    s_add_u32 m0, s90, 0
    v_mfma_f32_16x16x32_bf16 a[120:123], a[156:159], v[168:171], a[120:123]
    v_mfma_f32_16x16x32_bf16 a[124:127], a[152:155], v[176:179], a[124:127]
    v_exp_f32 v200, v200
    v_mfma_f32_16x16x32_bf16 a[124:127], a[156:159], v[184:187], a[124:127]
    v_cvt_pk_bf16_f32 v243, v246, v247
    v_mfma_f32_16x16x32_bf16 a[204:207], a[208:211], v[176:179], a[204:207]
    v_exp_f32 v201, v201
    v_mfma_f32_16x16x32_bf16 a[204:207], a[208:211], v[184:187], a[204:207]
    s_waitcnt lgkmcnt(0)
    v_mfma_f32_16x16x32_bf16 v[128:131], a[160:163], v[64:67], v[8:11]
    v_exp_f32 v202, v202
    v_mfma_f32_16x16x32_bf16 v[128:131], a[164:167], v[68:71], v[128:131]
    ds_read_b64_tr_b16 a[128:129], v32 offset:16384
    v_cvt_pk_bf16_f32 v200, v200, v201
    v_mfma_f32_16x16x32_bf16 v[128:131], a[168:171], v[72:75], v[128:131]
    v_exp_f32 v203, v203
    v_mfma_f32_16x16x32_bf16 v[128:131], a[172:175], v[76:79], v[128:131]
    ds_read_b64_tr_b16 a[130:131], v32 offset:20480
    buffer_load_dwordx4 v52, s[36:39], s88 offen offset:0 nt lds
    v_mfma_f32_16x16x32_bf16 v[144:147], a[160:163], v[80:83], v[12:15]
    v_exp_f32 v204, v204
    v_mfma_f32_16x16x32_bf16 v[144:147], a[164:167], v[84:87], v[144:147]
    v_cvt_pk_bf16_f32 v201, v202, v203
    v_mfma_f32_16x16x32_bf16 v[144:147], a[168:171], v[88:91], v[144:147]
    v_exp_f32 v205, v205
    v_mfma_f32_16x16x32_bf16 v[144:147], a[172:175], v[92:95], v[144:147]
    ds_read_b64_tr_b16 a[132:133], v32 offset:24576
    v_mfma_f32_16x16x32_bf16 v[160:163], a[160:163], v[96:99], v[24:27]
    v_exp_f32 v206, v206
    v_mfma_f32_16x16x32_bf16 v[160:163], a[164:167], v[100:103], v[160:163]
    buffer_load_dwordx4 v53, s[36:39], s88 offen offset:1024 nt lds
    v_cvt_pk_bf16_f32 v202, v204, v205
    v_mfma_f32_16x16x32_bf16 v[160:163], a[168:171], v[104:107], v[160:163]
    v_exp_f32 v207, v207
    v_mfma_f32_16x16x32_bf16 v[160:163], a[172:175], v[108:111], v[160:163]
    ds_read_b64_tr_b16 a[134:135], v32 offset:28672
    v_mfma_f32_16x16x32_bf16 v[176:179], a[160:163], v[112:115], v[28:31]
    v_mfma_f32_16x16x32_bf16 v[176:179], a[164:167], v[116:119], v[176:179]
    v_exp_f32 v216, v216
    v_mfma_f32_16x16x32_bf16 v[176:179], a[168:171], v[120:123], v[176:179]
    ds_read_b64_tr_b16 a[136:137], v33 offset:16384
    v_cvt_pk_bf16_f32 v203, v206, v207
    v_mfma_f32_16x16x32_bf16 v[176:179], a[172:175], v[124:127], v[176:179]
    v_exp_f32 v217, v217
    v_mfma_f32_16x16x32_bf16 v[132:135], a[176:179], v[64:67], v[8:11]
    ds_read_b128 a[160:163], v20 offset:24576
    ds_read_b128 a[164:167], v21 offset:24576
    v_mfma_f32_16x16x32_bf16 v[132:135], a[180:183], v[68:71], v[132:135]
    v_exp_f32 v218, v218
    v_mfma_f32_16x16x32_bf16 v[132:135], a[184:187], v[72:75], v[132:135]
    ds_read_b128 a[168:171], v22 offset:24576
    v_cvt_pk_bf16_f32 v216, v216, v217
    v_mfma_f32_16x16x32_bf16 v[132:135], a[188:191], v[76:79], v[132:135]
    v_exp_f32 v219, v219
    v_mfma_f32_16x16x32_bf16 v[148:151], a[176:179], v[80:83], v[12:15]
    ds_read_b128 a[172:175], v23 offset:24576
    ds_read_b64_tr_b16 a[138:139], v33 offset:20480
    v_mfma_f32_16x16x32_bf16 v[148:151], a[180:183], v[84:87], v[148:151]
    v_exp_f32 v220, v220
    v_mfma_f32_16x16x32_bf16 v[148:151], a[184:187], v[88:91], v[148:151]
    ds_read_b64_tr_b16 a[140:141], v33 offset:24576
    v_cvt_pk_bf16_f32 v217, v218, v219
    v_mfma_f32_16x16x32_bf16 v[148:151], a[188:191], v[92:95], v[148:151]
    v_exp_f32 v221, v221
    v_mfma_f32_16x16x32_bf16 v[164:167], a[176:179], v[96:99], v[24:27]
    buffer_load_dwordx4 v54, s[36:39], s88 offen offset:2048 nt lds
    v_mfma_f32_16x16x32_bf16 v[164:167], a[180:183], v[100:103], v[164:167]
    v_exp_f32 v222, v222
    v_mfma_f32_16x16x32_bf16 v[164:167], a[184:187], v[104:107], v[164:167]
    ds_read_b64_tr_b16 a[142:143], v33 offset:28672
    v_cvt_pk_bf16_f32 v218, v220, v221
    v_mfma_f32_16x16x32_bf16 v[164:167], a[188:191], v[108:111], v[164:167]
    v_exp_f32 v223, v223
    v_mfma_f32_16x16x32_bf16 v[180:183], a[176:179], v[112:115], v[28:31]
    buffer_load_dwordx4 v55, s[36:39], s88 offen offset:3072 nt lds
    v_mfma_f32_16x16x32_bf16 v[180:183], a[180:183], v[116:119], v[180:183]
    ds_read_b64_tr_b16 a[144:145], v34 offset:16384
    v_mfma_f32_16x16x32_bf16 v[180:183], a[184:187], v[120:123], v[180:183]
    v_exp_f32 v232, v232
    v_mfma_f32_16x16x32_bf16 v[180:183], a[188:191], v[124:127], v[180:183]
    v_cvt_pk_bf16_f32 v219, v222, v223
    s_waitcnt lgkmcnt(4)
    v_mfma_f32_16x16x32_bf16 v[136:139], a[160:163], v[64:67], v[8:11]
    ds_read_b64_tr_b16 a[146:147], v34 offset:20480
    v_exp_f32 v233, v233
    v_mfma_f32_16x16x32_bf16 v[136:139], a[164:167], v[68:71], v[136:139]
    ds_read_b128 a[176:179], v20 offset:28672
    ds_read_b128 a[180:183], v21 offset:28672
    s_add_u32 s88, s88, 16384
    v_mfma_f32_16x16x32_bf16 v[136:139], a[168:171], v[72:75], v[136:139]
    v_exp_f32 v234, v234
    v_mfma_f32_16x16x32_bf16 v[136:139], a[172:175], v[76:79], v[136:139]
    ds_read_b128 a[184:187], v22 offset:28672
    v_cvt_pk_bf16_f32 v232, v232, v233
    v_mfma_f32_16x16x32_bf16 v[152:155], a[160:163], v[80:83], v[12:15]
    v_exp_f32 v235, v235
    v_mfma_f32_16x16x32_bf16 v[152:155], a[164:167], v[84:87], v[152:155]
    ds_read_b128 a[188:191], v23 offset:28672
    ds_read_b64_tr_b16 a[148:149], v34 offset:24576
    v_mfma_f32_16x16x32_bf16 v[152:155], a[168:171], v[88:91], v[152:155]
    v_exp_f32 v236, v236
    v_mfma_f32_16x16x32_bf16 v[152:155], a[172:175], v[92:95], v[152:155]
    ds_read_b64_tr_b16 a[150:151], v34 offset:28672
    v_cvt_pk_bf16_f32 v233, v234, v235
    v_mfma_f32_16x16x32_bf16 v[168:171], a[160:163], v[96:99], v[24:27]
    v_exp_f32 v237, v237
    v_mfma_f32_16x16x32_bf16 v[168:171], a[164:167], v[100:103], v[168:171]
    v_mfma_f32_16x16x32_bf16 v[168:171], a[168:171], v[104:107], v[168:171]
    v_exp_f32 v238, v238
    v_mfma_f32_16x16x32_bf16 v[168:171], a[172:175], v[108:111], v[168:171]
    ds_read_b64_tr_b16 a[152:153], v35 offset:16384
    v_cvt_pk_bf16_f32 v234, v236, v237
    v_mfma_f32_16x16x32_bf16 v[184:187], a[160:163], v[112:115], v[28:31]
    v_exp_f32 v239, v239
    v_mfma_f32_16x16x32_bf16 v[184:187], a[164:167], v[116:119], v[184:187]
    v_mfma_f32_16x16x32_bf16 v[184:187], a[168:171], v[120:123], v[184:187]
    s_waitcnt vmcnt(12) lgkmcnt(3)
    ds_add_u32 v18, v19
    v_mfma_f32_16x16x32_bf16 v[184:187], a[172:175], v[124:127], v[184:187]
    v_exp_f32 v248, v248
    v_mfma_f32_16x16x32_bf16 v[140:143], a[176:179], v[64:67], v[8:11]
    ds_read_b64_tr_b16 a[154:155], v35 offset:20480
    v_cvt_pk_bf16_f32 v235, v238, v239
    v_mfma_f32_16x16x32_bf16 v[140:143], a[180:183], v[68:71], v[140:143]
    v_exp_f32 v249, v249
    v_mfma_f32_16x16x32_bf16 v[140:143], a[184:187], v[72:75], v[140:143]
    ds_read_b64_tr_b16 a[156:157], v35 offset:24576
    v_mfma_f32_16x16x32_bf16 v[140:143], a[188:191], v[76:79], v[140:143]
    v_exp_f32 v250, v250
    v_mfma_f32_16x16x32_bf16 v[156:159], a[176:179], v[80:83], v[12:15]
    v_cvt_pk_bf16_f32 v248, v248, v249
    v_mfma_f32_16x16x32_bf16 v[156:159], a[180:183], v[84:87], v[156:159]
    v_exp_f32 v251, v251
    v_mfma_f32_16x16x32_bf16 v[156:159], a[184:187], v[88:91], v[156:159]
    ds_read_b64_tr_b16 a[158:159], v35 offset:28672
    v_mfma_f32_16x16x32_bf16 v[156:159], a[188:191], v[92:95], v[156:159]
    v_exp_f32 v252, v252
    v_mfma_f32_16x16x32_bf16 v[172:175], a[176:179], v[96:99], v[24:27]
    v_cvt_pk_bf16_f32 v249, v250, v251
    v_mfma_f32_16x16x32_bf16 v[172:175], a[180:183], v[100:103], v[172:175]
    v_exp_f32 v253, v253
    v_mfma_f32_16x16x32_bf16 v[172:175], a[184:187], v[104:107], v[172:175]
    v_mfma_f32_16x16x32_bf16 v[172:175], a[188:191], v[108:111], v[172:175]
    v_exp_f32 v254, v254
    v_mfma_f32_16x16x32_bf16 v[188:191], a[176:179], v[112:115], v[28:31]
    ds_read_b32 v17, v18
    v_cvt_pk_bf16_f32 v250, v252, v253
    v_mfma_f32_16x16x32_bf16 v[188:191], a[180:183], v[116:119], v[188:191]
    v_exp_f32 v255, v255
    v_mfma_f32_16x16x32_bf16 v[188:191], a[184:187], v[120:123], v[188:191]
    v_mfma_f32_16x16x32_bf16 v[188:191], a[188:191], v[124:127], v[188:191]
    s_nop 0
    v_cvt_pk_bf16_f32 v251, v254, v255
    s_cmp_eq_u32 s87, s99
    s_cbranch_scc1 L_rkB
L_rkBb:
    s_sub_u32 s87, s87, 1
    s_cmp_lg_u32 s87, 0
    s_waitcnt lgkmcnt(0)
    s_cbranch_scc1 L_att
    s_lshl_b32 s81, s80, 2
    s_add_u32 s81, s81, s76
    s_lshl_b32 s81, s81, 10
    s_add_u32 s81, s81, L_epi-L_pc
    v_lshrrev_b32 v6, 3, v1
    v_lshlrev_b32 v6, 7, v6
    v_add_u32 v6, s81, v6
    v_min_u32 v6, L_slow-L_pc-4, v6
    global_load_dword v63, v6, s[30:31]
    s_cmp_lg_u32 s76, 0
    s_cbranch_scc1 L_tk0
    v_and_b32 v60, 7, v1
    v_lshlrev_b32 v60, 2, v60
    v_add_u32 v60, 192, v60
    global_load_dword v62, v60, s[24:25] sc1
L_tk0:
    s_mov_b32 exec_lo, 0x3fc000
    s_mov_b32 exec_hi, 0
    buffer_load_dword v58, v59, s[72:75], 0 offen sc1
    s_mov_b64 exec, -1
    v_mfma_f32_16x16x32_bf16 a[0:3], a[128:131], v[192:195], a[0:3]
    v_exp_f32 v128, v128
    v_mfma_f32_16x16x32_bf16 a[0:3], a[132:135], v[200:203], a[0:3]
    v_cmp_gt_u32 vcc, s98, v17
    v_mfma_f32_16x16x32_bf16 a[4:7], a[128:131], v[208:211], a[4:7]
    v_exp_f32 v129, v129
    v_mfma_f32_16x16x32_bf16 a[4:7], a[132:135], v[216:219], a[4:7]
    s_cbranch_vccnz L_spint
L_spunt:
    v_mfma_f32_16x16x32_bf16 a[8:11], a[128:131], v[224:227], a[8:11]
    v_exp_f32 v130, v130
    v_mfma_f32_16x16x32_bf16 a[8:11], a[132:135], v[232:235], a[8:11]
    s_add_u32 s98, s98, 4
    v_cvt_pk_bf16_f32 v128, v128, v129
    v_mfma_f32_16x16x32_bf16 a[12:15], a[128:131], v[240:243], a[12:15]
    v_exp_f32 v131, v131
    v_mfma_f32_16x16x32_bf16 a[12:15], a[132:135], v[248:251], a[12:15]
    ds_read_b128 a[160:163], v20 offset:32768
    ds_read_b128 a[164:167], v21 offset:32768
    v_mfma_f32_16x16x32_bf16 a[16:19], a[136:139], v[192:195], a[16:19]
    v_exp_f32 v132, v132
    v_mfma_f32_16x16x32_bf16 a[16:19], a[140:143], v[200:203], a[16:19]
    ds_read_b64_tr_b16 a[128:129], v36 offset:16384
    v_cvt_pk_bf16_f32 v129, v130, v131
    v_mfma_f32_16x16x32_bf16 a[20:23], a[136:139], v[208:211], a[20:23]
    v_exp_f32 v133, v133
    v_mfma_f32_16x16x32_bf16 a[20:23], a[140:143], v[216:219], a[20:23]
    ds_read_b64_tr_b16 a[130:131], v36 offset:20480
    ds_read_b64_tr_b16 a[132:133], v36 offset:24576
    v_mfma_f32_16x16x32_bf16 a[24:27], a[136:139], v[224:227], a[24:27]
    v_exp_f32 v134, v134
    v_mfma_f32_16x16x32_bf16 a[24:27], a[140:143], v[232:235], a[24:27]
    ds_read_b64_tr_b16 a[134:135], v36 offset:28672
    v_cvt_pk_bf16_f32 v130, v132, v133
    v_mfma_f32_16x16x32_bf16 a[28:31], a[136:139], v[240:243], a[28:31]
    v_exp_f32 v135, v135
    v_mfma_f32_16x16x32_bf16 a[28:31], a[140:143], v[248:251], a[28:31]
    ds_read_b128 a[168:171], v22 offset:32768
    ds_read_b128 a[172:175], v23 offset:32768
    v_mfma_f32_16x16x32_bf16 a[192:195], a[208:211], v[192:195], a[192:195]
    ds_read_b64_tr_b16 a[136:137], v37 offset:16384
    ds_read_b64_tr_b16 a[138:139], v37 offset:20480
    v_mfma_f32_16x16x32_bf16 a[192:195], a[208:211], v[200:203], a[192:195]
    v_exp_f32 v144, v144
    v_mfma_f32_16x16x32_bf16 a[32:35], a[144:147], v[192:195], a[32:35]
    ds_read_b64_tr_b16 a[140:141], v37 offset:24576
    v_cvt_pk_bf16_f32 v131, v134, v135
    v_mfma_f32_16x16x32_bf16 a[32:35], a[148:151], v[200:203], a[32:35]
    v_exp_f32 v145, v145
    v_mfma_f32_16x16x32_bf16 a[36:39], a[144:147], v[208:211], a[36:39]
    ds_read_b64_tr_b16 a[142:143], v37 offset:28672
    v_mfma_f32_16x16x32_bf16 a[36:39], a[148:151], v[216:219], a[36:39]
    v_exp_f32 v146, v146
    v_mfma_f32_16x16x32_bf16 a[40:43], a[144:147], v[224:227], a[40:43]
    v_cvt_pk_bf16_f32 v144, v144, v145
    v_mfma_f32_16x16x32_bf16 a[40:43], a[148:151], v[232:235], a[40:43]
    v_exp_f32 v147, v147
    v_mfma_f32_16x16x32_bf16 a[44:47], a[144:147], v[240:243], a[44:47]
    v_mfma_f32_16x16x32_bf16 a[44:47], a[148:151], v[248:251], a[44:47]
    v_exp_f32 v148, v148
    v_mfma_f32_16x16x32_bf16 a[48:51], a[152:155], v[192:195], a[48:51]
    ds_read_b64_tr_b16 a[144:145], v38 offset:16384
    v_cvt_pk_bf16_f32 v145, v146, v147
    v_mfma_f32_16x16x32_bf16 a[48:51], a[156:159], v[200:203], a[48:51]
    v_exp_f32 v149, v149
    v_mfma_f32_16x16x32_bf16 a[52:55], a[152:155], v[208:211], a[52:55]
    ds_read_b64_tr_b16 a[146:147], v38 offset:20480
    ds_read_b64_tr_b16 a[148:149], v38 offset:24576
    v_mfma_f32_16x16x32_bf16 a[52:55], a[156:159], v[216:219], a[52:55]
    v_exp_f32 v150, v150
    v_mfma_f32_16x16x32_bf16 a[56:59], a[152:155], v[224:227], a[56:59]
    ds_read_b64_tr_b16 a[150:151], v38 offset:28672
    v_cvt_pk_bf16_f32 v146, v148, v149
    v_mfma_f32_16x16x32_bf16 a[56:59], a[156:159], v[232:235], a[56:59]
    v_exp_f32 v151, v151
    v_mfma_f32_16x16x32_bf16 a[60:63], a[152:155], v[240:243], a[60:63]
    v_mfma_f32_16x16x32_bf16 a[60:63], a[156:159], v[248:251], a[60:63]
    v_mfma_f32_16x16x32_bf16 a[196:199], a[208:211], v[208:211], a[196:199]
    v_exp_f32 v160, v160
    v_mfma_f32_16x16x32_bf16 a[196:199], a[208:211], v[216:219], a[196:199]
    v_cvt_pk_bf16_f32 v147, v150, v151
    s_waitcnt lgkmcnt(10)
    v_mfma_f32_16x16x32_bf16 a[64:67], a[128:131], v[192:195], a[64:67]
    v_exp_f32 v161, v161
    v_mfma_f32_16x16x32_bf16 a[64:67], a[132:135], v[200:203], a[64:67]
    ds_read_b64_tr_b16 a[152:153], v39 offset:16384
    ds_read_b64_tr_b16 a[154:155], v39 offset:20480
    v_mfma_f32_16x16x32_bf16 a[68:71], a[128:131], v[208:211], a[68:71]
    v_exp_f32 v162, v162
    v_mfma_f32_16x16x32_bf16 a[68:71], a[132:135], v[216:219], a[68:71]
    ds_read_b64_tr_b16 a[156:157], v39 offset:24576
    v_cvt_pk_bf16_f32 v160, v160, v161
    v_mfma_f32_16x16x32_bf16 a[72:75], a[128:131], v[224:227], a[72:75]
    v_exp_f32 v163, v163
    v_mfma_f32_16x16x32_bf16 a[72:75], a[132:135], v[232:235], a[72:75]
    ds_read_b64_tr_b16 a[158:159], v39 offset:28672
    ds_read_b128 a[176:179], v20 offset:36864
    v_mfma_f32_16x16x32_bf16 a[76:79], a[128:131], v[240:243], a[76:79]
    v_exp_f32 v164, v164
    v_mfma_f32_16x16x32_bf16 a[76:79], a[132:135], v[248:251], a[76:79]
    v_cvt_pk_bf16_f32 v161, v162, v163
    s_waitcnt lgkmcnt(9)
    v_mfma_f32_16x16x32_bf16 a[80:83], a[136:139], v[192:195], a[80:83]
    v_exp_f32 v165, v165
    v_mfma_f32_16x16x32_bf16 a[80:83], a[140:143], v[200:203], a[80:83]
    ds_read_b128 a[180:183], v21 offset:36864
    ds_read_b128 a[184:187], v22 offset:36864
    v_mfma_f32_16x16x32_bf16 a[84:87], a[136:139], v[208:211], a[84:87]
    v_exp_f32 v166, v166
    v_mfma_f32_16x16x32_bf16 a[84:87], a[140:143], v[216:219], a[84:87]
    ds_read_b128 a[188:191], v23 offset:36864
    v_cvt_pk_bf16_f32 v162, v164, v165
    v_mfma_f32_16x16x32_bf16 a[88:91], a[136:139], v[224:227], a[88:91]
    v_exp_f32 v167, v167
    v_mfma_f32_16x16x32_bf16 a[88:91], a[140:143], v[232:235], a[88:91]
    v_mfma_f32_16x16x32_bf16 a[92:95], a[136:139], v[240:243], a[92:95]
    v_mfma_f32_16x16x32_bf16 a[92:95], a[140:143], v[248:251], a[92:95]
    v_exp_f32 v176, v176
    v_mfma_f32_16x16x32_bf16 a[200:203], a[208:211], v[224:227], a[200:203]
    v_cvt_pk_bf16_f32 v163, v166, v167
    s_waitcnt lgkmcnt(8)
    v_mfma_f32_16x16x32_bf16 a[200:203], a[208:211], v[232:235], a[200:203]
    v_exp_f32 v177, v177
    v_mfma_f32_16x16x32_bf16 a[96:99], a[144:147], v[192:195], a[96:99]
    v_mfma_f32_16x16x32_bf16 a[96:99], a[148:151], v[200:203], a[96:99]
    v_exp_f32 v178, v178
    v_mfma_f32_16x16x32_bf16 a[100:103], a[144:147], v[208:211], a[100:103]
    v_cvt_pk_bf16_f32 v176, v176, v177
    v_mfma_f32_16x16x32_bf16 a[100:103], a[148:151], v[216:219], a[100:103]
    v_exp_f32 v179, v179
    v_mfma_f32_16x16x32_bf16 a[104:107], a[144:147], v[224:227], a[104:107]
    v_mfma_f32_16x16x32_bf16 a[104:107], a[148:151], v[232:235], a[104:107]
    v_exp_f32 v180, v180
    v_mfma_f32_16x16x32_bf16 a[108:111], a[144:147], v[240:243], a[108:111]
    v_cvt_pk_bf16_f32 v177, v178, v179
    s_waitcnt lgkmcnt(4)
    v_mfma_f32_16x16x32_bf16 a[108:111], a[148:151], v[248:251], a[108:111]
    v_exp_f32 v181, v181
    v_mfma_f32_16x16x32_bf16 a[112:115], a[152:155], v[192:195], a[112:115]
    v_mfma_f32_16x16x32_bf16 a[112:115], a[156:159], v[200:203], a[112:115]
    v_exp_f32 v182, v182
    v_mfma_f32_16x16x32_bf16 a[116:119], a[152:155], v[208:211], a[116:119]
    v_cvt_pk_bf16_f32 v178, v180, v181
    v_mfma_f32_16x16x32_bf16 a[116:119], a[156:159], v[216:219], a[116:119]
    v_exp_f32 v183, v183
    v_mfma_f32_16x16x32_bf16 a[120:123], a[152:155], v[224:227], a[120:123]
    s_cmp_lg_u32 s76, 0
    s_cbranch_scc1 L_tk1
    s_waitcnt vmcnt(0)
    s_lshl_b32 s93, 1, s79
    s_mov_b32 s92, 0x40000
L_poll1:
    v_cmp_gt_u32 vcc, 1, v62
    s_nop 1
    s_and_b32 s86, vcc_lo, s93
    s_cbranch_scc0 L_polld1
    s_sub_u32 s92, s92, 1
    s_cbranch_scc1 L_polld1
    s_sleep 6
    global_load_dword v62, v60, s[24:25] sc1
    s_waitcnt vmcnt(0)
    s_branch L_poll1
L_polld1:
    v_add_u32 v6, -1, v62
    v_and_b32 v6, 0xff, v6
    v_lshl_or_b32 v6, v6, 2, v5
    v_readlane_b32 s81, v62, s79
    s_nop 0
    v_max_u32_dpp v6, v6, v6 quad_perm:[1,0,3,2] row_mask:0xf bank_mask:0xf
    s_nop 1
    v_max_u32_dpp v6, v6, v6 quad_perm:[2,3,0,1] row_mask:0xf bank_mask:0xf
    s_nop 0
    v_readlane_b32 s82, v6, 0
    v_readlane_b32 s83, v6, 4
    s_and_b32 s82, s82, 3
    s_and_b32 s83, s83, 3
    s_lshl_b32 s82, s82, 8
    s_lshl_b32 s83, s83, 10
    s_and_b32 s81, s81, 0xff
    s_or_b32 s81, s81, s82
    s_or_b32 s81, s81, s83
    v_mov_b32 v62, s81
    ds_write_b32 v61, v62
L_tk1:
    v_mfma_f32_16x16x32_bf16 a[120:123], a[156:159], v[232:235], a[120:123]
    v_mfma_f32_16x16x32_bf16 a[124:127], a[152:155], v[240:243], a[124:127]
    v_exp_f32 v136, v136
    v_mfma_f32_16x16x32_bf16 a[124:127], a[156:159], v[248:251], a[124:127]
    v_cvt_pk_bf16_f32 v179, v182, v183
    v_mfma_f32_16x16x32_bf16 a[204:207], a[208:211], v[240:243], a[204:207]
    v_exp_f32 v137, v137
    v_mfma_f32_16x16x32_bf16 a[204:207], a[208:211], v[248:251], a[204:207]
    s_waitcnt lgkmcnt(0)
    v_mfma_f32_16x16x32_bf16 v[192:195], a[160:163], v[64:67], v[8:11]
    v_exp_f32 v138, v138
    v_mfma_f32_16x16x32_bf16 v[192:195], a[164:167], v[68:71], v[192:195]
    ds_read_b64_tr_b16 a[128:129], v32 offset:32768
    v_cvt_pk_bf16_f32 v136, v136, v137
    v_mfma_f32_16x16x32_bf16 v[192:195], a[168:171], v[72:75], v[192:195]
    v_exp_f32 v139, v139
    v_mfma_f32_16x16x32_bf16 v[192:195], a[172:175], v[76:79], v[192:195]
    ds_read_b64_tr_b16 a[130:131], v32 offset:36864
    v_mfma_f32_16x16x32_bf16 v[208:211], a[160:163], v[80:83], v[12:15]
    v_exp_f32 v140, v140
    v_mfma_f32_16x16x32_bf16 v[208:211], a[164:167], v[84:87], v[208:211]
    v_cvt_pk_bf16_f32 v137, v138, v139
    v_mfma_f32_16x16x32_bf16 v[208:211], a[168:171], v[88:91], v[208:211]
    v_exp_f32 v141, v141
    v_mfma_f32_16x16x32_bf16 v[208:211], a[172:175], v[92:95], v[208:211]
    ds_read_b64_tr_b16 a[132:133], v32 offset:40960
    v_mfma_f32_16x16x32_bf16 v[224:227], a[160:163], v[96:99], v[24:27]
    v_exp_f32 v142, v142
    v_mfma_f32_16x16x32_bf16 v[224:227], a[164:167], v[100:103], v[224:227]
    v_cvt_pk_bf16_f32 v138, v140, v141
    v_mfma_f32_16x16x32_bf16 v[224:227], a[168:171], v[104:107], v[224:227]
    v_exp_f32 v143, v143
    v_mfma_f32_16x16x32_bf16 v[224:227], a[172:175], v[108:111], v[224:227]
    ds_read_b64_tr_b16 a[134:135], v32 offset:45056
    v_mfma_f32_16x16x32_bf16 v[240:243], a[160:163], v[112:115], v[28:31]
    v_mfma_f32_16x16x32_bf16 v[240:243], a[164:167], v[116:119], v[240:243]
    v_exp_f32 v152, v152
    v_mfma_f32_16x16x32_bf16 v[240:243], a[168:171], v[120:123], v[240:243]
    ds_read_b64_tr_b16 a[136:137], v33 offset:32768
    v_cvt_pk_bf16_f32 v139, v142, v143
    v_mfma_f32_16x16x32_bf16 v[240:243], a[172:175], v[124:127], v[240:243]
    v_exp_f32 v153, v153
    v_mfma_f32_16x16x32_bf16 v[196:199], a[176:179], v[64:67], v[8:11]
    ds_read_b128 a[160:163], v20 offset:40960
    ds_read_b128 a[164:167], v21 offset:40960
    v_mfma_f32_16x16x32_bf16 v[196:199], a[180:183], v[68:71], v[196:199]
    v_exp_f32 v154, v154
    v_mfma_f32_16x16x32_bf16 v[196:199], a[184:187], v[72:75], v[196:199]
    ds_read_b128 a[168:171], v22 offset:40960
    v_cvt_pk_bf16_f32 v152, v152, v153
    v_mfma_f32_16x16x32_bf16 v[196:199], a[188:191], v[76:79], v[196:199]
    v_exp_f32 v155, v155
    v_mfma_f32_16x16x32_bf16 v[212:215], a[176:179], v[80:83], v[12:15]
    ds_read_b128 a[172:175], v23 offset:40960
    ds_read_b64_tr_b16 a[138:139], v33 offset:36864
    v_mfma_f32_16x16x32_bf16 v[212:215], a[180:183], v[84:87], v[212:215]
    v_exp_f32 v156, v156
    v_mfma_f32_16x16x32_bf16 v[212:215], a[184:187], v[88:91], v[212:215]
    ds_read_b64_tr_b16 a[140:141], v33 offset:40960
    v_cvt_pk_bf16_f32 v153, v154, v155
    v_mfma_f32_16x16x32_bf16 v[212:215], a[188:191], v[92:95], v[212:215]
    v_exp_f32 v157, v157
    v_mfma_f32_16x16x32_bf16 v[228:231], a[176:179], v[96:99], v[24:27]
    v_mfma_f32_16x16x32_bf16 v[228:231], a[180:183], v[100:103], v[228:231]
    v_exp_f32 v158, v158
    v_mfma_f32_16x16x32_bf16 v[228:231], a[184:187], v[104:107], v[228:231]
    ds_read_b64_tr_b16 a[142:143], v33 offset:45056
    v_cvt_pk_bf16_f32 v154, v156, v157
    v_mfma_f32_16x16x32_bf16 v[228:231], a[188:191], v[108:111], v[228:231]
    v_exp_f32 v159, v159
    v_mfma_f32_16x16x32_bf16 v[244:247], a[176:179], v[112:115], v[28:31]
    v_mfma_f32_16x16x32_bf16 v[244:247], a[180:183], v[116:119], v[244:247]
    ds_read_b64_tr_b16 a[144:145], v34 offset:32768
    v_mfma_f32_16x16x32_bf16 v[244:247], a[184:187], v[120:123], v[244:247]
    v_exp_f32 v168, v168
    v_mfma_f32_16x16x32_bf16 v[244:247], a[188:191], v[124:127], v[244:247]
    v_cvt_pk_bf16_f32 v155, v158, v159
    s_waitcnt lgkmcnt(4)
    v_mfma_f32_16x16x32_bf16 v[200:203], a[160:163], v[64:67], v[8:11]
    ds_read_b64_tr_b16 a[146:147], v34 offset:36864
    v_exp_f32 v169, v169
    v_mfma_f32_16x16x32_bf16 v[200:203], a[164:167], v[68:71], v[200:203]
    ds_read_b128 a[176:179], v20 offset:45056
    ds_read_b128 a[180:183], v21 offset:45056
    v_mfma_f32_16x16x32_bf16 v[200:203], a[168:171], v[72:75], v[200:203]
    v_exp_f32 v170, v170
    v_mfma_f32_16x16x32_bf16 v[200:203], a[172:175], v[76:79], v[200:203]
    ds_read_b128 a[184:187], v22 offset:45056
    v_cvt_pk_bf16_f32 v168, v168, v169
    v_mfma_f32_16x16x32_bf16 v[216:219], a[160:163], v[80:83], v[12:15]
    v_exp_f32 v171, v171
    v_mfma_f32_16x16x32_bf16 v[216:219], a[164:167], v[84:87], v[216:219]
    ds_read_b128 a[188:191], v23 offset:45056
    ds_read_b64_tr_b16 a[148:149], v34 offset:40960
    v_mfma_f32_16x16x32_bf16 v[216:219], a[168:171], v[88:91], v[216:219]
    v_exp_f32 v172, v172
    v_mfma_f32_16x16x32_bf16 v[216:219], a[172:175], v[92:95], v[216:219]
    ds_read_b64_tr_b16 a[150:151], v34 offset:45056
    v_cvt_pk_bf16_f32 v169, v170, v171
    v_mfma_f32_16x16x32_bf16 v[232:235], a[160:163], v[96:99], v[24:27]
    v_exp_f32 v173, v173
    v_mfma_f32_16x16x32_bf16 v[232:235], a[164:167], v[100:103], v[232:235]
    v_mfma_f32_16x16x32_bf16 v[232:235], a[168:171], v[104:107], v[232:235]
    v_exp_f32 v174, v174
    v_mfma_f32_16x16x32_bf16 v[232:235], a[172:175], v[108:111], v[232:235]
    ds_read_b64_tr_b16 a[152:153], v35 offset:32768
    v_cvt_pk_bf16_f32 v170, v172, v173
    v_mfma_f32_16x16x32_bf16 v[248:251], a[160:163], v[112:115], v[28:31]
    v_exp_f32 v175, v175
    v_mfma_f32_16x16x32_bf16 v[248:251], a[164:167], v[116:119], v[248:251]
    v_mfma_f32_16x16x32_bf16 v[248:251], a[168:171], v[120:123], v[248:251]
    s_waitcnt vmcnt(0) lgkmcnt(3)
    ds_add_u32 v18, v19
    v_mfma_f32_16x16x32_bf16 v[248:251], a[172:175], v[124:127], v[248:251]
    v_exp_f32 v184, v184
    v_mfma_f32_16x16x32_bf16 v[204:207], a[176:179], v[64:67], v[8:11]
    ds_read_b64_tr_b16 a[154:155], v35 offset:36864
    v_cvt_pk_bf16_f32 v171, v174, v175
    v_mfma_f32_16x16x32_bf16 v[204:207], a[180:183], v[68:71], v[204:207]
    v_exp_f32 v185, v185
    v_mfma_f32_16x16x32_bf16 v[204:207], a[184:187], v[72:75], v[204:207]
    ds_read_b64_tr_b16 a[156:157], v35 offset:40960
    v_mfma_f32_16x16x32_bf16 v[204:207], a[188:191], v[76:79], v[204:207]
    v_exp_f32 v186, v186
    v_mfma_f32_16x16x32_bf16 v[220:223], a[176:179], v[80:83], v[12:15]
    v_cvt_pk_bf16_f32 v184, v184, v185
    v_mfma_f32_16x16x32_bf16 v[220:223], a[180:183], v[84:87], v[220:223]
    v_exp_f32 v187, v187
    v_mfma_f32_16x16x32_bf16 v[220:223], a[184:187], v[88:91], v[220:223]
    ds_read_b64_tr_b16 a[158:159], v35 offset:45056
    v_mfma_f32_16x16x32_bf16 v[220:223], a[188:191], v[92:95], v[220:223]
    v_exp_f32 v188, v188
    v_mfma_f32_16x16x32_bf16 v[236:239], a[176:179], v[96:99], v[24:27]
    v_cvt_pk_bf16_f32 v185, v186, v187
    v_mfma_f32_16x16x32_bf16 v[236:239], a[180:183], v[100:103], v[236:239]
    v_exp_f32 v189, v189
    v_mfma_f32_16x16x32_bf16 v[236:239], a[184:187], v[104:107], v[236:239]
    v_mfma_f32_16x16x32_bf16 v[236:239], a[188:191], v[108:111], v[236:239]
    v_exp_f32 v190, v190
    v_mfma_f32_16x16x32_bf16 v[252:255], a[176:179], v[112:115], v[28:31]
    ds_read_b32 v17, v18
    v_cvt_pk_bf16_f32 v186, v188, v189
    v_mfma_f32_16x16x32_bf16 v[252:255], a[180:183], v[116:119], v[252:255]
    v_exp_f32 v191, v191
    v_mfma_f32_16x16x32_bf16 v[252:255], a[184:187], v[120:123], v[252:255]
    v_mfma_f32_16x16x32_bf16 v[252:255], a[188:191], v[124:127], v[252:255]
    s_nop 0
    v_cvt_pk_bf16_f32 v187, v190, v191
    s_waitcnt lgkmcnt(0)
    v_mfma_f32_16x16x32_bf16 a[0:3], a[128:131], v[128:131], a[0:3]
    v_exp_f32 v192, v192
    v_mfma_f32_16x16x32_bf16 a[0:3], a[132:135], v[136:139], a[0:3]
    v_cmp_gt_u32 vcc, s98, v17
    v_mfma_f32_16x16x32_bf16 a[4:7], a[128:131], v[144:147], a[4:7]
    v_exp_f32 v193, v193
    v_mfma_f32_16x16x32_bf16 a[4:7], a[132:135], v[152:155], a[4:7]
    s_cbranch_vccnz L_spinu
L_spunu:
    v_mfma_f32_16x16x32_bf16 a[8:11], a[128:131], v[160:163], a[8:11]
    ds_read_b32 v62, v61
    v_exp_f32 v194, v194
    v_mfma_f32_16x16x32_bf16 a[8:11], a[132:135], v[168:171], a[8:11]
    s_add_u32 s98, s98, 4
    v_cvt_pk_bf16_f32 v192, v192, v193
    v_mfma_f32_16x16x32_bf16 a[12:15], a[128:131], v[176:179], a[12:15]
    v_exp_f32 v195, v195
    v_mfma_f32_16x16x32_bf16 a[12:15], a[132:135], v[184:187], a[12:15]
    v_mfma_f32_16x16x32_bf16 a[16:19], a[136:139], v[128:131], a[16:19]
    ds_read_b64_tr_b16 a[128:129], v36 offset:32768
    ds_read_b64_tr_b16 a[130:131], v36 offset:36864
    v_mfma_f32_16x16x32_bf16 a[16:19], a[140:143], v[136:139], a[16:19]
    v_exp_f32 v196, v196
    v_mfma_f32_16x16x32_bf16 a[20:23], a[136:139], v[144:147], a[20:23]
    ds_read_b64_tr_b16 a[132:133], v36 offset:40960
    v_cvt_pk_bf16_f32 v193, v194, v195
    v_mfma_f32_16x16x32_bf16 a[20:23], a[140:143], v[152:155], a[20:23]
    v_exp_f32 v197, v197
    v_mfma_f32_16x16x32_bf16 a[24:27], a[136:139], v[160:163], a[24:27]
    ds_read_b64_tr_b16 a[134:135], v36 offset:45056
    v_mfma_f32_16x16x32_bf16 a[24:27], a[140:143], v[168:171], a[24:27]
    v_exp_f32 v198, v198
    v_mfma_f32_16x16x32_bf16 a[28:31], a[136:139], v[176:179], a[28:31]
    v_cvt_pk_bf16_f32 v194, v196, v197
    v_mfma_f32_16x16x32_bf16 a[28:31], a[140:143], v[184:187], a[28:31]
    v_exp_f32 v199, v199
    v_mfma_f32_16x16x32_bf16 a[192:195], a[208:211], v[128:131], a[192:195]
    ds_read_b64_tr_b16 a[136:137], v37 offset:32768
    ds_read_b64_tr_b16 a[138:139], v37 offset:36864
    v_mfma_f32_16x16x32_bf16 a[192:195], a[208:211], v[136:139], a[192:195]
    ds_read_b64_tr_b16 a[140:141], v37 offset:40960
    ds_read_b64_tr_b16 a[142:143], v37 offset:45056
    v_mfma_f32_16x16x32_bf16 a[32:35], a[144:147], v[128:131], a[32:35]
    v_exp_f32 v208, v208
    v_mfma_f32_16x16x32_bf16 a[32:35], a[148:151], v[136:139], a[32:35]
    v_cvt_pk_bf16_f32 v195, v198, v199
    v_mfma_f32_16x16x32_bf16 a[36:39], a[144:147], v[144:147], a[36:39]
    v_exp_f32 v209, v209
    v_mfma_f32_16x16x32_bf16 a[36:39], a[148:151], v[152:155], a[36:39]
    v_mfma_f32_16x16x32_bf16 a[40:43], a[144:147], v[160:163], a[40:43]
    v_exp_f32 v210, v210
    v_mfma_f32_16x16x32_bf16 a[40:43], a[148:151], v[168:171], a[40:43]
    v_cvt_pk_bf16_f32 v208, v208, v209
    v_mfma_f32_16x16x32_bf16 a[44:47], a[144:147], v[176:179], a[44:47]
    v_exp_f32 v211, v211
    v_mfma_f32_16x16x32_bf16 a[44:47], a[148:151], v[184:187], a[44:47]
    v_mfma_f32_16x16x32_bf16 a[48:51], a[152:155], v[128:131], a[48:51]
    ds_read_b64_tr_b16 a[144:145], v38 offset:32768
    ds_read_b64_tr_b16 a[146:147], v38 offset:36864
    v_mfma_f32_16x16x32_bf16 a[48:51], a[156:159], v[136:139], a[48:51]
    v_exp_f32 v212, v212
    v_mfma_f32_16x16x32_bf16 a[52:55], a[152:155], v[144:147], a[52:55]
    ds_read_b64_tr_b16 a[148:149], v38 offset:40960
    v_cvt_pk_bf16_f32 v209, v210, v211
    v_mfma_f32_16x16x32_bf16 a[52:55], a[156:159], v[152:155], a[52:55]
    v_exp_f32 v213, v213
    v_mfma_f32_16x16x32_bf16 a[56:59], a[152:155], v[160:163], a[56:59]
    ds_read_b64_tr_b16 a[150:151], v38 offset:45056
    v_mfma_f32_16x16x32_bf16 a[56:59], a[156:159], v[168:171], a[56:59]
    v_exp_f32 v214, v214
    v_mfma_f32_16x16x32_bf16 a[60:63], a[152:155], v[176:179], a[60:63]
    v_cvt_pk_bf16_f32 v210, v212, v213
    v_mfma_f32_16x16x32_bf16 a[60:63], a[156:159], v[184:187], a[60:63]
    v_exp_f32 v215, v215
    v_mfma_f32_16x16x32_bf16 a[196:199], a[208:211], v[144:147], a[196:199]
    s_waitcnt lgkmcnt(8)
    ds_read_b64_tr_b16 a[152:153], v39 offset:32768
    v_mfma_f32_16x16x32_bf16 a[196:199], a[208:211], v[152:155], a[196:199]
    ds_read_b64_tr_b16 a[154:155], v39 offset:36864
    ds_read_b64_tr_b16 a[156:157], v39 offset:40960
    v_mfma_f32_16x16x32_bf16 a[64:67], a[128:131], v[128:131], a[64:67]
    v_readfirstlane_b32 s91, v62
    v_exp_f32 v224, v224
    v_mfma_f32_16x16x32_bf16 a[64:67], a[132:135], v[136:139], a[64:67]
    ds_read_b64_tr_b16 a[158:159], v39 offset:45056
    s_mov_b32 s81, s91
    s_sub_u32 s81, s81, 1
    v_cvt_pk_bf16_f32 v211, v214, v215
    v_mfma_f32_16x16x32_bf16 a[68:71], a[128:131], v[144:147], a[68:71]
    s_and_b32 s81, s81, 7
    s_mul_i32 s81, s81, 30
    v_exp_f32 v225, v225
    v_mfma_f32_16x16x32_bf16 a[68:71], a[132:135], v[152:155], a[68:71]
    s_add_u32 s81, s81, s80
    s_cmp_ge_u32 s80, 30
    v_mfma_f32_16x16x32_bf16 a[72:75], a[128:131], v[160:163], a[72:75]
    s_cselect_b32 s81, 255, s81
    s_sub_u32 s82, s81, 70
    v_exp_f32 v226, v226
    v_mfma_f32_16x16x32_bf16 a[72:75], a[132:135], v[168:171], a[72:75]
    s_cselect_b32 s95, 2, 0
    s_cselect_b32 s82, s81, s82
    v_cvt_pk_bf16_f32 v224, v224, v225
    v_mfma_f32_16x16x32_bf16 a[76:79], a[128:131], v[176:179], a[76:79]
    s_mul_i32 s83, s82, 205
    s_lshr_b32 s83, s83, 10
    v_exp_f32 v227, v227
    v_mfma_f32_16x16x32_bf16 a[76:79], a[132:135], v[184:187], a[76:79]
    s_waitcnt lgkmcnt(8)
    s_mul_i32 s84, s83, 5
    s_sub_u32 s97, s82, s84
    v_mfma_f32_16x16x32_bf16 a[80:83], a[136:139], v[128:131], a[80:83]
    ds_read_b64_tr_b16 a[128:129], v32 offset:49152
    ds_read_b64_tr_b16 a[130:131], v32 offset:53248
    s_and_b32 s96, s83, 15
    s_lshr_b32 s83, s83, 4
    v_mfma_f32_16x16x32_bf16 a[80:83], a[140:143], v[136:139], a[80:83]
    s_add_u32 s95, s95, s83
    s_cmp_ge_u32 s81, 230
    v_exp_f32 v228, v228
    v_mfma_f32_16x16x32_bf16 a[84:87], a[136:139], v[144:147], a[84:87]
    ds_read_b64_tr_b16 a[132:133], v33 offset:49152
    s_cselect_b32 s95, 3, s95
    s_lshl_b32 s81, s96, 7
    v_cvt_pk_bf16_f32 v225, v226, v227
    v_mfma_f32_16x16x32_bf16 a[84:87], a[140:143], v[152:155], a[84:87]
    s_lshl_b32 s82, s95, 6
    s_add_u32 s81, s81, s82
    v_exp_f32 v229, v229
    v_mfma_f32_16x16x32_bf16 a[88:91], a[136:139], v[160:163], a[88:91]
    ds_read_b64_tr_b16 a[134:135], v33 offset:53248
    s_lshl_b32 s81, s81, 13
    s_add_u32 s81, s81, 4194304
    v_mfma_f32_16x16x32_bf16 a[88:91], a[140:143], v[168:171], a[88:91]
    s_lshl_b32 s82, s97, 13
    s_add_u32 s82, s82, 65536
    v_exp_f32 v230, v230
    v_mfma_f32_16x16x32_bf16 a[92:95], a[136:139], v[176:179], a[92:95]
    s_mul_i32 s83, s95, 2621440
    s_lshl_b32 s84, s97, 8
    v_cvt_pk_bf16_f32 v226, v228, v229
    v_mfma_f32_16x16x32_bf16 a[92:95], a[140:143], v[184:187], a[92:95]
    s_add_u32 s83, s83, s84
    s_lshl_b32 s84, s96, 8
    v_exp_f32 v231, v231
    v_mfma_f32_16x16x32_bf16 a[200:203], a[208:211], v[160:163], a[200:203]
    s_waitcnt lgkmcnt(8)
    ds_read_b64_tr_b16 a[136:137], v34 offset:49152
    s_cmp_eq_u32 s95, 2
    s_cselect_b32 s0, s82, s81
    v_mfma_f32_16x16x32_bf16 a[200:203], a[208:211], v[168:171], a[200:203]
    ds_read_b64_tr_b16 a[138:139], v34 offset:53248
    ds_read_b64_tr_b16 a[140:141], v35 offset:49152
    v_mfma_f32_16x16x32_bf16 a[96:99], a[144:147], v[128:131], a[96:99]
    s_cselect_b32 s1, s84, s83
    s_mov_b32 s81, 81920
    v_exp_f32 v240, v240
    v_mfma_f32_16x16x32_bf16 a[96:99], a[148:151], v[136:139], a[96:99]
    ds_read_b64_tr_b16 a[142:143], v35 offset:53248
    s_cselect_b32 s30, s81, 0x4000
    s_mov_b32 s81, 3456
    v_cvt_pk_bf16_f32 v227, v230, v231
    v_mfma_f32_16x16x32_bf16 a[100:103], a[144:147], v[144:147], a[100:103]
    s_cselect_b32 s85, s81, 0x500
    s_cselect_b32 s44, s52, s48
    v_exp_f32 v241, v241
    v_mfma_f32_16x16x32_bf16 a[100:103], a[148:151], v[152:155], a[100:103]
    s_cselect_b32 s45, s53, s49
    s_cselect_b32 s46, s54, s50
    v_mfma_f32_16x16x32_bf16 a[104:107], a[144:147], v[160:163], a[104:107]
    s_mov_b32 s81, 40960
    s_cselect_b32 s81, s81, 0x2000
    v_exp_f32 v242, v242
    v_mfma_f32_16x16x32_bf16 a[104:107], a[148:151], v[168:171], a[104:107]
    s_lshr_b32 s82, s76, 1
    s_mul_i32 s81, s81, s82
    v_cvt_pk_bf16_f32 v240, v240, v241
    v_mfma_f32_16x16x32_bf16 a[108:111], a[144:147], v[176:179], a[108:111]
    s_and_b32 s82, s76, 1
    s_lshl_b32 s82, s82, 12
    v_exp_f32 v243, v243
    v_mfma_f32_16x16x32_bf16 a[108:111], a[148:151], v[184:187], a[108:111]
    s_waitcnt lgkmcnt(8)
    s_add_u32 s81, s81, s82
    v_add_u32 v40, s81, v50
    v_mfma_f32_16x16x32_bf16 a[112:115], a[152:155], v[128:131], a[112:115]
    ds_read_b64_tr_b16 a[144:145], v36 offset:49152
    ds_read_b64_tr_b16 a[146:147], v36 offset:53248
    s_lshl_b32 s31, s85, 6
    s_lshl_b32 s81, s76, 4
    v_mfma_f32_16x16x32_bf16 a[112:115], a[156:159], v[136:139], a[112:115]
    v_add_u32 v6, s81, v3
    v_mul_u32_u24 v6, s85, v6
    v_exp_f32 v244, v244
    v_mfma_f32_16x16x32_bf16 a[116:119], a[152:155], v[144:147], a[116:119]
    ds_read_b64_tr_b16 a[148:149], v37 offset:49152
    v_lshlrev_b32 v7, 1, v3
    v_xor_b32 v7, v7, v2
    v_cvt_pk_bf16_f32 v241, v242, v243
    v_mfma_f32_16x16x32_bf16 a[116:119], a[156:159], v[152:155], a[116:119]
    v_lshl_add_u32 v41, v7, 4, v6
    v_xor_b32 v7, 8, v7
    v_exp_f32 v245, v245
    v_mfma_f32_16x16x32_bf16 a[120:123], a[152:155], v[160:163], a[120:123]
    ds_read_b64_tr_b16 a[150:151], v37 offset:53248
    v_lshl_add_u32 v42, v7, 4, v6
    s_lshl_b32 s81, s85, 2
    v_mfma_f32_16x16x32_bf16 a[120:123], a[156:159], v[168:171], a[120:123]
    s_sub_u32 s81, s81, 1024
    v_add_u32 v42, s81, v42
    v_exp_f32 v246, v246
    v_mfma_f32_16x16x32_bf16 a[124:127], a[152:155], v[176:179], a[124:127]
    s_lshl_b32 s81, s81, 1
    v_add_u32 v43, s81, v41
    v_cvt_pk_bf16_f32 v242, v244, v245
    v_mfma_f32_16x16x32_bf16 a[124:127], a[156:159], v[184:187], a[124:127]
    v_add_u32 v44, s81, v42
    v_exp_f32 v247, v247
    v_mfma_f32_16x16x32_bf16 a[204:207], a[208:211], v[176:179], a[204:207]
    v_mfma_f32_16x16x32_bf16 a[204:207], a[208:211], v[184:187], a[204:207]
    s_nop 0
    v_cvt_pk_bf16_f32 v243, v246, v247
    ds_read_b64_tr_b16 a[152:153], v38 offset:49152
    ds_read_b64_tr_b16 a[154:155], v38 offset:53248
    ds_read_b64_tr_b16 a[156:157], v39 offset:49152
    ds_read_b64_tr_b16 a[158:159], v39 offset:53248
    s_mov_b32 s93, 0x3fc000
    v_accvgpr_read_b32 v7, a250
    s_mov_b32 s92, 0x40000
L_poll2:
    v_sub_u32 v58, v58, v7
    v_cmp_gt_u32 vcc, 32, v58
    s_nop 1
    s_and_b32 s86, vcc_lo, s93
    s_cbranch_scc0 L_polld2
    s_sub_u32 s92, s92, 1
    s_cbranch_scc1 L_polld2
    s_sleep 6
    s_mov_b32 exec_lo, s93
    s_mov_b32 exec_hi, 0
    buffer_load_dword v58, v59, s[72:75], 0 offen sc1
    s_mov_b64 exec, -1
    s_waitcnt vmcnt(0)
    s_branch L_poll2
L_polld2:
    s_waitcnt lgkmcnt(0)
    v_mfma_f32_16x16x32_bf16 a[0:3], a[128:131], v[192:195], a[0:3]
    v_exp_f32 v200, v200
    v_mfma_f32_16x16x32_bf16 a[4:7], a[128:131], v[208:211], a[4:7]
    v_exp_f32 v201, v201
    v_mfma_f32_16x16x32_bf16 a[8:11], a[128:131], v[224:227], a[8:11]
    v_exp_f32 v202, v202
    v_cvt_pk_bf16_f32 v200, v200, v201
    v_mfma_f32_16x16x32_bf16 a[12:15], a[128:131], v[240:243], a[12:15]
    v_exp_f32 v203, v203
    v_mfma_f32_16x16x32_bf16 a[16:19], a[132:135], v[192:195], a[16:19]
    v_exp_f32 v204, v204
    v_cvt_pk_bf16_f32 v201, v202, v203
    v_mfma_f32_16x16x32_bf16 a[20:23], a[132:135], v[208:211], a[20:23]
    ds_read_b64_tr_b16 a[128:129], v32 offset:57344
    v_exp_f32 v205, v205
    v_mfma_f32_16x16x32_bf16 a[24:27], a[132:135], v[224:227], a[24:27]
    ds_read_b64_tr_b16 a[130:131], v32 offset:61440
    v_exp_f32 v206, v206
    v_mfma_f32_16x16x32_bf16 a[28:31], a[132:135], v[240:243], a[28:31]
    v_exp_f32 v207, v207
    v_mfma_f32_16x16x32_bf16 a[192:195], a[208:211], v[192:195], a[192:195]
    ds_read_b64_tr_b16 a[132:133], v33 offset:57344
    v_cvt_pk_bf16_f32 v202, v204, v205
    v_cvt_pk_bf16_f32 v203, v206, v207
    v_mfma_f32_16x16x32_bf16 a[32:35], a[136:139], v[192:195], a[32:35]
    ds_read_b64_tr_b16 a[134:135], v33 offset:61440
    v_exp_f32 v216, v216
    v_mfma_f32_16x16x32_bf16 a[36:39], a[136:139], v[208:211], a[36:39]
    v_exp_f32 v217, v217
    v_mfma_f32_16x16x32_bf16 a[40:43], a[136:139], v[224:227], a[40:43]
    v_exp_f32 v218, v218
    v_cvt_pk_bf16_f32 v216, v216, v217
    v_mfma_f32_16x16x32_bf16 a[44:47], a[136:139], v[240:243], a[44:47]
    v_exp_f32 v219, v219
    v_mfma_f32_16x16x32_bf16 a[48:51], a[140:143], v[192:195], a[48:51]
    v_exp_f32 v220, v220
    v_cvt_pk_bf16_f32 v217, v218, v219
    v_mfma_f32_16x16x32_bf16 a[52:55], a[140:143], v[208:211], a[52:55]
    ds_read_b64_tr_b16 a[136:137], v34 offset:57344
    v_exp_f32 v221, v221
    v_mfma_f32_16x16x32_bf16 a[56:59], a[140:143], v[224:227], a[56:59]
    ds_read_b64_tr_b16 a[138:139], v34 offset:61440
    v_exp_f32 v222, v222
    v_mfma_f32_16x16x32_bf16 a[60:63], a[140:143], v[240:243], a[60:63]
    v_exp_f32 v223, v223
    v_mfma_f32_16x16x32_bf16 a[196:199], a[208:211], v[208:211], a[196:199]
    ds_read_b64_tr_b16 a[140:141], v35 offset:57344
    v_cvt_pk_bf16_f32 v218, v220, v221
    v_cvt_pk_bf16_f32 v219, v222, v223
    v_mfma_f32_16x16x32_bf16 a[64:67], a[144:147], v[192:195], a[64:67]
    ds_read_b64_tr_b16 a[142:143], v35 offset:61440
    v_exp_f32 v232, v232
    v_mfma_f32_16x16x32_bf16 a[68:71], a[144:147], v[208:211], a[68:71]
    v_exp_f32 v233, v233
    v_mfma_f32_16x16x32_bf16 a[72:75], a[144:147], v[224:227], a[72:75]
    v_exp_f32 v234, v234
    v_cvt_pk_bf16_f32 v232, v232, v233
    v_mfma_f32_16x16x32_bf16 a[76:79], a[144:147], v[240:243], a[76:79]
    v_exp_f32 v235, v235
    v_mfma_f32_16x16x32_bf16 a[80:83], a[148:151], v[192:195], a[80:83]
    v_exp_f32 v236, v236
    v_cvt_pk_bf16_f32 v233, v234, v235
    v_mfma_f32_16x16x32_bf16 a[84:87], a[148:151], v[208:211], a[84:87]
    ds_read_b64_tr_b16 a[144:145], v36 offset:57344
    v_exp_f32 v237, v237
    v_mfma_f32_16x16x32_bf16 a[88:91], a[148:151], v[224:227], a[88:91]
    ds_read_b64_tr_b16 a[146:147], v36 offset:61440
    v_exp_f32 v238, v238
    v_mfma_f32_16x16x32_bf16 a[92:95], a[148:151], v[240:243], a[92:95]
    v_exp_f32 v239, v239
    v_mfma_f32_16x16x32_bf16 a[200:203], a[208:211], v[224:227], a[200:203]
    ds_read_b64_tr_b16 a[148:149], v37 offset:57344
    v_cvt_pk_bf16_f32 v234, v236, v237
    v_cvt_pk_bf16_f32 v235, v238, v239
    v_mfma_f32_16x16x32_bf16 a[96:99], a[152:155], v[192:195], a[96:99]
    ds_read_b64_tr_b16 a[150:151], v37 offset:61440
    v_exp_f32 v248, v248
    v_mfma_f32_16x16x32_bf16 a[100:103], a[152:155], v[208:211], a[100:103]
    v_exp_f32 v249, v249
    v_mfma_f32_16x16x32_bf16 a[104:107], a[152:155], v[224:227], a[104:107]
    v_exp_f32 v250, v250
    v_cvt_pk_bf16_f32 v248, v248, v249
    v_mfma_f32_16x16x32_bf16 a[108:111], a[152:155], v[240:243], a[108:111]
    v_exp_f32 v251, v251
    v_mfma_f32_16x16x32_bf16 a[112:115], a[156:159], v[192:195], a[112:115]
    v_exp_f32 v252, v252
    v_cvt_pk_bf16_f32 v249, v250, v251
    v_mfma_f32_16x16x32_bf16 a[116:119], a[156:159], v[208:211], a[116:119]
    ds_read_b64_tr_b16 a[152:153], v38 offset:57344
    v_exp_f32 v253, v253
    v_mfma_f32_16x16x32_bf16 a[120:123], a[156:159], v[224:227], a[120:123]
    ds_read_b64_tr_b16 a[154:155], v38 offset:61440
    v_exp_f32 v254, v254
    v_mfma_f32_16x16x32_bf16 a[124:127], a[156:159], v[240:243], a[124:127]
    v_exp_f32 v255, v255
    v_mfma_f32_16x16x32_bf16 a[204:207], a[208:211], v[240:243], a[204:207]
    v_cvt_pk_bf16_f32 v250, v252, v253
    v_cvt_pk_bf16_f32 v251, v254, v255
    ds_read_b64_tr_b16 a[156:157], v39 offset:57344
    ds_read_b64_tr_b16 a[158:159], v39 offset:61440
    s_waitcnt lgkmcnt(2)
    v_mfma_f32_16x16x32_bf16 a[0:3], a[128:131], v[200:203], a[0:3]
    s_cmp_eq_u32 s95, 2
    s_mov_b32 s88, s0
    v_mfma_f32_16x16x32_bf16 a[4:7], a[128:131], v[216:219], a[4:7]
    s_cselect_b32 s81, s1, 0x40000000
    s_cmp_eq_u32 s95, 3
    v_mfma_f32_16x16x32_bf16 a[8:11], a[128:131], v[232:235], a[8:11]
    v_mfma_f32_16x16x32_bf16 a[12:15], a[128:131], v[248:251], a[12:15]
    s_cselect_b32 s89, 0x40000000, s1
    v_mfma_f32_16x16x32_bf16 a[16:19], a[132:135], v[200:203], a[16:19]
    v_mfma_f32_16x16x32_bf16 a[20:23], a[132:135], v[216:219], a[20:23]
    buffer_load_dwordx2 v[24:25], v51, s[60:63], s81 offen offset:0
    v_mfma_f32_16x16x32_bf16 a[24:27], a[132:135], v[232:235], a[24:27]
    buffer_load_dwordx2 v[26:27], v51, s[60:63], s81 offen offset:32
    v_mfma_f32_16x16x32_bf16 a[28:31], a[132:135], v[248:251], a[28:31]
    v_mfma_f32_16x16x32_bf16 a[192:195], a[208:211], v[200:203], a[192:195]
    buffer_load_dwordx2 v[28:29], v51, s[60:63], s81 offen offset:64
    v_mfma_f32_16x16x32_bf16 a[32:35], a[136:139], v[200:203], a[32:35]
    v_mfma_f32_16x16x32_bf16 a[36:39], a[136:139], v[216:219], a[36:39]
    buffer_load_dwordx2 v[30:31], v51, s[60:63], s81 offen offset:96
    v_mfma_f32_16x16x32_bf16 a[40:43], a[136:139], v[232:235], a[40:43]
    s_add_u32 m0, s90, 65536
    s_nop 0
    v_mfma_f32_16x16x32_bf16 a[44:47], a[136:139], v[248:251], a[44:47]
    v_mfma_f32_16x16x32_bf16 a[48:51], a[140:143], v[200:203], a[48:51]
    buffer_load_dwordx4 v41, s[44:47], s89 offen offset:0 lds
    v_mfma_f32_16x16x32_bf16 a[52:55], a[140:143], v[216:219], a[52:55]
    v_mfma_f32_16x16x32_bf16 a[56:59], a[140:143], v[232:235], a[56:59]
    buffer_load_dwordx4 v42, s[44:47], s89 offen offset:1024 lds
    v_mfma_f32_16x16x32_bf16 a[60:63], a[140:143], v[248:251], a[60:63]
    buffer_load_dwordx4 v43, s[44:47], s89 offen offset:2048 lds
    v_mfma_f32_16x16x32_bf16 a[196:199], a[208:211], v[216:219], a[196:199]
    v_mfma_f32_16x16x32_bf16 a[64:67], a[144:147], v[200:203], a[64:67]
    buffer_load_dwordx4 v44, s[44:47], s89 offen offset:3072 lds
    v_mfma_f32_16x16x32_bf16 a[68:71], a[144:147], v[216:219], a[68:71]
    v_mfma_f32_16x16x32_bf16 a[72:75], a[144:147], v[232:235], a[72:75]
    s_add_u32 s89, s89, s31
    v_mfma_f32_16x16x32_bf16 a[76:79], a[144:147], v[248:251], a[76:79]
    s_cmp_lg_u32 s95, 2
    s_cbranch_scc1 L_oma_0
    s_add_u32 m0, s90, 0
    s_nop 0
    buffer_load_dwordx4 v40, s[72:75], s88 offen offset:0 sc1 lds
    buffer_load_dwordx4 v40, s[72:75], s88 offen offset:1024 sc1 lds
    buffer_load_dwordx4 v40, s[72:75], s88 offen offset:2048 sc1 lds
    buffer_load_dwordx4 v40, s[72:75], s88 offen offset:3072 sc1 lds
    s_add_u32 s88, s88, s30
L_oma_0:
    v_mfma_f32_16x16x32_bf16 a[80:83], a[148:151], v[200:203], a[80:83]
    s_waitcnt lgkmcnt(0)
    v_mfma_f32_16x16x32_bf16 a[84:87], a[148:151], v[216:219], a[84:87]
    s_add_u32 m0, s90, 81920
    s_nop 0
    v_mfma_f32_16x16x32_bf16 a[88:91], a[148:151], v[232:235], a[88:91]
    v_mfma_f32_16x16x32_bf16 a[92:95], a[148:151], v[248:251], a[92:95]
    buffer_load_dwordx4 v41, s[44:47], s89 offen offset:0 lds
    v_mfma_f32_16x16x32_bf16 a[200:203], a[208:211], v[232:235], a[200:203]
    buffer_load_dwordx4 v42, s[44:47], s89 offen offset:1024 lds
    v_mfma_f32_16x16x32_bf16 a[96:99], a[152:155], v[200:203], a[96:99]
    v_mfma_f32_16x16x32_bf16 a[100:103], a[152:155], v[216:219], a[100:103]
    buffer_load_dwordx4 v43, s[44:47], s89 offen offset:2048 lds
    v_mfma_f32_16x16x32_bf16 a[104:107], a[152:155], v[232:235], a[104:107]
    v_mfma_f32_16x16x32_bf16 a[108:111], a[152:155], v[248:251], a[108:111]
    buffer_load_dwordx4 v44, s[44:47], s89 offen offset:3072 lds
    v_mfma_f32_16x16x32_bf16 a[112:115], a[156:159], v[200:203], a[112:115]
    s_add_u32 s89, s89, s31
    v_mfma_f32_16x16x32_bf16 a[116:119], a[156:159], v[216:219], a[116:119]
    v_mfma_f32_16x16x32_bf16 a[120:123], a[156:159], v[232:235], a[120:123]
    s_cmp_lg_u32 s95, 2
    s_cbranch_scc1 L_omb_1
    s_add_u32 m0, s90, 16384
    s_nop 0
    buffer_load_dwordx4 v40, s[72:75], s88 offen offset:0 sc1 lds
    buffer_load_dwordx4 v40, s[72:75], s88 offen offset:1024 sc1 lds
    buffer_load_dwordx4 v40, s[72:75], s88 offen offset:2048 sc1 lds
    buffer_load_dwordx4 v40, s[72:75], s88 offen offset:3072 sc1 lds
    s_add_u32 s88, s88, s30
L_omb_1:
    v_mfma_f32_16x16x32_bf16 a[124:127], a[156:159], v[248:251], a[124:127]
    v_mfma_f32_16x16x32_bf16 a[204:207], a[208:211], v[248:251], a[204:207]
    s_barrier
    s_cmp_lg_u32 s95, 2
    s_cbranch_scc1 L_omc_2
    s_add_u32 m0, s90, 98304
    s_nop 0
    buffer_load_dwordx4 v41, s[44:47], s89 offen offset:0 lds
    buffer_load_dwordx4 v42, s[44:47], s89 offen offset:1024 lds
    buffer_load_dwordx4 v43, s[44:47], s89 offen offset:2048 lds
    buffer_load_dwordx4 v44, s[44:47], s89 offen offset:3072 lds
    s_add_u32 s89, s89, s31
    s_add_u32 m0, s90, 32768
    s_nop 0
    buffer_load_dwordx4 v40, s[72:75], s88 offen offset:0 sc1 lds
    buffer_load_dwordx4 v40, s[72:75], s88 offen offset:1024 sc1 lds
    buffer_load_dwordx4 v40, s[72:75], s88 offen offset:2048 sc1 lds
    buffer_load_dwordx4 v40, s[72:75], s88 offen offset:3072 sc1 lds
    s_add_u32 s88, s88, s30
L_omc_2:
    s_cmp_lg_u32 s95, 2
    s_cbranch_scc1 L_omd_3
    s_add_u32 m0, s90, 114688
    s_nop 0
    buffer_load_dwordx4 v41, s[44:47], s89 offen offset:0 lds
    buffer_load_dwordx4 v42, s[44:47], s89 offen offset:1024 lds
    buffer_load_dwordx4 v43, s[44:47], s89 offen offset:2048 lds
    buffer_load_dwordx4 v44, s[44:47], s89 offen offset:3072 lds
    s_add_u32 s89, s89, s31
    s_add_u32 m0, s90, 49152
    s_nop 0
    buffer_load_dwordx4 v40, s[72:75], s88 offen offset:0 sc1 lds
    buffer_load_dwordx4 v40, s[72:75], s88 offen offset:1024 sc1 lds
    buffer_load_dwordx4 v40, s[72:75], s88 offen offset:2048 sc1 lds
    buffer_load_dwordx4 v40, s[72:75], s88 offen offset:3072 sc1 lds
    s_add_u32 s88, s88, s30
L_omd_3:
    s_nop 7
    v_accvgpr_read_b32 v8, a192
    v_accvgpr_read_b32 v9, a196
    v_accvgpr_read_b32 v10, a200
    v_accvgpr_read_b32 v11, a204
L_epi:
    v_add_f32 v7, v8, v9
    v_add_f32 v7, v7, v10
    v_add_f32 v7, v7, v11
    v_cmp_nge_f32 vcc, 0x5d800000, v7
    v_rcp_f32 v12, v8
    v_rcp_f32 v13, v9
    v_rcp_f32 v14, v10
    v_rcp_f32 v15, v11
    s_cmp_lg_u64 vcc, 0
    s_cselect_b32 s81, 1, 0
    v_mov_b32 v7, s81
    s_lshl_b32 s82, s76, 2
    s_add_u32 s82, s82, 158208
    v_mov_b32 v6, s82
    ds_write_b32 v6, v7
    s_lshl_b32 s81, s78, 1
    s_lshr_b32 s82, s76, 1
    s_add_u32 s81, s81, s82
    s_lshl_b32 s81, s81, 7
    s_lshl_b32 s82, s77, 2
    s_add_u32 s81, s81, s82
    s_lshl_b32 s81, s81, 13
    s_and_b32 s82, s76, 1
    s_lshl_b32 s82, s82, 12
    s_add_u32 s81, s81, s82
    s_add_u32 s3, s81, 4194304
    v_lshlrev_b32 v16, 4, v1
    v_mov_b32 v176, v12
    v_mov_b32 v177, v12
    v_mov_b32 v178, v13
    v_mov_b32 v179, v13
    v_mov_b32 v180, v14
    v_mov_b32 v181, v14
    v_mov_b32 v182, v15
    v_mov_b32 v183, v15
    v_accvgpr_read_b32 v128, a0
    v_accvgpr_read_b32 v129, a1
    v_accvgpr_read_b32 v130, a2
    v_accvgpr_read_b32 v131, a3
    v_accvgpr_read_b32 v132, a16
    v_accvgpr_read_b32 v133, a17
    v_accvgpr_read_b32 v134, a18
    v_accvgpr_read_b32 v135, a19
    v_pk_mul_f32 v[128:129], v[128:129], v[176:177]
    v_pk_mul_f32 v[130:131], v[130:131], v[176:177]
    v_pk_mul_f32 v[132:133], v[132:133], v[176:177]
    v_pk_mul_f32 v[134:135], v[134:135], v[176:177]
    v_cvt_pk_bf16_f32 v136, v128, v129
    v_cvt_pk_bf16_f32 v137, v130, v131
    v_cvt_pk_bf16_f32 v138, v132, v133
    v_cvt_pk_bf16_f32 v139, v134, v135
    buffer_store_dwordx4 v[136:139], v16, s[72:75], s3 offen offset:0 sc1
    v_accvgpr_read_b32 v140, a4
    v_accvgpr_read_b32 v141, a5
    v_accvgpr_read_b32 v142, a6
    v_accvgpr_read_b32 v143, a7
    v_accvgpr_read_b32 v144, a20
    v_accvgpr_read_b32 v145, a21
    v_accvgpr_read_b32 v146, a22
    v_accvgpr_read_b32 v147, a23
    v_pk_mul_f32 v[140:141], v[140:141], v[178:179]
    v_pk_mul_f32 v[142:143], v[142:143], v[178:179]
    v_pk_mul_f32 v[144:145], v[144:145], v[178:179]
    v_pk_mul_f32 v[146:147], v[146:147], v[178:179]
    v_cvt_pk_bf16_f32 v148, v140, v141
    v_cvt_pk_bf16_f32 v149, v142, v143
    v_cvt_pk_bf16_f32 v150, v144, v145
    v_cvt_pk_bf16_f32 v151, v146, v147
    buffer_store_dwordx4 v[148:151], v16, s[72:75], s3 offen offset:1024 sc1
    v_accvgpr_read_b32 v152, a8
    v_accvgpr_read_b32 v153, a9
    v_accvgpr_read_b32 v154, a10
    v_accvgpr_read_b32 v155, a11
    v_accvgpr_read_b32 v156, a24
    v_accvgpr_read_b32 v157, a25
    v_accvgpr_read_b32 v158, a26
    v_accvgpr_read_b32 v159, a27
    v_pk_mul_f32 v[152:153], v[152:153], v[180:181]
    v_pk_mul_f32 v[154:155], v[154:155], v[180:181]
    v_pk_mul_f32 v[156:157], v[156:157], v[180:181]
    v_pk_mul_f32 v[158:159], v[158:159], v[180:181]
    v_cvt_pk_bf16_f32 v160, v152, v153
    v_cvt_pk_bf16_f32 v161, v154, v155
    v_cvt_pk_bf16_f32 v162, v156, v157
    v_cvt_pk_bf16_f32 v163, v158, v159
    buffer_store_dwordx4 v[160:163], v16, s[72:75], s3 offen offset:2048 sc1
    v_accvgpr_read_b32 v164, a12
    v_accvgpr_read_b32 v165, a13
    v_accvgpr_read_b32 v166, a14
    v_accvgpr_read_b32 v167, a15
    v_accvgpr_read_b32 v168, a28
    v_accvgpr_read_b32 v169, a29
    v_accvgpr_read_b32 v170, a30
    v_accvgpr_read_b32 v171, a31
    v_pk_mul_f32 v[164:165], v[164:165], v[182:183]
    v_pk_mul_f32 v[166:167], v[166:167], v[182:183]
    v_pk_mul_f32 v[168:169], v[168:169], v[182:183]
    v_pk_mul_f32 v[170:171], v[170:171], v[182:183]
    v_cvt_pk_bf16_f32 v172, v164, v165
    v_cvt_pk_bf16_f32 v173, v166, v167
    v_cvt_pk_bf16_f32 v174, v168, v169
    v_cvt_pk_bf16_f32 v175, v170, v171
    buffer_store_dwordx4 v[172:175], v16, s[72:75], s3 offen offset:3072 sc1
    s_add_u32 s3, s3, 8192
    v_accvgpr_read_b32 v128, a32
    v_accvgpr_read_b32 v129, a33
    v_accvgpr_read_b32 v130, a34
    v_accvgpr_read_b32 v131, a35
    v_accvgpr_read_b32 v132, a48
    v_accvgpr_read_b32 v133, a49
    v_accvgpr_read_b32 v134, a50
    v_accvgpr_read_b32 v135, a51
    v_pk_mul_f32 v[128:129], v[128:129], v[176:177]
    v_pk_mul_f32 v[130:131], v[130:131], v[176:177]
    v_pk_mul_f32 v[132:133], v[132:133], v[176:177]
    v_pk_mul_f32 v[134:135], v[134:135], v[176:177]
    v_cvt_pk_bf16_f32 v136, v128, v129
    v_cvt_pk_bf16_f32 v137, v130, v131
    v_cvt_pk_bf16_f32 v138, v132, v133
    v_cvt_pk_bf16_f32 v139, v134, v135
    buffer_store_dwordx4 v[136:139], v16, s[72:75], s3 offen offset:0 sc1
    v_accvgpr_read_b32 v140, a36
    v_accvgpr_read_b32 v141, a37
    v_accvgpr_read_b32 v142, a38
    v_accvgpr_read_b32 v143, a39
    v_accvgpr_read_b32 v144, a52
    v_accvgpr_read_b32 v145, a53
    v_accvgpr_read_b32 v146, a54
    v_accvgpr_read_b32 v147, a55
    v_pk_mul_f32 v[140:141], v[140:141], v[178:179]
    v_pk_mul_f32 v[142:143], v[142:143], v[178:179]
    v_pk_mul_f32 v[144:145], v[144:145], v[178:179]
    v_pk_mul_f32 v[146:147], v[146:147], v[178:179]
    v_cvt_pk_bf16_f32 v148, v140, v141
    v_cvt_pk_bf16_f32 v149, v142, v143
    v_cvt_pk_bf16_f32 v150, v144, v145
    v_cvt_pk_bf16_f32 v151, v146, v147
    buffer_store_dwordx4 v[148:151], v16, s[72:75], s3 offen offset:1024 sc1
    v_accvgpr_read_b32 v152, a40
    v_accvgpr_read_b32 v153, a41
    v_accvgpr_read_b32 v154, a42
    v_accvgpr_read_b32 v155, a43
    v_accvgpr_read_b32 v156, a56
    v_accvgpr_read_b32 v157, a57
    v_accvgpr_read_b32 v158, a58
    v_accvgpr_read_b32 v159, a59
    v_pk_mul_f32 v[152:153], v[152:153], v[180:181]
    v_pk_mul_f32 v[154:155], v[154:155], v[180:181]
    v_pk_mul_f32 v[156:157], v[156:157], v[180:181]
    v_pk_mul_f32 v[158:159], v[158:159], v[180:181]
    v_cvt_pk_bf16_f32 v160, v152, v153
    v_cvt_pk_bf16_f32 v161, v154, v155
    v_cvt_pk_bf16_f32 v162, v156, v157
    v_cvt_pk_bf16_f32 v163, v158, v159
    buffer_store_dwordx4 v[160:163], v16, s[72:75], s3 offen offset:2048 sc1
    v_accvgpr_read_b32 v164, a44
    v_accvgpr_read_b32 v165, a45
    v_accvgpr_read_b32 v166, a46
    v_accvgpr_read_b32 v167, a47
    v_accvgpr_read_b32 v168, a60
    v_accvgpr_read_b32 v169, a61
    v_accvgpr_read_b32 v170, a62
    v_accvgpr_read_b32 v171, a63
    v_pk_mul_f32 v[164:165], v[164:165], v[182:183]
    v_pk_mul_f32 v[166:167], v[166:167], v[182:183]
    v_pk_mul_f32 v[168:169], v[168:169], v[182:183]
    v_pk_mul_f32 v[170:171], v[170:171], v[182:183]
    v_cvt_pk_bf16_f32 v172, v164, v165
    v_cvt_pk_bf16_f32 v173, v166, v167
    v_cvt_pk_bf16_f32 v174, v168, v169
    v_cvt_pk_bf16_f32 v175, v170, v171
    buffer_store_dwordx4 v[172:175], v16, s[72:75], s3 offen offset:3072 sc1
    s_add_u32 s3, s3, 8192
    v_accvgpr_read_b32 v128, a64
    v_accvgpr_read_b32 v129, a65
    v_accvgpr_read_b32 v130, a66
    v_accvgpr_read_b32 v131, a67
    v_accvgpr_read_b32 v132, a80
    v_accvgpr_read_b32 v133, a81
    v_accvgpr_read_b32 v134, a82
    v_accvgpr_read_b32 v135, a83
    v_pk_mul_f32 v[128:129], v[128:129], v[176:177]
    v_pk_mul_f32 v[130:131], v[130:131], v[176:177]
    v_pk_mul_f32 v[132:133], v[132:133], v[176:177]
    v_pk_mul_f32 v[134:135], v[134:135], v[176:177]
    v_cvt_pk_bf16_f32 v136, v128, v129
    v_cvt_pk_bf16_f32 v137, v130, v131
    v_cvt_pk_bf16_f32 v138, v132, v133
    v_cvt_pk_bf16_f32 v139, v134, v135
    buffer_store_dwordx4 v[136:139], v16, s[72:75], s3 offen offset:0 sc1
    v_accvgpr_read_b32 v140, a68
    v_accvgpr_read_b32 v141, a69
    v_accvgpr_read_b32 v142, a70
    v_accvgpr_read_b32 v143, a71
    v_accvgpr_read_b32 v144, a84
    v_accvgpr_read_b32 v145, a85
    v_accvgpr_read_b32 v146, a86
    v_accvgpr_read_b32 v147, a87
    v_pk_mul_f32 v[140:141], v[140:141], v[178:179]
    v_pk_mul_f32 v[142:143], v[142:143], v[178:179]
    v_pk_mul_f32 v[144:145], v[144:145], v[178:179]
    v_pk_mul_f32 v[146:147], v[146:147], v[178:179]
    v_cvt_pk_bf16_f32 v148, v140, v141
    v_cvt_pk_bf16_f32 v149, v142, v143
    v_cvt_pk_bf16_f32 v150, v144, v145
    v_cvt_pk_bf16_f32 v151, v146, v147
    buffer_store_dwordx4 v[148:151], v16, s[72:75], s3 offen offset:1024 sc1
    v_accvgpr_read_b32 v152, a72
    v_accvgpr_read_b32 v153, a73
    v_accvgpr_read_b32 v154, a74
    v_accvgpr_read_b32 v155, a75
    v_accvgpr_read_b32 v156, a88
    v_accvgpr_read_b32 v157, a89
    v_accvgpr_read_b32 v158, a90
    v_accvgpr_read_b32 v159, a91
    v_pk_mul_f32 v[152:153], v[152:153], v[180:181]
    v_pk_mul_f32 v[154:155], v[154:155], v[180:181]
    v_pk_mul_f32 v[156:157], v[156:157], v[180:181]
    v_pk_mul_f32 v[158:159], v[158:159], v[180:181]
    v_cvt_pk_bf16_f32 v160, v152, v153
    v_cvt_pk_bf16_f32 v161, v154, v155
    v_cvt_pk_bf16_f32 v162, v156, v157
    v_cvt_pk_bf16_f32 v163, v158, v159
    buffer_store_dwordx4 v[160:163], v16, s[72:75], s3 offen offset:2048 sc1
    v_accvgpr_read_b32 v164, a76
    v_accvgpr_read_b32 v165, a77
    v_accvgpr_read_b32 v166, a78
    v_accvgpr_read_b32 v167, a79
    v_accvgpr_read_b32 v168, a92
    v_accvgpr_read_b32 v169, a93
    v_accvgpr_read_b32 v170, a94
    v_accvgpr_read_b32 v171, a95
    v_pk_mul_f32 v[164:165], v[164:165], v[182:183]
    v_pk_mul_f32 v[166:167], v[166:167], v[182:183]
    v_pk_mul_f32 v[168:169], v[168:169], v[182:183]
    v_pk_mul_f32 v[170:171], v[170:171], v[182:183]
    v_cvt_pk_bf16_f32 v172, v164, v165
    v_cvt_pk_bf16_f32 v173, v166, v167
    v_cvt_pk_bf16_f32 v174, v168, v169
    v_cvt_pk_bf16_f32 v175, v170, v171
    buffer_store_dwordx4 v[172:175], v16, s[72:75], s3 offen offset:3072 sc1
    s_add_u32 s3, s3, 8192
    v_accvgpr_read_b32 v128, a96
    v_accvgpr_read_b32 v129, a97
    v_accvgpr_read_b32 v130, a98
    v_accvgpr_read_b32 v131, a99
    v_accvgpr_read_b32 v132, a112
    v_accvgpr_read_b32 v133, a113
    v_accvgpr_read_b32 v134, a114
    v_accvgpr_read_b32 v135, a115
    v_pk_mul_f32 v[128:129], v[128:129], v[176:177]
    v_pk_mul_f32 v[130:131], v[130:131], v[176:177]
    v_pk_mul_f32 v[132:133], v[132:133], v[176:177]
    v_pk_mul_f32 v[134:135], v[134:135], v[176:177]
    v_cvt_pk_bf16_f32 v136, v128, v129
    v_cvt_pk_bf16_f32 v137, v130, v131
    v_cvt_pk_bf16_f32 v138, v132, v133
    v_cvt_pk_bf16_f32 v139, v134, v135
    buffer_store_dwordx4 v[136:139], v16, s[72:75], s3 offen offset:0 sc1
    v_accvgpr_read_b32 v140, a100
    v_accvgpr_read_b32 v141, a101
    v_accvgpr_read_b32 v142, a102
    v_accvgpr_read_b32 v143, a103
    v_accvgpr_read_b32 v144, a116
    v_accvgpr_read_b32 v145, a117
    v_accvgpr_read_b32 v146, a118
    v_accvgpr_read_b32 v147, a119
    v_pk_mul_f32 v[140:141], v[140:141], v[178:179]
    v_pk_mul_f32 v[142:143], v[142:143], v[178:179]
    v_pk_mul_f32 v[144:145], v[144:145], v[178:179]
    v_pk_mul_f32 v[146:147], v[146:147], v[178:179]
    v_cvt_pk_bf16_f32 v148, v140, v141
    v_cvt_pk_bf16_f32 v149, v142, v143
    v_cvt_pk_bf16_f32 v150, v144, v145
    v_cvt_pk_bf16_f32 v151, v146, v147
    buffer_store_dwordx4 v[148:151], v16, s[72:75], s3 offen offset:1024 sc1
    v_accvgpr_read_b32 v152, a104
    v_accvgpr_read_b32 v153, a105
    v_accvgpr_read_b32 v154, a106
    v_accvgpr_read_b32 v155, a107
    v_accvgpr_read_b32 v156, a120
    v_accvgpr_read_b32 v157, a121
    v_accvgpr_read_b32 v158, a122
    v_accvgpr_read_b32 v159, a123
    v_pk_mul_f32 v[152:153], v[152:153], v[180:181]
    v_pk_mul_f32 v[154:155], v[154:155], v[180:181]
    v_pk_mul_f32 v[156:157], v[156:157], v[180:181]
    v_pk_mul_f32 v[158:159], v[158:159], v[180:181]
    v_cvt_pk_bf16_f32 v160, v152, v153
    v_cvt_pk_bf16_f32 v161, v154, v155
    v_cvt_pk_bf16_f32 v162, v156, v157
    v_cvt_pk_bf16_f32 v163, v158, v159
    buffer_store_dwordx4 v[160:163], v16, s[72:75], s3 offen offset:2048 sc1
    v_accvgpr_read_b32 v164, a108
    v_accvgpr_read_b32 v165, a109
    v_accvgpr_read_b32 v166, a110
    v_accvgpr_read_b32 v167, a111
    v_accvgpr_read_b32 v168, a124
    v_accvgpr_read_b32 v169, a125
    v_accvgpr_read_b32 v170, a126
    v_accvgpr_read_b32 v171, a127
    v_pk_mul_f32 v[164:165], v[164:165], v[182:183]
    v_pk_mul_f32 v[166:167], v[166:167], v[182:183]
    v_pk_mul_f32 v[168:169], v[168:169], v[182:183]
    v_pk_mul_f32 v[170:171], v[170:171], v[182:183]
    v_cvt_pk_bf16_f32 v172, v164, v165
    v_cvt_pk_bf16_f32 v173, v166, v167
    v_cvt_pk_bf16_f32 v174, v168, v169
    v_cvt_pk_bf16_f32 v175, v170, v171
    buffer_store_dwordx4 v[172:175], v16, s[72:75], s3 offen offset:3072 sc1
    s_add_u32 s3, s3, 8192
    s_cmp_eq_u32 s95, 2
    s_cbranch_scc1 L_p1m
    s_waitcnt vmcnt(0) lgkmcnt(0)
    s_barrier
    v_mov_b32 v6, 158208
    ds_read_b128 v[184:187], v6
    s_waitcnt lgkmcnt(0)
    v_or3_b32 v184, v184, v185, v186
    v_or_b32 v184, v184, v187
    s_nop 0
    v_readfirstlane_b32 s81, v184
    s_andn2_b32 s81, s81, s94
    s_cbranch_scc1 L_slow
    s_lshl_b32 s83, s78, 8
    s_add_u32 s83, s83, 35651584
    s_cmp_eq_u32 s76, 0
    s_cselect_b32 s83, s83, 0x40000000
    v_mov_b32 v7, 1
    s_mov_b64 exec, 1
    buffer_atomic_add v7, off, s[72:75], s83
    s_mov_b64 exec, -1
    s_lshl_b32 s81, s76, 5
    v_lshrrev_b32 v6, 3, v1
    v_add_u32 v6, s81, v6
    v_lshlrev_b32 v6, 12, v6
    s_lshl_b32 s81, s28, 7
    v_add_u32 v6, s81, v6
    v_lshlrev_b32 v7, 1, v3
    v_and_b32 v36, 7, v1
    v_xor_b32 v7, v7, v36
    v_lshl_add_u32 v32, v7, 4, v6
    v_add_u32 v33, 31744, v32
    v_add_u32 v34, 63488, v32
    v_add_u32 v35, 95232, v32
    v_lshl_add_u32 v6, v3, 2, v4
    v_lshrrev_b32 v7, 1, v6
    v_and_b32 v7, 3, v7
    v_lshlrev_b32 v6, 7, v6
    v_lshl_add_u32 v6, v5, 3, v6
    s_lshl_b32 s81, s76, 14
    v_add_u32 v6, s81, v6
    v_xor_b32 v7, s76, v7
    v_lshl_add_u32 v36, v7, 5, v6
    v_xor_b32 v37, 32, v36
    v_xor_b32 v38, 64, v36
    v_xor_b32 v39, 96, v36
    s_add_u32 m0, s90, 98304
    s_nop 0
    buffer_load_dwordx4 v41, s[44:47], s89 offen offset:0 lds
    buffer_load_dwordx4 v42, s[44:47], s89 offen offset:1024 lds
    buffer_load_dwordx4 v43, s[44:47], s89 offen offset:2048 lds
    buffer_load_dwordx4 v44, s[44:47], s89 offen offset:3072 lds
    s_add_u32 s89, s89, s31
    s_add_u32 m0, s90, 114688
    s_nop 0
    buffer_load_dwordx4 v41, s[44:47], s89 offen offset:0 lds
    buffer_load_dwordx4 v42, s[44:47], s89 offen offset:1024 lds
    buffer_load_dwordx4 v43, s[44:47], s89 offen offset:2048 lds
    buffer_load_dwordx4 v44, s[44:47], s89 offen offset:3072 lds
    s_add_u32 s89, s89, s31
    s_mov_b32 s99, 2097152
    s_lshl_b32 s98, s76, 14
    s_add_u32 m0, s98, 0
    s_nop 0
    buffer_load_dwordx4 v32, s[56:59], s99 offen offset:0 lds
    buffer_load_dwordx4 v33, s[56:59], s99 offen offset:1024 lds
    buffer_load_dwordx4 v34, s[56:59], s99 offen offset:2048 lds
    buffer_load_dwordx4 v35, s[56:59], s99 offen offset:3072 lds
    s_add_u32 s99, s99, 524288
    s_add_u32 m0, s98, 4096
    s_nop 0
    buffer_load_dwordx4 v32, s[56:59], s99 offen offset:0 lds
    buffer_load_dwordx4 v33, s[56:59], s99 offen offset:1024 lds
    buffer_load_dwordx4 v34, s[56:59], s99 offen offset:2048 lds
    buffer_load_dwordx4 v35, s[56:59], s99 offen offset:3072 lds
    s_add_u32 s99, s99, 524288
    s_add_u32 m0, s98, 8192
    s_nop 0
    buffer_load_dwordx4 v32, s[56:59], s99 offen offset:0 lds
    buffer_load_dwordx4 v33, s[56:59], s99 offen offset:1024 lds
    buffer_load_dwordx4 v34, s[56:59], s99 offen offset:2048 lds
    buffer_load_dwordx4 v35, s[56:59], s99 offen offset:3072 lds
    s_add_u32 s99, s99, 524288
    s_add_u32 m0, s98, 12288
    s_nop 0
    buffer_load_dwordx4 v32, s[56:59], s99 offen offset:0 lds
    buffer_load_dwordx4 v33, s[56:59], s99 offen offset:1024 lds
    buffer_load_dwordx4 v34, s[56:59], s99 offen offset:2048 lds
    buffer_load_dwordx4 v35, s[56:59], s99 offen offset:3072 lds
    s_add_u32 s99, s99, 524288
    s_waitcnt vmcnt(12)
    ds_read_b64_tr_b16 a[0:1], v36 offset:0
    ds_read_b64_tr_b16 a[2:3], v36 offset:2048
    ds_read_b64_tr_b16 a[4:5], v37 offset:0
    ds_read_b64_tr_b16 a[6:7], v37 offset:2048
    ds_read_b64_tr_b16 a[8:9], v38 offset:0
    ds_read_b64_tr_b16 a[10:11], v38 offset:2048
    ds_read_b64_tr_b16 a[12:13], v39 offset:0
    ds_read_b64_tr_b16 a[14:15], v39 offset:2048
    s_waitcnt vmcnt(8)
    ds_read_b64_tr_b16 a[16:17], v36 offset:4096
    ds_read_b64_tr_b16 a[18:19], v36 offset:6144
    ds_read_b64_tr_b16 a[20:21], v37 offset:4096
    ds_read_b64_tr_b16 a[22:23], v37 offset:6144
    ds_read_b64_tr_b16 a[24:25], v38 offset:4096
    ds_read_b64_tr_b16 a[26:27], v38 offset:6144
    ds_read_b64_tr_b16 a[28:29], v39 offset:4096
    ds_read_b64_tr_b16 a[30:31], v39 offset:6144
    s_waitcnt lgkmcnt(8)
    s_add_u32 m0, s98, 0
    s_nop 0
    buffer_load_dwordx4 v32, s[56:59], s99 offen offset:0 lds
    buffer_load_dwordx4 v33, s[56:59], s99 offen offset:1024 lds
    buffer_load_dwordx4 v34, s[56:59], s99 offen offset:2048 lds
    buffer_load_dwordx4 v35, s[56:59], s99 offen offset:3072 lds
    s_add_u32 s99, s99, 524288
    s_waitcnt vmcnt(8)
    ds_read_b64_tr_b16 a[32:33], v36 offset:8192
    ds_read_b64_tr_b16 a[34:35], v36 offset:10240
    ds_read_b64_tr_b16 a[36:37], v37 offset:8192
    ds_read_b64_tr_b16 a[38:39], v37 offset:10240
    ds_read_b64_tr_b16 a[40:41], v38 offset:8192
    ds_read_b64_tr_b16 a[42:43], v38 offset:10240
    ds_read_b64_tr_b16 a[44:45], v39 offset:8192
    ds_read_b64_tr_b16 a[46:47], v39 offset:10240
    s_waitcnt lgkmcnt(8)
    s_add_u32 m0, s98, 4096
    s_nop 0
    buffer_load_dwordx4 v32, s[56:59], s99 offen offset:0 lds
    buffer_load_dwordx4 v33, s[56:59], s99 offen offset:1024 lds
    buffer_load_dwordx4 v34, s[56:59], s99 offen offset:2048 lds
    buffer_load_dwordx4 v35, s[56:59], s99 offen offset:3072 lds
    s_add_u32 s99, s99, 524288
    s_waitcnt vmcnt(8)
    ds_read_b64_tr_b16 a[48:49], v36 offset:12288
    ds_read_b64_tr_b16 a[50:51], v36 offset:14336
    ds_read_b64_tr_b16 a[52:53], v37 offset:12288
    ds_read_b64_tr_b16 a[54:55], v37 offset:14336
    ds_read_b64_tr_b16 a[56:57], v38 offset:12288
    ds_read_b64_tr_b16 a[58:59], v38 offset:14336
    ds_read_b64_tr_b16 a[60:61], v39 offset:12288
    ds_read_b64_tr_b16 a[62:63], v39 offset:14336
    s_waitcnt lgkmcnt(8)
    s_add_u32 m0, s98, 8192
    s_nop 0
    buffer_load_dwordx4 v32, s[56:59], s99 offen offset:0 lds
    buffer_load_dwordx4 v33, s[56:59], s99 offen offset:1024 lds
    buffer_load_dwordx4 v34, s[56:59], s99 offen offset:2048 lds
    buffer_load_dwordx4 v35, s[56:59], s99 offen offset:3072 lds
    s_add_u32 s99, s99, 524288
    s_waitcnt vmcnt(8)
    ds_read_b64_tr_b16 a[64:65], v36 offset:0
    ds_read_b64_tr_b16 a[66:67], v36 offset:2048
    ds_read_b64_tr_b16 a[68:69], v37 offset:0
    ds_read_b64_tr_b16 a[70:71], v37 offset:2048
    ds_read_b64_tr_b16 a[72:73], v38 offset:0
    ds_read_b64_tr_b16 a[74:75], v38 offset:2048
    ds_read_b64_tr_b16 a[76:77], v39 offset:0
    ds_read_b64_tr_b16 a[78:79], v39 offset:2048
    s_waitcnt lgkmcnt(8)
    s_add_u32 m0, s98, 12288
    s_nop 0
    buffer_load_dwordx4 v32, s[56:59], s99 offen offset:0 lds
    buffer_load_dwordx4 v33, s[56:59], s99 offen offset:1024 lds
    buffer_load_dwordx4 v34, s[56:59], s99 offen offset:2048 lds
    buffer_load_dwordx4 v35, s[56:59], s99 offen offset:3072 lds
    s_add_u32 s99, s99, 524288
    s_waitcnt vmcnt(8)
    ds_read_b64_tr_b16 a[80:81], v36 offset:4096
    ds_read_b64_tr_b16 a[82:83], v36 offset:6144
    ds_read_b64_tr_b16 a[84:85], v37 offset:4096
    ds_read_b64_tr_b16 a[86:87], v37 offset:6144
    ds_read_b64_tr_b16 a[88:89], v38 offset:4096
    ds_read_b64_tr_b16 a[90:91], v38 offset:6144
    ds_read_b64_tr_b16 a[92:93], v39 offset:4096
    ds_read_b64_tr_b16 a[94:95], v39 offset:6144
    s_waitcnt lgkmcnt(8)
    s_add_u32 m0, s98, 0
    s_nop 0
    buffer_load_dwordx4 v32, s[56:59], s99 offen offset:0 lds
    buffer_load_dwordx4 v33, s[56:59], s99 offen offset:1024 lds
    buffer_load_dwordx4 v34, s[56:59], s99 offen offset:2048 lds
    buffer_load_dwordx4 v35, s[56:59], s99 offen offset:3072 lds
    s_add_u32 s99, s99, 524288
    s_waitcnt vmcnt(8)
    ds_read_b64_tr_b16 a[96:97], v36 offset:8192
    ds_read_b64_tr_b16 a[98:99], v36 offset:10240
    ds_read_b64_tr_b16 a[100:101], v37 offset:8192
    ds_read_b64_tr_b16 a[102:103], v37 offset:10240
    ds_read_b64_tr_b16 a[104:105], v38 offset:8192
    ds_read_b64_tr_b16 a[106:107], v38 offset:10240
    ds_read_b64_tr_b16 a[108:109], v39 offset:8192
    ds_read_b64_tr_b16 a[110:111], v39 offset:10240
    s_waitcnt lgkmcnt(8)
    s_add_u32 m0, s98, 4096
    s_nop 0
    buffer_load_dwordx4 v32, s[56:59], s99 offen offset:0 lds
    buffer_load_dwordx4 v33, s[56:59], s99 offen offset:1024 lds
    buffer_load_dwordx4 v34, s[56:59], s99 offen offset:2048 lds
    buffer_load_dwordx4 v35, s[56:59], s99 offen offset:3072 lds
    s_add_u32 s99, s99, 524288
    s_waitcnt vmcnt(8)
    ds_read_b64_tr_b16 a[112:113], v36 offset:12288
    ds_read_b64_tr_b16 a[114:115], v36 offset:14336
    ds_read_b64_tr_b16 a[116:117], v37 offset:12288
    ds_read_b64_tr_b16 a[118:119], v37 offset:14336
    ds_read_b64_tr_b16 a[120:121], v38 offset:12288
    ds_read_b64_tr_b16 a[122:123], v38 offset:14336
    ds_read_b64_tr_b16 a[124:125], v39 offset:12288
    ds_read_b64_tr_b16 a[126:127], v39 offset:14336
    s_waitcnt vmcnt(4)
    ds_read_b64_tr_b16 a[192:193], v36 offset:0
    ds_read_b64_tr_b16 a[194:195], v36 offset:2048
    ds_read_b64_tr_b16 a[196:197], v37 offset:0
    ds_read_b64_tr_b16 a[198:199], v37 offset:2048
    ds_read_b64_tr_b16 a[200:201], v38 offset:0
    ds_read_b64_tr_b16 a[202:203], v38 offset:2048
    ds_read_b64_tr_b16 a[204:205], v39 offset:0
    ds_read_b64_tr_b16 a[206:207], v39 offset:2048
    s_waitcnt vmcnt(0)
    ds_read_b64_tr_b16 a[208:209], v36 offset:4096
    ds_read_b64_tr_b16 a[210:211], v36 offset:6144
    ds_read_b64_tr_b16 a[212:213], v37 offset:4096
    ds_read_b64_tr_b16 a[214:215], v37 offset:6144
    ds_read_b64_tr_b16 a[216:217], v38 offset:4096
    ds_read_b64_tr_b16 a[218:219], v38 offset:6144
    ds_read_b64_tr_b16 a[220:221], v39 offset:4096
    ds_read_b64_tr_b16 a[222:223], v39 offset:6144
    s_waitcnt lgkmcnt(0)
    s_cmp_eq_u32 s95, 3
    s_cbranch_scc1 L_p2idle
    s_lshr_b32 s81, s96, 1
    s_lshl_b32 s93, 1, s81
    s_cmp_lg_u32 s76, 0
    s_cbranch_scc1 L_p1w
    s_mov_b32 exec_lo, s93
    s_mov_b32 exec_hi, 0
    buffer_load_dword v58, v59, s[72:75], 0 offen sc1
    s_mov_b64 exec, -1
    s_waitcnt vmcnt(0)
    v_accvgpr_read_b32 v7, a250
    s_mov_b32 s92, 0x40000
L_poll3:
    v_sub_u32 v58, v58, v7
    v_cmp_gt_u32 vcc, 32, v58
    s_nop 1
    s_and_b32 s86, vcc_lo, s93
    s_cbranch_scc0 L_polld3
    s_sub_u32 s92, s92, 1
    s_cbranch_scc1 L_polld3
    s_sleep 2
    s_mov_b32 exec_lo, s93
    s_mov_b32 exec_hi, 0
    buffer_load_dword v58, v59, s[72:75], 0 offen sc1
    s_mov_b64 exec, -1
    s_waitcnt vmcnt(0)
    s_branch L_poll3
L_polld3:
L_p1w:
    s_barrier
    s_add_u32 m0, s90, 0
    s_nop 0
    buffer_load_dwordx4 v40, s[72:75], s88 offen offset:0 sc1 lds
    buffer_load_dwordx4 v40, s[72:75], s88 offen offset:1024 sc1 lds
    buffer_load_dwordx4 v40, s[72:75], s88 offen offset:2048 sc1 lds
    buffer_load_dwordx4 v40, s[72:75], s88 offen offset:3072 sc1 lds
    s_add_u32 s88, s88, s30
    s_add_u32 m0, s90, 16384
    s_nop 0
    buffer_load_dwordx4 v40, s[72:75], s88 offen offset:0 sc1 lds
    buffer_load_dwordx4 v40, s[72:75], s88 offen offset:1024 sc1 lds
    buffer_load_dwordx4 v40, s[72:75], s88 offen offset:2048 sc1 lds
    buffer_load_dwordx4 v40, s[72:75], s88 offen offset:3072 sc1 lds
    s_add_u32 s88, s88, s30
    s_add_u32 m0, s90, 32768
    s_nop 0
    buffer_load_dwordx4 v40, s[72:75], s88 offen offset:0 sc1 lds
    buffer_load_dwordx4 v40, s[72:75], s88 offen offset:1024 sc1 lds
    buffer_load_dwordx4 v40, s[72:75], s88 offen offset:2048 sc1 lds
    buffer_load_dwordx4 v40, s[72:75], s88 offen offset:3072 sc1 lds
    s_add_u32 s88, s88, s30
    s_add_u32 m0, s90, 49152
    s_nop 0
    buffer_load_dwordx4 v40, s[72:75], s88 offen offset:0 sc1 lds
    buffer_load_dwordx4 v40, s[72:75], s88 offen offset:1024 sc1 lds
    buffer_load_dwordx4 v40, s[72:75], s88 offen offset:2048 sc1 lds
    buffer_load_dwordx4 v40, s[72:75], s88 offen offset:3072 sc1 lds
    s_add_u32 s88, s88, s30
    v_lshlrev_b32 v64, 16, v24
    v_and_b32 v65, 0xffff0000, v24
    v_lshlrev_b32 v66, 16, v25
    v_and_b32 v67, 0xffff0000, v25
    v_lshlrev_b32 v80, 16, v26
    v_and_b32 v81, 0xffff0000, v26
    v_lshlrev_b32 v82, 16, v27
    v_and_b32 v83, 0xffff0000, v27
    v_lshlrev_b32 v96, 16, v28
    v_and_b32 v97, 0xffff0000, v28
    v_lshlrev_b32 v98, 16, v29
    v_and_b32 v99, 0xffff0000, v29
    v_lshlrev_b32 v112, 16, v30
    v_and_b32 v113, 0xffff0000, v30
    v_lshlrev_b32 v114, 16, v31
    v_and_b32 v115, 0xffff0000, v31
    v_mov_b32 v68, v64
    v_mov_b32 v69, v65
    v_mov_b32 v70, v66
    v_mov_b32 v71, v67
    v_mov_b32 v72, v64
    v_mov_b32 v73, v65
    v_mov_b32 v74, v66
    v_mov_b32 v75, v67
    v_mov_b32 v76, v64
    v_mov_b32 v77, v65
    v_mov_b32 v78, v66
    v_mov_b32 v79, v67
    v_mov_b32 v84, v80
    v_mov_b32 v85, v81
    v_mov_b32 v86, v82
    v_mov_b32 v87, v83
    v_mov_b32 v88, v80
    v_mov_b32 v89, v81
    v_mov_b32 v90, v82
    v_mov_b32 v91, v83
    v_mov_b32 v92, v80
    v_mov_b32 v93, v81
    v_mov_b32 v94, v82
    v_mov_b32 v95, v83
    v_mov_b32 v100, v96
    v_mov_b32 v101, v97
    v_mov_b32 v102, v98
    v_mov_b32 v103, v99
    v_mov_b32 v104, v96
    v_mov_b32 v105, v97
    v_mov_b32 v106, v98
    v_mov_b32 v107, v99
    v_mov_b32 v108, v96
    v_mov_b32 v109, v97
    v_mov_b32 v110, v98
    v_mov_b32 v111, v99
    v_mov_b32 v116, v112
    v_mov_b32 v117, v113
    v_mov_b32 v118, v114
    v_mov_b32 v119, v115
    v_mov_b32 v120, v112
    v_mov_b32 v121, v113
    v_mov_b32 v122, v114
    v_mov_b32 v123, v115
    v_mov_b32 v124, v112
    v_mov_b32 v125, v113
    v_mov_b32 v126, v114
    v_mov_b32 v127, v115
    s_waitcnt vmcnt(12)
    s_barrier
    ds_read_b128 a[160:163], v45 offset:0
    ds_read_b128 a[164:167], v45 offset:1024
    ds_read_b128 a[168:171], v45 offset:2048
    ds_read_b128 a[172:175], v45 offset:3072
    ds_read_b128 a[176:179], v45 offset:8192
    ds_read_b128 a[180:183], v45 offset:9216
    ds_read_b128 a[184:187], v45 offset:10240
    ds_read_b128 a[188:191], v45 offset:11264
    ds_read_b64_tr_b16 a[128:129], v46 offset:0
    ds_read_b64_tr_b16 a[130:131], v46 offset:4096
    ds_read_b64_tr_b16 a[132:133], v46 offset:8192
    ds_read_b64_tr_b16 a[134:135], v46 offset:12288
    ds_read_b64_tr_b16 a[136:137], v47 offset:0
    ds_read_b64_tr_b16 a[138:139], v47 offset:4096
    ds_read_b64_tr_b16 a[140:141], v47 offset:8192
    ds_read_b64_tr_b16 a[142:143], v47 offset:12288
    ds_read_b64_tr_b16 a[144:145], v48 offset:0
    ds_read_b64_tr_b16 a[146:147], v48 offset:4096
    ds_read_b64_tr_b16 a[148:149], v48 offset:8192
    ds_read_b64_tr_b16 a[150:151], v48 offset:12288
    ds_read_b64_tr_b16 a[152:153], v49 offset:0
    ds_read_b64_tr_b16 a[154:155], v49 offset:4096
    ds_read_b64_tr_b16 a[156:157], v49 offset:8192
    ds_read_b64_tr_b16 a[158:159], v49 offset:12288
    s_waitcnt vmcnt(8) lgkmcnt(0)
    s_barrier
    v_mfma_f32_16x16x32_bf16 v[64:67], a[128:131], a[160:163], v[64:67]
    ds_read_b128 v[224:227], v45 offset:16384
    v_mfma_f32_16x16x32_bf16 v[64:67], a[132:135], a[176:179], v[64:67]
    ds_read_b128 v[228:231], v45 offset:17408
    s_add_u32 m0, s90, 65536
    s_nop 0
    v_mfma_f32_16x16x32_bf16 v[68:71], a[128:131], a[164:167], v[68:71]
    ds_read_b128 v[232:235], v45 offset:18432
    v_mfma_f32_16x16x32_bf16 v[68:71], a[132:135], a[180:183], v[68:71]
    ds_read_b128 v[236:239], v45 offset:19456
    buffer_load_dwordx4 v41, s[44:47], s89 offen offset:0 lds
    v_mfma_f32_16x16x32_bf16 v[72:75], a[128:131], a[168:171], v[72:75]
    ds_read_b128 v[240:243], v45 offset:24576
    v_mfma_f32_16x16x32_bf16 v[72:75], a[132:135], a[184:187], v[72:75]
    ds_read_b128 v[244:247], v45 offset:25600
    v_mfma_f32_16x16x32_bf16 v[76:79], a[128:131], a[172:175], v[76:79]
    ds_read_b128 v[248:251], v45 offset:26624
    buffer_load_dwordx4 v42, s[44:47], s89 offen offset:1024 lds
    v_mfma_f32_16x16x32_bf16 v[76:79], a[132:135], a[188:191], v[76:79]
    ds_read_b128 v[252:255], v45 offset:27648
    v_mfma_f32_16x16x32_bf16 v[80:83], a[136:139], a[160:163], v[80:83]
    ds_read_b64_tr_b16 a[128:129], v46 offset:16384
    buffer_load_dwordx4 v43, s[44:47], s89 offen offset:2048 lds
    v_mfma_f32_16x16x32_bf16 v[80:83], a[140:143], a[176:179], v[80:83]
    ds_read_b64_tr_b16 a[130:131], v46 offset:20480
    v_mfma_f32_16x16x32_bf16 v[84:87], a[136:139], a[164:167], v[84:87]
    ds_read_b64_tr_b16 a[132:133], v46 offset:24576
    v_mfma_f32_16x16x32_bf16 v[84:87], a[140:143], a[180:183], v[84:87]
    ds_read_b64_tr_b16 a[134:135], v46 offset:28672
    buffer_load_dwordx4 v44, s[44:47], s89 offen offset:3072 lds
    v_mfma_f32_16x16x32_bf16 v[88:91], a[136:139], a[168:171], v[88:91]
    ds_read_b64_tr_b16 v[128:129], v49 offset:16384
    v_mfma_f32_16x16x32_bf16 v[88:91], a[140:143], a[184:187], v[88:91]
    ds_read_b64_tr_b16 v[130:131], v49 offset:20480
    s_add_u32 s89, s89, s31
    v_mfma_f32_16x16x32_bf16 v[92:95], a[136:139], a[172:175], v[92:95]
    ds_read_b64_tr_b16 v[132:133], v49 offset:24576
    v_mfma_f32_16x16x32_bf16 v[92:95], a[140:143], a[188:191], v[92:95]
    ds_read_b64_tr_b16 v[134:135], v49 offset:28672
    v_mfma_f32_16x16x32_bf16 v[96:99], a[144:147], a[160:163], v[96:99]
    ds_read_b64_tr_b16 a[136:137], v47 offset:16384
    s_add_u32 m0, s90, 0
    s_nop 0
    v_mfma_f32_16x16x32_bf16 v[96:99], a[148:151], a[176:179], v[96:99]
    ds_read_b64_tr_b16 a[138:139], v47 offset:20480
    v_mfma_f32_16x16x32_bf16 v[100:103], a[144:147], a[164:167], v[100:103]
    ds_read_b64_tr_b16 a[140:141], v47 offset:24576
    buffer_load_dwordx4 v40, s[72:75], s88 offen offset:0 sc1 lds
    v_mfma_f32_16x16x32_bf16 v[100:103], a[148:151], a[180:183], v[100:103]
    ds_read_b64_tr_b16 a[142:143], v47 offset:28672
    v_mfma_f32_16x16x32_bf16 v[104:107], a[144:147], a[168:171], v[104:107]
    v_mfma_f32_16x16x32_bf16 v[104:107], a[148:151], a[184:187], v[104:107]
    buffer_load_dwordx4 v40, s[72:75], s88 offen offset:1024 sc1 lds
    v_mfma_f32_16x16x32_bf16 v[108:111], a[144:147], a[172:175], v[108:111]
    v_mfma_f32_16x16x32_bf16 v[108:111], a[148:151], a[188:191], v[108:111]
    buffer_load_dwordx4 v40, s[72:75], s88 offen offset:2048 sc1 lds
    v_mfma_f32_16x16x32_bf16 v[112:115], a[152:155], a[160:163], v[112:115]
    ds_read_b64_tr_b16 a[144:145], v48 offset:16384
    v_mfma_f32_16x16x32_bf16 v[112:115], a[156:159], a[176:179], v[112:115]
    ds_read_b64_tr_b16 a[146:147], v48 offset:20480
    v_mfma_f32_16x16x32_bf16 v[116:119], a[152:155], a[164:167], v[116:119]
    ds_read_b64_tr_b16 a[148:149], v48 offset:24576
    buffer_load_dwordx4 v40, s[72:75], s88 offen offset:3072 sc1 lds
    v_mfma_f32_16x16x32_bf16 v[116:119], a[156:159], a[180:183], v[116:119]
    ds_read_b64_tr_b16 a[150:151], v48 offset:28672
    v_mfma_f32_16x16x32_bf16 v[120:123], a[152:155], a[168:171], v[120:123]
    s_add_u32 s88, s88, s30
    v_mfma_f32_16x16x32_bf16 v[120:123], a[156:159], a[184:187], v[120:123]
    v_mfma_f32_16x16x32_bf16 v[124:127], a[152:155], a[172:175], v[124:127]
    v_mfma_f32_16x16x32_bf16 v[124:127], a[156:159], a[188:191], v[124:127]
    s_waitcnt vmcnt(12) lgkmcnt(0)
    s_barrier
    v_mfma_f32_16x16x32_bf16 v[64:67], a[128:131], v[224:227], v[64:67]
    ds_read_b128 a[160:163], v45 offset:32768
    v_mfma_f32_16x16x32_bf16 v[64:67], a[132:135], v[240:243], v[64:67]
    ds_read_b128 a[164:167], v45 offset:33792
    s_add_u32 m0, s90, 81920
    s_nop 0
    v_mfma_f32_16x16x32_bf16 v[68:71], a[128:131], v[228:231], v[68:71]
    ds_read_b128 a[168:171], v45 offset:34816
    v_mfma_f32_16x16x32_bf16 v[68:71], a[132:135], v[244:247], v[68:71]
    ds_read_b128 a[172:175], v45 offset:35840
    buffer_load_dwordx4 v41, s[44:47], s89 offen offset:0 lds
    v_mfma_f32_16x16x32_bf16 v[72:75], a[128:131], v[232:235], v[72:75]
    ds_read_b128 a[176:179], v45 offset:40960
    v_mfma_f32_16x16x32_bf16 v[72:75], a[132:135], v[248:251], v[72:75]
    ds_read_b128 a[180:183], v45 offset:41984
    v_mfma_f32_16x16x32_bf16 v[76:79], a[128:131], v[236:239], v[76:79]
    ds_read_b128 a[184:187], v45 offset:43008
    buffer_load_dwordx4 v42, s[44:47], s89 offen offset:1024 lds
    v_mfma_f32_16x16x32_bf16 v[76:79], a[132:135], v[252:255], v[76:79]
    ds_read_b128 a[188:191], v45 offset:44032
    v_mfma_f32_16x16x32_bf16 v[80:83], a[136:139], v[224:227], v[80:83]
    ds_read_b64_tr_b16 a[128:129], v46 offset:32768
    buffer_load_dwordx4 v43, s[44:47], s89 offen offset:2048 lds
    v_mfma_f32_16x16x32_bf16 v[80:83], a[140:143], v[240:243], v[80:83]
    ds_read_b64_tr_b16 a[130:131], v46 offset:36864
    v_mfma_f32_16x16x32_bf16 v[84:87], a[136:139], v[228:231], v[84:87]
    ds_read_b64_tr_b16 a[132:133], v46 offset:40960
    v_mfma_f32_16x16x32_bf16 v[84:87], a[140:143], v[244:247], v[84:87]
    ds_read_b64_tr_b16 a[134:135], v46 offset:45056
    buffer_load_dwordx4 v44, s[44:47], s89 offen offset:3072 lds
    v_mfma_f32_16x16x32_bf16 v[88:91], a[136:139], v[232:235], v[88:91]
    ds_read_b64_tr_b16 a[152:153], v49 offset:32768
    v_mfma_f32_16x16x32_bf16 v[88:91], a[140:143], v[248:251], v[88:91]
    ds_read_b64_tr_b16 a[154:155], v49 offset:36864
    s_add_u32 s89, s89, s31
    v_mfma_f32_16x16x32_bf16 v[92:95], a[136:139], v[236:239], v[92:95]
    ds_read_b64_tr_b16 a[156:157], v49 offset:40960
    v_mfma_f32_16x16x32_bf16 v[92:95], a[140:143], v[252:255], v[92:95]
    ds_read_b64_tr_b16 a[158:159], v49 offset:45056
    v_mfma_f32_16x16x32_bf16 v[96:99], a[144:147], v[224:227], v[96:99]
    ds_read_b64_tr_b16 a[136:137], v47 offset:32768
    s_add_u32 m0, s90, 16384
    s_nop 0
    v_mfma_f32_16x16x32_bf16 v[96:99], a[148:151], v[240:243], v[96:99]
    ds_read_b64_tr_b16 a[138:139], v47 offset:36864
    v_mfma_f32_16x16x32_bf16 v[100:103], a[144:147], v[228:231], v[100:103]
    ds_read_b64_tr_b16 a[140:141], v47 offset:40960
    buffer_load_dwordx4 v40, s[72:75], s88 offen offset:0 sc1 lds
    v_mfma_f32_16x16x32_bf16 v[100:103], a[148:151], v[244:247], v[100:103]
    ds_read_b64_tr_b16 a[142:143], v47 offset:45056
    v_mfma_f32_16x16x32_bf16 v[104:107], a[144:147], v[232:235], v[104:107]
    v_mfma_f32_16x16x32_bf16 v[104:107], a[148:151], v[248:251], v[104:107]
    buffer_load_dwordx4 v40, s[72:75], s88 offen offset:1024 sc1 lds
    v_mfma_f32_16x16x32_bf16 v[108:111], a[144:147], v[236:239], v[108:111]
    v_mfma_f32_16x16x32_bf16 v[108:111], a[148:151], v[252:255], v[108:111]
    buffer_load_dwordx4 v40, s[72:75], s88 offen offset:2048 sc1 lds
    v_mfma_f32_16x16x32_bf16 v[112:115], v[128:131], v[224:227], v[112:115]
    ds_read_b64_tr_b16 a[144:145], v48 offset:32768
    v_mfma_f32_16x16x32_bf16 v[112:115], v[132:135], v[240:243], v[112:115]
    ds_read_b64_tr_b16 a[146:147], v48 offset:36864
    v_mfma_f32_16x16x32_bf16 v[116:119], v[128:131], v[228:231], v[116:119]
    ds_read_b64_tr_b16 a[148:149], v48 offset:40960
    buffer_load_dwordx4 v40, s[72:75], s88 offen offset:3072 sc1 lds
    v_mfma_f32_16x16x32_bf16 v[116:119], v[132:135], v[244:247], v[116:119]
    ds_read_b64_tr_b16 a[150:151], v48 offset:45056
    v_mfma_f32_16x16x32_bf16 v[120:123], v[128:131], v[232:235], v[120:123]
    s_add_u32 s88, s88, s30
    v_mfma_f32_16x16x32_bf16 v[120:123], v[132:135], v[248:251], v[120:123]
    v_mfma_f32_16x16x32_bf16 v[124:127], v[128:131], v[236:239], v[124:127]
    v_mfma_f32_16x16x32_bf16 v[124:127], v[132:135], v[252:255], v[124:127]
    s_waitcnt vmcnt(16) lgkmcnt(0)
    s_barrier
    v_mfma_f32_16x16x32_bf16 v[64:67], a[128:131], a[160:163], v[64:67]
    ds_read_b128 v[224:227], v45 offset:49152
    v_mfma_f32_16x16x32_bf16 v[64:67], a[132:135], a[176:179], v[64:67]
    ds_read_b128 v[228:231], v45 offset:50176
    s_add_u32 m0, s90, 98304
    s_nop 0
    v_mfma_f32_16x16x32_bf16 v[68:71], a[128:131], a[164:167], v[68:71]
    ds_read_b128 v[232:235], v45 offset:51200
    v_mfma_f32_16x16x32_bf16 v[68:71], a[132:135], a[180:183], v[68:71]
    ds_read_b128 v[236:239], v45 offset:52224
    buffer_load_dwordx4 v41, s[44:47], s89 offen offset:0 lds
    v_mfma_f32_16x16x32_bf16 v[72:75], a[128:131], a[168:171], v[72:75]
    ds_read_b128 v[240:243], v45 offset:57344
    v_mfma_f32_16x16x32_bf16 v[72:75], a[132:135], a[184:187], v[72:75]
    ds_read_b128 v[244:247], v45 offset:58368
    v_mfma_f32_16x16x32_bf16 v[76:79], a[128:131], a[172:175], v[76:79]
    ds_read_b128 v[248:251], v45 offset:59392
    buffer_load_dwordx4 v42, s[44:47], s89 offen offset:1024 lds
    v_mfma_f32_16x16x32_bf16 v[76:79], a[132:135], a[188:191], v[76:79]
    ds_read_b128 v[252:255], v45 offset:60416
    v_mfma_f32_16x16x32_bf16 v[80:83], a[136:139], a[160:163], v[80:83]
    ds_read_b64_tr_b16 a[128:129], v46 offset:49152
    buffer_load_dwordx4 v43, s[44:47], s89 offen offset:2048 lds
    v_mfma_f32_16x16x32_bf16 v[80:83], a[140:143], a[176:179], v[80:83]
    ds_read_b64_tr_b16 a[130:131], v46 offset:53248
    v_mfma_f32_16x16x32_bf16 v[84:87], a[136:139], a[164:167], v[84:87]
    ds_read_b64_tr_b16 a[132:133], v46 offset:57344
    v_mfma_f32_16x16x32_bf16 v[84:87], a[140:143], a[180:183], v[84:87]
    ds_read_b64_tr_b16 a[134:135], v46 offset:61440
    buffer_load_dwordx4 v44, s[44:47], s89 offen offset:3072 lds
    v_mfma_f32_16x16x32_bf16 v[88:91], a[136:139], a[168:171], v[88:91]
    ds_read_b64_tr_b16 v[128:129], v49 offset:49152
    v_mfma_f32_16x16x32_bf16 v[88:91], a[140:143], a[184:187], v[88:91]
    ds_read_b64_tr_b16 v[130:131], v49 offset:53248
    s_add_u32 s89, s89, s31
    v_mfma_f32_16x16x32_bf16 v[92:95], a[136:139], a[172:175], v[92:95]
    ds_read_b64_tr_b16 v[132:133], v49 offset:57344
    v_mfma_f32_16x16x32_bf16 v[92:95], a[140:143], a[188:191], v[92:95]
    ds_read_b64_tr_b16 v[134:135], v49 offset:61440
    v_mfma_f32_16x16x32_bf16 v[96:99], a[144:147], a[160:163], v[96:99]
    ds_read_b64_tr_b16 a[136:137], v47 offset:49152
    s_add_u32 m0, s90, 32768
    s_nop 0
    v_mfma_f32_16x16x32_bf16 v[96:99], a[148:151], a[176:179], v[96:99]
    ds_read_b64_tr_b16 a[138:139], v47 offset:53248
    v_mfma_f32_16x16x32_bf16 v[100:103], a[144:147], a[164:167], v[100:103]
    ds_read_b64_tr_b16 a[140:141], v47 offset:57344
    buffer_load_dwordx4 v40, s[72:75], s88 offen offset:0 sc1 lds
    v_mfma_f32_16x16x32_bf16 v[100:103], a[148:151], a[180:183], v[100:103]
    ds_read_b64_tr_b16 a[142:143], v47 offset:61440
    v_mfma_f32_16x16x32_bf16 v[104:107], a[144:147], a[168:171], v[104:107]
    v_mfma_f32_16x16x32_bf16 v[104:107], a[148:151], a[184:187], v[104:107]
    buffer_load_dwordx4 v40, s[72:75], s88 offen offset:1024 sc1 lds
    v_mfma_f32_16x16x32_bf16 v[108:111], a[144:147], a[172:175], v[108:111]
    v_mfma_f32_16x16x32_bf16 v[108:111], a[148:151], a[188:191], v[108:111]
    buffer_load_dwordx4 v40, s[72:75], s88 offen offset:2048 sc1 lds
    v_mfma_f32_16x16x32_bf16 v[112:115], a[152:155], a[160:163], v[112:115]
    ds_read_b64_tr_b16 a[144:145], v48 offset:49152
    v_mfma_f32_16x16x32_bf16 v[112:115], a[156:159], a[176:179], v[112:115]
    ds_read_b64_tr_b16 a[146:147], v48 offset:53248
    v_mfma_f32_16x16x32_bf16 v[116:119], a[152:155], a[164:167], v[116:119]
    ds_read_b64_tr_b16 a[148:149], v48 offset:57344
    buffer_load_dwordx4 v40, s[72:75], s88 offen offset:3072 sc1 lds
    v_mfma_f32_16x16x32_bf16 v[116:119], a[156:159], a[180:183], v[116:119]
    ds_read_b64_tr_b16 a[150:151], v48 offset:61440
    v_mfma_f32_16x16x32_bf16 v[120:123], a[152:155], a[168:171], v[120:123]
    s_add_u32 s88, s88, s30
    v_mfma_f32_16x16x32_bf16 v[120:123], a[156:159], a[184:187], v[120:123]
    v_mfma_f32_16x16x32_bf16 v[124:127], a[152:155], a[172:175], v[124:127]
    v_mfma_f32_16x16x32_bf16 v[124:127], a[156:159], a[188:191], v[124:127]
    s_waitcnt vmcnt(16) lgkmcnt(0)
    s_barrier
    v_mfma_f32_16x16x32_bf16 v[64:67], a[128:131], v[224:227], v[64:67]
    ds_read_b128 a[160:163], v45 offset:0
    v_mfma_f32_16x16x32_bf16 v[64:67], a[132:135], v[240:243], v[64:67]
    ds_read_b128 a[164:167], v45 offset:1024
    s_add_u32 m0, s90, 114688
    s_nop 0
    v_mfma_f32_16x16x32_bf16 v[68:71], a[128:131], v[228:231], v[68:71]
    ds_read_b128 a[168:171], v45 offset:2048
    v_mfma_f32_16x16x32_bf16 v[68:71], a[132:135], v[244:247], v[68:71]
    ds_read_b128 a[172:175], v45 offset:3072
    buffer_load_dwordx4 v41, s[44:47], s89 offen offset:0 lds
    v_mfma_f32_16x16x32_bf16 v[72:75], a[128:131], v[232:235], v[72:75]
    ds_read_b128 a[176:179], v45 offset:8192
    v_mfma_f32_16x16x32_bf16 v[72:75], a[132:135], v[248:251], v[72:75]
    ds_read_b128 a[180:183], v45 offset:9216
    v_mfma_f32_16x16x32_bf16 v[76:79], a[128:131], v[236:239], v[76:79]
    ds_read_b128 a[184:187], v45 offset:10240
    buffer_load_dwordx4 v42, s[44:47], s89 offen offset:1024 lds
    v_mfma_f32_16x16x32_bf16 v[76:79], a[132:135], v[252:255], v[76:79]
    ds_read_b128 a[188:191], v45 offset:11264
    v_mfma_f32_16x16x32_bf16 v[80:83], a[136:139], v[224:227], v[80:83]
    ds_read_b64_tr_b16 a[128:129], v46 offset:0
    buffer_load_dwordx4 v43, s[44:47], s89 offen offset:2048 lds
    v_mfma_f32_16x16x32_bf16 v[80:83], a[140:143], v[240:243], v[80:83]
    ds_read_b64_tr_b16 a[130:131], v46 offset:4096
    v_mfma_f32_16x16x32_bf16 v[84:87], a[136:139], v[228:231], v[84:87]
    ds_read_b64_tr_b16 a[132:133], v46 offset:8192
    v_mfma_f32_16x16x32_bf16 v[84:87], a[140:143], v[244:247], v[84:87]
    ds_read_b64_tr_b16 a[134:135], v46 offset:12288
    buffer_load_dwordx4 v44, s[44:47], s89 offen offset:3072 lds
    v_mfma_f32_16x16x32_bf16 v[88:91], a[136:139], v[232:235], v[88:91]
    ds_read_b64_tr_b16 a[152:153], v49 offset:0
    v_mfma_f32_16x16x32_bf16 v[88:91], a[140:143], v[248:251], v[88:91]
    ds_read_b64_tr_b16 a[154:155], v49 offset:4096
    s_add_u32 s89, s89, s31
    v_mfma_f32_16x16x32_bf16 v[92:95], a[136:139], v[236:239], v[92:95]
    ds_read_b64_tr_b16 a[156:157], v49 offset:8192
    v_mfma_f32_16x16x32_bf16 v[92:95], a[140:143], v[252:255], v[92:95]
    ds_read_b64_tr_b16 a[158:159], v49 offset:12288
    v_mfma_f32_16x16x32_bf16 v[96:99], a[144:147], v[224:227], v[96:99]
    ds_read_b64_tr_b16 a[136:137], v47 offset:0
    s_add_u32 m0, s90, 49152
    s_nop 0
    v_mfma_f32_16x16x32_bf16 v[96:99], a[148:151], v[240:243], v[96:99]
    ds_read_b64_tr_b16 a[138:139], v47 offset:4096
    v_mfma_f32_16x16x32_bf16 v[100:103], a[144:147], v[228:231], v[100:103]
    ds_read_b64_tr_b16 a[140:141], v47 offset:8192
    buffer_load_dwordx4 v40, s[72:75], s88 offen offset:0 sc1 lds
    v_mfma_f32_16x16x32_bf16 v[100:103], a[148:151], v[244:247], v[100:103]
    ds_read_b64_tr_b16 a[142:143], v47 offset:12288
    v_mfma_f32_16x16x32_bf16 v[104:107], a[144:147], v[232:235], v[104:107]
    v_mfma_f32_16x16x32_bf16 v[104:107], a[148:151], v[248:251], v[104:107]
    buffer_load_dwordx4 v40, s[72:75], s88 offen offset:1024 sc1 lds
    v_mfma_f32_16x16x32_bf16 v[108:111], a[144:147], v[236:239], v[108:111]
    v_mfma_f32_16x16x32_bf16 v[108:111], a[148:151], v[252:255], v[108:111]
    buffer_load_dwordx4 v40, s[72:75], s88 offen offset:2048 sc1 lds
    v_mfma_f32_16x16x32_bf16 v[112:115], v[128:131], v[224:227], v[112:115]
    ds_read_b64_tr_b16 a[144:145], v48 offset:0
    v_mfma_f32_16x16x32_bf16 v[112:115], v[132:135], v[240:243], v[112:115]
    ds_read_b64_tr_b16 a[146:147], v48 offset:4096
    v_mfma_f32_16x16x32_bf16 v[116:119], v[128:131], v[228:231], v[116:119]
    ds_read_b64_tr_b16 a[148:149], v48 offset:8192
    buffer_load_dwordx4 v40, s[72:75], s88 offen offset:3072 sc1 lds
    v_mfma_f32_16x16x32_bf16 v[116:119], v[132:135], v[244:247], v[116:119]
    ds_read_b64_tr_b16 a[150:151], v48 offset:12288
    v_mfma_f32_16x16x32_bf16 v[120:123], v[128:131], v[232:235], v[120:123]
    s_add_u32 s88, s88, s30
    v_mfma_f32_16x16x32_bf16 v[120:123], v[132:135], v[248:251], v[120:123]
    v_mfma_f32_16x16x32_bf16 v[124:127], v[128:131], v[236:239], v[124:127]
    v_mfma_f32_16x16x32_bf16 v[124:127], v[132:135], v[252:255], v[124:127]
    s_mov_b32 s87, 6
    s_branch L_p1loop0
L_p1m:
    s_waitcnt vmcnt(40)
    s_waitcnt lgkmcnt(0)
    s_barrier
    v_mov_b32 v6, 158208
    ds_read_b128 v[184:187], v6
    s_waitcnt lgkmcnt(0)
    v_or3_b32 v184, v184, v185, v186
    v_or_b32 v184, v184, v187
    s_nop 0
    v_readfirstlane_b32 s81, v184
    s_andn2_b32 s81, s81, s94
    s_cbranch_scc1 L_slow
    s_lshl_b32 s81, s76, 5
    v_lshrrev_b32 v6, 3, v1
    v_add_u32 v6, s81, v6
    v_lshlrev_b32 v6, 12, v6
    s_lshl_b32 s81, s28, 7
    v_add_u32 v6, s81, v6
    v_lshlrev_b32 v7, 1, v3
    v_and_b32 v36, 7, v1
    v_xor_b32 v7, v7, v36
    v_lshl_add_u32 v32, v7, 4, v6
    v_add_u32 v33, 31744, v32
    v_add_u32 v34, 63488, v32
    v_add_u32 v35, 95232, v32
    v_lshl_add_u32 v6, v3, 2, v4
    v_lshrrev_b32 v7, 1, v6
    v_and_b32 v7, 3, v7
    v_lshlrev_b32 v6, 7, v6
    v_lshl_add_u32 v6, v5, 3, v6
    s_lshl_b32 s81, s76, 14
    v_add_u32 v6, s81, v6
    v_xor_b32 v7, s76, v7
    v_lshl_add_u32 v36, v7, 5, v6
    v_xor_b32 v37, 32, v36
    v_xor_b32 v38, 64, v36
    v_xor_b32 v39, 96, v36
    v_lshlrev_b32 v64, 16, v24
    v_and_b32 v65, 0xffff0000, v24
    v_lshlrev_b32 v66, 16, v25
    v_and_b32 v67, 0xffff0000, v25
    v_lshlrev_b32 v80, 16, v26
    v_and_b32 v81, 0xffff0000, v26
    v_lshlrev_b32 v82, 16, v27
    v_and_b32 v83, 0xffff0000, v27
    v_lshlrev_b32 v96, 16, v28
    v_and_b32 v97, 0xffff0000, v28
    v_lshlrev_b32 v98, 16, v29
    v_and_b32 v99, 0xffff0000, v29
    v_lshlrev_b32 v112, 16, v30
    v_and_b32 v113, 0xffff0000, v30
    v_lshlrev_b32 v114, 16, v31
    v_and_b32 v115, 0xffff0000, v31
    v_mov_b32 v68, v64
    v_mov_b32 v69, v65
    v_mov_b32 v70, v66
    v_mov_b32 v71, v67
    v_mov_b32 v72, v64
    v_mov_b32 v73, v65
    v_mov_b32 v74, v66
    v_mov_b32 v75, v67
    v_mov_b32 v76, v64
    v_mov_b32 v77, v65
    v_mov_b32 v78, v66
    v_mov_b32 v79, v67
    v_mov_b32 v84, v80
    v_mov_b32 v85, v81
    v_mov_b32 v86, v82
    v_mov_b32 v87, v83
    v_mov_b32 v88, v80
    v_mov_b32 v89, v81
    v_mov_b32 v90, v82
    v_mov_b32 v91, v83
    v_mov_b32 v92, v80
    v_mov_b32 v93, v81
    v_mov_b32 v94, v82
    v_mov_b32 v95, v83
    v_mov_b32 v100, v96
    v_mov_b32 v101, v97
    v_mov_b32 v102, v98
    v_mov_b32 v103, v99
    v_mov_b32 v104, v96
    v_mov_b32 v105, v97
    v_mov_b32 v106, v98
    v_mov_b32 v107, v99
    v_mov_b32 v108, v96
    v_mov_b32 v109, v97
    v_mov_b32 v110, v98
    v_mov_b32 v111, v99
    v_mov_b32 v116, v112
    v_mov_b32 v117, v113
    v_mov_b32 v118, v114
    v_mov_b32 v119, v115
    v_mov_b32 v120, v112
    v_mov_b32 v121, v113
    v_mov_b32 v122, v114
    v_mov_b32 v123, v115
    v_mov_b32 v124, v112
    v_mov_b32 v125, v113
    v_mov_b32 v126, v114
    v_mov_b32 v127, v115
    ds_read_b128 a[160:163], v45 offset:0
    ds_read_b128 a[164:167], v45 offset:1024
    ds_read_b128 a[168:171], v45 offset:2048
    ds_read_b128 a[172:175], v45 offset:3072
    ds_read_b128 a[176:179], v45 offset:8192
    ds_read_b128 a[180:183], v45 offset:9216
    ds_read_b128 a[184:187], v45 offset:10240
    ds_read_b128 a[188:191], v45 offset:11264
    ds_read_b64_tr_b16 a[128:129], v46 offset:0
    ds_read_b64_tr_b16 a[130:131], v46 offset:4096
    ds_read_b64_tr_b16 a[132:133], v46 offset:8192
    ds_read_b64_tr_b16 a[134:135], v46 offset:12288
    ds_read_b64_tr_b16 a[136:137], v47 offset:0
    ds_read_b64_tr_b16 a[138:139], v47 offset:4096
    ds_read_b64_tr_b16 a[140:141], v47 offset:8192
    ds_read_b64_tr_b16 a[142:143], v47 offset:12288
    ds_read_b64_tr_b16 a[144:145], v48 offset:0
    ds_read_b64_tr_b16 a[146:147], v48 offset:4096
    ds_read_b64_tr_b16 a[148:149], v48 offset:8192
    ds_read_b64_tr_b16 a[150:151], v48 offset:12288
    ds_read_b64_tr_b16 a[152:153], v49 offset:0
    ds_read_b64_tr_b16 a[154:155], v49 offset:4096
    ds_read_b64_tr_b16 a[156:157], v49 offset:8192
    ds_read_b64_tr_b16 a[158:159], v49 offset:12288
    s_waitcnt vmcnt(32) lgkmcnt(0)
    s_barrier
    v_mfma_f32_16x16x32_bf16 v[64:67], a[128:131], a[160:163], v[64:67]
    ds_read_b128 v[224:227], v45 offset:16384
    v_mfma_f32_16x16x32_bf16 v[64:67], a[132:135], a[176:179], v[64:67]
    ds_read_b128 v[228:231], v45 offset:17408
    s_add_u32 m0, s90, 65536
    s_nop 0
    v_mfma_f32_16x16x32_bf16 v[68:71], a[128:131], a[164:167], v[68:71]
    ds_read_b128 v[232:235], v45 offset:18432
    v_mfma_f32_16x16x32_bf16 v[68:71], a[132:135], a[180:183], v[68:71]
    ds_read_b128 v[236:239], v45 offset:19456
    buffer_load_dwordx4 v41, s[44:47], s89 offen offset:0 lds
    v_mfma_f32_16x16x32_bf16 v[72:75], a[128:131], a[168:171], v[72:75]
    ds_read_b128 v[240:243], v45 offset:24576
    v_mfma_f32_16x16x32_bf16 v[72:75], a[132:135], a[184:187], v[72:75]
    ds_read_b128 v[244:247], v45 offset:25600
    v_mfma_f32_16x16x32_bf16 v[76:79], a[128:131], a[172:175], v[76:79]
    ds_read_b128 v[248:251], v45 offset:26624
    buffer_load_dwordx4 v42, s[44:47], s89 offen offset:1024 lds
    v_mfma_f32_16x16x32_bf16 v[76:79], a[132:135], a[188:191], v[76:79]
    ds_read_b128 v[252:255], v45 offset:27648
    v_mfma_f32_16x16x32_bf16 v[80:83], a[136:139], a[160:163], v[80:83]
    ds_read_b64_tr_b16 a[128:129], v46 offset:16384
    buffer_load_dwordx4 v43, s[44:47], s89 offen offset:2048 lds
    v_mfma_f32_16x16x32_bf16 v[80:83], a[140:143], a[176:179], v[80:83]
    ds_read_b64_tr_b16 a[130:131], v46 offset:20480
    v_mfma_f32_16x16x32_bf16 v[84:87], a[136:139], a[164:167], v[84:87]
    ds_read_b64_tr_b16 a[132:133], v46 offset:24576
    v_mfma_f32_16x16x32_bf16 v[84:87], a[140:143], a[180:183], v[84:87]
    ds_read_b64_tr_b16 a[134:135], v46 offset:28672
    buffer_load_dwordx4 v44, s[44:47], s89 offen offset:3072 lds
    v_mfma_f32_16x16x32_bf16 v[88:91], a[136:139], a[168:171], v[88:91]
    ds_read_b64_tr_b16 v[128:129], v49 offset:16384
    v_mfma_f32_16x16x32_bf16 v[88:91], a[140:143], a[184:187], v[88:91]
    ds_read_b64_tr_b16 v[130:131], v49 offset:20480
    s_add_u32 s89, s89, s31
    v_mfma_f32_16x16x32_bf16 v[92:95], a[136:139], a[172:175], v[92:95]
    ds_read_b64_tr_b16 v[132:133], v49 offset:24576
    v_mfma_f32_16x16x32_bf16 v[92:95], a[140:143], a[188:191], v[92:95]
    ds_read_b64_tr_b16 v[134:135], v49 offset:28672
    v_mfma_f32_16x16x32_bf16 v[96:99], a[144:147], a[160:163], v[96:99]
    ds_read_b64_tr_b16 a[136:137], v47 offset:16384
    s_add_u32 m0, s90, 0
    s_nop 0
    v_mfma_f32_16x16x32_bf16 v[96:99], a[148:151], a[176:179], v[96:99]
    ds_read_b64_tr_b16 a[138:139], v47 offset:20480
    v_mfma_f32_16x16x32_bf16 v[100:103], a[144:147], a[164:167], v[100:103]
    ds_read_b64_tr_b16 a[140:141], v47 offset:24576
    buffer_load_dwordx4 v40, s[72:75], s88 offen offset:0 sc1 lds
    v_mfma_f32_16x16x32_bf16 v[100:103], a[148:151], a[180:183], v[100:103]
    ds_read_b64_tr_b16 a[142:143], v47 offset:28672
    v_mfma_f32_16x16x32_bf16 v[104:107], a[144:147], a[168:171], v[104:107]
    v_mfma_f32_16x16x32_bf16 v[104:107], a[148:151], a[184:187], v[104:107]
    buffer_load_dwordx4 v40, s[72:75], s88 offen offset:1024 sc1 lds
    v_mfma_f32_16x16x32_bf16 v[108:111], a[144:147], a[172:175], v[108:111]
    v_mfma_f32_16x16x32_bf16 v[108:111], a[148:151], a[188:191], v[108:111]
    buffer_load_dwordx4 v40, s[72:75], s88 offen offset:2048 sc1 lds
    v_mfma_f32_16x16x32_bf16 v[112:115], a[152:155], a[160:163], v[112:115]
    ds_read_b64_tr_b16 a[144:145], v48 offset:16384
    v_mfma_f32_16x16x32_bf16 v[112:115], a[156:159], a[176:179], v[112:115]
    ds_read_b64_tr_b16 a[146:147], v48 offset:20480
    v_mfma_f32_16x16x32_bf16 v[116:119], a[152:155], a[164:167], v[116:119]
    ds_read_b64_tr_b16 a[148:149], v48 offset:24576
    buffer_load_dwordx4 v40, s[72:75], s88 offen offset:3072 sc1 lds
    v_mfma_f32_16x16x32_bf16 v[116:119], a[156:159], a[180:183], v[116:119]
    ds_read_b64_tr_b16 a[150:151], v48 offset:28672
    v_mfma_f32_16x16x32_bf16 v[120:123], a[152:155], a[168:171], v[120:123]
    s_add_u32 s88, s88, s30
    v_mfma_f32_16x16x32_bf16 v[120:123], a[156:159], a[184:187], v[120:123]
    v_mfma_f32_16x16x32_bf16 v[124:127], a[152:155], a[172:175], v[124:127]
    v_mfma_f32_16x16x32_bf16 v[124:127], a[156:159], a[188:191], v[124:127]
    s_waitcnt vmcnt(32) lgkmcnt(0)
    s_barrier
    v_mfma_f32_16x16x32_bf16 v[64:67], a[128:131], v[224:227], v[64:67]
    ds_read_b128 a[160:163], v45 offset:32768
    v_mfma_f32_16x16x32_bf16 v[64:67], a[132:135], v[240:243], v[64:67]
    ds_read_b128 a[164:167], v45 offset:33792
    s_add_u32 m0, s90, 81920
    s_nop 0
    v_mfma_f32_16x16x32_bf16 v[68:71], a[128:131], v[228:231], v[68:71]
    ds_read_b128 a[168:171], v45 offset:34816
    v_mfma_f32_16x16x32_bf16 v[68:71], a[132:135], v[244:247], v[68:71]
    ds_read_b128 a[172:175], v45 offset:35840
    buffer_load_dwordx4 v41, s[44:47], s89 offen offset:0 lds
    v_mfma_f32_16x16x32_bf16 v[72:75], a[128:131], v[232:235], v[72:75]
    ds_read_b128 a[176:179], v45 offset:40960
    v_mfma_f32_16x16x32_bf16 v[72:75], a[132:135], v[248:251], v[72:75]
    ds_read_b128 a[180:183], v45 offset:41984
    v_mfma_f32_16x16x32_bf16 v[76:79], a[128:131], v[236:239], v[76:79]
    ds_read_b128 a[184:187], v45 offset:43008
    buffer_load_dwordx4 v42, s[44:47], s89 offen offset:1024 lds
    v_mfma_f32_16x16x32_bf16 v[76:79], a[132:135], v[252:255], v[76:79]
    ds_read_b128 a[188:191], v45 offset:44032
    v_mfma_f32_16x16x32_bf16 v[80:83], a[136:139], v[224:227], v[80:83]
    ds_read_b64_tr_b16 a[128:129], v46 offset:32768
    buffer_load_dwordx4 v43, s[44:47], s89 offen offset:2048 lds
    v_mfma_f32_16x16x32_bf16 v[80:83], a[140:143], v[240:243], v[80:83]
    ds_read_b64_tr_b16 a[130:131], v46 offset:36864
    v_mfma_f32_16x16x32_bf16 v[84:87], a[136:139], v[228:231], v[84:87]
    ds_read_b64_tr_b16 a[132:133], v46 offset:40960
    v_mfma_f32_16x16x32_bf16 v[84:87], a[140:143], v[244:247], v[84:87]
    ds_read_b64_tr_b16 a[134:135], v46 offset:45056
    buffer_load_dwordx4 v44, s[44:47], s89 offen offset:3072 lds
    v_mfma_f32_16x16x32_bf16 v[88:91], a[136:139], v[232:235], v[88:91]
    ds_read_b64_tr_b16 a[152:153], v49 offset:32768
    v_mfma_f32_16x16x32_bf16 v[88:91], a[140:143], v[248:251], v[88:91]
    ds_read_b64_tr_b16 a[154:155], v49 offset:36864
    s_add_u32 s89, s89, s31
    v_mfma_f32_16x16x32_bf16 v[92:95], a[136:139], v[236:239], v[92:95]
    ds_read_b64_tr_b16 a[156:157], v49 offset:40960
    v_mfma_f32_16x16x32_bf16 v[92:95], a[140:143], v[252:255], v[92:95]
    ds_read_b64_tr_b16 a[158:159], v49 offset:45056
    v_mfma_f32_16x16x32_bf16 v[96:99], a[144:147], v[224:227], v[96:99]
    ds_read_b64_tr_b16 a[136:137], v47 offset:32768
    s_add_u32 m0, s90, 16384
    s_nop 0
    v_mfma_f32_16x16x32_bf16 v[96:99], a[148:151], v[240:243], v[96:99]
    ds_read_b64_tr_b16 a[138:139], v47 offset:36864
    v_mfma_f32_16x16x32_bf16 v[100:103], a[144:147], v[228:231], v[100:103]
    ds_read_b64_tr_b16 a[140:141], v47 offset:40960
    buffer_load_dwordx4 v40, s[72:75], s88 offen offset:0 sc1 lds
    v_mfma_f32_16x16x32_bf16 v[100:103], a[148:151], v[244:247], v[100:103]
    ds_read_b64_tr_b16 a[142:143], v47 offset:45056
    v_mfma_f32_16x16x32_bf16 v[104:107], a[144:147], v[232:235], v[104:107]
    v_mfma_f32_16x16x32_bf16 v[104:107], a[148:151], v[248:251], v[104:107]
    buffer_load_dwordx4 v40, s[72:75], s88 offen offset:1024 sc1 lds
    v_mfma_f32_16x16x32_bf16 v[108:111], a[144:147], v[236:239], v[108:111]
    v_mfma_f32_16x16x32_bf16 v[108:111], a[148:151], v[252:255], v[108:111]
    buffer_load_dwordx4 v40, s[72:75], s88 offen offset:2048 sc1 lds
    v_mfma_f32_16x16x32_bf16 v[112:115], v[128:131], v[224:227], v[112:115]
    ds_read_b64_tr_b16 a[144:145], v48 offset:32768
    v_mfma_f32_16x16x32_bf16 v[112:115], v[132:135], v[240:243], v[112:115]
    ds_read_b64_tr_b16 a[146:147], v48 offset:36864
    v_mfma_f32_16x16x32_bf16 v[116:119], v[128:131], v[228:231], v[116:119]
    ds_read_b64_tr_b16 a[148:149], v48 offset:40960
    buffer_load_dwordx4 v40, s[72:75], s88 offen offset:3072 sc1 lds
    v_mfma_f32_16x16x32_bf16 v[116:119], v[132:135], v[244:247], v[116:119]
    ds_read_b64_tr_b16 a[150:151], v48 offset:45056
    v_mfma_f32_16x16x32_bf16 v[120:123], v[128:131], v[232:235], v[120:123]
    s_add_u32 s88, s88, s30
    v_mfma_f32_16x16x32_bf16 v[120:123], v[132:135], v[248:251], v[120:123]
    v_mfma_f32_16x16x32_bf16 v[124:127], v[128:131], v[236:239], v[124:127]
    v_mfma_f32_16x16x32_bf16 v[124:127], v[132:135], v[252:255], v[124:127]
    s_waitcnt vmcnt(32) lgkmcnt(0)
    s_barrier
    v_mfma_f32_16x16x32_bf16 v[64:67], a[128:131], a[160:163], v[64:67]
    ds_read_b128 v[224:227], v45 offset:49152
    v_mfma_f32_16x16x32_bf16 v[64:67], a[132:135], a[176:179], v[64:67]
    ds_read_b128 v[228:231], v45 offset:50176
    s_add_u32 m0, s90, 98304
    s_nop 0
    v_mfma_f32_16x16x32_bf16 v[68:71], a[128:131], a[164:167], v[68:71]
    ds_read_b128 v[232:235], v45 offset:51200
    v_mfma_f32_16x16x32_bf16 v[68:71], a[132:135], a[180:183], v[68:71]
    ds_read_b128 v[236:239], v45 offset:52224
    buffer_load_dwordx4 v41, s[44:47], s89 offen offset:0 lds
    v_mfma_f32_16x16x32_bf16 v[72:75], a[128:131], a[168:171], v[72:75]
    ds_read_b128 v[240:243], v45 offset:57344
    v_mfma_f32_16x16x32_bf16 v[72:75], a[132:135], a[184:187], v[72:75]
    ds_read_b128 v[244:247], v45 offset:58368
    v_mfma_f32_16x16x32_bf16 v[76:79], a[128:131], a[172:175], v[76:79]
    ds_read_b128 v[248:251], v45 offset:59392
    buffer_load_dwordx4 v42, s[44:47], s89 offen offset:1024 lds
    v_mfma_f32_16x16x32_bf16 v[76:79], a[132:135], a[188:191], v[76:79]
    ds_read_b128 v[252:255], v45 offset:60416
    v_mfma_f32_16x16x32_bf16 v[80:83], a[136:139], a[160:163], v[80:83]
    ds_read_b64_tr_b16 a[128:129], v46 offset:49152
    buffer_load_dwordx4 v43, s[44:47], s89 offen offset:2048 lds
    v_mfma_f32_16x16x32_bf16 v[80:83], a[140:143], a[176:179], v[80:83]
    ds_read_b64_tr_b16 a[130:131], v46 offset:53248
    v_mfma_f32_16x16x32_bf16 v[84:87], a[136:139], a[164:167], v[84:87]
    ds_read_b64_tr_b16 a[132:133], v46 offset:57344
    v_mfma_f32_16x16x32_bf16 v[84:87], a[140:143], a[180:183], v[84:87]
    ds_read_b64_tr_b16 a[134:135], v46 offset:61440
    buffer_load_dwordx4 v44, s[44:47], s89 offen offset:3072 lds
    v_mfma_f32_16x16x32_bf16 v[88:91], a[136:139], a[168:171], v[88:91]
    ds_read_b64_tr_b16 v[128:129], v49 offset:49152
    v_mfma_f32_16x16x32_bf16 v[88:91], a[140:143], a[184:187], v[88:91]
    ds_read_b64_tr_b16 v[130:131], v49 offset:53248
    s_add_u32 s89, s89, s31
    v_mfma_f32_16x16x32_bf16 v[92:95], a[136:139], a[172:175], v[92:95]
    ds_read_b64_tr_b16 v[132:133], v49 offset:57344
    v_mfma_f32_16x16x32_bf16 v[92:95], a[140:143], a[188:191], v[92:95]
    ds_read_b64_tr_b16 v[134:135], v49 offset:61440
    v_mfma_f32_16x16x32_bf16 v[96:99], a[144:147], a[160:163], v[96:99]
    ds_read_b64_tr_b16 a[136:137], v47 offset:49152
    s_add_u32 m0, s90, 32768
    s_nop 0
    v_mfma_f32_16x16x32_bf16 v[96:99], a[148:151], a[176:179], v[96:99]
    ds_read_b64_tr_b16 a[138:139], v47 offset:53248
    v_mfma_f32_16x16x32_bf16 v[100:103], a[144:147], a[164:167], v[100:103]
    ds_read_b64_tr_b16 a[140:141], v47 offset:57344
    buffer_load_dwordx4 v40, s[72:75], s88 offen offset:0 sc1 lds
    v_mfma_f32_16x16x32_bf16 v[100:103], a[148:151], a[180:183], v[100:103]
    ds_read_b64_tr_b16 a[142:143], v47 offset:61440
    v_mfma_f32_16x16x32_bf16 v[104:107], a[144:147], a[168:171], v[104:107]
    v_mfma_f32_16x16x32_bf16 v[104:107], a[148:151], a[184:187], v[104:107]
    buffer_load_dwordx4 v40, s[72:75], s88 offen offset:1024 sc1 lds
    v_mfma_f32_16x16x32_bf16 v[108:111], a[144:147], a[172:175], v[108:111]
    v_mfma_f32_16x16x32_bf16 v[108:111], a[148:151], a[188:191], v[108:111]
    buffer_load_dwordx4 v40, s[72:75], s88 offen offset:2048 sc1 lds
    v_mfma_f32_16x16x32_bf16 v[112:115], a[152:155], a[160:163], v[112:115]
    ds_read_b64_tr_b16 a[144:145], v48 offset:49152
    v_mfma_f32_16x16x32_bf16 v[112:115], a[156:159], a[176:179], v[112:115]
    ds_read_b64_tr_b16 a[146:147], v48 offset:53248
    v_mfma_f32_16x16x32_bf16 v[116:119], a[152:155], a[164:167], v[116:119]
    ds_read_b64_tr_b16 a[148:149], v48 offset:57344
    buffer_load_dwordx4 v40, s[72:75], s88 offen offset:3072 sc1 lds
    v_mfma_f32_16x16x32_bf16 v[116:119], a[156:159], a[180:183], v[116:119]
    ds_read_b64_tr_b16 a[150:151], v48 offset:61440
    v_mfma_f32_16x16x32_bf16 v[120:123], a[152:155], a[168:171], v[120:123]
    s_add_u32 s88, s88, s30
    v_mfma_f32_16x16x32_bf16 v[120:123], a[156:159], a[184:187], v[120:123]
    v_mfma_f32_16x16x32_bf16 v[124:127], a[152:155], a[172:175], v[124:127]
    v_mfma_f32_16x16x32_bf16 v[124:127], a[156:159], a[188:191], v[124:127]
    s_waitcnt vmcnt(16) lgkmcnt(0)
    s_barrier
    s_lshl_b32 s83, s78, 8
    s_add_u32 s83, s83, 35651584
    s_cmp_eq_u32 s76, 0
    s_cselect_b32 s83, s83, 0x40000000
    v_mov_b32 v7, 1
    s_mov_b64 exec, 1
    buffer_atomic_add v7, off, s[72:75], s83
    s_mov_b64 exec, -1
    v_mfma_f32_16x16x32_bf16 v[64:67], a[128:131], v[224:227], v[64:67]
    ds_read_b128 a[160:163], v45 offset:0
    v_mfma_f32_16x16x32_bf16 v[64:67], a[132:135], v[240:243], v[64:67]
    ds_read_b128 a[164:167], v45 offset:1024
    s_add_u32 m0, s90, 114688
    s_nop 0
    v_mfma_f32_16x16x32_bf16 v[68:71], a[128:131], v[228:231], v[68:71]
    ds_read_b128 a[168:171], v45 offset:2048
    v_mfma_f32_16x16x32_bf16 v[68:71], a[132:135], v[244:247], v[68:71]
    ds_read_b128 a[172:175], v45 offset:3072
    buffer_load_dwordx4 v41, s[44:47], s89 offen offset:0 lds
    v_mfma_f32_16x16x32_bf16 v[72:75], a[128:131], v[232:235], v[72:75]
    ds_read_b128 a[176:179], v45 offset:8192
    v_mfma_f32_16x16x32_bf16 v[72:75], a[132:135], v[248:251], v[72:75]
    ds_read_b128 a[180:183], v45 offset:9216
    v_mfma_f32_16x16x32_bf16 v[76:79], a[128:131], v[236:239], v[76:79]
    ds_read_b128 a[184:187], v45 offset:10240
    buffer_load_dwordx4 v42, s[44:47], s89 offen offset:1024 lds
    v_mfma_f32_16x16x32_bf16 v[76:79], a[132:135], v[252:255], v[76:79]
    ds_read_b128 a[188:191], v45 offset:11264
    v_mfma_f32_16x16x32_bf16 v[80:83], a[136:139], v[224:227], v[80:83]
    ds_read_b64_tr_b16 a[128:129], v46 offset:0
    buffer_load_dwordx4 v43, s[44:47], s89 offen offset:2048 lds
    v_mfma_f32_16x16x32_bf16 v[80:83], a[140:143], v[240:243], v[80:83]
    ds_read_b64_tr_b16 a[130:131], v46 offset:4096
    v_mfma_f32_16x16x32_bf16 v[84:87], a[136:139], v[228:231], v[84:87]
    ds_read_b64_tr_b16 a[132:133], v46 offset:8192
    v_mfma_f32_16x16x32_bf16 v[84:87], a[140:143], v[244:247], v[84:87]
    ds_read_b64_tr_b16 a[134:135], v46 offset:12288
    buffer_load_dwordx4 v44, s[44:47], s89 offen offset:3072 lds
    v_mfma_f32_16x16x32_bf16 v[88:91], a[136:139], v[232:235], v[88:91]
    ds_read_b64_tr_b16 a[152:153], v49 offset:0
    v_mfma_f32_16x16x32_bf16 v[88:91], a[140:143], v[248:251], v[88:91]
    ds_read_b64_tr_b16 a[154:155], v49 offset:4096
    s_add_u32 s89, s89, s31
    v_mfma_f32_16x16x32_bf16 v[92:95], a[136:139], v[236:239], v[92:95]
    ds_read_b64_tr_b16 a[156:157], v49 offset:8192
    v_mfma_f32_16x16x32_bf16 v[92:95], a[140:143], v[252:255], v[92:95]
    ds_read_b64_tr_b16 a[158:159], v49 offset:12288
    v_mfma_f32_16x16x32_bf16 v[96:99], a[144:147], v[224:227], v[96:99]
    ds_read_b64_tr_b16 a[136:137], v47 offset:0
    s_add_u32 m0, s90, 49152
    s_nop 0
    v_mfma_f32_16x16x32_bf16 v[96:99], a[148:151], v[240:243], v[96:99]
    ds_read_b64_tr_b16 a[138:139], v47 offset:4096
    v_mfma_f32_16x16x32_bf16 v[100:103], a[144:147], v[228:231], v[100:103]
    ds_read_b64_tr_b16 a[140:141], v47 offset:8192
    buffer_load_dwordx4 v40, s[72:75], s88 offen offset:0 sc1 lds
    v_mfma_f32_16x16x32_bf16 v[100:103], a[148:151], v[244:247], v[100:103]
    ds_read_b64_tr_b16 a[142:143], v47 offset:12288
    v_mfma_f32_16x16x32_bf16 v[104:107], a[144:147], v[232:235], v[104:107]
    v_mfma_f32_16x16x32_bf16 v[104:107], a[148:151], v[248:251], v[104:107]
    buffer_load_dwordx4 v40, s[72:75], s88 offen offset:1024 sc1 lds
    v_mfma_f32_16x16x32_bf16 v[108:111], a[144:147], v[236:239], v[108:111]
    v_mfma_f32_16x16x32_bf16 v[108:111], a[148:151], v[252:255], v[108:111]
    buffer_load_dwordx4 v40, s[72:75], s88 offen offset:2048 sc1 lds
    v_mfma_f32_16x16x32_bf16 v[112:115], v[128:131], v[224:227], v[112:115]
    ds_read_b64_tr_b16 a[144:145], v48 offset:0
    v_mfma_f32_16x16x32_bf16 v[112:115], v[132:135], v[240:243], v[112:115]
    ds_read_b64_tr_b16 a[146:147], v48 offset:4096
    v_mfma_f32_16x16x32_bf16 v[116:119], v[128:131], v[228:231], v[116:119]
    ds_read_b64_tr_b16 a[148:149], v48 offset:8192
    buffer_load_dwordx4 v40, s[72:75], s88 offen offset:3072 sc1 lds
    v_mfma_f32_16x16x32_bf16 v[116:119], v[132:135], v[244:247], v[116:119]
    ds_read_b64_tr_b16 a[150:151], v48 offset:12288
    v_mfma_f32_16x16x32_bf16 v[120:123], v[128:131], v[232:235], v[120:123]
    s_add_u32 s88, s88, s30
    v_mfma_f32_16x16x32_bf16 v[120:123], v[132:135], v[248:251], v[120:123]
    v_mfma_f32_16x16x32_bf16 v[124:127], v[128:131], v[236:239], v[124:127]
    v_mfma_f32_16x16x32_bf16 v[124:127], v[132:135], v[252:255], v[124:127]
    s_mov_b32 s87, 6
L_p1loop0:
L_p1loop:
    s_waitcnt vmcnt(16) lgkmcnt(0)
    s_barrier
    v_mfma_f32_16x16x32_bf16 v[64:67], a[128:131], a[160:163], v[64:67]
    ds_read_b128 v[224:227], v45 offset:16384
    v_mfma_f32_16x16x32_bf16 v[64:67], a[132:135], a[176:179], v[64:67]
    ds_read_b128 v[228:231], v45 offset:17408
    s_add_u32 m0, s90, 65536
    s_nop 0
    v_mfma_f32_16x16x32_bf16 v[68:71], a[128:131], a[164:167], v[68:71]
    ds_read_b128 v[232:235], v45 offset:18432
    v_mfma_f32_16x16x32_bf16 v[68:71], a[132:135], a[180:183], v[68:71]
    ds_read_b128 v[236:239], v45 offset:19456
    buffer_load_dwordx4 v41, s[44:47], s89 offen offset:0 lds
    v_mfma_f32_16x16x32_bf16 v[72:75], a[128:131], a[168:171], v[72:75]
    ds_read_b128 v[240:243], v45 offset:24576
    v_mfma_f32_16x16x32_bf16 v[72:75], a[132:135], a[184:187], v[72:75]
    ds_read_b128 v[244:247], v45 offset:25600
    v_mfma_f32_16x16x32_bf16 v[76:79], a[128:131], a[172:175], v[76:79]
    ds_read_b128 v[248:251], v45 offset:26624
    buffer_load_dwordx4 v42, s[44:47], s89 offen offset:1024 lds
    v_mfma_f32_16x16x32_bf16 v[76:79], a[132:135], a[188:191], v[76:79]
    ds_read_b128 v[252:255], v45 offset:27648
    v_mfma_f32_16x16x32_bf16 v[80:83], a[136:139], a[160:163], v[80:83]
    ds_read_b64_tr_b16 a[128:129], v46 offset:16384
    buffer_load_dwordx4 v43, s[44:47], s89 offen offset:2048 lds
    v_mfma_f32_16x16x32_bf16 v[80:83], a[140:143], a[176:179], v[80:83]
    ds_read_b64_tr_b16 a[130:131], v46 offset:20480
    v_mfma_f32_16x16x32_bf16 v[84:87], a[136:139], a[164:167], v[84:87]
    ds_read_b64_tr_b16 a[132:133], v46 offset:24576
    v_mfma_f32_16x16x32_bf16 v[84:87], a[140:143], a[180:183], v[84:87]
    ds_read_b64_tr_b16 a[134:135], v46 offset:28672
    buffer_load_dwordx4 v44, s[44:47], s89 offen offset:3072 lds
    v_mfma_f32_16x16x32_bf16 v[88:91], a[136:139], a[168:171], v[88:91]
    ds_read_b64_tr_b16 v[128:129], v49 offset:16384
    v_mfma_f32_16x16x32_bf16 v[88:91], a[140:143], a[184:187], v[88:91]
    ds_read_b64_tr_b16 v[130:131], v49 offset:20480
    s_add_u32 s89, s89, s31
    v_mfma_f32_16x16x32_bf16 v[92:95], a[136:139], a[172:175], v[92:95]
    ds_read_b64_tr_b16 v[132:133], v49 offset:24576
    v_mfma_f32_16x16x32_bf16 v[92:95], a[140:143], a[188:191], v[92:95]
    ds_read_b64_tr_b16 v[134:135], v49 offset:28672
    v_mfma_f32_16x16x32_bf16 v[96:99], a[144:147], a[160:163], v[96:99]
    ds_read_b64_tr_b16 a[136:137], v47 offset:16384
    s_add_u32 m0, s90, 0
    s_nop 0
    v_mfma_f32_16x16x32_bf16 v[96:99], a[148:151], a[176:179], v[96:99]
    ds_read_b64_tr_b16 a[138:139], v47 offset:20480
    v_mfma_f32_16x16x32_bf16 v[100:103], a[144:147], a[164:167], v[100:103]
    ds_read_b64_tr_b16 a[140:141], v47 offset:24576
    buffer_load_dwordx4 v40, s[72:75], s88 offen offset:0 sc1 lds
    v_mfma_f32_16x16x32_bf16 v[100:103], a[148:151], a[180:183], v[100:103]
    ds_read_b64_tr_b16 a[142:143], v47 offset:28672
    v_mfma_f32_16x16x32_bf16 v[104:107], a[144:147], a[168:171], v[104:107]
    v_mfma_f32_16x16x32_bf16 v[104:107], a[148:151], a[184:187], v[104:107]
    buffer_load_dwordx4 v40, s[72:75], s88 offen offset:1024 sc1 lds
    v_mfma_f32_16x16x32_bf16 v[108:111], a[144:147], a[172:175], v[108:111]
    v_mfma_f32_16x16x32_bf16 v[108:111], a[148:151], a[188:191], v[108:111]
    buffer_load_dwordx4 v40, s[72:75], s88 offen offset:2048 sc1 lds
    v_mfma_f32_16x16x32_bf16 v[112:115], a[152:155], a[160:163], v[112:115]
    ds_read_b64_tr_b16 a[144:145], v48 offset:16384
    v_mfma_f32_16x16x32_bf16 v[112:115], a[156:159], a[176:179], v[112:115]
    ds_read_b64_tr_b16 a[146:147], v48 offset:20480
    v_mfma_f32_16x16x32_bf16 v[116:119], a[152:155], a[164:167], v[116:119]
    ds_read_b64_tr_b16 a[148:149], v48 offset:24576
    buffer_load_dwordx4 v40, s[72:75], s88 offen offset:3072 sc1 lds
    v_mfma_f32_16x16x32_bf16 v[116:119], a[156:159], a[180:183], v[116:119]
    ds_read_b64_tr_b16 a[150:151], v48 offset:28672
    v_mfma_f32_16x16x32_bf16 v[120:123], a[152:155], a[168:171], v[120:123]
    s_add_u32 s88, s88, s30
    v_mfma_f32_16x16x32_bf16 v[120:123], a[156:159], a[184:187], v[120:123]
    v_mfma_f32_16x16x32_bf16 v[124:127], a[152:155], a[172:175], v[124:127]
    v_mfma_f32_16x16x32_bf16 v[124:127], a[156:159], a[188:191], v[124:127]
    s_waitcnt vmcnt(16) lgkmcnt(0)
    s_barrier
    v_mfma_f32_16x16x32_bf16 v[64:67], a[128:131], v[224:227], v[64:67]
    ds_read_b128 a[160:163], v45 offset:32768
    v_mfma_f32_16x16x32_bf16 v[64:67], a[132:135], v[240:243], v[64:67]
    ds_read_b128 a[164:167], v45 offset:33792
    s_add_u32 m0, s90, 81920
    s_nop 0
    v_mfma_f32_16x16x32_bf16 v[68:71], a[128:131], v[228:231], v[68:71]
    ds_read_b128 a[168:171], v45 offset:34816
    v_mfma_f32_16x16x32_bf16 v[68:71], a[132:135], v[244:247], v[68:71]
    ds_read_b128 a[172:175], v45 offset:35840
    buffer_load_dwordx4 v41, s[44:47], s89 offen offset:0 lds
    v_mfma_f32_16x16x32_bf16 v[72:75], a[128:131], v[232:235], v[72:75]
    ds_read_b128 a[176:179], v45 offset:40960
    v_mfma_f32_16x16x32_bf16 v[72:75], a[132:135], v[248:251], v[72:75]
    ds_read_b128 a[180:183], v45 offset:41984
    v_mfma_f32_16x16x32_bf16 v[76:79], a[128:131], v[236:239], v[76:79]
    ds_read_b128 a[184:187], v45 offset:43008
    buffer_load_dwordx4 v42, s[44:47], s89 offen offset:1024 lds
    v_mfma_f32_16x16x32_bf16 v[76:79], a[132:135], v[252:255], v[76:79]
    ds_read_b128 a[188:191], v45 offset:44032
    v_mfma_f32_16x16x32_bf16 v[80:83], a[136:139], v[224:227], v[80:83]
    ds_read_b64_tr_b16 a[128:129], v46 offset:32768
    buffer_load_dwordx4 v43, s[44:47], s89 offen offset:2048 lds
    v_mfma_f32_16x16x32_bf16 v[80:83], a[140:143], v[240:243], v[80:83]
    ds_read_b64_tr_b16 a[130:131], v46 offset:36864
    v_mfma_f32_16x16x32_bf16 v[84:87], a[136:139], v[228:231], v[84:87]
    ds_read_b64_tr_b16 a[132:133], v46 offset:40960
    v_mfma_f32_16x16x32_bf16 v[84:87], a[140:143], v[244:247], v[84:87]
    ds_read_b64_tr_b16 a[134:135], v46 offset:45056
    buffer_load_dwordx4 v44, s[44:47], s89 offen offset:3072 lds
    v_mfma_f32_16x16x32_bf16 v[88:91], a[136:139], v[232:235], v[88:91]
    ds_read_b64_tr_b16 a[152:153], v49 offset:32768
    v_mfma_f32_16x16x32_bf16 v[88:91], a[140:143], v[248:251], v[88:91]
    ds_read_b64_tr_b16 a[154:155], v49 offset:36864
    s_add_u32 s89, s89, s31
    v_mfma_f32_16x16x32_bf16 v[92:95], a[136:139], v[236:239], v[92:95]
    ds_read_b64_tr_b16 a[156:157], v49 offset:40960
    v_mfma_f32_16x16x32_bf16 v[92:95], a[140:143], v[252:255], v[92:95]
    ds_read_b64_tr_b16 a[158:159], v49 offset:45056
    v_mfma_f32_16x16x32_bf16 v[96:99], a[144:147], v[224:227], v[96:99]
    ds_read_b64_tr_b16 a[136:137], v47 offset:32768
    s_add_u32 m0, s90, 16384
    s_nop 0
    v_mfma_f32_16x16x32_bf16 v[96:99], a[148:151], v[240:243], v[96:99]
    ds_read_b64_tr_b16 a[138:139], v47 offset:36864
    v_mfma_f32_16x16x32_bf16 v[100:103], a[144:147], v[228:231], v[100:103]
    ds_read_b64_tr_b16 a[140:141], v47 offset:40960
    buffer_load_dwordx4 v40, s[72:75], s88 offen offset:0 sc1 lds
    v_mfma_f32_16x16x32_bf16 v[100:103], a[148:151], v[244:247], v[100:103]
    ds_read_b64_tr_b16 a[142:143], v47 offset:45056
    v_mfma_f32_16x16x32_bf16 v[104:107], a[144:147], v[232:235], v[104:107]
    v_mfma_f32_16x16x32_bf16 v[104:107], a[148:151], v[248:251], v[104:107]
    buffer_load_dwordx4 v40, s[72:75], s88 offen offset:1024 sc1 lds
    v_mfma_f32_16x16x32_bf16 v[108:111], a[144:147], v[236:239], v[108:111]
    v_mfma_f32_16x16x32_bf16 v[108:111], a[148:151], v[252:255], v[108:111]
    buffer_load_dwordx4 v40, s[72:75], s88 offen offset:2048 sc1 lds
    v_mfma_f32_16x16x32_bf16 v[112:115], v[128:131], v[224:227], v[112:115]
    ds_read_b64_tr_b16 a[144:145], v48 offset:32768
    v_mfma_f32_16x16x32_bf16 v[112:115], v[132:135], v[240:243], v[112:115]
    ds_read_b64_tr_b16 a[146:147], v48 offset:36864
    v_mfma_f32_16x16x32_bf16 v[116:119], v[128:131], v[228:231], v[116:119]
    ds_read_b64_tr_b16 a[148:149], v48 offset:40960
    buffer_load_dwordx4 v40, s[72:75], s88 offen offset:3072 sc1 lds
    v_mfma_f32_16x16x32_bf16 v[116:119], v[132:135], v[244:247], v[116:119]
    ds_read_b64_tr_b16 a[150:151], v48 offset:45056
    v_mfma_f32_16x16x32_bf16 v[120:123], v[128:131], v[232:235], v[120:123]
    s_add_u32 s88, s88, s30
    v_mfma_f32_16x16x32_bf16 v[120:123], v[132:135], v[248:251], v[120:123]
    v_mfma_f32_16x16x32_bf16 v[124:127], v[128:131], v[236:239], v[124:127]
    v_mfma_f32_16x16x32_bf16 v[124:127], v[132:135], v[252:255], v[124:127]
    s_waitcnt vmcnt(16) lgkmcnt(0)
    s_barrier
    v_mfma_f32_16x16x32_bf16 v[64:67], a[128:131], a[160:163], v[64:67]
    ds_read_b128 v[224:227], v45 offset:49152
    v_mfma_f32_16x16x32_bf16 v[64:67], a[132:135], a[176:179], v[64:67]
    ds_read_b128 v[228:231], v45 offset:50176
    s_add_u32 m0, s90, 98304
    s_nop 0
    v_mfma_f32_16x16x32_bf16 v[68:71], a[128:131], a[164:167], v[68:71]
    ds_read_b128 v[232:235], v45 offset:51200
    v_mfma_f32_16x16x32_bf16 v[68:71], a[132:135], a[180:183], v[68:71]
    ds_read_b128 v[236:239], v45 offset:52224
    buffer_load_dwordx4 v41, s[44:47], s89 offen offset:0 lds
    v_mfma_f32_16x16x32_bf16 v[72:75], a[128:131], a[168:171], v[72:75]
    ds_read_b128 v[240:243], v45 offset:57344
    v_mfma_f32_16x16x32_bf16 v[72:75], a[132:135], a[184:187], v[72:75]
    ds_read_b128 v[244:247], v45 offset:58368
    v_mfma_f32_16x16x32_bf16 v[76:79], a[128:131], a[172:175], v[76:79]
    ds_read_b128 v[248:251], v45 offset:59392
    buffer_load_dwordx4 v42, s[44:47], s89 offen offset:1024 lds
    v_mfma_f32_16x16x32_bf16 v[76:79], a[132:135], a[188:191], v[76:79]
    ds_read_b128 v[252:255], v45 offset:60416
    v_mfma_f32_16x16x32_bf16 v[80:83], a[136:139], a[160:163], v[80:83]
    ds_read_b64_tr_b16 a[128:129], v46 offset:49152
    buffer_load_dwordx4 v43, s[44:47], s89 offen offset:2048 lds
    v_mfma_f32_16x16x32_bf16 v[80:83], a[140:143], a[176:179], v[80:83]
    ds_read_b64_tr_b16 a[130:131], v46 offset:53248
    v_mfma_f32_16x16x32_bf16 v[84:87], a[136:139], a[164:167], v[84:87]
    ds_read_b64_tr_b16 a[132:133], v46 offset:57344
    v_mfma_f32_16x16x32_bf16 v[84:87], a[140:143], a[180:183], v[84:87]
    ds_read_b64_tr_b16 a[134:135], v46 offset:61440
    buffer_load_dwordx4 v44, s[44:47], s89 offen offset:3072 lds
    v_mfma_f32_16x16x32_bf16 v[88:91], a[136:139], a[168:171], v[88:91]
    ds_read_b64_tr_b16 v[128:129], v49 offset:49152
    v_mfma_f32_16x16x32_bf16 v[88:91], a[140:143], a[184:187], v[88:91]
    ds_read_b64_tr_b16 v[130:131], v49 offset:53248
    s_add_u32 s89, s89, s31
    v_mfma_f32_16x16x32_bf16 v[92:95], a[136:139], a[172:175], v[92:95]
    ds_read_b64_tr_b16 v[132:133], v49 offset:57344
    v_mfma_f32_16x16x32_bf16 v[92:95], a[140:143], a[188:191], v[92:95]
    ds_read_b64_tr_b16 v[134:135], v49 offset:61440
    v_mfma_f32_16x16x32_bf16 v[96:99], a[144:147], a[160:163], v[96:99]
    ds_read_b64_tr_b16 a[136:137], v47 offset:49152
    s_add_u32 m0, s90, 32768
    s_nop 0
    v_mfma_f32_16x16x32_bf16 v[96:99], a[148:151], a[176:179], v[96:99]
    ds_read_b64_tr_b16 a[138:139], v47 offset:53248
    v_mfma_f32_16x16x32_bf16 v[100:103], a[144:147], a[164:167], v[100:103]
    ds_read_b64_tr_b16 a[140:141], v47 offset:57344
    buffer_load_dwordx4 v40, s[72:75], s88 offen offset:0 sc1 lds
    v_mfma_f32_16x16x32_bf16 v[100:103], a[148:151], a[180:183], v[100:103]
    ds_read_b64_tr_b16 a[142:143], v47 offset:61440
    v_mfma_f32_16x16x32_bf16 v[104:107], a[144:147], a[168:171], v[104:107]
    v_mfma_f32_16x16x32_bf16 v[104:107], a[148:151], a[184:187], v[104:107]
    buffer_load_dwordx4 v40, s[72:75], s88 offen offset:1024 sc1 lds
    v_mfma_f32_16x16x32_bf16 v[108:111], a[144:147], a[172:175], v[108:111]
    v_mfma_f32_16x16x32_bf16 v[108:111], a[148:151], a[188:191], v[108:111]
    buffer_load_dwordx4 v40, s[72:75], s88 offen offset:2048 sc1 lds
    v_mfma_f32_16x16x32_bf16 v[112:115], a[152:155], a[160:163], v[112:115]
    ds_read_b64_tr_b16 a[144:145], v48 offset:49152
    v_mfma_f32_16x16x32_bf16 v[112:115], a[156:159], a[176:179], v[112:115]
    ds_read_b64_tr_b16 a[146:147], v48 offset:53248
    v_mfma_f32_16x16x32_bf16 v[116:119], a[152:155], a[164:167], v[116:119]
    ds_read_b64_tr_b16 a[148:149], v48 offset:57344
    buffer_load_dwordx4 v40, s[72:75], s88 offen offset:3072 sc1 lds
    v_mfma_f32_16x16x32_bf16 v[116:119], a[156:159], a[180:183], v[116:119]
    ds_read_b64_tr_b16 a[150:151], v48 offset:61440
    v_mfma_f32_16x16x32_bf16 v[120:123], a[152:155], a[168:171], v[120:123]
    s_add_u32 s88, s88, s30
    v_mfma_f32_16x16x32_bf16 v[120:123], a[156:159], a[184:187], v[120:123]
    v_mfma_f32_16x16x32_bf16 v[124:127], a[152:155], a[172:175], v[124:127]
    v_mfma_f32_16x16x32_bf16 v[124:127], a[156:159], a[188:191], v[124:127]
    s_waitcnt vmcnt(16) lgkmcnt(0)
    s_barrier
    v_mfma_f32_16x16x32_bf16 v[64:67], a[128:131], v[224:227], v[64:67]
    ds_read_b128 a[160:163], v45 offset:0
    v_mfma_f32_16x16x32_bf16 v[64:67], a[132:135], v[240:243], v[64:67]
    ds_read_b128 a[164:167], v45 offset:1024
    s_add_u32 m0, s90, 114688
    s_nop 0
    v_mfma_f32_16x16x32_bf16 v[68:71], a[128:131], v[228:231], v[68:71]
    ds_read_b128 a[168:171], v45 offset:2048
    v_mfma_f32_16x16x32_bf16 v[68:71], a[132:135], v[244:247], v[68:71]
    ds_read_b128 a[172:175], v45 offset:3072
    buffer_load_dwordx4 v41, s[44:47], s89 offen offset:0 lds
    v_mfma_f32_16x16x32_bf16 v[72:75], a[128:131], v[232:235], v[72:75]
    ds_read_b128 a[176:179], v45 offset:8192
    v_mfma_f32_16x16x32_bf16 v[72:75], a[132:135], v[248:251], v[72:75]
    ds_read_b128 a[180:183], v45 offset:9216
    v_mfma_f32_16x16x32_bf16 v[76:79], a[128:131], v[236:239], v[76:79]
    ds_read_b128 a[184:187], v45 offset:10240
    buffer_load_dwordx4 v42, s[44:47], s89 offen offset:1024 lds
    v_mfma_f32_16x16x32_bf16 v[76:79], a[132:135], v[252:255], v[76:79]
    ds_read_b128 a[188:191], v45 offset:11264
    v_mfma_f32_16x16x32_bf16 v[80:83], a[136:139], v[224:227], v[80:83]
    ds_read_b64_tr_b16 a[128:129], v46 offset:0
    buffer_load_dwordx4 v43, s[44:47], s89 offen offset:2048 lds
    v_mfma_f32_16x16x32_bf16 v[80:83], a[140:143], v[240:243], v[80:83]
    ds_read_b64_tr_b16 a[130:131], v46 offset:4096
    v_mfma_f32_16x16x32_bf16 v[84:87], a[136:139], v[228:231], v[84:87]
    ds_read_b64_tr_b16 a[132:133], v46 offset:8192
    v_mfma_f32_16x16x32_bf16 v[84:87], a[140:143], v[244:247], v[84:87]
    ds_read_b64_tr_b16 a[134:135], v46 offset:12288
    buffer_load_dwordx4 v44, s[44:47], s89 offen offset:3072 lds
    v_mfma_f32_16x16x32_bf16 v[88:91], a[136:139], v[232:235], v[88:91]
    ds_read_b64_tr_b16 a[152:153], v49 offset:0
    v_mfma_f32_16x16x32_bf16 v[88:91], a[140:143], v[248:251], v[88:91]
    ds_read_b64_tr_b16 a[154:155], v49 offset:4096
    s_add_u32 s89, s89, s31
    v_mfma_f32_16x16x32_bf16 v[92:95], a[136:139], v[236:239], v[92:95]
    ds_read_b64_tr_b16 a[156:157], v49 offset:8192
    v_mfma_f32_16x16x32_bf16 v[92:95], a[140:143], v[252:255], v[92:95]
    ds_read_b64_tr_b16 a[158:159], v49 offset:12288
    v_mfma_f32_16x16x32_bf16 v[96:99], a[144:147], v[224:227], v[96:99]
    ds_read_b64_tr_b16 a[136:137], v47 offset:0
    s_add_u32 m0, s90, 49152
    s_nop 0
    v_mfma_f32_16x16x32_bf16 v[96:99], a[148:151], v[240:243], v[96:99]
    ds_read_b64_tr_b16 a[138:139], v47 offset:4096
    v_mfma_f32_16x16x32_bf16 v[100:103], a[144:147], v[228:231], v[100:103]
    ds_read_b64_tr_b16 a[140:141], v47 offset:8192
    buffer_load_dwordx4 v40, s[72:75], s88 offen offset:0 sc1 lds
    v_mfma_f32_16x16x32_bf16 v[100:103], a[148:151], v[244:247], v[100:103]
    ds_read_b64_tr_b16 a[142:143], v47 offset:12288
    v_mfma_f32_16x16x32_bf16 v[104:107], a[144:147], v[232:235], v[104:107]
    v_mfma_f32_16x16x32_bf16 v[104:107], a[148:151], v[248:251], v[104:107]
    buffer_load_dwordx4 v40, s[72:75], s88 offen offset:1024 sc1 lds
    v_mfma_f32_16x16x32_bf16 v[108:111], a[144:147], v[236:239], v[108:111]
    v_mfma_f32_16x16x32_bf16 v[108:111], a[148:151], v[252:255], v[108:111]
    buffer_load_dwordx4 v40, s[72:75], s88 offen offset:2048 sc1 lds
    v_mfma_f32_16x16x32_bf16 v[112:115], v[128:131], v[224:227], v[112:115]
    ds_read_b64_tr_b16 a[144:145], v48 offset:0
    v_mfma_f32_16x16x32_bf16 v[112:115], v[132:135], v[240:243], v[112:115]
    ds_read_b64_tr_b16 a[146:147], v48 offset:4096
    v_mfma_f32_16x16x32_bf16 v[116:119], v[128:131], v[228:231], v[116:119]
    ds_read_b64_tr_b16 a[148:149], v48 offset:8192
    buffer_load_dwordx4 v40, s[72:75], s88 offen offset:3072 sc1 lds
    v_mfma_f32_16x16x32_bf16 v[116:119], v[132:135], v[244:247], v[116:119]
    ds_read_b64_tr_b16 a[150:151], v48 offset:12288
    v_mfma_f32_16x16x32_bf16 v[120:123], v[128:131], v[232:235], v[120:123]
    s_add_u32 s88, s88, s30
    v_mfma_f32_16x16x32_bf16 v[120:123], v[132:135], v[248:251], v[120:123]
    v_mfma_f32_16x16x32_bf16 v[124:127], v[128:131], v[236:239], v[124:127]
    v_mfma_f32_16x16x32_bf16 v[124:127], v[132:135], v[252:255], v[124:127]
    s_sub_u32 s87, s87, 1
    s_cmp_lg_u32 s87, 0
    s_cbranch_scc1 L_p1loop
    s_waitcnt vmcnt(16) lgkmcnt(0)
    s_barrier
    v_mfma_f32_16x16x32_bf16 v[64:67], a[128:131], a[160:163], v[64:67]
    ds_read_b128 v[224:227], v45 offset:16384
    s_mul_i32 s81, s76, 40960
    s_mul_i32 s82, s29, 5120
    v_mfma_f32_16x16x32_bf16 v[64:67], a[132:135], a[176:179], v[64:67]
    ds_read_b128 v[228:231], v45 offset:17408
    s_add_u32 s81, s81, s82
    s_add_u32 s81, s81, 20971520
    v_mfma_f32_16x16x32_bf16 v[68:71], a[128:131], a[164:167], v[68:71]
    ds_read_b128 v[232:235], v45 offset:18432
    v_add_u32 v24, s81, v50
    s_lshl_b32 s81, s28, 6
    v_mfma_f32_16x16x32_bf16 v[68:71], a[132:135], a[180:183], v[68:71]
    ds_read_b128 v[236:239], v45 offset:19456
    s_lshl_b32 s82, s76, 4
    v_mfma_f32_16x16x32_bf16 v[72:75], a[128:131], a[168:171], v[72:75]
    ds_read_b128 v[240:243], v45 offset:24576
    s_add_u32 s81, s81, s82
    s_mul_i32 s81, s81, 1280
    v_mfma_f32_16x16x32_bf16 v[72:75], a[132:135], a[184:187], v[72:75]
    ds_read_b128 v[244:247], v45 offset:25600
    s_mul_i32 s82, s29, 160
    s_add_u32 s81, s81, s82
    v_mfma_f32_16x16x32_bf16 v[76:79], a[128:131], a[172:175], v[76:79]
    ds_read_b128 v[248:251], v45 offset:26624
    s_mul_i32 s82, s76, 2816
    s_add_u32 s82, s82, 147456
    v_mfma_f32_16x16x32_bf16 v[76:79], a[132:135], a[188:191], v[76:79]
    ds_read_b128 v[252:255], v45 offset:27648
    v_add_u32 v6, 0, v1
    v_mfma_f32_16x16x32_bf16 v[80:83], a[136:139], a[160:163], v[80:83]
    ds_read_b64_tr_b16 a[128:129], v46 offset:16384
    v_mul_u32_u24 v7, 205, v6
    v_lshrrev_b32 v7, 11, v7
    v_mfma_f32_16x16x32_bf16 v[80:83], a[140:143], a[176:179], v[80:83]
    ds_read_b64_tr_b16 a[130:131], v46 offset:20480
    v_mul_u32_u24 v25, 10, v7
    v_sub_u32 v6, v6, v25
    v_mfma_f32_16x16x32_bf16 v[84:87], a[136:139], a[164:167], v[84:87]
    ds_read_b64_tr_b16 a[132:133], v46 offset:24576
    v_lshlrev_b32 v6, 4, v6
    v_mul_u32_u24 v25, 1280, v7
    v_mfma_f32_16x16x32_bf16 v[84:87], a[140:143], a[180:183], v[84:87]
    ds_read_b64_tr_b16 a[134:135], v46 offset:28672
    v_add3_u32 v26, v25, v6, s81
    v_mfma_f32_16x16x32_bf16 v[88:91], a[136:139], a[168:171], v[88:91]
    ds_read_b64_tr_b16 v[128:129], v49 offset:16384
    v_mul_u32_u24 v25, 176, v7
    v_add3_u32 v29, v25, v6, s82
    v_mfma_f32_16x16x32_bf16 v[88:91], a[140:143], a[184:187], v[88:91]
    ds_read_b64_tr_b16 v[130:131], v49 offset:20480
    v_add_u32 v6, 64, v1
    v_mul_u32_u24 v7, 205, v6
    v_mfma_f32_16x16x32_bf16 v[92:95], a[136:139], a[172:175], v[92:95]
    ds_read_b64_tr_b16 v[132:133], v49 offset:24576
    v_lshrrev_b32 v7, 11, v7
    v_mul_u32_u24 v25, 10, v7
    v_mfma_f32_16x16x32_bf16 v[92:95], a[140:143], a[188:191], v[92:95]
    ds_read_b64_tr_b16 v[134:135], v49 offset:28672
    v_sub_u32 v6, v6, v25
    v_mfma_f32_16x16x32_bf16 v[96:99], a[144:147], a[160:163], v[96:99]
    ds_read_b64_tr_b16 a[136:137], v47 offset:16384
    v_lshlrev_b32 v6, 4, v6
    v_mul_u32_u24 v25, 1280, v7
    v_mfma_f32_16x16x32_bf16 v[96:99], a[148:151], a[176:179], v[96:99]
    ds_read_b64_tr_b16 a[138:139], v47 offset:20480
    v_add3_u32 v27, v25, v6, s81
    v_mul_u32_u24 v25, 176, v7
    v_mfma_f32_16x16x32_bf16 v[100:103], a[144:147], a[164:167], v[100:103]
    ds_read_b64_tr_b16 a[140:141], v47 offset:24576
    v_add3_u32 v30, v25, v6, s82
    v_add_u32 v6, 128, v1
    v_mfma_f32_16x16x32_bf16 v[100:103], a[148:151], a[180:183], v[100:103]
    ds_read_b64_tr_b16 a[142:143], v47 offset:28672
    v_mul_u32_u24 v7, 205, v6
    v_lshrrev_b32 v7, 11, v7
    v_mfma_f32_16x16x32_bf16 v[104:107], a[144:147], a[168:171], v[104:107]
    v_mul_u32_u24 v25, 10, v7
    v_sub_u32 v6, v6, v25
    v_mfma_f32_16x16x32_bf16 v[104:107], a[148:151], a[184:187], v[104:107]
    v_lshlrev_b32 v6, 4, v6
    v_mfma_f32_16x16x32_bf16 v[108:111], a[144:147], a[172:175], v[108:111]
    v_mul_u32_u24 v25, 1280, v7
    v_add3_u32 v28, v25, v6, s81
    v_mfma_f32_16x16x32_bf16 v[108:111], a[148:151], a[188:191], v[108:111]
    v_mul_u32_u24 v25, 176, v7
    v_add3_u32 v31, v25, v6, s82
    v_mfma_f32_16x16x32_bf16 v[112:115], a[152:155], a[160:163], v[112:115]
    ds_read_b64_tr_b16 a[144:145], v48 offset:16384
    v_mul_u32_u24 v6, 176, v2
    v_lshl_add_u32 v6, v3, 3, v6
    v_mfma_f32_16x16x32_bf16 v[112:115], a[156:159], a[176:179], v[112:115]
    ds_read_b64_tr_b16 a[146:147], v48 offset:20480
    v_add_u32 v17, s82, v6
    s_mul_i32 s81, s76, 15360
    v_mfma_f32_16x16x32_bf16 v[116:119], a[152:155], a[164:167], v[116:119]
    ds_read_b64_tr_b16 a[148:149], v48 offset:24576
    s_add_u32 s81, s81, 65536
    v_mfma_f32_16x16x32_bf16 v[116:119], a[156:159], a[180:183], v[116:119]
    ds_read_b64_tr_b16 a[150:151], v48 offset:28672
    v_add_u32 v25, s81, v50
    s_lshr_b32 s82, s29, 1
    v_mfma_f32_16x16x32_bf16 v[120:123], a[152:155], a[168:171], v[120:123]
    s_lshl_b32 s82, s82, 3
    s_mov_b32 s83, 0x180c0201
    v_mfma_f32_16x16x32_bf16 v[120:123], a[156:159], a[184:187], v[120:123]
    s_bitcmp1_b32 s29, 0
    s_cselect_b32 s81, 0x10080603, s83
    v_mfma_f32_16x16x32_bf16 v[124:127], a[152:155], a[172:175], v[124:127]
    s_lshr_b32 s81, s81, s82
    s_and_b32 s81, s81, 0x1f
    v_mfma_f32_16x16x32_bf16 v[124:127], a[156:159], a[188:191], v[124:127]
    s_lshl_b32 s93, s81, 8
    s_waitcnt vmcnt(8) lgkmcnt(0)
    s_barrier
    s_cmp_eq_u32 s95, 2
    s_cbranch_scc1 L_nopoll
    s_mov_b32 exec_lo, s93
    s_mov_b32 exec_hi, 0
    buffer_load_dword v58, v59, s[72:75], 0 offen sc1
    s_mov_b64 exec, -1
L_nopoll:
    v_mfma_f32_16x16x32_bf16 v[64:67], a[128:131], v[224:227], v[64:67]
    ds_read_b128 a[160:163], v45 offset:32768
    v_mfma_f32_16x16x32_bf16 v[64:67], a[132:135], v[240:243], v[64:67]
    ds_read_b128 a[164:167], v45 offset:33792
    v_mfma_f32_16x16x32_bf16 v[68:71], a[128:131], v[228:231], v[68:71]
    ds_read_b128 a[168:171], v45 offset:34816
    v_mfma_f32_16x16x32_bf16 v[68:71], a[132:135], v[244:247], v[68:71]
    ds_read_b128 a[172:175], v45 offset:35840
    v_mfma_f32_16x16x32_bf16 v[72:75], a[128:131], v[232:235], v[72:75]
    ds_read_b128 a[176:179], v45 offset:40960
    v_mfma_f32_16x16x32_bf16 v[72:75], a[132:135], v[248:251], v[72:75]
    ds_read_b128 a[180:183], v45 offset:41984
    v_mfma_f32_16x16x32_bf16 v[76:79], a[128:131], v[236:239], v[76:79]
    ds_read_b128 a[184:187], v45 offset:43008
    v_mfma_f32_16x16x32_bf16 v[76:79], a[132:135], v[252:255], v[76:79]
    ds_read_b128 a[188:191], v45 offset:44032
    v_mfma_f32_16x16x32_bf16 v[80:83], a[136:139], v[224:227], v[80:83]
    ds_read_b64_tr_b16 a[128:129], v46 offset:32768
    v_mfma_f32_16x16x32_bf16 v[80:83], a[140:143], v[240:243], v[80:83]
    ds_read_b64_tr_b16 a[130:131], v46 offset:36864
    v_mfma_f32_16x16x32_bf16 v[84:87], a[136:139], v[228:231], v[84:87]
    ds_read_b64_tr_b16 a[132:133], v46 offset:40960
    v_mfma_f32_16x16x32_bf16 v[84:87], a[140:143], v[244:247], v[84:87]
    ds_read_b64_tr_b16 a[134:135], v46 offset:45056
    v_mfma_f32_16x16x32_bf16 v[88:91], a[136:139], v[232:235], v[88:91]
    ds_read_b64_tr_b16 a[152:153], v49 offset:32768
    v_mfma_f32_16x16x32_bf16 v[88:91], a[140:143], v[248:251], v[88:91]
    ds_read_b64_tr_b16 a[154:155], v49 offset:36864
    v_mfma_f32_16x16x32_bf16 v[92:95], a[136:139], v[236:239], v[92:95]
    ds_read_b64_tr_b16 a[156:157], v49 offset:40960
    v_mfma_f32_16x16x32_bf16 v[92:95], a[140:143], v[252:255], v[92:95]
    ds_read_b64_tr_b16 a[158:159], v49 offset:45056
    v_mfma_f32_16x16x32_bf16 v[96:99], a[144:147], v[224:227], v[96:99]
    ds_read_b64_tr_b16 a[136:137], v47 offset:32768
    v_mfma_f32_16x16x32_bf16 v[96:99], a[148:151], v[240:243], v[96:99]
    ds_read_b64_tr_b16 a[138:139], v47 offset:36864
    v_mfma_f32_16x16x32_bf16 v[100:103], a[144:147], v[228:231], v[100:103]
    ds_read_b64_tr_b16 a[140:141], v47 offset:40960
    v_mfma_f32_16x16x32_bf16 v[100:103], a[148:151], v[244:247], v[100:103]
    ds_read_b64_tr_b16 a[142:143], v47 offset:45056
    v_mfma_f32_16x16x32_bf16 v[104:107], a[144:147], v[232:235], v[104:107]
    v_mfma_f32_16x16x32_bf16 v[104:107], a[148:151], v[248:251], v[104:107]
    v_mfma_f32_16x16x32_bf16 v[108:111], a[144:147], v[236:239], v[108:111]
    v_mfma_f32_16x16x32_bf16 v[108:111], a[148:151], v[252:255], v[108:111]
    v_mfma_f32_16x16x32_bf16 v[112:115], v[128:131], v[224:227], v[112:115]
    ds_read_b64_tr_b16 a[144:145], v48 offset:32768
    v_mfma_f32_16x16x32_bf16 v[112:115], v[132:135], v[240:243], v[112:115]
    ds_read_b64_tr_b16 a[146:147], v48 offset:36864
    v_mfma_f32_16x16x32_bf16 v[116:119], v[128:131], v[228:231], v[116:119]
    ds_read_b64_tr_b16 a[148:149], v48 offset:40960
    v_mfma_f32_16x16x32_bf16 v[116:119], v[132:135], v[244:247], v[116:119]
    ds_read_b64_tr_b16 a[150:151], v48 offset:45056
    v_mfma_f32_16x16x32_bf16 v[120:123], v[128:131], v[232:235], v[120:123]
    v_mfma_f32_16x16x32_bf16 v[120:123], v[132:135], v[248:251], v[120:123]
    v_mfma_f32_16x16x32_bf16 v[124:127], v[128:131], v[236:239], v[124:127]
    v_mfma_f32_16x16x32_bf16 v[124:127], v[132:135], v[252:255], v[124:127]
    s_waitcnt vmcnt(0) lgkmcnt(0)
    s_barrier
    s_cmp_eq_u32 s95, 2
    s_cbranch_scc1 L_nou
    v_accvgpr_read_b32 v7, a250
    s_mov_b32 s92, 0x40000
L_poll4:
    v_sub_u32 v58, v58, v7
    v_cmp_gt_u32 vcc, 14, v58
    s_nop 1
    s_and_b32 s86, vcc_lo, s93
    s_cbranch_scc0 L_polld4
    s_sub_u32 s92, s92, 1
    s_cbranch_scc1 L_polld4
    s_sleep 6
    s_mov_b32 exec_lo, s93
    s_mov_b32 exec_hi, 0
    buffer_load_dword v58, v59, s[72:75], 0 offen sc1
    s_mov_b64 exec, -1
    s_waitcnt vmcnt(0)
    s_branch L_poll4
L_polld4:
L_nou:
    s_mov_b32 s0, 0
    s_cmp_eq_u32 s95, 2
    s_cselect_b32 s0, 0x40000000, s0
    v_add_u32 v41, 4096, v24
    v_mfma_f32_16x16x32_bf16 v[64:67], a[128:131], a[160:163], v[64:67]
    ds_read_b128 v[224:227], v45 offset:49152
    buffer_load_dwordx4 v[144:147], v24, s[72:75], s0 offen offset:0 sc1
    v_mfma_f32_16x16x32_bf16 v[64:67], a[132:135], a[176:179], v[64:67]
    ds_read_b128 v[228:231], v45 offset:50176
    buffer_load_dwordx4 v[148:151], v24, s[72:75], s0 offen offset:1024 sc1
    v_mfma_f32_16x16x32_bf16 v[68:71], a[128:131], a[164:167], v[68:71]
    ds_read_b128 v[232:235], v45 offset:51200
    buffer_load_dwordx4 v[152:155], v24, s[72:75], s0 offen offset:2048 sc1
    v_mfma_f32_16x16x32_bf16 v[68:71], a[132:135], a[180:183], v[68:71]
    ds_read_b128 v[236:239], v45 offset:52224
    v_mfma_f32_16x16x32_bf16 v[72:75], a[128:131], a[168:171], v[72:75]
    ds_read_b128 v[240:243], v45 offset:57344
    buffer_load_dwordx4 v[156:159], v24, s[72:75], s0 offen offset:3072 sc1
    v_mfma_f32_16x16x32_bf16 v[72:75], a[132:135], a[184:187], v[72:75]
    ds_read_b128 v[244:247], v45 offset:58368
    buffer_load_dwordx4 v[160:163], v41, s[72:75], s0 offen sc1
    v_mfma_f32_16x16x32_bf16 v[76:79], a[128:131], a[172:175], v[76:79]
    ds_read_b128 v[248:251], v45 offset:59392
    s_add_u32 s0, s0, 163840
    v_mfma_f32_16x16x32_bf16 v[76:79], a[132:135], a[188:191], v[76:79]
    ds_read_b128 v[252:255], v45 offset:60416
    v_mfma_f32_16x16x32_bf16 v[80:83], a[136:139], a[160:163], v[80:83]
    ds_read_b64_tr_b16 a[128:129], v46 offset:49152
    buffer_load_dwordx4 v[164:167], v24, s[72:75], s0 offen offset:0 sc1
    v_mfma_f32_16x16x32_bf16 v[80:83], a[140:143], a[176:179], v[80:83]
    ds_read_b64_tr_b16 a[130:131], v46 offset:53248
    buffer_load_dwordx4 v[168:171], v24, s[72:75], s0 offen offset:1024 sc1
    v_mfma_f32_16x16x32_bf16 v[84:87], a[136:139], a[164:167], v[84:87]
    ds_read_b64_tr_b16 a[132:133], v46 offset:57344
    buffer_load_dwordx4 v[172:175], v24, s[72:75], s0 offen offset:2048 sc1
    v_mfma_f32_16x16x32_bf16 v[84:87], a[140:143], a[180:183], v[84:87]
    ds_read_b64_tr_b16 a[134:135], v46 offset:61440
    v_mfma_f32_16x16x32_bf16 v[88:91], a[136:139], a[168:171], v[88:91]
    ds_read_b64_tr_b16 v[128:129], v49 offset:49152
    buffer_load_dwordx4 v[176:179], v24, s[72:75], s0 offen offset:3072 sc1
    v_mfma_f32_16x16x32_bf16 v[88:91], a[140:143], a[184:187], v[88:91]
    ds_read_b64_tr_b16 v[130:131], v49 offset:53248
    buffer_load_dwordx4 v[180:183], v41, s[72:75], s0 offen sc1
    v_mfma_f32_16x16x32_bf16 v[92:95], a[136:139], a[172:175], v[92:95]
    ds_read_b64_tr_b16 v[132:133], v49 offset:57344
    s_add_u32 s0, s0, 163840
    v_mfma_f32_16x16x32_bf16 v[92:95], a[140:143], a[188:191], v[92:95]
    ds_read_b64_tr_b16 v[134:135], v49 offset:61440
    v_mfma_f32_16x16x32_bf16 v[96:99], a[144:147], a[160:163], v[96:99]
    ds_read_b64_tr_b16 a[136:137], v47 offset:49152
    buffer_load_dwordx4 v[184:187], v24, s[72:75], s0 offen offset:0 sc1
    v_mfma_f32_16x16x32_bf16 v[96:99], a[148:151], a[176:179], v[96:99]
    ds_read_b64_tr_b16 a[138:139], v47 offset:53248
    buffer_load_dwordx4 v[188:191], v24, s[72:75], s0 offen offset:1024 sc1
    v_mfma_f32_16x16x32_bf16 v[100:103], a[144:147], a[164:167], v[100:103]
    ds_read_b64_tr_b16 a[140:141], v47 offset:57344
    buffer_load_dwordx4 v[192:195], v24, s[72:75], s0 offen offset:2048 sc1
    v_mfma_f32_16x16x32_bf16 v[100:103], a[148:151], a[180:183], v[100:103]
    ds_read_b64_tr_b16 a[142:143], v47 offset:61440
    v_mfma_f32_16x16x32_bf16 v[104:107], a[144:147], a[168:171], v[104:107]
    buffer_load_dwordx4 v[196:199], v24, s[72:75], s0 offen offset:3072 sc1
    v_mfma_f32_16x16x32_bf16 v[104:107], a[148:151], a[184:187], v[104:107]
    buffer_load_dwordx4 v[200:203], v41, s[72:75], s0 offen sc1
    v_mfma_f32_16x16x32_bf16 v[108:111], a[144:147], a[172:175], v[108:111]
    s_add_u32 s0, s0, 163840
    v_mfma_f32_16x16x32_bf16 v[108:111], a[148:151], a[188:191], v[108:111]
    v_mfma_f32_16x16x32_bf16 v[112:115], a[152:155], a[160:163], v[112:115]
    ds_read_b64_tr_b16 a[144:145], v48 offset:49152
    buffer_load_dwordx4 v[204:207], v24, s[72:75], s0 offen offset:0 sc1
    v_mfma_f32_16x16x32_bf16 v[112:115], a[156:159], a[176:179], v[112:115]
    ds_read_b64_tr_b16 a[146:147], v48 offset:53248
    buffer_load_dwordx4 v[208:211], v24, s[72:75], s0 offen offset:1024 sc1
    v_mfma_f32_16x16x32_bf16 v[116:119], a[152:155], a[164:167], v[116:119]
    ds_read_b64_tr_b16 a[148:149], v48 offset:57344
    buffer_load_dwordx4 v[212:215], v24, s[72:75], s0 offen offset:2048 sc1
    v_mfma_f32_16x16x32_bf16 v[116:119], a[156:159], a[180:183], v[116:119]
    ds_read_b64_tr_b16 a[150:151], v48 offset:61440
    v_mfma_f32_16x16x32_bf16 v[120:123], a[152:155], a[168:171], v[120:123]
    buffer_load_dwordx4 v[216:219], v24, s[72:75], s0 offen offset:3072 sc1
    v_mfma_f32_16x16x32_bf16 v[120:123], a[156:159], a[184:187], v[120:123]
    buffer_load_dwordx4 v[220:223], v41, s[72:75], s0 offen sc1
    v_mfma_f32_16x16x32_bf16 v[124:127], a[152:155], a[172:175], v[124:127]
    s_add_u32 s0, s0, 163840
    v_mfma_f32_16x16x32_bf16 v[124:127], a[156:159], a[188:191], v[124:127]
    s_waitcnt lgkmcnt(0)
    s_barrier
    v_mfma_f32_16x16x32_bf16 v[64:67], a[128:131], v[224:227], v[64:67]
    s_lshl_b32 s31, s76, 14
    s_mov_b32 s1, 0
    s_lshl_b32 s81, s28, 7
    v_mfma_f32_16x16x32_bf16 v[64:67], a[132:135], v[240:243], v[64:67]
    s_lshl_b32 s82, s76, 5
    s_add_u32 s81, s81, s82
    v_mfma_f32_16x16x32_bf16 v[68:71], a[128:131], v[228:231], v[68:71]
    v_lshlrev_b32 v6, 1, v2
    v_mfma_f32_16x16x32_bf16 v[68:71], a[132:135], v[244:247], v[68:71]
    v_mov_b32 v40, v17
    v_mfma_f32_16x16x32_bf16 v[72:75], a[128:131], v[232:235], v[72:75]
    buffer_load_ushort v42, v6, s[64:67], s81 offen
    v_mfma_f32_16x16x32_bf16 v[72:75], a[132:135], v[248:251], v[72:75]
    s_add_u32 m0, s31, 0
    s_nop 0
    v_mfma_f32_16x16x32_bf16 v[76:79], a[128:131], v[236:239], v[76:79]
    buffer_load_dwordx4 v32, s[56:59], s1 offen offset:0 lds
    v_mfma_f32_16x16x32_bf16 v[76:79], a[132:135], v[252:255], v[76:79]
    buffer_load_dwordx4 v33, s[56:59], s1 offen offset:1024 lds
    v_mfma_f32_16x16x32_bf16 v[80:83], a[136:139], v[224:227], v[80:83]
    buffer_load_dwordx4 v34, s[56:59], s1 offen offset:2048 lds
    buffer_load_dwordx4 v35, s[56:59], s1 offen offset:3072 lds
    v_mfma_f32_16x16x32_bf16 v[80:83], a[140:143], v[240:243], v[80:83]
    s_add_u32 s1, s1, 524288
    v_mfma_f32_16x16x32_bf16 v[84:87], a[136:139], v[228:231], v[84:87]
    s_add_u32 m0, s31, 4096
    s_nop 0
    v_mfma_f32_16x16x32_bf16 v[84:87], a[140:143], v[244:247], v[84:87]
    buffer_load_dwordx4 v32, s[56:59], s1 offen offset:0 lds
    v_mfma_f32_16x16x32_bf16 v[88:91], a[136:139], v[232:235], v[88:91]
    buffer_load_dwordx4 v33, s[56:59], s1 offen offset:1024 lds
    v_mfma_f32_16x16x32_bf16 v[88:91], a[140:143], v[248:251], v[88:91]
    buffer_load_dwordx4 v34, s[56:59], s1 offen offset:2048 lds
    v_mfma_f32_16x16x32_bf16 v[92:95], a[136:139], v[236:239], v[92:95]
    buffer_load_dwordx4 v35, s[56:59], s1 offen offset:3072 lds
    v_mfma_f32_16x16x32_bf16 v[92:95], a[140:143], v[252:255], v[92:95]
    s_add_u32 s1, s1, 524288
    v_mfma_f32_16x16x32_bf16 v[96:99], a[144:147], v[224:227], v[96:99]
    s_add_u32 m0, s31, 8192
    s_nop 0
    v_mfma_f32_16x16x32_bf16 v[96:99], a[148:151], v[240:243], v[96:99]
    buffer_load_dwordx4 v32, s[56:59], s1 offen offset:0 lds
    v_mfma_f32_16x16x32_bf16 v[100:103], a[144:147], v[228:231], v[100:103]
    buffer_load_dwordx4 v33, s[56:59], s1 offen offset:1024 lds
    v_mfma_f32_16x16x32_bf16 v[100:103], a[148:151], v[244:247], v[100:103]
    v_mfma_f32_16x16x32_bf16 v[104:107], a[144:147], v[232:235], v[104:107]
    buffer_load_dwordx4 v34, s[56:59], s1 offen offset:2048 lds
    v_mfma_f32_16x16x32_bf16 v[104:107], a[148:151], v[248:251], v[104:107]
    buffer_load_dwordx4 v35, s[56:59], s1 offen offset:3072 lds
    v_mfma_f32_16x16x32_bf16 v[108:111], a[144:147], v[236:239], v[108:111]
    s_add_u32 s1, s1, 524288
    v_mfma_f32_16x16x32_bf16 v[108:111], a[148:151], v[252:255], v[108:111]
    v_mfma_f32_16x16x32_bf16 v[112:115], v[128:131], v[224:227], v[112:115]
    s_add_u32 m0, s31, 12288
    s_nop 0
    v_mfma_f32_16x16x32_bf16 v[112:115], v[132:135], v[240:243], v[112:115]
    buffer_load_dwordx4 v32, s[56:59], s1 offen offset:0 lds
    v_mfma_f32_16x16x32_bf16 v[116:119], v[128:131], v[228:231], v[116:119]
    buffer_load_dwordx4 v33, s[56:59], s1 offen offset:1024 lds
    v_mfma_f32_16x16x32_bf16 v[116:119], v[132:135], v[244:247], v[116:119]
    v_mfma_f32_16x16x32_bf16 v[120:123], v[128:131], v[232:235], v[120:123]
    buffer_load_dwordx4 v34, s[56:59], s1 offen offset:2048 lds
    v_mfma_f32_16x16x32_bf16 v[120:123], v[132:135], v[248:251], v[120:123]
    buffer_load_dwordx4 v35, s[56:59], s1 offen offset:3072 lds
    v_mfma_f32_16x16x32_bf16 v[124:127], v[128:131], v[236:239], v[124:127]
    s_add_u32 s1, s1, 524288
    v_mfma_f32_16x16x32_bf16 v[124:127], v[132:135], v[252:255], v[124:127]
    s_cmp_eq_u32 s95, 2
    s_cbranch_scc1 L_epim
L_p2go:
    s_lshl_b32 s81, s95, 7
    s_lshl_b32 s82, s96, 3
    s_add_u32 s81, s81, s82
    s_lshr_b32 s82, s76, 1
    s_lshl_b32 s82, s82, 2
    s_add_u32 s81, s81, s82
    s_mul_i32 s81, s81, 20480
    s_lshl_b32 s82, s97, 12
    s_add_u32 s81, s81, s82
    s_and_b32 s82, s76, 1
    s_lshl_b32 s82, s82, 11
    s_add_u32 s81, s81, s82
    s_add_u32 s81, s81, 29360128
    s_cmp_lt_u32 s95, 2
    s_cselect_b32 s88, s81, 0x40000000
    v_cvt_pk_bf16_f32 v224, v64, v65
    v_cvt_pk_bf16_f32 v225, v66, v67
    v_cvt_pk_bf16_f32 v226, v80, v81
    v_cvt_pk_bf16_f32 v227, v82, v83
    v_cvt_pk_bf16_f32 v228, v96, v97
    v_cvt_pk_bf16_f32 v229, v98, v99
    v_cvt_pk_bf16_f32 v230, v112, v113
    v_cvt_pk_bf16_f32 v231, v114, v115
    v_cvt_pk_bf16_f32 v232, v68, v69
    v_cvt_pk_bf16_f32 v233, v70, v71
    v_cvt_pk_bf16_f32 v234, v84, v85
    v_cvt_pk_bf16_f32 v235, v86, v87
    v_cvt_pk_bf16_f32 v236, v100, v101
    v_cvt_pk_bf16_f32 v237, v102, v103
    v_cvt_pk_bf16_f32 v238, v116, v117
    v_cvt_pk_bf16_f32 v239, v118, v119
    v_cvt_pk_bf16_f32 v240, v72, v73
    v_cvt_pk_bf16_f32 v241, v74, v75
    v_cvt_pk_bf16_f32 v242, v88, v89
    v_cvt_pk_bf16_f32 v243, v90, v91
    v_cvt_pk_bf16_f32 v244, v104, v105
    v_cvt_pk_bf16_f32 v245, v106, v107
    v_cvt_pk_bf16_f32 v246, v120, v121
    v_cvt_pk_bf16_f32 v247, v122, v123
    v_cvt_pk_bf16_f32 v248, v76, v77
    v_cvt_pk_bf16_f32 v249, v78, v79
    v_cvt_pk_bf16_f32 v250, v92, v93
    v_cvt_pk_bf16_f32 v251, v94, v95
    v_cvt_pk_bf16_f32 v252, v108, v109
    v_cvt_pk_bf16_f32 v253, v110, v111
    v_cvt_pk_bf16_f32 v254, v124, v125
    v_cvt_pk_bf16_f32 v255, v126, v127
    s_waitcnt vmcnt(12)
    ds_read_b64_tr_b16 a[128:129], v36 offset:0
    ds_read_b64_tr_b16 a[130:131], v36 offset:2048
    ds_read_b64_tr_b16 a[132:133], v37 offset:0
    ds_read_b64_tr_b16 a[134:135], v37 offset:2048
    ds_read_b64_tr_b16 a[136:137], v38 offset:0
    ds_read_b64_tr_b16 a[138:139], v38 offset:2048
    ds_read_b64_tr_b16 a[140:141], v39 offset:0
    ds_read_b64_tr_b16 a[142:143], v39 offset:2048
    s_waitcnt vmcnt(8) lgkmcnt(0)
    v_mfma_f32_16x16x32_bf16 v[64:67], v[144:147], a[128:131], 0
    ds_read_b64_tr_b16 a[144:145], v36 offset:4096
    v_mfma_f32_16x16x32_bf16 v[84:87], v[144:147], a[132:135], 0
    ds_read_b64_tr_b16 a[146:147], v36 offset:6144
    v_mfma_f32_16x16x32_bf16 v[104:107], v[144:147], a[136:139], 0
    ds_read_b64_tr_b16 a[148:149], v37 offset:4096
    buffer_store_dwordx4 v[224:227], v50, s[72:75], s88 offen offset:0 sc1
    v_mfma_f32_16x16x32_bf16 v[124:127], v[144:147], a[140:143], 0
    ds_read_b64_tr_b16 a[150:151], v37 offset:6144
    v_mfma_f32_16x16x32_bf16 v[68:71], v[148:151], a[128:131], 0
    buffer_load_dwordx4 v[144:147], v24, s[72:75], s0 offen offset:0 sc1
    v_mfma_f32_16x16x32_bf16 v[88:91], v[148:151], a[132:135], 0
    ds_read_b64_tr_b16 a[152:153], v38 offset:4096
    v_mfma_f32_16x16x32_bf16 v[108:111], v[148:151], a[136:139], 0
    ds_read_b64_tr_b16 a[154:155], v38 offset:6144
    v_mfma_f32_16x16x32_bf16 v[128:131], v[148:151], a[140:143], 0
    ds_read_b64_tr_b16 a[156:157], v39 offset:4096
    v_mfma_f32_16x16x32_bf16 v[72:75], v[152:155], a[128:131], 0
    ds_read_b64_tr_b16 a[158:159], v39 offset:6144
    buffer_store_dwordx4 v[228:231], v50, s[72:75], s88 offen offset:1024 sc1
    buffer_load_dwordx4 v[148:151], v24, s[72:75], s0 offen offset:1024 sc1
    v_mfma_f32_16x16x32_bf16 v[92:95], v[152:155], a[132:135], 0
    v_mfma_f32_16x16x32_bf16 v[112:115], v[152:155], a[136:139], 0
    v_mfma_f32_16x16x32_bf16 v[132:135], v[152:155], a[140:143], 0
    v_mfma_f32_16x16x32_bf16 v[76:79], v[156:159], a[128:131], 0
    buffer_load_dwordx4 v[152:155], v24, s[72:75], s0 offen offset:2048 sc1
    v_mfma_f32_16x16x32_bf16 v[96:99], v[156:159], a[132:135], 0
    v_mfma_f32_16x16x32_bf16 v[116:119], v[156:159], a[136:139], 0
    s_add_u32 s88, s88, 20480
    v_mfma_f32_16x16x32_bf16 v[136:139], v[156:159], a[140:143], 0
    v_mfma_f32_16x16x32_bf16 v[80:83], v[160:163], a[128:131], 0
    buffer_load_dwordx4 v[156:159], v24, s[72:75], s0 offen offset:3072 sc1
    v_mfma_f32_16x16x32_bf16 v[100:103], v[160:163], a[132:135], 0
    v_mfma_f32_16x16x32_bf16 v[120:123], v[160:163], a[136:139], 0
    v_mfma_f32_16x16x32_bf16 v[140:143], v[160:163], a[140:143], 0
    buffer_load_dwordx4 v[160:163], v41, s[72:75], s0 offen sc1
    s_add_u32 s0, s0, 163840
    s_waitcnt vmcnt(11) lgkmcnt(0)
    v_mfma_f32_16x16x32_bf16 v[64:67], v[164:167], a[144:147], v[64:67]
    ds_read_b64_tr_b16 a[128:129], v36 offset:8192
    v_mfma_f32_16x16x32_bf16 v[84:87], v[164:167], a[148:151], v[84:87]
    ds_read_b64_tr_b16 a[130:131], v36 offset:10240
    v_mfma_f32_16x16x32_bf16 v[104:107], v[164:167], a[152:155], v[104:107]
    ds_read_b64_tr_b16 a[132:133], v37 offset:8192
    buffer_store_dwordx4 v[232:235], v50, s[72:75], s88 offen offset:0 sc1
    v_mfma_f32_16x16x32_bf16 v[124:127], v[164:167], a[156:159], v[124:127]
    ds_read_b64_tr_b16 a[134:135], v37 offset:10240
    v_mfma_f32_16x16x32_bf16 v[68:71], v[168:171], a[144:147], v[68:71]
    buffer_load_dwordx4 v[164:167], v24, s[72:75], s0 offen offset:0 sc1
    v_mfma_f32_16x16x32_bf16 v[88:91], v[168:171], a[148:151], v[88:91]
    ds_read_b64_tr_b16 a[136:137], v38 offset:8192
    v_mfma_f32_16x16x32_bf16 v[108:111], v[168:171], a[152:155], v[108:111]
    ds_read_b64_tr_b16 a[138:139], v38 offset:10240
    v_mfma_f32_16x16x32_bf16 v[128:131], v[168:171], a[156:159], v[128:131]
    ds_read_b64_tr_b16 a[140:141], v39 offset:8192
    v_mfma_f32_16x16x32_bf16 v[72:75], v[172:175], a[144:147], v[72:75]
    ds_read_b64_tr_b16 a[142:143], v39 offset:10240
    buffer_store_dwordx4 v[236:239], v50, s[72:75], s88 offen offset:1024 sc1
    buffer_load_dwordx4 v[168:171], v24, s[72:75], s0 offen offset:1024 sc1
    v_mfma_f32_16x16x32_bf16 v[92:95], v[172:175], a[148:151], v[92:95]
    v_mfma_f32_16x16x32_bf16 v[112:115], v[172:175], a[152:155], v[112:115]
    v_mfma_f32_16x16x32_bf16 v[132:135], v[172:175], a[156:159], v[132:135]
    v_mfma_f32_16x16x32_bf16 v[76:79], v[176:179], a[144:147], v[76:79]
    buffer_load_dwordx4 v[172:175], v24, s[72:75], s0 offen offset:2048 sc1
    v_mfma_f32_16x16x32_bf16 v[96:99], v[176:179], a[148:151], v[96:99]
    v_mfma_f32_16x16x32_bf16 v[116:119], v[176:179], a[152:155], v[116:119]
    s_add_u32 s88, s88, 20480
    v_mfma_f32_16x16x32_bf16 v[136:139], v[176:179], a[156:159], v[136:139]
    v_mfma_f32_16x16x32_bf16 v[80:83], v[180:183], a[144:147], v[80:83]
    buffer_load_dwordx4 v[176:179], v24, s[72:75], s0 offen offset:3072 sc1
    v_mfma_f32_16x16x32_bf16 v[100:103], v[180:183], a[148:151], v[100:103]
    v_mfma_f32_16x16x32_bf16 v[120:123], v[180:183], a[152:155], v[120:123]
    v_mfma_f32_16x16x32_bf16 v[140:143], v[180:183], a[156:159], v[140:143]
    buffer_load_dwordx4 v[180:183], v41, s[72:75], s0 offen sc1
    s_add_u32 s0, s0, 163840
    s_waitcnt vmcnt(14) lgkmcnt(0)
    v_mfma_f32_16x16x32_bf16 v[64:67], v[184:187], a[128:131], v[64:67]
    ds_read_b64_tr_b16 a[144:145], v36 offset:12288
    v_mfma_f32_16x16x32_bf16 v[84:87], v[184:187], a[132:135], v[84:87]
    ds_read_b64_tr_b16 a[146:147], v36 offset:14336
    v_mfma_f32_16x16x32_bf16 v[104:107], v[184:187], a[136:139], v[104:107]
    ds_read_b64_tr_b16 a[148:149], v37 offset:12288
    buffer_store_dwordx4 v[240:243], v50, s[72:75], s88 offen offset:0 sc1
    v_mfma_f32_16x16x32_bf16 v[124:127], v[184:187], a[140:143], v[124:127]
    ds_read_b64_tr_b16 a[150:151], v37 offset:14336
    v_mfma_f32_16x16x32_bf16 v[68:71], v[188:191], a[128:131], v[68:71]
    buffer_load_dwordx4 v[184:187], v24, s[72:75], s0 offen offset:0 sc1
    v_mfma_f32_16x16x32_bf16 v[88:91], v[188:191], a[132:135], v[88:91]
    ds_read_b64_tr_b16 a[152:153], v38 offset:12288
    v_mfma_f32_16x16x32_bf16 v[108:111], v[188:191], a[136:139], v[108:111]
    ds_read_b64_tr_b16 a[154:155], v38 offset:14336
    v_mfma_f32_16x16x32_bf16 v[128:131], v[188:191], a[140:143], v[128:131]
    ds_read_b64_tr_b16 a[156:157], v39 offset:12288
    v_mfma_f32_16x16x32_bf16 v[72:75], v[192:195], a[128:131], v[72:75]
    ds_read_b64_tr_b16 a[158:159], v39 offset:14336
    buffer_store_dwordx4 v[244:247], v50, s[72:75], s88 offen offset:1024 sc1
    buffer_load_dwordx4 v[188:191], v24, s[72:75], s0 offen offset:1024 sc1
    v_mfma_f32_16x16x32_bf16 v[92:95], v[192:195], a[132:135], v[92:95]
    v_mfma_f32_16x16x32_bf16 v[112:115], v[192:195], a[136:139], v[112:115]
    v_mfma_f32_16x16x32_bf16 v[132:135], v[192:195], a[140:143], v[132:135]
    v_mfma_f32_16x16x32_bf16 v[76:79], v[196:199], a[128:131], v[76:79]
    buffer_load_dwordx4 v[192:195], v24, s[72:75], s0 offen offset:2048 sc1
    v_mfma_f32_16x16x32_bf16 v[96:99], v[196:199], a[132:135], v[96:99]
    v_mfma_f32_16x16x32_bf16 v[116:119], v[196:199], a[136:139], v[116:119]
    s_add_u32 s88, s88, 20480
    v_mfma_f32_16x16x32_bf16 v[136:139], v[196:199], a[140:143], v[136:139]
    v_mfma_f32_16x16x32_bf16 v[80:83], v[200:203], a[128:131], v[80:83]
    buffer_load_dwordx4 v[196:199], v24, s[72:75], s0 offen offset:3072 sc1
    v_mfma_f32_16x16x32_bf16 v[100:103], v[200:203], a[132:135], v[100:103]
    v_mfma_f32_16x16x32_bf16 v[120:123], v[200:203], a[136:139], v[120:123]
    v_mfma_f32_16x16x32_bf16 v[140:143], v[200:203], a[140:143], v[140:143]
    buffer_load_dwordx4 v[200:203], v41, s[72:75], s0 offen sc1
    s_add_u32 s0, s0, 163840
    s_waitcnt vmcnt(38) lgkmcnt(0)
    v_mfma_f32_16x16x32_bf16 v[64:67], v[204:207], a[144:147], v[64:67]
    v_mfma_f32_16x16x32_bf16 v[84:87], v[204:207], a[148:151], v[84:87]
    v_mfma_f32_16x16x32_bf16 v[104:107], v[204:207], a[152:155], v[104:107]
    buffer_store_dwordx4 v[248:251], v50, s[72:75], s88 offen offset:0 sc1
    v_mfma_f32_16x16x32_bf16 v[124:127], v[204:207], a[156:159], v[124:127]
    v_mfma_f32_16x16x32_bf16 v[68:71], v[208:211], a[144:147], v[68:71]
    buffer_load_dwordx4 v[204:207], v24, s[72:75], s0 offen offset:0 sc1
    v_mfma_f32_16x16x32_bf16 v[88:91], v[208:211], a[148:151], v[88:91]
    v_mfma_f32_16x16x32_bf16 v[108:111], v[208:211], a[152:155], v[108:111]
    v_mfma_f32_16x16x32_bf16 v[128:131], v[208:211], a[156:159], v[128:131]
    v_mfma_f32_16x16x32_bf16 v[72:75], v[212:215], a[144:147], v[72:75]
    buffer_store_dwordx4 v[252:255], v50, s[72:75], s88 offen offset:1024 sc1
    buffer_load_dwordx4 v[208:211], v24, s[72:75], s0 offen offset:1024 sc1
    v_mfma_f32_16x16x32_bf16 v[92:95], v[212:215], a[148:151], v[92:95]
    v_mfma_f32_16x16x32_bf16 v[112:115], v[212:215], a[152:155], v[112:115]
    v_mfma_f32_16x16x32_bf16 v[132:135], v[212:215], a[156:159], v[132:135]
    v_mfma_f32_16x16x32_bf16 v[76:79], v[216:219], a[144:147], v[76:79]
    buffer_load_dwordx4 v[212:215], v24, s[72:75], s0 offen offset:2048 sc1
    v_mfma_f32_16x16x32_bf16 v[96:99], v[216:219], a[148:151], v[96:99]
    v_mfma_f32_16x16x32_bf16 v[116:119], v[216:219], a[152:155], v[116:119]
    s_add_u32 s88, s88, 20480
    v_mfma_f32_16x16x32_bf16 v[136:139], v[216:219], a[156:159], v[136:139]
    v_mfma_f32_16x16x32_bf16 v[80:83], v[220:223], a[144:147], v[80:83]
    buffer_load_dwordx4 v[216:219], v24, s[72:75], s0 offen offset:3072 sc1
    v_mfma_f32_16x16x32_bf16 v[100:103], v[220:223], a[148:151], v[100:103]
    v_mfma_f32_16x16x32_bf16 v[120:123], v[220:223], a[152:155], v[120:123]
    v_mfma_f32_16x16x32_bf16 v[140:143], v[220:223], a[156:159], v[140:143]
    buffer_load_dwordx4 v[220:223], v41, s[72:75], s0 offen sc1
    s_add_u32 s0, s0, 163840
    s_waitcnt vmcnt(21) lgkmcnt(0)
    v_mfma_f32_16x16x32_bf16 v[64:67], v[144:147], a[0:3], v[64:67]
    v_mfma_f32_16x16x32_bf16 v[84:87], v[144:147], a[4:7], v[84:87]
    v_mfma_f32_16x16x32_bf16 v[104:107], v[144:147], a[8:11], v[104:107]
    v_mfma_f32_16x16x32_bf16 v[124:127], v[144:147], a[12:15], v[124:127]
    v_mfma_f32_16x16x32_bf16 v[68:71], v[148:151], a[0:3], v[68:71]
    buffer_load_dwordx4 v[144:147], v24, s[72:75], s0 offen offset:0 sc1
    v_mfma_f32_16x16x32_bf16 v[88:91], v[148:151], a[4:7], v[88:91]
    v_mfma_f32_16x16x32_bf16 v[108:111], v[148:151], a[8:11], v[108:111]
    v_mfma_f32_16x16x32_bf16 v[128:131], v[148:151], a[12:15], v[128:131]
    v_mfma_f32_16x16x32_bf16 v[72:75], v[152:155], a[0:3], v[72:75]
    buffer_load_dwordx4 v[148:151], v24, s[72:75], s0 offen offset:1024 sc1
    v_mfma_f32_16x16x32_bf16 v[92:95], v[152:155], a[4:7], v[92:95]
    v_mfma_f32_16x16x32_bf16 v[112:115], v[152:155], a[8:11], v[112:115]
    v_mfma_f32_16x16x32_bf16 v[132:135], v[152:155], a[12:15], v[132:135]
    v_mfma_f32_16x16x32_bf16 v[76:79], v[156:159], a[0:3], v[76:79]
    buffer_load_dwordx4 v[152:155], v24, s[72:75], s0 offen offset:2048 sc1
    v_mfma_f32_16x16x32_bf16 v[96:99], v[156:159], a[4:7], v[96:99]
    v_mfma_f32_16x16x32_bf16 v[116:119], v[156:159], a[8:11], v[116:119]
    v_mfma_f32_16x16x32_bf16 v[136:139], v[156:159], a[12:15], v[136:139]
    v_mfma_f32_16x16x32_bf16 v[80:83], v[160:163], a[0:3], v[80:83]
    buffer_load_dwordx4 v[156:159], v24, s[72:75], s0 offen offset:3072 sc1
    v_mfma_f32_16x16x32_bf16 v[100:103], v[160:163], a[4:7], v[100:103]
    v_mfma_f32_16x16x32_bf16 v[120:123], v[160:163], a[8:11], v[120:123]
    v_mfma_f32_16x16x32_bf16 v[140:143], v[160:163], a[12:15], v[140:143]
    buffer_load_dwordx4 v[160:163], v41, s[72:75], s0 offen sc1
    s_add_u32 s0, s0, 163840
    s_waitcnt vmcnt(19) lgkmcnt(0)
    v_mfma_f32_16x16x32_bf16 v[64:67], v[164:167], a[16:19], v[64:67]
    v_mfma_f32_16x16x32_bf16 v[84:87], v[164:167], a[20:23], v[84:87]
    v_mfma_f32_16x16x32_bf16 v[104:107], v[164:167], a[24:27], v[104:107]
    buffer_load_dwordx4 v[224:227], v26, s[32:35], 0 offen
    v_mfma_f32_16x16x32_bf16 v[124:127], v[164:167], a[28:31], v[124:127]
    v_mfma_f32_16x16x32_bf16 v[68:71], v[168:171], a[16:19], v[68:71]
    buffer_load_dwordx4 v[164:167], v24, s[72:75], s0 offen offset:0 sc1
    v_mfma_f32_16x16x32_bf16 v[88:91], v[168:171], a[20:23], v[88:91]
    v_mfma_f32_16x16x32_bf16 v[108:111], v[168:171], a[24:27], v[108:111]
    v_mfma_f32_16x16x32_bf16 v[128:131], v[168:171], a[28:31], v[128:131]
    v_mfma_f32_16x16x32_bf16 v[72:75], v[172:175], a[16:19], v[72:75]
    buffer_load_dwordx4 v[228:231], v27, s[32:35], 0 offen
    buffer_load_dwordx4 v[168:171], v24, s[72:75], s0 offen offset:1024 sc1
    v_mfma_f32_16x16x32_bf16 v[92:95], v[172:175], a[20:23], v[92:95]
    v_mfma_f32_16x16x32_bf16 v[112:115], v[172:175], a[24:27], v[112:115]
    v_mfma_f32_16x16x32_bf16 v[132:135], v[172:175], a[28:31], v[132:135]
    v_mfma_f32_16x16x32_bf16 v[76:79], v[176:179], a[16:19], v[76:79]
    buffer_load_dwordx4 v[172:175], v24, s[72:75], s0 offen offset:2048 sc1
    v_mfma_f32_16x16x32_bf16 v[96:99], v[176:179], a[20:23], v[96:99]
    v_mfma_f32_16x16x32_bf16 v[116:119], v[176:179], a[24:27], v[116:119]
    s_mov_b32 exec_hi, 0
    buffer_load_dwordx4 v[232:235], v28, s[32:35], 0 offen
    s_mov_b32 exec_hi, -1
    v_mfma_f32_16x16x32_bf16 v[136:139], v[176:179], a[28:31], v[136:139]
    v_mfma_f32_16x16x32_bf16 v[80:83], v[180:183], a[16:19], v[80:83]
    buffer_load_dwordx4 v[176:179], v24, s[72:75], s0 offen offset:3072 sc1
    v_mfma_f32_16x16x32_bf16 v[100:103], v[180:183], a[20:23], v[100:103]
    v_mfma_f32_16x16x32_bf16 v[120:123], v[180:183], a[24:27], v[120:123]
    v_mfma_f32_16x16x32_bf16 v[140:143], v[180:183], a[28:31], v[140:143]
    buffer_load_dwordx4 v[180:183], v41, s[72:75], s0 offen sc1
    s_add_u32 s0, s0, 163840
    s_waitcnt vmcnt(20) lgkmcnt(0)
    v_mfma_f32_16x16x32_bf16 v[64:67], v[184:187], a[32:35], v[64:67]
    v_mfma_f32_16x16x32_bf16 v[84:87], v[184:187], a[36:39], v[84:87]
    v_mfma_f32_16x16x32_bf16 v[104:107], v[184:187], a[40:43], v[104:107]
    v_mfma_f32_16x16x32_bf16 v[124:127], v[184:187], a[44:47], v[124:127]
    v_mfma_f32_16x16x32_bf16 v[68:71], v[188:191], a[32:35], v[68:71]
    buffer_load_dwordx4 v[184:187], v24, s[72:75], s0 offen offset:0 sc1
    v_mfma_f32_16x16x32_bf16 v[88:91], v[188:191], a[36:39], v[88:91]
    v_mfma_f32_16x16x32_bf16 v[108:111], v[188:191], a[40:43], v[108:111]
    v_mfma_f32_16x16x32_bf16 v[128:131], v[188:191], a[44:47], v[128:131]
    v_mfma_f32_16x16x32_bf16 v[72:75], v[192:195], a[32:35], v[72:75]
    buffer_load_dwordx4 v[188:191], v24, s[72:75], s0 offen offset:1024 sc1
    v_mfma_f32_16x16x32_bf16 v[92:95], v[192:195], a[36:39], v[92:95]
    v_mfma_f32_16x16x32_bf16 v[112:115], v[192:195], a[40:43], v[112:115]
    v_mfma_f32_16x16x32_bf16 v[132:135], v[192:195], a[44:47], v[132:135]
    v_mfma_f32_16x16x32_bf16 v[76:79], v[196:199], a[32:35], v[76:79]
    buffer_load_dwordx4 v[192:195], v24, s[72:75], s0 offen offset:2048 sc1
    v_mfma_f32_16x16x32_bf16 v[96:99], v[196:199], a[36:39], v[96:99]
    v_mfma_f32_16x16x32_bf16 v[116:119], v[196:199], a[40:43], v[116:119]
    v_mfma_f32_16x16x32_bf16 v[136:139], v[196:199], a[44:47], v[136:139]
    v_mfma_f32_16x16x32_bf16 v[80:83], v[200:203], a[32:35], v[80:83]
    buffer_load_dwordx4 v[196:199], v24, s[72:75], s0 offen offset:3072 sc1
    v_mfma_f32_16x16x32_bf16 v[100:103], v[200:203], a[36:39], v[100:103]
    v_mfma_f32_16x16x32_bf16 v[120:123], v[200:203], a[40:43], v[120:123]
    v_mfma_f32_16x16x32_bf16 v[140:143], v[200:203], a[44:47], v[140:143]
    buffer_load_dwordx4 v[200:203], v41, s[72:75], s0 offen sc1
    s_add_u32 s0, s0, 163840
    s_waitcnt vmcnt(18) lgkmcnt(0)
    s_barrier
    s_lshl_b32 s83, s96, 8
    s_add_u32 s83, s83, 35655680
    s_cmp_lt_u32 s95, 2
    s_cselect_b32 s83, s83, 0x40000000
    s_cmp_eq_u32 s76, 0
    s_cselect_b32 s83, s83, 0x40000000
    v_mov_b32 v7, 1
    s_mov_b64 exec, 1
    buffer_atomic_add v7, off, s[72:75], s83
    s_mov_b64 exec, -1
    v_mfma_f32_16x16x32_bf16 v[64:67], v[204:207], a[48:51], v[64:67]
    v_mfma_f32_16x16x32_bf16 v[84:87], v[204:207], a[52:55], v[84:87]
    v_mfma_f32_16x16x32_bf16 v[104:107], v[204:207], a[56:59], v[104:107]
    v_mfma_f32_16x16x32_bf16 v[124:127], v[204:207], a[60:63], v[124:127]
    v_mfma_f32_16x16x32_bf16 v[68:71], v[208:211], a[48:51], v[68:71]
    buffer_load_dwordx4 v[204:207], v24, s[72:75], s0 offen offset:0 sc1
    v_mfma_f32_16x16x32_bf16 v[88:91], v[208:211], a[52:55], v[88:91]
    v_mfma_f32_16x16x32_bf16 v[108:111], v[208:211], a[56:59], v[108:111]
    v_mfma_f32_16x16x32_bf16 v[128:131], v[208:211], a[60:63], v[128:131]
    v_mfma_f32_16x16x32_bf16 v[72:75], v[212:215], a[48:51], v[72:75]
    buffer_load_dwordx4 v[208:211], v24, s[72:75], s0 offen offset:1024 sc1
    v_mfma_f32_16x16x32_bf16 v[92:95], v[212:215], a[52:55], v[92:95]
    v_mfma_f32_16x16x32_bf16 v[112:115], v[212:215], a[56:59], v[112:115]
    v_mfma_f32_16x16x32_bf16 v[132:135], v[212:215], a[60:63], v[132:135]
    v_mfma_f32_16x16x32_bf16 v[76:79], v[216:219], a[48:51], v[76:79]
    buffer_load_dwordx4 v[212:215], v24, s[72:75], s0 offen offset:2048 sc1
    v_mfma_f32_16x16x32_bf16 v[96:99], v[216:219], a[52:55], v[96:99]
    v_mfma_f32_16x16x32_bf16 v[116:119], v[216:219], a[56:59], v[116:119]
    v_mfma_f32_16x16x32_bf16 v[136:139], v[216:219], a[60:63], v[136:139]
    v_mfma_f32_16x16x32_bf16 v[80:83], v[220:223], a[48:51], v[80:83]
    buffer_load_dwordx4 v[216:219], v24, s[72:75], s0 offen offset:3072 sc1
    v_mfma_f32_16x16x32_bf16 v[100:103], v[220:223], a[52:55], v[100:103]
    v_mfma_f32_16x16x32_bf16 v[120:123], v[220:223], a[56:59], v[120:123]
    v_mfma_f32_16x16x32_bf16 v[140:143], v[220:223], a[60:63], v[140:143]
    buffer_load_dwordx4 v[220:223], v41, s[72:75], s0 offen sc1
    s_add_u32 s0, s0, 163840
    s_waitcnt vmcnt(19) lgkmcnt(0)
    v_mfma_f32_16x16x32_bf16 v[64:67], v[144:147], a[64:67], v[64:67]
    v_mfma_f32_16x16x32_bf16 v[84:87], v[144:147], a[68:71], v[84:87]
    v_mfma_f32_16x16x32_bf16 v[104:107], v[144:147], a[72:75], v[104:107]
    v_mfma_f32_16x16x32_bf16 v[124:127], v[144:147], a[76:79], v[124:127]
    v_mfma_f32_16x16x32_bf16 v[68:71], v[148:151], a[64:67], v[68:71]
    buffer_load_dwordx4 v[144:147], v24, s[72:75], s0 offen offset:0 sc1
    v_mfma_f32_16x16x32_bf16 v[88:91], v[148:151], a[68:71], v[88:91]
    v_mfma_f32_16x16x32_bf16 v[108:111], v[148:151], a[72:75], v[108:111]
    v_mfma_f32_16x16x32_bf16 v[128:131], v[148:151], a[76:79], v[128:131]
    v_mfma_f32_16x16x32_bf16 v[72:75], v[152:155], a[64:67], v[72:75]
    buffer_load_dwordx4 v[148:151], v24, s[72:75], s0 offen offset:1024 sc1
    v_mfma_f32_16x16x32_bf16 v[92:95], v[152:155], a[68:71], v[92:95]
    v_mfma_f32_16x16x32_bf16 v[112:115], v[152:155], a[72:75], v[112:115]
    v_mfma_f32_16x16x32_bf16 v[132:135], v[152:155], a[76:79], v[132:135]
    v_mfma_f32_16x16x32_bf16 v[76:79], v[156:159], a[64:67], v[76:79]
    buffer_load_dwordx4 v[152:155], v24, s[72:75], s0 offen offset:2048 sc1
    v_mfma_f32_16x16x32_bf16 v[96:99], v[156:159], a[68:71], v[96:99]
    v_mfma_f32_16x16x32_bf16 v[116:119], v[156:159], a[72:75], v[116:119]
    v_mfma_f32_16x16x32_bf16 v[136:139], v[156:159], a[76:79], v[136:139]
    v_mfma_f32_16x16x32_bf16 v[80:83], v[160:163], a[64:67], v[80:83]
    buffer_load_dwordx4 v[156:159], v24, s[72:75], s0 offen offset:3072 sc1
    v_mfma_f32_16x16x32_bf16 v[100:103], v[160:163], a[68:71], v[100:103]
    v_mfma_f32_16x16x32_bf16 v[120:123], v[160:163], a[72:75], v[120:123]
    v_mfma_f32_16x16x32_bf16 v[140:143], v[160:163], a[76:79], v[140:143]
    buffer_load_dwordx4 v[160:163], v41, s[72:75], s0 offen sc1
    s_add_u32 s0, s0, 163840
    s_waitcnt vmcnt(16) lgkmcnt(0)
    v_mfma_f32_16x16x32_bf16 v[64:67], v[164:167], a[80:83], v[64:67]
    v_mfma_f32_16x16x32_bf16 v[84:87], v[164:167], a[84:87], v[84:87]
    v_mfma_f32_16x16x32_bf16 v[104:107], v[164:167], a[88:91], v[104:107]
    ds_write_b128 v29, v[224:227]
    v_mfma_f32_16x16x32_bf16 v[124:127], v[164:167], a[92:95], v[124:127]
    v_mfma_f32_16x16x32_bf16 v[68:71], v[168:171], a[80:83], v[68:71]
    buffer_load_dwordx4 v[164:167], v24, s[72:75], s0 offen offset:0 sc1
    v_mfma_f32_16x16x32_bf16 v[88:91], v[168:171], a[84:87], v[88:91]
    v_mfma_f32_16x16x32_bf16 v[108:111], v[168:171], a[88:91], v[108:111]
    v_mfma_f32_16x16x32_bf16 v[128:131], v[168:171], a[92:95], v[128:131]
    v_mfma_f32_16x16x32_bf16 v[72:75], v[172:175], a[80:83], v[72:75]
    ds_write_b128 v30, v[228:231]
    buffer_load_dwordx4 v[168:171], v24, s[72:75], s0 offen offset:1024 sc1
    v_mfma_f32_16x16x32_bf16 v[92:95], v[172:175], a[84:87], v[92:95]
    v_mfma_f32_16x16x32_bf16 v[112:115], v[172:175], a[88:91], v[112:115]
    v_mfma_f32_16x16x32_bf16 v[132:135], v[172:175], a[92:95], v[132:135]
    v_mfma_f32_16x16x32_bf16 v[76:79], v[176:179], a[80:83], v[76:79]
    buffer_load_dwordx4 v[172:175], v24, s[72:75], s0 offen offset:2048 sc1
    v_mfma_f32_16x16x32_bf16 v[96:99], v[176:179], a[84:87], v[96:99]
    v_mfma_f32_16x16x32_bf16 v[116:119], v[176:179], a[88:91], v[116:119]
    s_mov_b32 exec_hi, 0
    ds_write_b128 v31, v[232:235]
    s_mov_b32 exec_hi, -1
    v_mfma_f32_16x16x32_bf16 v[136:139], v[176:179], a[92:95], v[136:139]
    v_mfma_f32_16x16x32_bf16 v[80:83], v[180:183], a[80:83], v[80:83]
    buffer_load_dwordx4 v[176:179], v24, s[72:75], s0 offen offset:3072 sc1
    v_mfma_f32_16x16x32_bf16 v[100:103], v[180:183], a[84:87], v[100:103]
    v_mfma_f32_16x16x32_bf16 v[120:123], v[180:183], a[88:91], v[120:123]
    v_mfma_f32_16x16x32_bf16 v[140:143], v[180:183], a[92:95], v[140:143]
    buffer_load_dwordx4 v[180:183], v41, s[72:75], s0 offen sc1
    s_add_u32 s0, s0, 163840
    s_waitcnt vmcnt(16) lgkmcnt(0)
    v_mfma_f32_16x16x32_bf16 v[64:67], v[184:187], a[96:99], v[64:67]
    v_mfma_f32_16x16x32_bf16 v[84:87], v[184:187], a[100:103], v[84:87]
    v_mfma_f32_16x16x32_bf16 v[104:107], v[184:187], a[104:107], v[104:107]
    ds_read_b64 v[224:225], v40 offset:0
    v_mfma_f32_16x16x32_bf16 v[124:127], v[184:187], a[108:111], v[124:127]
    v_mfma_f32_16x16x32_bf16 v[68:71], v[188:191], a[96:99], v[68:71]
    v_mfma_f32_16x16x32_bf16 v[88:91], v[188:191], a[100:103], v[88:91]
    ds_read_b64 v[226:227], v40 offset:32
    v_mfma_f32_16x16x32_bf16 v[108:111], v[188:191], a[104:107], v[108:111]
    v_mfma_f32_16x16x32_bf16 v[128:131], v[188:191], a[108:111], v[128:131]
    v_mfma_f32_16x16x32_bf16 v[72:75], v[192:195], a[96:99], v[72:75]
    v_mfma_f32_16x16x32_bf16 v[92:95], v[192:195], a[100:103], v[92:95]
    ds_read_b64 v[228:229], v40 offset:64
    v_mfma_f32_16x16x32_bf16 v[112:115], v[192:195], a[104:107], v[112:115]
    v_mfma_f32_16x16x32_bf16 v[132:135], v[192:195], a[108:111], v[132:135]
    v_mfma_f32_16x16x32_bf16 v[76:79], v[196:199], a[96:99], v[76:79]
    ds_read_b64 v[230:231], v40 offset:96
    v_mfma_f32_16x16x32_bf16 v[96:99], v[196:199], a[100:103], v[96:99]
    v_mfma_f32_16x16x32_bf16 v[116:119], v[196:199], a[104:107], v[116:119]
    v_mfma_f32_16x16x32_bf16 v[136:139], v[196:199], a[108:111], v[136:139]
    v_mfma_f32_16x16x32_bf16 v[80:83], v[200:203], a[96:99], v[80:83]
    ds_read_b64 v[232:233], v40 offset:128
    v_mfma_f32_16x16x32_bf16 v[100:103], v[200:203], a[100:103], v[100:103]
    v_mfma_f32_16x16x32_bf16 v[120:123], v[200:203], a[104:107], v[120:123]
    v_mfma_f32_16x16x32_bf16 v[140:143], v[200:203], a[108:111], v[140:143]
    s_waitcnt vmcnt(10) lgkmcnt(0)
    s_mov_b32 exec_lo, 0x2000
    s_mov_b32 exec_hi, 0
    buffer_load_dword v58, v59, s[72:75], 0 offen sc1
    s_mov_b64 exec, -1
    v_mfma_f32_16x16x32_bf16 v[64:67], v[204:207], a[112:115], v[64:67]
    v_mfma_f32_16x16x32_bf16 v[84:87], v[204:207], a[116:119], v[84:87]
    v_mfma_f32_16x16x32_bf16 v[104:107], v[204:207], a[120:123], v[104:107]
    v_lshlrev_b32 v236, 16, v224
    v_and_b32 v237, 0xffff0000, v224
    v_mfma_f32_16x16x32_bf16 v[124:127], v[204:207], a[124:127], v[124:127]
    v_lshlrev_b32 v238, 16, v225
    v_and_b32 v239, 0xffff0000, v225
    v_mfma_f32_16x16x32_bf16 v[68:71], v[208:211], a[112:115], v[68:71]
    v_mfma_f32_16x16x32_bf16 v[88:91], v[208:211], a[116:119], v[88:91]
    v_lshlrev_b32 v240, 16, v226
    v_and_b32 v241, 0xffff0000, v226
    v_mfma_f32_16x16x32_bf16 v[108:111], v[208:211], a[120:123], v[108:111]
    v_mfma_f32_16x16x32_bf16 v[128:131], v[208:211], a[124:127], v[128:131]
    v_lshlrev_b32 v242, 16, v227
    v_and_b32 v243, 0xffff0000, v227
    v_mfma_f32_16x16x32_bf16 v[72:75], v[212:215], a[112:115], v[72:75]
    v_mfma_f32_16x16x32_bf16 v[92:95], v[212:215], a[116:119], v[92:95]
    v_lshlrev_b32 v244, 16, v228
    v_and_b32 v245, 0xffff0000, v228
    v_mfma_f32_16x16x32_bf16 v[112:115], v[212:215], a[120:123], v[112:115]
    v_mfma_f32_16x16x32_bf16 v[132:135], v[212:215], a[124:127], v[132:135]
    v_lshlrev_b32 v246, 16, v229
    v_and_b32 v247, 0xffff0000, v229
    v_mfma_f32_16x16x32_bf16 v[76:79], v[216:219], a[112:115], v[76:79]
    v_lshlrev_b32 v248, 16, v230
    v_and_b32 v249, 0xffff0000, v230
    v_mfma_f32_16x16x32_bf16 v[96:99], v[216:219], a[116:119], v[96:99]
    v_mfma_f32_16x16x32_bf16 v[116:119], v[216:219], a[120:123], v[116:119]
    v_lshlrev_b32 v250, 16, v231
    v_and_b32 v251, 0xffff0000, v231
    v_mfma_f32_16x16x32_bf16 v[136:139], v[216:219], a[124:127], v[136:139]
    v_mfma_f32_16x16x32_bf16 v[80:83], v[220:223], a[112:115], v[80:83]
    v_lshlrev_b32 v252, 16, v232
    v_and_b32 v253, 0xffff0000, v232
    v_mfma_f32_16x16x32_bf16 v[100:103], v[220:223], a[116:119], v[100:103]
    v_mfma_f32_16x16x32_bf16 v[120:123], v[220:223], a[120:123], v[120:123]
    v_lshlrev_b32 v254, 16, v233
    v_and_b32 v255, 0xffff0000, v233
    v_mfma_f32_16x16x32_bf16 v[140:143], v[220:223], a[124:127], v[140:143]
    s_waitcnt vmcnt(0) lgkmcnt(0)
    s_mov_b32 s93, 0x2000
    v_accvgpr_read_b32 v7, a250
    s_mov_b32 s92, 0x40000
L_poll6:
    v_sub_u32 v58, v58, v7
    v_cmp_gt_u32 vcc, 10, v58
    s_nop 1
    s_and_b32 s86, vcc_lo, s93
    s_cbranch_scc0 L_polld6
    s_sub_u32 s92, s92, 1
    s_cbranch_scc1 L_polld6
    s_sleep 6
    s_mov_b32 exec_lo, s93
    s_mov_b32 exec_hi, 0
    buffer_load_dword v58, v59, s[72:75], 0 offen sc1
    s_mov_b64 exec, -1
    s_waitcnt vmcnt(0)
    s_branch L_poll6
L_polld6:
    s_lshl_b32 s81, s28, 2
    s_add_u32 s81, s81, s76
    s_mul_i32 s81, s81, 20480
    s_mul_i32 s82, s29, 5
    s_lshr_b32 s82, s82, 1
    s_lshl_b32 s82, s82, 10
    s_add_u32 s81, s81, s82
    s_add_u32 s81, s81, 29360128
    s_add_u32 s82, s81, 2621440
    buffer_load_dwordx4 v[184:187], v50, s[72:75], s81 offen offset:0 sc1
    buffer_load_dwordx4 v[188:191], v50, s[72:75], s81 offen offset:1024 sc1
    buffer_load_dwordx4 v[192:195], v50, s[72:75], s81 offen offset:2048 sc1
    buffer_load_dwordx4 v[196:199], v50, s[72:75], s82 offen offset:0 sc1
    buffer_load_dwordx4 v[200:203], v50, s[72:75], s82 offen offset:1024 sc1
    buffer_load_dwordx4 v[204:207], v50, s[72:75], s82 offen offset:2048 sc1
    v_mfma_f32_16x16x32_bf16 v[64:67], v[144:147], a[192:195], v[64:67]
    v_mfma_f32_16x16x32_bf16 v[84:87], v[144:147], a[196:199], v[84:87]
    v_mfma_f32_16x16x32_bf16 v[104:107], v[144:147], a[200:203], v[104:107]
    v_mfma_f32_16x16x32_bf16 v[124:127], v[144:147], a[204:207], v[124:127]
    v_mfma_f32_16x16x32_bf16 v[68:71], v[148:151], a[192:195], v[68:71]
    v_mfma_f32_16x16x32_bf16 v[88:91], v[148:151], a[196:199], v[88:91]
    v_mfma_f32_16x16x32_bf16 v[108:111], v[148:151], a[200:203], v[108:111]
    v_mfma_f32_16x16x32_bf16 v[128:131], v[148:151], a[204:207], v[128:131]
    v_mfma_f32_16x16x32_bf16 v[72:75], v[152:155], a[192:195], v[72:75]
    v_mfma_f32_16x16x32_bf16 v[92:95], v[152:155], a[196:199], v[92:95]
    v_mfma_f32_16x16x32_bf16 v[112:115], v[152:155], a[200:203], v[112:115]
    v_mfma_f32_16x16x32_bf16 v[132:135], v[152:155], a[204:207], v[132:135]
    v_mfma_f32_16x16x32_bf16 v[76:79], v[156:159], a[192:195], v[76:79]
    v_mfma_f32_16x16x32_bf16 v[96:99], v[156:159], a[196:199], v[96:99]
    v_mfma_f32_16x16x32_bf16 v[116:119], v[156:159], a[200:203], v[116:119]
    v_mfma_f32_16x16x32_bf16 v[136:139], v[156:159], a[204:207], v[136:139]
    v_mfma_f32_16x16x32_bf16 v[80:83], v[160:163], a[192:195], v[80:83]
    v_mfma_f32_16x16x32_bf16 v[100:103], v[160:163], a[196:199], v[100:103]
    v_mfma_f32_16x16x32_bf16 v[120:123], v[160:163], a[200:203], v[120:123]
    v_mfma_f32_16x16x32_bf16 v[140:143], v[160:163], a[204:207], v[140:143]
    s_waitcnt vmcnt(7) lgkmcnt(0)
    s_cmp_ge_u32 s76, 2
    s_cbranch_scc1 L_p2end
    v_mfma_f32_16x16x32_bf16 v[64:67], v[164:167], a[208:211], v[64:67]
    v_mfma_f32_16x16x32_bf16 v[84:87], v[164:167], a[212:215], v[84:87]
    v_mfma_f32_16x16x32_bf16 v[104:107], v[164:167], a[216:219], v[104:107]
    v_mfma_f32_16x16x32_bf16 v[124:127], v[164:167], a[220:223], v[124:127]
    v_mfma_f32_16x16x32_bf16 v[68:71], v[168:171], a[208:211], v[68:71]
    v_mfma_f32_16x16x32_bf16 v[88:91], v[168:171], a[212:215], v[88:91]
    v_mfma_f32_16x16x32_bf16 v[108:111], v[168:171], a[216:219], v[108:111]
    v_mfma_f32_16x16x32_bf16 v[128:131], v[168:171], a[220:223], v[128:131]
    v_mfma_f32_16x16x32_bf16 v[72:75], v[172:175], a[208:211], v[72:75]
    v_mfma_f32_16x16x32_bf16 v[92:95], v[172:175], a[212:215], v[92:95]
    v_mfma_f32_16x16x32_bf16 v[112:115], v[172:175], a[216:219], v[112:115]
    v_mfma_f32_16x16x32_bf16 v[132:135], v[172:175], a[220:223], v[132:135]
    v_mfma_f32_16x16x32_bf16 v[76:79], v[176:179], a[208:211], v[76:79]
    v_mfma_f32_16x16x32_bf16 v[96:99], v[176:179], a[212:215], v[96:99]
    v_mfma_f32_16x16x32_bf16 v[116:119], v[176:179], a[216:219], v[116:119]
    v_mfma_f32_16x16x32_bf16 v[136:139], v[176:179], a[220:223], v[136:139]
    v_mfma_f32_16x16x32_bf16 v[80:83], v[180:183], a[208:211], v[80:83]
    v_mfma_f32_16x16x32_bf16 v[100:103], v[180:183], a[212:215], v[100:103]
    v_mfma_f32_16x16x32_bf16 v[120:123], v[180:183], a[216:219], v[120:123]
    v_mfma_f32_16x16x32_bf16 v[140:143], v[180:183], a[220:223], v[140:143]
L_p2end:
    v_mov_b32 v8, 0xbfb8aa3b
    v_mov_b32 v9, v8
    v_mov_b32 v10, 1.0
    v_mov_b32 v11, 1.0
    v_lshlrev_b32 v14, 16, v42
    v_mov_b32 v15, v14
    s_nop 1
    ds_write_b128 v25, v[84:87] offset:0
    ds_write_b128 v25, v[88:91] offset:1024
    ds_write_b128 v25, v[92:95] offset:2048
    ds_write_b128 v25, v[96:99] offset:3072
    ds_write_b128 v25, v[100:103] offset:4096
    ds_write_b128 v25, v[104:107] offset:5120
    ds_write_b128 v25, v[108:111] offset:6144
    ds_write_b128 v25, v[112:115] offset:7168
    ds_write_b128 v25, v[116:119] offset:8192
    ds_write_b128 v25, v[120:123] offset:9216
    ds_write_b128 v25, v[124:127] offset:10240
    ds_write_b128 v25, v[128:131] offset:11264
    ds_write_b128 v25, v[132:135] offset:12288
    ds_write_b128 v25, v[136:139] offset:13312
    ds_write_b128 v25, v[140:143] offset:14336
    s_waitcnt vmcnt(0)
    v_lshlrev_b32 v144, 16, v184
    v_and_b32 v145, 0xffff0000, v184
    v_lshlrev_b32 v12, 16, v196
    v_and_b32 v13, 0xffff0000, v196
    v_pk_add_f32 v[144:145], v[144:145], v[12:13]
    v_lshlrev_b32 v146, 16, v185
    v_and_b32 v147, 0xffff0000, v185
    v_lshlrev_b32 v12, 16, v197
    v_and_b32 v13, 0xffff0000, v197
    v_pk_add_f32 v[146:147], v[146:147], v[12:13]
    v_lshlrev_b32 v148, 16, v186
    v_and_b32 v149, 0xffff0000, v186
    v_lshlrev_b32 v12, 16, v198
    v_and_b32 v13, 0xffff0000, v198
    v_pk_add_f32 v[148:149], v[148:149], v[12:13]
    v_lshlrev_b32 v150, 16, v187
    v_and_b32 v151, 0xffff0000, v187
    v_lshlrev_b32 v12, 16, v199
    v_and_b32 v13, 0xffff0000, v199
    v_pk_add_f32 v[150:151], v[150:151], v[12:13]
    v_lshlrev_b32 v152, 16, v188
    v_and_b32 v153, 0xffff0000, v188
    v_lshlrev_b32 v12, 16, v200
    v_and_b32 v13, 0xffff0000, v200
    v_pk_add_f32 v[152:153], v[152:153], v[12:13]
    v_lshlrev_b32 v154, 16, v189
    v_and_b32 v155, 0xffff0000, v189
    v_lshlrev_b32 v12, 16, v201
    v_and_b32 v13, 0xffff0000, v201
    v_pk_add_f32 v[154:155], v[154:155], v[12:13]
    v_lshlrev_b32 v156, 16, v190
    v_and_b32 v157, 0xffff0000, v190
    v_lshlrev_b32 v12, 16, v202
    v_and_b32 v13, 0xffff0000, v202
    v_pk_add_f32 v[156:157], v[156:157], v[12:13]
    v_lshlrev_b32 v158, 16, v191
    v_and_b32 v159, 0xffff0000, v191
    v_lshlrev_b32 v12, 16, v203
    v_and_b32 v13, 0xffff0000, v203
    v_pk_add_f32 v[158:159], v[158:159], v[12:13]
    v_lshlrev_b32 v160, 16, v192
    v_and_b32 v161, 0xffff0000, v192
    v_lshlrev_b32 v12, 16, v204
    v_and_b32 v13, 0xffff0000, v204
    v_pk_add_f32 v[160:161], v[160:161], v[12:13]
    v_lshlrev_b32 v162, 16, v193
    v_and_b32 v163, 0xffff0000, v193
    v_lshlrev_b32 v12, 16, v205
    v_and_b32 v13, 0xffff0000, v205
    v_pk_add_f32 v[162:163], v[162:163], v[12:13]
    v_lshlrev_b32 v164, 16, v194
    v_and_b32 v165, 0xffff0000, v194
    v_lshlrev_b32 v12, 16, v206
    v_and_b32 v13, 0xffff0000, v206
    v_pk_add_f32 v[164:165], v[164:165], v[12:13]
    v_lshlrev_b32 v166, 16, v195
    v_and_b32 v167, 0xffff0000, v195
    v_lshlrev_b32 v12, 16, v207
    v_and_b32 v13, 0xffff0000, v207
    v_pk_add_f32 v[166:167], v[166:167], v[12:13]
    s_bitcmp1_b32 s29, 0
    s_cbranch_scc0 L_even
    v_mov_b64 v[144:145], v[148:149]
    v_mov_b64 v[146:147], v[150:151]
    v_mov_b64 v[148:149], v[152:153]
    v_mov_b64 v[150:151], v[154:155]
    v_mov_b64 v[152:153], v[156:157]
    v_mov_b64 v[154:155], v[158:159]
    v_mov_b64 v[156:157], v[160:161]
    v_mov_b64 v[158:159], v[162:163]
    v_mov_b64 v[160:161], v[164:165]
    v_mov_b64 v[162:163], v[166:167]
L_even:
    s_xor_b32 s81, s76, 1
    s_mul_i32 s81, s81, 15360
    s_add_u32 s81, s81, 65536
    v_add_u32 v18, s81, v50
    s_xor_b32 s81, s76, 2
    s_mul_i32 s81, s81, 15360
    s_add_u32 s81, s81, 70656
    v_add_u32 v19, s81, v50
    s_xor_b32 s81, s76, 3
    s_mul_i32 s81, s81, 15360
    s_add_u32 s81, s81, 75776
    v_add_u32 v20, s81, v50
    s_waitcnt lgkmcnt(0)
    s_barrier
    ds_read_b128 v[84:87], v18 offset:0
    ds_read_b128 v[88:91], v18 offset:1024
    ds_read_b128 v[92:95], v18 offset:2048
    ds_read_b128 v[96:99], v18 offset:3072
    ds_read_b128 v[100:103], v18 offset:4096
    ds_read_b128 v[104:107], v19 offset:0
    ds_read_b128 v[108:111], v19 offset:1024
    ds_read_b128 v[112:115], v19 offset:2048
    ds_read_b128 v[116:119], v19 offset:3072
    ds_read_b128 v[120:123], v19 offset:4096
    ds_read_b128 v[124:127], v20 offset:0
    ds_read_b128 v[128:131], v20 offset:1024
    ds_read_b128 v[132:135], v20 offset:2048
    ds_read_b128 v[136:139], v20 offset:3072
    ds_read_b128 v[140:143], v20 offset:4096
    v_pk_add_f32 v[64:65], v[64:65], v[14:15]
    v_pk_add_f32 v[66:67], v[66:67], v[14:15]
    v_pk_add_f32 v[68:69], v[68:69], v[14:15]
    v_pk_add_f32 v[70:71], v[70:71], v[14:15]
    v_pk_add_f32 v[72:73], v[72:73], v[14:15]
    v_pk_add_f32 v[74:75], v[74:75], v[14:15]
    v_pk_add_f32 v[76:77], v[76:77], v[14:15]
    v_pk_add_f32 v[78:79], v[78:79], v[14:15]
    v_pk_add_f32 v[80:81], v[80:81], v[14:15]
    v_pk_add_f32 v[82:83], v[82:83], v[14:15]
    s_waitcnt lgkmcnt(10)
    v_pk_add_f32 v[64:65], v[64:65], v[84:85]
    v_pk_add_f32 v[66:67], v[66:67], v[86:87]
    v_pk_add_f32 v[68:69], v[68:69], v[88:89]
    v_pk_add_f32 v[70:71], v[70:71], v[90:91]
    v_pk_add_f32 v[72:73], v[72:73], v[92:93]
    v_pk_add_f32 v[74:75], v[74:75], v[94:95]
    v_pk_add_f32 v[76:77], v[76:77], v[96:97]
    v_pk_add_f32 v[78:79], v[78:79], v[98:99]
    v_pk_add_f32 v[80:81], v[80:81], v[100:101]
    v_pk_add_f32 v[82:83], v[82:83], v[102:103]
    s_waitcnt lgkmcnt(5)
    v_pk_add_f32 v[64:65], v[64:65], v[104:105]
    v_pk_add_f32 v[66:67], v[66:67], v[106:107]
    v_pk_add_f32 v[68:69], v[68:69], v[108:109]
    v_pk_add_f32 v[70:71], v[70:71], v[110:111]
    v_pk_add_f32 v[72:73], v[72:73], v[112:113]
    v_pk_add_f32 v[74:75], v[74:75], v[114:115]
    v_pk_add_f32 v[76:77], v[76:77], v[116:117]
    v_pk_add_f32 v[78:79], v[78:79], v[118:119]
    v_pk_add_f32 v[80:81], v[80:81], v[120:121]
    v_pk_add_f32 v[82:83], v[82:83], v[122:123]
    s_waitcnt lgkmcnt(0)
    v_pk_add_f32 v[64:65], v[64:65], v[124:125]
    v_pk_add_f32 v[66:67], v[66:67], v[126:127]
    v_pk_add_f32 v[68:69], v[68:69], v[128:129]
    v_pk_add_f32 v[70:71], v[70:71], v[130:131]
    v_pk_add_f32 v[72:73], v[72:73], v[132:133]
    v_pk_add_f32 v[74:75], v[74:75], v[134:135]
    v_pk_add_f32 v[76:77], v[76:77], v[136:137]
    v_pk_add_f32 v[78:79], v[78:79], v[138:139]
    v_pk_add_f32 v[80:81], v[80:81], v[140:141]
    v_pk_add_f32 v[82:83], v[82:83], v[142:143]
    v_pk_mul_f32 v[84:85], v[64:65], v[8:9]
    v_pk_mul_f32 v[86:87], v[66:67], v[8:9]
    v_pk_mul_f32 v[88:89], v[68:69], v[8:9]
    v_pk_mul_f32 v[90:91], v[70:71], v[8:9]
    v_pk_mul_f32 v[92:93], v[72:73], v[8:9]
    v_pk_mul_f32 v[94:95], v[74:75], v[8:9]
    v_pk_mul_f32 v[96:97], v[76:77], v[8:9]
    v_pk_mul_f32 v[98:99], v[78:79], v[8:9]
    v_pk_mul_f32 v[100:101], v[80:81], v[8:9]
    v_pk_mul_f32 v[102:103], v[82:83], v[8:9]
    v_exp_f32 v84, v84
    v_exp_f32 v85, v85
    v_exp_f32 v86, v86
    v_exp_f32 v87, v87
    v_exp_f32 v88, v88
    v_exp_f32 v89, v89
    v_exp_f32 v90, v90
    v_exp_f32 v91, v91
    v_exp_f32 v92, v92
    v_exp_f32 v93, v93
    v_exp_f32 v94, v94
    v_exp_f32 v95, v95
    v_exp_f32 v96, v96
    v_exp_f32 v97, v97
    v_exp_f32 v98, v98
    v_exp_f32 v99, v99
    v_exp_f32 v100, v100
    v_exp_f32 v101, v101
    v_exp_f32 v102, v102
    v_exp_f32 v103, v103
    v_pk_mul_f32 v[64:65], v[64:65], v[144:145]
    v_pk_mul_f32 v[66:67], v[66:67], v[146:147]
    v_pk_mul_f32 v[68:69], v[68:69], v[148:149]
    v_pk_mul_f32 v[70:71], v[70:71], v[150:151]
    v_pk_mul_f32 v[72:73], v[72:73], v[152:153]
    v_pk_mul_f32 v[74:75], v[74:75], v[154:155]
    v_pk_mul_f32 v[76:77], v[76:77], v[156:157]
    v_pk_mul_f32 v[78:79], v[78:79], v[158:159]
    v_pk_mul_f32 v[80:81], v[80:81], v[160:161]
    v_pk_mul_f32 v[82:83], v[82:83], v[162:163]
    v_pk_add_f32 v[84:85], v[84:85], v[10:11]
    v_pk_add_f32 v[86:87], v[86:87], v[10:11]
    v_pk_add_f32 v[88:89], v[88:89], v[10:11]
    v_pk_add_f32 v[90:91], v[90:91], v[10:11]
    v_pk_add_f32 v[92:93], v[92:93], v[10:11]
    v_pk_add_f32 v[94:95], v[94:95], v[10:11]
    v_pk_add_f32 v[96:97], v[96:97], v[10:11]
    v_pk_add_f32 v[98:99], v[98:99], v[10:11]
    v_pk_add_f32 v[100:101], v[100:101], v[10:11]
    v_pk_add_f32 v[102:103], v[102:103], v[10:11]
    v_rcp_f32 v84, v84
    v_rcp_f32 v85, v85
    v_rcp_f32 v86, v86
    v_rcp_f32 v87, v87
    v_rcp_f32 v88, v88
    v_rcp_f32 v89, v89
    v_rcp_f32 v90, v90
    v_rcp_f32 v91, v91
    v_rcp_f32 v92, v92
    v_rcp_f32 v93, v93
    v_rcp_f32 v94, v94
    v_rcp_f32 v95, v95
    v_rcp_f32 v96, v96
    v_rcp_f32 v97, v97
    v_rcp_f32 v98, v98
    v_rcp_f32 v99, v99
    v_rcp_f32 v100, v100
    v_rcp_f32 v101, v101
    v_rcp_f32 v102, v102
    v_rcp_f32 v103, v103
    v_pk_fma_f32 v[64:65], v[64:65], v[84:85], v[236:237]
    v_pk_fma_f32 v[66:67], v[66:67], v[86:87], v[238:239]
    v_pk_fma_f32 v[68:69], v[68:69], v[88:89], v[240:241]
    v_pk_fma_f32 v[70:71], v[70:71], v[90:91], v[242:243]
    v_pk_fma_f32 v[72:73], v[72:73], v[92:93], v[244:245]
    v_pk_fma_f32 v[74:75], v[74:75], v[94:95], v[246:247]
    v_pk_fma_f32 v[76:77], v[76:77], v[96:97], v[248:249]
    v_pk_fma_f32 v[78:79], v[78:79], v[98:99], v[250:251]
    v_pk_fma_f32 v[80:81], v[80:81], v[100:101], v[252:253]
    v_pk_fma_f32 v[82:83], v[82:83], v[102:103], v[254:255]
    v_cvt_pk_bf16_f32 v64, v64, v65
    v_cvt_pk_bf16_f32 v65, v66, v67
    v_cvt_pk_bf16_f32 v66, v68, v69
    v_cvt_pk_bf16_f32 v67, v70, v71
    v_cvt_pk_bf16_f32 v68, v72, v73
    v_cvt_pk_bf16_f32 v69, v74, v75
    v_cvt_pk_bf16_f32 v70, v76, v77
    v_cvt_pk_bf16_f32 v71, v78, v79
    v_cvt_pk_bf16_f32 v72, v80, v81
    v_cvt_pk_bf16_f32 v73, v82, v83
    ds_write_b64 v40, v[64:65] offset:0
    ds_write_b64 v40, v[66:67] offset:32
    ds_write_b64 v40, v[68:69] offset:64
    ds_write_b64 v40, v[70:71] offset:96
    ds_write_b64 v40, v[72:73] offset:128
    s_waitcnt lgkmcnt(0)
    ds_read_b128 v[224:227], v29
    ds_read_b128 v[228:231], v30
    ds_read_b128 v[232:235], v31
    s_waitcnt lgkmcnt(2)
    buffer_store_dwordx4 v[224:227], v26, s[68:71], 0 offen sc1
    s_waitcnt lgkmcnt(1)
    buffer_store_dwordx4 v[228:231], v27, s[68:71], 0 offen sc1
    s_mov_b32 exec_hi, 0
    s_waitcnt lgkmcnt(0)
    buffer_store_dwordx4 v[232:235], v28, s[68:71], 0 offen sc1
    s_mov_b32 exec_hi, -1
    s_branch L_end2
L_epim:
    s_waitcnt vmcnt(17)
    v_mov_b32 v8, 0xc0135761
    v_mov_b32 v9, v8
    v_mov_b32 v10, 0xbdd2d3e8
    v_mov_b32 v11, v10
    v_mov_b32 v12, 1.0
    v_mov_b32 v13, 1.0
    s_lshl_b32 s81, s96, 2
    s_and_b32 s82, s76, 1
    s_lshl_b32 s82, s82, 1
    s_add_u32 s81, s81, s82
    s_mul_i32 s81, s81, 40960
    s_lshl_b32 s82, s97, 13
    s_add_u32 s81, s81, s82
    s_lshr_b32 s82, s76, 1
    s_lshl_b32 s82, s82, 12
    s_add_u32 s81, s81, s82
    s_add_u32 s81, s81, 20971520
    s_add_u32 s82, s81, 40960
    v_pk_mul_f32 v[128:129], v[64:65], v[64:65]
    v_pk_mul_f32 v[130:131], v[66:67], v[66:67]
    v_pk_mul_f32 v[132:133], v[80:81], v[80:81]
    v_pk_mul_f32 v[134:135], v[82:83], v[82:83]
    v_pk_fma_f32 v[128:129], v[128:129], v[10:11], v[8:9]
    v_pk_fma_f32 v[130:131], v[130:131], v[10:11], v[8:9]
    v_pk_fma_f32 v[132:133], v[132:133], v[10:11], v[8:9]
    v_pk_fma_f32 v[134:135], v[134:135], v[10:11], v[8:9]
    v_pk_mul_f32 v[128:129], v[128:129], v[64:65]
    v_pk_mul_f32 v[130:131], v[130:131], v[66:67]
    v_pk_mul_f32 v[132:133], v[132:133], v[80:81]
    v_pk_mul_f32 v[134:135], v[134:135], v[82:83]
    v_exp_f32 v128, v128
    v_exp_f32 v129, v129
    v_exp_f32 v130, v130
    v_exp_f32 v131, v131
    v_exp_f32 v132, v132
    v_exp_f32 v133, v133
    v_exp_f32 v134, v134
    v_exp_f32 v135, v135
    v_pk_add_f32 v[128:129], v[128:129], v[12:13]
    v_pk_add_f32 v[130:131], v[130:131], v[12:13]
    v_pk_add_f32 v[132:133], v[132:133], v[12:13]
    v_pk_add_f32 v[134:135], v[134:135], v[12:13]
    v_rcp_f32 v128, v128
    v_rcp_f32 v129, v129
    v_rcp_f32 v130, v130
    v_rcp_f32 v131, v131
    v_rcp_f32 v132, v132
    v_rcp_f32 v133, v133
    v_rcp_f32 v134, v134
    v_rcp_f32 v135, v135
    v_pk_mul_f32 v[64:65], v[64:65], v[128:129]
    v_pk_mul_f32 v[66:67], v[66:67], v[130:131]
    v_pk_mul_f32 v[80:81], v[80:81], v[132:133]
    v_pk_mul_f32 v[82:83], v[82:83], v[134:135]
    v_cvt_pk_bf16_f32 v144, v64, v65
    v_cvt_pk_bf16_f32 v145, v66, v67
    v_cvt_pk_bf16_f32 v146, v80, v81
    v_cvt_pk_bf16_f32 v147, v82, v83
    buffer_store_dwordx4 v[144:147], v50, s[72:75], s81 offen offset:0 sc1
    v_pk_mul_f32 v[136:137], v[68:69], v[68:69]
    v_pk_mul_f32 v[138:139], v[70:71], v[70:71]
    v_pk_mul_f32 v[140:141], v[84:85], v[84:85]
    v_pk_mul_f32 v[142:143], v[86:87], v[86:87]
    v_pk_fma_f32 v[136:137], v[136:137], v[10:11], v[8:9]
    v_pk_fma_f32 v[138:139], v[138:139], v[10:11], v[8:9]
    v_pk_fma_f32 v[140:141], v[140:141], v[10:11], v[8:9]
    v_pk_fma_f32 v[142:143], v[142:143], v[10:11], v[8:9]
    v_pk_mul_f32 v[136:137], v[136:137], v[68:69]
    v_pk_mul_f32 v[138:139], v[138:139], v[70:71]
    v_pk_mul_f32 v[140:141], v[140:141], v[84:85]
    v_pk_mul_f32 v[142:143], v[142:143], v[86:87]
    v_exp_f32 v136, v136
    v_exp_f32 v137, v137
    v_exp_f32 v138, v138
    v_exp_f32 v139, v139
    v_exp_f32 v140, v140
    v_exp_f32 v141, v141
    v_exp_f32 v142, v142
    v_exp_f32 v143, v143
    v_pk_add_f32 v[136:137], v[136:137], v[12:13]
    v_pk_add_f32 v[138:139], v[138:139], v[12:13]
    v_pk_add_f32 v[140:141], v[140:141], v[12:13]
    v_pk_add_f32 v[142:143], v[142:143], v[12:13]
    v_rcp_f32 v136, v136
    v_rcp_f32 v137, v137
    v_rcp_f32 v138, v138
    v_rcp_f32 v139, v139
    v_rcp_f32 v140, v140
    v_rcp_f32 v141, v141
    v_rcp_f32 v142, v142
    v_rcp_f32 v143, v143
    v_pk_mul_f32 v[68:69], v[68:69], v[136:137]
    v_pk_mul_f32 v[70:71], v[70:71], v[138:139]
    v_pk_mul_f32 v[84:85], v[84:85], v[140:141]
    v_pk_mul_f32 v[86:87], v[86:87], v[142:143]
    v_cvt_pk_bf16_f32 v148, v68, v69
    v_cvt_pk_bf16_f32 v149, v70, v71
    v_cvt_pk_bf16_f32 v150, v84, v85
    v_cvt_pk_bf16_f32 v151, v86, v87
    buffer_store_dwordx4 v[148:151], v50, s[72:75], s81 offen offset:1024 sc1
    v_pk_mul_f32 v[128:129], v[72:73], v[72:73]
    v_pk_mul_f32 v[130:131], v[74:75], v[74:75]
    v_pk_mul_f32 v[132:133], v[88:89], v[88:89]
    v_pk_mul_f32 v[134:135], v[90:91], v[90:91]
    v_pk_fma_f32 v[128:129], v[128:129], v[10:11], v[8:9]
    v_pk_fma_f32 v[130:131], v[130:131], v[10:11], v[8:9]
    v_pk_fma_f32 v[132:133], v[132:133], v[10:11], v[8:9]
    v_pk_fma_f32 v[134:135], v[134:135], v[10:11], v[8:9]
    v_pk_mul_f32 v[128:129], v[128:129], v[72:73]
    v_pk_mul_f32 v[130:131], v[130:131], v[74:75]
    v_pk_mul_f32 v[132:133], v[132:133], v[88:89]
    v_pk_mul_f32 v[134:135], v[134:135], v[90:91]
    v_exp_f32 v128, v128
    v_exp_f32 v129, v129
    v_exp_f32 v130, v130
    v_exp_f32 v131, v131
    v_exp_f32 v132, v132
    v_exp_f32 v133, v133
    v_exp_f32 v134, v134
    v_exp_f32 v135, v135
    v_pk_add_f32 v[128:129], v[128:129], v[12:13]
    v_pk_add_f32 v[130:131], v[130:131], v[12:13]
    v_pk_add_f32 v[132:133], v[132:133], v[12:13]
    v_pk_add_f32 v[134:135], v[134:135], v[12:13]
    v_rcp_f32 v128, v128
    v_rcp_f32 v129, v129
    v_rcp_f32 v130, v130
    v_rcp_f32 v131, v131
    v_rcp_f32 v132, v132
    v_rcp_f32 v133, v133
    v_rcp_f32 v134, v134
    v_rcp_f32 v135, v135
    v_pk_mul_f32 v[72:73], v[72:73], v[128:129]
    v_pk_mul_f32 v[74:75], v[74:75], v[130:131]
    v_pk_mul_f32 v[88:89], v[88:89], v[132:133]
    v_pk_mul_f32 v[90:91], v[90:91], v[134:135]
    v_cvt_pk_bf16_f32 v152, v72, v73
    v_cvt_pk_bf16_f32 v153, v74, v75
    v_cvt_pk_bf16_f32 v154, v88, v89
    v_cvt_pk_bf16_f32 v155, v90, v91
    buffer_store_dwordx4 v[152:155], v50, s[72:75], s81 offen offset:2048 sc1
    v_pk_mul_f32 v[136:137], v[76:77], v[76:77]
    v_pk_mul_f32 v[138:139], v[78:79], v[78:79]
    v_pk_mul_f32 v[140:141], v[92:93], v[92:93]
    v_pk_mul_f32 v[142:143], v[94:95], v[94:95]
    v_pk_fma_f32 v[136:137], v[136:137], v[10:11], v[8:9]
    v_pk_fma_f32 v[138:139], v[138:139], v[10:11], v[8:9]
    v_pk_fma_f32 v[140:141], v[140:141], v[10:11], v[8:9]
    v_pk_fma_f32 v[142:143], v[142:143], v[10:11], v[8:9]
    v_pk_mul_f32 v[136:137], v[136:137], v[76:77]
    v_pk_mul_f32 v[138:139], v[138:139], v[78:79]
    v_pk_mul_f32 v[140:141], v[140:141], v[92:93]
    v_pk_mul_f32 v[142:143], v[142:143], v[94:95]
    v_exp_f32 v136, v136
    v_exp_f32 v137, v137
    v_exp_f32 v138, v138
    v_exp_f32 v139, v139
    v_exp_f32 v140, v140
    v_exp_f32 v141, v141
    v_exp_f32 v142, v142
    v_exp_f32 v143, v143
    v_pk_add_f32 v[136:137], v[136:137], v[12:13]
    v_pk_add_f32 v[138:139], v[138:139], v[12:13]
    v_pk_add_f32 v[140:141], v[140:141], v[12:13]
    v_pk_add_f32 v[142:143], v[142:143], v[12:13]
    v_rcp_f32 v136, v136
    v_rcp_f32 v137, v137
    v_rcp_f32 v138, v138
    v_rcp_f32 v139, v139
    v_rcp_f32 v140, v140
    v_rcp_f32 v141, v141
    v_rcp_f32 v142, v142
    v_rcp_f32 v143, v143
    v_pk_mul_f32 v[76:77], v[76:77], v[136:137]
    v_pk_mul_f32 v[78:79], v[78:79], v[138:139]
    v_pk_mul_f32 v[92:93], v[92:93], v[140:141]
    v_pk_mul_f32 v[94:95], v[94:95], v[142:143]
    v_cvt_pk_bf16_f32 v156, v76, v77
    v_cvt_pk_bf16_f32 v157, v78, v79
    v_cvt_pk_bf16_f32 v158, v92, v93
    v_cvt_pk_bf16_f32 v159, v94, v95
    buffer_store_dwordx4 v[156:159], v50, s[72:75], s81 offen offset:3072 sc1
    v_pk_mul_f32 v[128:129], v[96:97], v[96:97]
    v_pk_mul_f32 v[130:131], v[98:99], v[98:99]
    v_pk_mul_f32 v[132:133], v[112:113], v[112:113]
    v_pk_mul_f32 v[134:135], v[114:115], v[114:115]
    v_pk_fma_f32 v[128:129], v[128:129], v[10:11], v[8:9]
    v_pk_fma_f32 v[130:131], v[130:131], v[10:11], v[8:9]
    v_pk_fma_f32 v[132:133], v[132:133], v[10:11], v[8:9]
    v_pk_fma_f32 v[134:135], v[134:135], v[10:11], v[8:9]
    v_pk_mul_f32 v[128:129], v[128:129], v[96:97]
    v_pk_mul_f32 v[130:131], v[130:131], v[98:99]
    v_pk_mul_f32 v[132:133], v[132:133], v[112:113]
    v_pk_mul_f32 v[134:135], v[134:135], v[114:115]
    v_exp_f32 v128, v128
    v_exp_f32 v129, v129
    v_exp_f32 v130, v130
    v_exp_f32 v131, v131
    v_exp_f32 v132, v132
    v_exp_f32 v133, v133
    v_exp_f32 v134, v134
    v_exp_f32 v135, v135
    v_pk_add_f32 v[128:129], v[128:129], v[12:13]
    v_pk_add_f32 v[130:131], v[130:131], v[12:13]
    v_pk_add_f32 v[132:133], v[132:133], v[12:13]
    v_pk_add_f32 v[134:135], v[134:135], v[12:13]
    v_rcp_f32 v128, v128
    v_rcp_f32 v129, v129
    v_rcp_f32 v130, v130
    v_rcp_f32 v131, v131
    v_rcp_f32 v132, v132
    v_rcp_f32 v133, v133
    v_rcp_f32 v134, v134
    v_rcp_f32 v135, v135
    v_pk_mul_f32 v[96:97], v[96:97], v[128:129]
    v_pk_mul_f32 v[98:99], v[98:99], v[130:131]
    v_pk_mul_f32 v[112:113], v[112:113], v[132:133]
    v_pk_mul_f32 v[114:115], v[114:115], v[134:135]
    v_cvt_pk_bf16_f32 v160, v96, v97
    v_cvt_pk_bf16_f32 v161, v98, v99
    v_cvt_pk_bf16_f32 v162, v112, v113
    v_cvt_pk_bf16_f32 v163, v114, v115
    buffer_store_dwordx4 v[160:163], v50, s[72:75], s82 offen offset:0 sc1
    v_pk_mul_f32 v[136:137], v[100:101], v[100:101]
    v_pk_mul_f32 v[138:139], v[102:103], v[102:103]
    v_pk_mul_f32 v[140:141], v[116:117], v[116:117]
    v_pk_mul_f32 v[142:143], v[118:119], v[118:119]
    v_pk_fma_f32 v[136:137], v[136:137], v[10:11], v[8:9]
    v_pk_fma_f32 v[138:139], v[138:139], v[10:11], v[8:9]
    v_pk_fma_f32 v[140:141], v[140:141], v[10:11], v[8:9]
    v_pk_fma_f32 v[142:143], v[142:143], v[10:11], v[8:9]
    v_pk_mul_f32 v[136:137], v[136:137], v[100:101]
    v_pk_mul_f32 v[138:139], v[138:139], v[102:103]
    v_pk_mul_f32 v[140:141], v[140:141], v[116:117]
    v_pk_mul_f32 v[142:143], v[142:143], v[118:119]
    v_exp_f32 v136, v136
    v_exp_f32 v137, v137
    v_exp_f32 v138, v138
    v_exp_f32 v139, v139
    v_exp_f32 v140, v140
    v_exp_f32 v141, v141
    v_exp_f32 v142, v142
    v_exp_f32 v143, v143
    v_pk_add_f32 v[136:137], v[136:137], v[12:13]
    v_pk_add_f32 v[138:139], v[138:139], v[12:13]
    v_pk_add_f32 v[140:141], v[140:141], v[12:13]
    v_pk_add_f32 v[142:143], v[142:143], v[12:13]
    v_rcp_f32 v136, v136
    v_rcp_f32 v137, v137
    v_rcp_f32 v138, v138
    v_rcp_f32 v139, v139
    v_rcp_f32 v140, v140
    v_rcp_f32 v141, v141
    v_rcp_f32 v142, v142
    v_rcp_f32 v143, v143
    v_pk_mul_f32 v[100:101], v[100:101], v[136:137]
    v_pk_mul_f32 v[102:103], v[102:103], v[138:139]
    v_pk_mul_f32 v[116:117], v[116:117], v[140:141]
    v_pk_mul_f32 v[118:119], v[118:119], v[142:143]
    v_cvt_pk_bf16_f32 v164, v100, v101
    v_cvt_pk_bf16_f32 v165, v102, v103
    v_cvt_pk_bf16_f32 v166, v116, v117
    v_cvt_pk_bf16_f32 v167, v118, v119
    buffer_store_dwordx4 v[164:167], v50, s[72:75], s82 offen offset:1024 sc1
    v_pk_mul_f32 v[128:129], v[104:105], v[104:105]
    v_pk_mul_f32 v[130:131], v[106:107], v[106:107]
    v_pk_mul_f32 v[132:133], v[120:121], v[120:121]
    v_pk_mul_f32 v[134:135], v[122:123], v[122:123]
    v_pk_fma_f32 v[128:129], v[128:129], v[10:11], v[8:9]
    v_pk_fma_f32 v[130:131], v[130:131], v[10:11], v[8:9]
    v_pk_fma_f32 v[132:133], v[132:133], v[10:11], v[8:9]
    v_pk_fma_f32 v[134:135], v[134:135], v[10:11], v[8:9]
    v_pk_mul_f32 v[128:129], v[128:129], v[104:105]
    v_pk_mul_f32 v[130:131], v[130:131], v[106:107]
    v_pk_mul_f32 v[132:133], v[132:133], v[120:121]
    v_pk_mul_f32 v[134:135], v[134:135], v[122:123]
    v_exp_f32 v128, v128
    v_exp_f32 v129, v129
    v_exp_f32 v130, v130
    v_exp_f32 v131, v131
    v_exp_f32 v132, v132
    v_exp_f32 v133, v133
    v_exp_f32 v134, v134
    v_exp_f32 v135, v135
    v_pk_add_f32 v[128:129], v[128:129], v[12:13]
    v_pk_add_f32 v[130:131], v[130:131], v[12:13]
    v_pk_add_f32 v[132:133], v[132:133], v[12:13]
    v_pk_add_f32 v[134:135], v[134:135], v[12:13]
    v_rcp_f32 v128, v128
    v_rcp_f32 v129, v129
    v_rcp_f32 v130, v130
    v_rcp_f32 v131, v131
    v_rcp_f32 v132, v132
    v_rcp_f32 v133, v133
    v_rcp_f32 v134, v134
    v_rcp_f32 v135, v135
    v_pk_mul_f32 v[104:105], v[104:105], v[128:129]
    v_pk_mul_f32 v[106:107], v[106:107], v[130:131]
    v_pk_mul_f32 v[120:121], v[120:121], v[132:133]
    v_pk_mul_f32 v[122:123], v[122:123], v[134:135]
    v_cvt_pk_bf16_f32 v168, v104, v105
    v_cvt_pk_bf16_f32 v169, v106, v107
    v_cvt_pk_bf16_f32 v170, v120, v121
    v_cvt_pk_bf16_f32 v171, v122, v123
    buffer_store_dwordx4 v[168:171], v50, s[72:75], s82 offen offset:2048 sc1
    v_pk_mul_f32 v[136:137], v[108:109], v[108:109]
    v_pk_mul_f32 v[138:139], v[110:111], v[110:111]
    v_pk_mul_f32 v[140:141], v[124:125], v[124:125]
    v_pk_mul_f32 v[142:143], v[126:127], v[126:127]
    v_pk_fma_f32 v[136:137], v[136:137], v[10:11], v[8:9]
    v_pk_fma_f32 v[138:139], v[138:139], v[10:11], v[8:9]
    v_pk_fma_f32 v[140:141], v[140:141], v[10:11], v[8:9]
    v_pk_fma_f32 v[142:143], v[142:143], v[10:11], v[8:9]
    v_pk_mul_f32 v[136:137], v[136:137], v[108:109]
    v_pk_mul_f32 v[138:139], v[138:139], v[110:111]
    v_pk_mul_f32 v[140:141], v[140:141], v[124:125]
    v_pk_mul_f32 v[142:143], v[142:143], v[126:127]
    v_exp_f32 v136, v136
    v_exp_f32 v137, v137
    v_exp_f32 v138, v138
    v_exp_f32 v139, v139
    v_exp_f32 v140, v140
    v_exp_f32 v141, v141
    v_exp_f32 v142, v142
    v_exp_f32 v143, v143
    v_pk_add_f32 v[136:137], v[136:137], v[12:13]
    v_pk_add_f32 v[138:139], v[138:139], v[12:13]
    v_pk_add_f32 v[140:141], v[140:141], v[12:13]
    v_pk_add_f32 v[142:143], v[142:143], v[12:13]
    v_rcp_f32 v136, v136
    v_rcp_f32 v137, v137
    v_rcp_f32 v138, v138
    v_rcp_f32 v139, v139
    v_rcp_f32 v140, v140
    v_rcp_f32 v141, v141
    v_rcp_f32 v142, v142
    v_rcp_f32 v143, v143
    v_pk_mul_f32 v[108:109], v[108:109], v[136:137]
    v_pk_mul_f32 v[110:111], v[110:111], v[138:139]
    v_pk_mul_f32 v[124:125], v[124:125], v[140:141]
    v_pk_mul_f32 v[126:127], v[126:127], v[142:143]
    v_cvt_pk_bf16_f32 v172, v108, v109
    v_cvt_pk_bf16_f32 v173, v110, v111
    v_cvt_pk_bf16_f32 v174, v124, v125
    v_cvt_pk_bf16_f32 v175, v126, v127
    buffer_store_dwordx4 v[172:175], v50, s[72:75], s82 offen offset:3072 sc1
    s_lshl_b32 s83, s97, 8
    s_add_u32 s83, s83, 35653632
    s_waitcnt vmcnt(0)
    s_barrier
    s_cmp_eq_u32 s76, 0
    s_cselect_b32 s83, s83, 0x40000000
    v_mov_b32 v7, 1
    s_mov_b64 exec, 1
    buffer_atomic_add v7, off, s[72:75], s83
    s_mov_b64 exec, -1
    s_mov_b32 s99, 2097152
    s_lshl_b32 s98, s76, 14
    v_add_u32 v44, 65536, v36
    v_add_u32 v45, 65536, v37
    v_add_u32 v46, 65536, v38
    v_add_u32 v47, 65536, v39
    s_add_u32 m0, s98, 65536
    s_nop 0
    buffer_load_dwordx4 v32, s[56:59], s99 offen offset:0 lds
    buffer_load_dwordx4 v33, s[56:59], s99 offen offset:1024 lds
    buffer_load_dwordx4 v34, s[56:59], s99 offen offset:2048 lds
    buffer_load_dwordx4 v35, s[56:59], s99 offen offset:3072 lds
    s_add_u32 s99, s99, 524288
    s_add_u32 m0, s98, 69632
    s_nop 0
    buffer_load_dwordx4 v32, s[56:59], s99 offen offset:0 lds
    buffer_load_dwordx4 v33, s[56:59], s99 offen offset:1024 lds
    buffer_load_dwordx4 v34, s[56:59], s99 offen offset:2048 lds
    buffer_load_dwordx4 v35, s[56:59], s99 offen offset:3072 lds
    s_add_u32 s99, s99, 524288
    s_add_u32 m0, s98, 73728
    s_nop 0
    buffer_load_dwordx4 v32, s[56:59], s99 offen offset:0 lds
    buffer_load_dwordx4 v33, s[56:59], s99 offen offset:1024 lds
    buffer_load_dwordx4 v34, s[56:59], s99 offen offset:2048 lds
    buffer_load_dwordx4 v35, s[56:59], s99 offen offset:3072 lds
    s_add_u32 s99, s99, 524288
    s_add_u32 m0, s98, 77824
    s_nop 0
    buffer_load_dwordx4 v32, s[56:59], s99 offen offset:0 lds
    buffer_load_dwordx4 v33, s[56:59], s99 offen offset:1024 lds
    buffer_load_dwordx4 v34, s[56:59], s99 offen offset:2048 lds
    buffer_load_dwordx4 v35, s[56:59], s99 offen offset:3072 lds
    s_add_u32 s99, s99, 524288
    s_waitcnt vmcnt(12)
    ds_read_b64_tr_b16 a[0:1], v44 offset:0
    ds_read_b64_tr_b16 a[2:3], v44 offset:2048
    ds_read_b64_tr_b16 a[4:5], v45 offset:0
    ds_read_b64_tr_b16 a[6:7], v45 offset:2048
    ds_read_b64_tr_b16 a[8:9], v46 offset:0
    ds_read_b64_tr_b16 a[10:11], v46 offset:2048
    ds_read_b64_tr_b16 a[12:13], v47 offset:0
    ds_read_b64_tr_b16 a[14:15], v47 offset:2048
    s_waitcnt vmcnt(8)
    ds_read_b64_tr_b16 a[16:17], v44 offset:4096
    ds_read_b64_tr_b16 a[18:19], v44 offset:6144
    ds_read_b64_tr_b16 a[20:21], v45 offset:4096
    ds_read_b64_tr_b16 a[22:23], v45 offset:6144
    ds_read_b64_tr_b16 a[24:25], v46 offset:4096
    ds_read_b64_tr_b16 a[26:27], v46 offset:6144
    ds_read_b64_tr_b16 a[28:29], v47 offset:4096
    ds_read_b64_tr_b16 a[30:31], v47 offset:6144
    s_waitcnt lgkmcnt(8)
    s_add_u32 m0, s98, 65536
    s_nop 0
    buffer_load_dwordx4 v32, s[56:59], s99 offen offset:0 lds
    buffer_load_dwordx4 v33, s[56:59], s99 offen offset:1024 lds
    buffer_load_dwordx4 v34, s[56:59], s99 offen offset:2048 lds
    buffer_load_dwordx4 v35, s[56:59], s99 offen offset:3072 lds
    s_add_u32 s99, s99, 524288
    s_waitcnt vmcnt(8)
    ds_read_b64_tr_b16 a[32:33], v44 offset:8192
    ds_read_b64_tr_b16 a[34:35], v44 offset:10240
    ds_read_b64_tr_b16 a[36:37], v45 offset:8192
    ds_read_b64_tr_b16 a[38:39], v45 offset:10240
    ds_read_b64_tr_b16 a[40:41], v46 offset:8192
    ds_read_b64_tr_b16 a[42:43], v46 offset:10240
    ds_read_b64_tr_b16 a[44:45], v47 offset:8192
    ds_read_b64_tr_b16 a[46:47], v47 offset:10240
    s_waitcnt lgkmcnt(8)
    s_add_u32 m0, s98, 69632
    s_nop 0
    buffer_load_dwordx4 v32, s[56:59], s99 offen offset:0 lds
    buffer_load_dwordx4 v33, s[56:59], s99 offen offset:1024 lds
    buffer_load_dwordx4 v34, s[56:59], s99 offen offset:2048 lds
    buffer_load_dwordx4 v35, s[56:59], s99 offen offset:3072 lds
    s_add_u32 s99, s99, 524288
    s_waitcnt vmcnt(8)
    ds_read_b64_tr_b16 a[48:49], v44 offset:12288
    ds_read_b64_tr_b16 a[50:51], v44 offset:14336
    ds_read_b64_tr_b16 a[52:53], v45 offset:12288
    ds_read_b64_tr_b16 a[54:55], v45 offset:14336
    ds_read_b64_tr_b16 a[56:57], v46 offset:12288
    ds_read_b64_tr_b16 a[58:59], v46 offset:14336
    ds_read_b64_tr_b16 a[60:61], v47 offset:12288
    ds_read_b64_tr_b16 a[62:63], v47 offset:14336
    s_waitcnt lgkmcnt(8)
    s_add_u32 m0, s98, 73728
    s_nop 0
    buffer_load_dwordx4 v32, s[56:59], s99 offen offset:0 lds
    buffer_load_dwordx4 v33, s[56:59], s99 offen offset:1024 lds
    buffer_load_dwordx4 v34, s[56:59], s99 offen offset:2048 lds
    buffer_load_dwordx4 v35, s[56:59], s99 offen offset:3072 lds
    s_add_u32 s99, s99, 524288
    s_waitcnt vmcnt(8)
    ds_read_b64_tr_b16 a[64:65], v44 offset:0
    ds_read_b64_tr_b16 a[66:67], v44 offset:2048
    ds_read_b64_tr_b16 a[68:69], v45 offset:0
    ds_read_b64_tr_b16 a[70:71], v45 offset:2048
    ds_read_b64_tr_b16 a[72:73], v46 offset:0
    ds_read_b64_tr_b16 a[74:75], v46 offset:2048
    ds_read_b64_tr_b16 a[76:77], v47 offset:0
    ds_read_b64_tr_b16 a[78:79], v47 offset:2048
    s_waitcnt lgkmcnt(8)
    s_add_u32 m0, s98, 77824
    s_nop 0
    buffer_load_dwordx4 v32, s[56:59], s99 offen offset:0 lds
    buffer_load_dwordx4 v33, s[56:59], s99 offen offset:1024 lds
    buffer_load_dwordx4 v34, s[56:59], s99 offen offset:2048 lds
    buffer_load_dwordx4 v35, s[56:59], s99 offen offset:3072 lds
    s_add_u32 s99, s99, 524288
    s_waitcnt vmcnt(8)
    ds_read_b64_tr_b16 a[80:81], v44 offset:4096
    ds_read_b64_tr_b16 a[82:83], v44 offset:6144
    ds_read_b64_tr_b16 a[84:85], v45 offset:4096
    ds_read_b64_tr_b16 a[86:87], v45 offset:6144
    ds_read_b64_tr_b16 a[88:89], v46 offset:4096
    ds_read_b64_tr_b16 a[90:91], v46 offset:6144
    ds_read_b64_tr_b16 a[92:93], v47 offset:4096
    ds_read_b64_tr_b16 a[94:95], v47 offset:6144
    s_waitcnt lgkmcnt(8)
    s_add_u32 m0, s98, 65536
    s_nop 0
    buffer_load_dwordx4 v32, s[56:59], s99 offen offset:0 lds
    buffer_load_dwordx4 v33, s[56:59], s99 offen offset:1024 lds
    buffer_load_dwordx4 v34, s[56:59], s99 offen offset:2048 lds
    buffer_load_dwordx4 v35, s[56:59], s99 offen offset:3072 lds
    s_add_u32 s99, s99, 524288
    s_waitcnt vmcnt(8)
    ds_read_b64_tr_b16 a[96:97], v44 offset:8192
    ds_read_b64_tr_b16 a[98:99], v44 offset:10240
    ds_read_b64_tr_b16 a[100:101], v45 offset:8192
    ds_read_b64_tr_b16 a[102:103], v45 offset:10240
    ds_read_b64_tr_b16 a[104:105], v46 offset:8192
    ds_read_b64_tr_b16 a[106:107], v46 offset:10240
    ds_read_b64_tr_b16 a[108:109], v47 offset:8192
    ds_read_b64_tr_b16 a[110:111], v47 offset:10240
    s_waitcnt lgkmcnt(8)
    s_add_u32 m0, s98, 69632
    s_nop 0
    buffer_load_dwordx4 v32, s[56:59], s99 offen offset:0 lds
    buffer_load_dwordx4 v33, s[56:59], s99 offen offset:1024 lds
    buffer_load_dwordx4 v34, s[56:59], s99 offen offset:2048 lds
    buffer_load_dwordx4 v35, s[56:59], s99 offen offset:3072 lds
    s_add_u32 s99, s99, 524288
    s_waitcnt vmcnt(8)
    ds_read_b64_tr_b16 a[112:113], v44 offset:12288
    ds_read_b64_tr_b16 a[114:115], v44 offset:14336
    ds_read_b64_tr_b16 a[116:117], v45 offset:12288
    ds_read_b64_tr_b16 a[118:119], v45 offset:14336
    ds_read_b64_tr_b16 a[120:121], v46 offset:12288
    ds_read_b64_tr_b16 a[122:123], v46 offset:14336
    ds_read_b64_tr_b16 a[124:125], v47 offset:12288
    ds_read_b64_tr_b16 a[126:127], v47 offset:14336
    s_waitcnt vmcnt(4)
    ds_read_b64_tr_b16 a[192:193], v44 offset:0
    ds_read_b64_tr_b16 a[194:195], v44 offset:2048
    ds_read_b64_tr_b16 a[196:197], v45 offset:0
    ds_read_b64_tr_b16 a[198:199], v45 offset:2048
    ds_read_b64_tr_b16 a[200:201], v46 offset:0
    ds_read_b64_tr_b16 a[202:203], v46 offset:2048
    ds_read_b64_tr_b16 a[204:205], v47 offset:0
    ds_read_b64_tr_b16 a[206:207], v47 offset:2048
    s_waitcnt vmcnt(0)
    ds_read_b64_tr_b16 a[208:209], v44 offset:4096
    ds_read_b64_tr_b16 a[210:211], v44 offset:6144
    ds_read_b64_tr_b16 a[212:213], v45 offset:4096
    ds_read_b64_tr_b16 a[214:215], v45 offset:6144
    ds_read_b64_tr_b16 a[216:217], v46 offset:4096
    ds_read_b64_tr_b16 a[218:219], v46 offset:6144
    ds_read_b64_tr_b16 a[220:221], v47 offset:4096
    ds_read_b64_tr_b16 a[222:223], v47 offset:6144
    s_waitcnt lgkmcnt(0)
L_p2wait:
    s_cmp_lg_u32 s76, 0
    s_cbranch_scc1 L_p2w
    s_mov_b32 exec_lo, s93
    s_mov_b32 exec_hi, 0
    buffer_load_dword v58, v59, s[72:75], 0 offen sc1
    s_mov_b64 exec, -1
    s_waitcnt vmcnt(0)
    v_accvgpr_read_b32 v7, a250
    s_mov_b32 s92, 0x40000
L_poll5:
    v_sub_u32 v58, v58, v7
    v_cmp_gt_u32 vcc, 14, v58
    s_nop 1
    s_and_b32 s86, vcc_lo, s93
    s_cbranch_scc0 L_polld5
    s_sub_u32 s92, s92, 1
    s_cbranch_scc1 L_polld5
    s_sleep 6
    s_mov_b32 exec_lo, s93
    s_mov_b32 exec_hi, 0
    buffer_load_dword v58, v59, s[72:75], 0 offen sc1
    s_mov_b64 exec, -1
    s_waitcnt vmcnt(0)
    s_branch L_poll5
L_polld5:
L_p2w:
    s_barrier
    s_mov_b32 s0, 0
    v_add_u32 v41, 4096, v24
    buffer_load_dwordx4 v[144:147], v24, s[72:75], s0 offen offset:0 sc1
    buffer_load_dwordx4 v[148:151], v24, s[72:75], s0 offen offset:1024 sc1
    buffer_load_dwordx4 v[152:155], v24, s[72:75], s0 offen offset:2048 sc1
    buffer_load_dwordx4 v[156:159], v24, s[72:75], s0 offen offset:3072 sc1
    buffer_load_dwordx4 v[160:163], v41, s[72:75], s0 offen sc1
    s_add_u32 s0, s0, 163840
    buffer_load_dwordx4 v[164:167], v24, s[72:75], s0 offen offset:0 sc1
    buffer_load_dwordx4 v[168:171], v24, s[72:75], s0 offen offset:1024 sc1
    buffer_load_dwordx4 v[172:175], v24, s[72:75], s0 offen offset:2048 sc1
    buffer_load_dwordx4 v[176:179], v24, s[72:75], s0 offen offset:3072 sc1
    buffer_load_dwordx4 v[180:183], v41, s[72:75], s0 offen sc1
    s_add_u32 s0, s0, 163840
    buffer_load_dwordx4 v[184:187], v24, s[72:75], s0 offen offset:0 sc1
    buffer_load_dwordx4 v[188:191], v24, s[72:75], s0 offen offset:1024 sc1
    buffer_load_dwordx4 v[192:195], v24, s[72:75], s0 offen offset:2048 sc1
    buffer_load_dwordx4 v[196:199], v24, s[72:75], s0 offen offset:3072 sc1
    buffer_load_dwordx4 v[200:203], v41, s[72:75], s0 offen sc1
    s_add_u32 s0, s0, 163840
    buffer_load_dwordx4 v[204:207], v24, s[72:75], s0 offen offset:0 sc1
    buffer_load_dwordx4 v[208:211], v24, s[72:75], s0 offen offset:1024 sc1
    buffer_load_dwordx4 v[212:215], v24, s[72:75], s0 offen offset:2048 sc1
    buffer_load_dwordx4 v[216:219], v24, s[72:75], s0 offen offset:3072 sc1
    buffer_load_dwordx4 v[220:223], v41, s[72:75], s0 offen sc1
    s_add_u32 s0, s0, 163840
    s_waitcnt vmcnt(0)
    s_branch L_p2go
L_p2idle:
    s_waitcnt vmcnt(0)
    s_barrier
    s_mul_i32 s81, s76, 40960
    s_mul_i32 s82, s29, 5120
    s_add_u32 s81, s81, s82
    s_add_u32 s81, s81, 20971520
    v_add_u32 v24, s81, v50
    s_lshl_b32 s81, s28, 6
    s_lshl_b32 s82, s76, 4
    s_add_u32 s81, s81, s82
    s_mul_i32 s81, s81, 1280
    s_mul_i32 s82, s29, 160
    s_add_u32 s81, s81, s82
    s_mul_i32 s82, s76, 2816
    s_add_u32 s82, s82, 147456
    v_add_u32 v6, 0, v1
    v_mul_u32_u24 v7, 205, v6
    v_lshrrev_b32 v7, 11, v7
    v_mul_u32_u24 v25, 10, v7
    v_sub_u32 v6, v6, v25
    v_lshlrev_b32 v6, 4, v6
    v_mul_u32_u24 v25, 1280, v7
    v_add3_u32 v26, v25, v6, s81
    v_mul_u32_u24 v25, 176, v7
    v_add3_u32 v29, v25, v6, s82
    v_add_u32 v6, 64, v1
    v_mul_u32_u24 v7, 205, v6
    v_lshrrev_b32 v7, 11, v7
    v_mul_u32_u24 v25, 10, v7
    v_sub_u32 v6, v6, v25
    v_lshlrev_b32 v6, 4, v6
    v_mul_u32_u24 v25, 1280, v7
    v_add3_u32 v27, v25, v6, s81
    v_mul_u32_u24 v25, 176, v7
    v_add3_u32 v30, v25, v6, s82
    v_add_u32 v6, 128, v1
    v_mul_u32_u24 v7, 205, v6
    v_lshrrev_b32 v7, 11, v7
    v_mul_u32_u24 v25, 10, v7
    v_sub_u32 v6, v6, v25
    v_lshlrev_b32 v6, 4, v6
    v_mul_u32_u24 v25, 1280, v7
    v_add3_u32 v28, v25, v6, s81
    v_mul_u32_u24 v25, 176, v7
    v_add3_u32 v31, v25, v6, s82
    v_mul_u32_u24 v6, 176, v2
    v_lshl_add_u32 v6, v3, 3, v6
    v_add_u32 v17, s82, v6
    s_mul_i32 s81, s76, 15360
    s_add_u32 s81, s81, 65536
    v_add_u32 v25, s81, v50
    s_lshr_b32 s82, s29, 1
    s_lshl_b32 s82, s82, 3
    s_mov_b32 s83, 0x180c0201
    s_bitcmp1_b32 s29, 0
    s_cselect_b32 s81, 0x10080603, s83
    s_lshr_b32 s81, s81, s82
    s_and_b32 s81, s81, 0x1f
    s_lshl_b32 s93, s81, 8
    s_lshl_b32 s31, s76, 14
    s_mov_b32 s1, 0
    s_lshl_b32 s81, s28, 7
    s_lshl_b32 s82, s76, 5
    s_add_u32 s81, s81, s82
    v_lshlrev_b32 v6, 1, v2
    v_mov_b32 v40, v17
    buffer_load_ushort v42, v6, s[64:67], s81 offen
    s_add_u32 m0, s31, 0
    s_nop 0
    buffer_load_dwordx4 v32, s[56:59], s1 offen offset:0 lds
    buffer_load_dwordx4 v33, s[56:59], s1 offen offset:1024 lds
    buffer_load_dwordx4 v34, s[56:59], s1 offen offset:2048 lds
    buffer_load_dwordx4 v35, s[56:59], s1 offen offset:3072 lds
    s_add_u32 s1, s1, 524288
    s_add_u32 m0, s31, 4096
    s_nop 0
    buffer_load_dwordx4 v32, s[56:59], s1 offen offset:0 lds
    buffer_load_dwordx4 v33, s[56:59], s1 offen offset:1024 lds
    buffer_load_dwordx4 v34, s[56:59], s1 offen offset:2048 lds
    buffer_load_dwordx4 v35, s[56:59], s1 offen offset:3072 lds
    s_add_u32 s1, s1, 524288
    s_add_u32 m0, s31, 8192
    s_nop 0
    buffer_load_dwordx4 v32, s[56:59], s1 offen offset:0 lds
    buffer_load_dwordx4 v33, s[56:59], s1 offen offset:1024 lds
    buffer_load_dwordx4 v34, s[56:59], s1 offen offset:2048 lds
    buffer_load_dwordx4 v35, s[56:59], s1 offen offset:3072 lds
    s_add_u32 s1, s1, 524288
    s_add_u32 m0, s31, 12288
    s_nop 0
    buffer_load_dwordx4 v32, s[56:59], s1 offen offset:0 lds
    buffer_load_dwordx4 v33, s[56:59], s1 offen offset:1024 lds
    buffer_load_dwordx4 v34, s[56:59], s1 offen offset:2048 lds
    buffer_load_dwordx4 v35, s[56:59], s1 offen offset:3072 lds
    s_add_u32 s1, s1, 524288
    s_branch L_p2wait
L_rkA:
    v_mov_b32 v6, 64
    v_mov_b32 v7, 1
    s_mov_b64 exec, 1
    global_atomic_add v62, v6, v7, s[24:25] sc0
    s_mov_b64 exec, -1
    s_branch L_rkAb
L_rkB:
    s_lshl_b32 s81, s79, 2
    s_add_u32 s81, s81, 192
    v_mov_b32 v6, s81
    v_and_b32 v7, 7, v62
    v_add_u32 v7, 1, v7
    s_mov_b64 exec, 1
    global_store_dword v6, v7, s[24:25] sc1
    s_mov_b64 exec, -1
    s_branch L_rkBb
L_spinh:
    s_mov_b32 s92, 0x100000
L_spinlh:
    ds_read_b32 v17, v18
    s_waitcnt lgkmcnt(0)
    v_cmp_gt_u32 vcc, s98, v17
    s_sub_u32 s92, s92, 1
    s_cbranch_scc1 L_spunh
    s_cbranch_vccnz L_spinlh
    s_branch L_spunh
L_spin0:
    s_mov_b32 s92, 0x100000
L_spinl0:
    ds_read_b32 v17, v18
    s_waitcnt lgkmcnt(0)
    v_cmp_gt_u32 vcc, s98, v17
    s_sub_u32 s92, s92, 1
    s_cbranch_scc1 L_spun0
    s_cbranch_vccnz L_spinl0
    s_branch L_spun0
L_spin1:
    s_mov_b32 s92, 0x100000
L_spinl1:
    ds_read_b32 v17, v18
    s_waitcnt lgkmcnt(0)
    v_cmp_gt_u32 vcc, s98, v17
    s_sub_u32 s92, s92, 1
    s_cbranch_scc1 L_spun1
    s_cbranch_vccnz L_spinl1
    s_branch L_spun1
L_spin2:
    s_mov_b32 s92, 0x100000
L_spinl2:
    ds_read_b32 v17, v18
    s_waitcnt lgkmcnt(0)
    v_cmp_gt_u32 vcc, s98, v17
    s_sub_u32 s92, s92, 1
    s_cbranch_scc1 L_spun2
    s_cbranch_vccnz L_spinl2
    s_branch L_spun2
L_spin3:
    s_mov_b32 s92, 0x100000
L_spinl3:
    ds_read_b32 v17, v18
    s_waitcnt lgkmcnt(0)
    v_cmp_gt_u32 vcc, s98, v17
    s_sub_u32 s92, s92, 1
    s_cbranch_scc1 L_spun3
    s_cbranch_vccnz L_spinl3
    s_branch L_spun3
L_spint:
    s_mov_b32 s92, 0x100000
L_spinlt:
    ds_read_b32 v17, v18
    s_waitcnt lgkmcnt(0)
    v_cmp_gt_u32 vcc, s98, v17
    s_sub_u32 s92, s92, 1
    s_cbranch_scc1 L_spunt
    s_cbranch_vccnz L_spinlt
    s_branch L_spunt
L_spinu:
    s_mov_b32 s92, 0x100000
L_spinlu:
    ds_read_b32 v17, v18
    s_waitcnt lgkmcnt(0)
    v_cmp_gt_u32 vcc, s98, v17
    s_sub_u32 s92, s92, 1
    s_cbranch_scc1 L_spunu
    s_cbranch_vccnz L_spinlu
    s_branch L_spunu
L_slow:
    s_waitcnt vmcnt(0)
    s_mov_b32 s94, 1
    s_mov_b32 s88, 0
    v_mov_b32 v24, 0xff800000
    v_mov_b32 v8, 0
    v_mov_b32 v25, 0xff800000
    v_mov_b32 v9, 0
    v_mov_b32 v26, 0xff800000
    v_mov_b32 v10, 0
    v_mov_b32 v27, 0xff800000
    v_mov_b32 v11, 0
    v_accvgpr_write_b32 a0, 0
    v_accvgpr_write_b32 a1, 0
    v_accvgpr_write_b32 a2, 0
    v_accvgpr_write_b32 a3, 0
    v_accvgpr_write_b32 a4, 0
    v_accvgpr_write_b32 a5, 0
    v_accvgpr_write_b32 a6, 0
    v_accvgpr_write_b32 a7, 0
    v_accvgpr_write_b32 a8, 0
    v_accvgpr_write_b32 a9, 0
    v_accvgpr_write_b32 a10, 0
    v_accvgpr_write_b32 a11, 0
    v_accvgpr_write_b32 a12, 0
    v_accvgpr_write_b32 a13, 0
    v_accvgpr_write_b32 a14, 0
    v_accvgpr_write_b32 a15, 0
    v_accvgpr_write_b32 a16, 0
    v_accvgpr_write_b32 a17, 0
    v_accvgpr_write_b32 a18, 0
    v_accvgpr_write_b32 a19, 0
    v_accvgpr_write_b32 a20, 0
    v_accvgpr_write_b32 a21, 0
    v_accvgpr_write_b32 a22, 0
    v_accvgpr_write_b32 a23, 0
    v_accvgpr_write_b32 a24, 0
    v_accvgpr_write_b32 a25, 0
    v_accvgpr_write_b32 a26, 0
    v_accvgpr_write_b32 a27, 0
    v_accvgpr_write_b32 a28, 0
    v_accvgpr_write_b32 a29, 0
    v_accvgpr_write_b32 a30, 0
    v_accvgpr_write_b32 a31, 0
    v_accvgpr_write_b32 a32, 0
    v_accvgpr_write_b32 a33, 0
    v_accvgpr_write_b32 a34, 0
    v_accvgpr_write_b32 a35, 0
    v_accvgpr_write_b32 a36, 0
    v_accvgpr_write_b32 a37, 0
    v_accvgpr_write_b32 a38, 0
    v_accvgpr_write_b32 a39, 0
    v_accvgpr_write_b32 a40, 0
    v_accvgpr_write_b32 a41, 0
    v_accvgpr_write_b32 a42, 0
    v_accvgpr_write_b32 a43, 0
    v_accvgpr_write_b32 a44, 0
    v_accvgpr_write_b32 a45, 0
    v_accvgpr_write_b32 a46, 0
    v_accvgpr_write_b32 a47, 0
    v_accvgpr_write_b32 a48, 0
    v_accvgpr_write_b32 a49, 0
    v_accvgpr_write_b32 a50, 0
    v_accvgpr_write_b32 a51, 0
    v_accvgpr_write_b32 a52, 0
    v_accvgpr_write_b32 a53, 0
    v_accvgpr_write_b32 a54, 0
    v_accvgpr_write_b32 a55, 0
    v_accvgpr_write_b32 a56, 0
    v_accvgpr_write_b32 a57, 0
    v_accvgpr_write_b32 a58, 0
    v_accvgpr_write_b32 a59, 0
    v_accvgpr_write_b32 a60, 0
    v_accvgpr_write_b32 a61, 0
    v_accvgpr_write_b32 a62, 0
    v_accvgpr_write_b32 a63, 0
    v_accvgpr_write_b32 a64, 0
    v_accvgpr_write_b32 a65, 0
    v_accvgpr_write_b32 a66, 0
    v_accvgpr_write_b32 a67, 0
    v_accvgpr_write_b32 a68, 0
    v_accvgpr_write_b32 a69, 0
    v_accvgpr_write_b32 a70, 0
    v_accvgpr_write_b32 a71, 0
    v_accvgpr_write_b32 a72, 0
    v_accvgpr_write_b32 a73, 0
    v_accvgpr_write_b32 a74, 0
    v_accvgpr_write_b32 a75, 0
    v_accvgpr_write_b32 a76, 0
    v_accvgpr_write_b32 a77, 0
    v_accvgpr_write_b32 a78, 0
    v_accvgpr_write_b32 a79, 0
    v_accvgpr_write_b32 a80, 0
    v_accvgpr_write_b32 a81, 0
    v_accvgpr_write_b32 a82, 0
    v_accvgpr_write_b32 a83, 0
    v_accvgpr_write_b32 a84, 0
    v_accvgpr_write_b32 a85, 0
    v_accvgpr_write_b32 a86, 0
    v_accvgpr_write_b32 a87, 0
    v_accvgpr_write_b32 a88, 0
    v_accvgpr_write_b32 a89, 0
    v_accvgpr_write_b32 a90, 0
    v_accvgpr_write_b32 a91, 0
    v_accvgpr_write_b32 a92, 0
    v_accvgpr_write_b32 a93, 0
    v_accvgpr_write_b32 a94, 0
    v_accvgpr_write_b32 a95, 0
    v_accvgpr_write_b32 a96, 0
    v_accvgpr_write_b32 a97, 0
    v_accvgpr_write_b32 a98, 0
    v_accvgpr_write_b32 a99, 0
    v_accvgpr_write_b32 a100, 0
    v_accvgpr_write_b32 a101, 0
    v_accvgpr_write_b32 a102, 0
    v_accvgpr_write_b32 a103, 0
    v_accvgpr_write_b32 a104, 0
    v_accvgpr_write_b32 a105, 0
    v_accvgpr_write_b32 a106, 0
    v_accvgpr_write_b32 a107, 0
    v_accvgpr_write_b32 a108, 0
    v_accvgpr_write_b32 a109, 0
    v_accvgpr_write_b32 a110, 0
    v_accvgpr_write_b32 a111, 0
    v_accvgpr_write_b32 a112, 0
    v_accvgpr_write_b32 a113, 0
    v_accvgpr_write_b32 a114, 0
    v_accvgpr_write_b32 a115, 0
    v_accvgpr_write_b32 a116, 0
    v_accvgpr_write_b32 a117, 0
    v_accvgpr_write_b32 a118, 0
    v_accvgpr_write_b32 a119, 0
    v_accvgpr_write_b32 a120, 0
    v_accvgpr_write_b32 a121, 0
    v_accvgpr_write_b32 a122, 0
    v_accvgpr_write_b32 a123, 0
    v_accvgpr_write_b32 a124, 0
    v_accvgpr_write_b32 a125, 0
    v_accvgpr_write_b32 a126, 0
    v_accvgpr_write_b32 a127, 0
L_slowloop:
    s_barrier
    s_add_u32 m0, s90, 49152
    s_nop 0
    buffer_load_dwordx4 v52, s[36:39], s88 offen offset:0 nt lds
    buffer_load_dwordx4 v53, s[36:39], s88 offen offset:1024 nt lds
    buffer_load_dwordx4 v54, s[36:39], s88 offen offset:2048 nt lds
    buffer_load_dwordx4 v55, s[36:39], s88 offen offset:3072 nt lds
    s_add_u32 m0, s90, 65536
    s_nop 0
    buffer_load_dwordx4 v56, s[40:43], s88 offen offset:0 nt lds
    buffer_load_dwordx4 v57, s[40:43], s88 offen offset:1024 nt lds
    buffer_load_dwordx4 v56, s[40:43], s88 offen offset:2048 nt lds
    buffer_load_dwordx4 v57, s[40:43], s88 offen offset:3072 nt lds
    s_waitcnt vmcnt(0)
    s_barrier
    ds_read_b128 a[160:163], v20 offset:49152
    ds_read_b128 a[164:167], v20 offset:53248
    ds_read_b128 a[168:171], v21 offset:49152
    ds_read_b128 a[172:175], v21 offset:53248
    ds_read_b128 a[176:179], v22 offset:49152
    ds_read_b128 a[180:183], v22 offset:53248
    ds_read_b128 a[184:187], v23 offset:49152
    ds_read_b128 a[188:191], v23 offset:53248
    ds_read_b64_tr_b16 a[128:129], v32 offset:0
    ds_read_b64_tr_b16 a[130:131], v32 offset:4096
    ds_read_b64_tr_b16 a[132:133], v33 offset:0
    ds_read_b64_tr_b16 a[134:135], v33 offset:4096
    ds_read_b64_tr_b16 a[136:137], v34 offset:0
    ds_read_b64_tr_b16 a[138:139], v34 offset:4096
    ds_read_b64_tr_b16 a[140:141], v35 offset:0
    ds_read_b64_tr_b16 a[142:143], v35 offset:4096
    ds_read_b64_tr_b16 a[144:145], v36 offset:0
    ds_read_b64_tr_b16 a[146:147], v36 offset:4096
    ds_read_b64_tr_b16 a[148:149], v37 offset:0
    ds_read_b64_tr_b16 a[150:151], v37 offset:4096
    ds_read_b64_tr_b16 a[152:153], v38 offset:0
    ds_read_b64_tr_b16 a[154:155], v38 offset:4096
    ds_read_b64_tr_b16 a[156:157], v39 offset:0
    ds_read_b64_tr_b16 a[158:159], v39 offset:4096
    s_waitcnt lgkmcnt(0)
    v_mfma_f32_16x16x32_bf16 v[128:131], a[160:163], v[64:67], 0
    v_mfma_f32_16x16x32_bf16 v[128:131], a[168:171], v[68:71], v[128:131]
    v_mfma_f32_16x16x32_bf16 v[128:131], a[176:179], v[72:75], v[128:131]
    v_mfma_f32_16x16x32_bf16 v[128:131], a[184:187], v[76:79], v[128:131]
    v_mfma_f32_16x16x32_bf16 v[136:139], a[160:163], v[80:83], 0
    v_mfma_f32_16x16x32_bf16 v[136:139], a[168:171], v[84:87], v[136:139]
    v_mfma_f32_16x16x32_bf16 v[136:139], a[176:179], v[88:91], v[136:139]
    v_mfma_f32_16x16x32_bf16 v[136:139], a[184:187], v[92:95], v[136:139]
    v_mfma_f32_16x16x32_bf16 v[144:147], a[160:163], v[96:99], 0
    v_mfma_f32_16x16x32_bf16 v[144:147], a[168:171], v[100:103], v[144:147]
    v_mfma_f32_16x16x32_bf16 v[144:147], a[176:179], v[104:107], v[144:147]
    v_mfma_f32_16x16x32_bf16 v[144:147], a[184:187], v[108:111], v[144:147]
    v_mfma_f32_16x16x32_bf16 v[152:155], a[160:163], v[112:115], 0
    v_mfma_f32_16x16x32_bf16 v[152:155], a[168:171], v[116:119], v[152:155]
    v_mfma_f32_16x16x32_bf16 v[152:155], a[176:179], v[120:123], v[152:155]
    v_mfma_f32_16x16x32_bf16 v[152:155], a[184:187], v[124:127], v[152:155]
    v_mfma_f32_16x16x32_bf16 v[132:135], a[164:167], v[64:67], 0
    v_mfma_f32_16x16x32_bf16 v[132:135], a[172:175], v[68:71], v[132:135]
    v_mfma_f32_16x16x32_bf16 v[132:135], a[180:183], v[72:75], v[132:135]
    v_mfma_f32_16x16x32_bf16 v[132:135], a[188:191], v[76:79], v[132:135]
    v_mfma_f32_16x16x32_bf16 v[140:143], a[164:167], v[80:83], 0
    v_mfma_f32_16x16x32_bf16 v[140:143], a[172:175], v[84:87], v[140:143]
    v_mfma_f32_16x16x32_bf16 v[140:143], a[180:183], v[88:91], v[140:143]
    v_mfma_f32_16x16x32_bf16 v[140:143], a[188:191], v[92:95], v[140:143]
    v_mfma_f32_16x16x32_bf16 v[148:151], a[164:167], v[96:99], 0
    v_mfma_f32_16x16x32_bf16 v[148:151], a[172:175], v[100:103], v[148:151]
    v_mfma_f32_16x16x32_bf16 v[148:151], a[180:183], v[104:107], v[148:151]
    v_mfma_f32_16x16x32_bf16 v[148:151], a[188:191], v[108:111], v[148:151]
    v_mfma_f32_16x16x32_bf16 v[156:159], a[164:167], v[112:115], 0
    v_mfma_f32_16x16x32_bf16 v[156:159], a[172:175], v[116:119], v[156:159]
    v_mfma_f32_16x16x32_bf16 v[156:159], a[180:183], v[120:123], v[156:159]
    v_mfma_f32_16x16x32_bf16 v[156:159], a[188:191], v[124:127], v[156:159]
    s_nop 7
    v_max3_f32 v248, v128, v129, v130
    v_max3_f32 v249, v131, v132, v133
    v_max3_f32 v248, v248, v134, v135
    v_max3_f32 v248, v248, v249, v24
    v_mov_b32 v249, v248
    s_nop 1
    v_permlane16_swap_b32 v248, v249
    s_nop 0
    v_max_f32 v248, v248, v249
    v_mov_b32 v249, v248
    s_nop 1
    v_permlane32_swap_b32 v248, v249
    s_nop 0
    v_max_f32 v248, v248, v249
    v_sub_f32 v249, v24, v248
    v_exp_f32 v28, v249
    v_mov_b32 v24, v248
    v_sub_f32 v128, v128, v248
    v_sub_f32 v129, v129, v248
    v_sub_f32 v130, v130, v248
    v_sub_f32 v131, v131, v248
    v_sub_f32 v132, v132, v248
    v_sub_f32 v133, v133, v248
    v_sub_f32 v134, v134, v248
    v_sub_f32 v135, v135, v248
    v_exp_f32 v128, v128
    v_exp_f32 v129, v129
    v_exp_f32 v130, v130
    v_exp_f32 v131, v131
    v_exp_f32 v132, v132
    v_exp_f32 v133, v133
    v_exp_f32 v134, v134
    v_exp_f32 v135, v135
    v_mul_f32 v8, v8, v28
    v_add_f32 v8, v8, v128
    v_add_f32 v8, v8, v129
    v_add_f32 v8, v8, v130
    v_add_f32 v8, v8, v131
    v_add_f32 v8, v8, v132
    v_add_f32 v8, v8, v133
    v_add_f32 v8, v8, v134
    v_add_f32 v8, v8, v135
    v_cvt_pk_bf16_f32 v128, v128, v129
    v_cvt_pk_bf16_f32 v129, v130, v131
    v_cvt_pk_bf16_f32 v130, v132, v133
    v_cvt_pk_bf16_f32 v131, v134, v135
    v_accvgpr_read_b32 v252, a0
    v_accvgpr_read_b32 v253, a1
    v_accvgpr_read_b32 v254, a2
    v_accvgpr_read_b32 v255, a3
    v_mul_f32 v252, v252, v28
    v_mul_f32 v253, v253, v28
    v_mul_f32 v254, v254, v28
    v_mul_f32 v255, v255, v28
    v_accvgpr_write_b32 a0, v252
    v_accvgpr_write_b32 a1, v253
    v_accvgpr_write_b32 a2, v254
    v_accvgpr_write_b32 a3, v255
    v_accvgpr_read_b32 v252, a16
    v_accvgpr_read_b32 v253, a17
    v_accvgpr_read_b32 v254, a18
    v_accvgpr_read_b32 v255, a19
    v_mul_f32 v252, v252, v28
    v_mul_f32 v253, v253, v28
    v_mul_f32 v254, v254, v28
    v_mul_f32 v255, v255, v28
    v_accvgpr_write_b32 a16, v252
    v_accvgpr_write_b32 a17, v253
    v_accvgpr_write_b32 a18, v254
    v_accvgpr_write_b32 a19, v255
    v_accvgpr_read_b32 v252, a32
    v_accvgpr_read_b32 v253, a33
    v_accvgpr_read_b32 v254, a34
    v_accvgpr_read_b32 v255, a35
    v_mul_f32 v252, v252, v28
    v_mul_f32 v253, v253, v28
    v_mul_f32 v254, v254, v28
    v_mul_f32 v255, v255, v28
    v_accvgpr_write_b32 a32, v252
    v_accvgpr_write_b32 a33, v253
    v_accvgpr_write_b32 a34, v254
    v_accvgpr_write_b32 a35, v255
    v_accvgpr_read_b32 v252, a48
    v_accvgpr_read_b32 v253, a49
    v_accvgpr_read_b32 v254, a50
    v_accvgpr_read_b32 v255, a51
    v_mul_f32 v252, v252, v28
    v_mul_f32 v253, v253, v28
    v_mul_f32 v254, v254, v28
    v_mul_f32 v255, v255, v28
    v_accvgpr_write_b32 a48, v252
    v_accvgpr_write_b32 a49, v253
    v_accvgpr_write_b32 a50, v254
    v_accvgpr_write_b32 a51, v255
    v_accvgpr_read_b32 v252, a64
    v_accvgpr_read_b32 v253, a65
    v_accvgpr_read_b32 v254, a66
    v_accvgpr_read_b32 v255, a67
    v_mul_f32 v252, v252, v28
    v_mul_f32 v253, v253, v28
    v_mul_f32 v254, v254, v28
    v_mul_f32 v255, v255, v28
    v_accvgpr_write_b32 a64, v252
    v_accvgpr_write_b32 a65, v253
    v_accvgpr_write_b32 a66, v254
    v_accvgpr_write_b32 a67, v255
    v_accvgpr_read_b32 v252, a80
    v_accvgpr_read_b32 v253, a81
    v_accvgpr_read_b32 v254, a82
    v_accvgpr_read_b32 v255, a83
    v_mul_f32 v252, v252, v28
    v_mul_f32 v253, v253, v28
    v_mul_f32 v254, v254, v28
    v_mul_f32 v255, v255, v28
    v_accvgpr_write_b32 a80, v252
    v_accvgpr_write_b32 a81, v253
    v_accvgpr_write_b32 a82, v254
    v_accvgpr_write_b32 a83, v255
    v_accvgpr_read_b32 v252, a96
    v_accvgpr_read_b32 v253, a97
    v_accvgpr_read_b32 v254, a98
    v_accvgpr_read_b32 v255, a99
    v_mul_f32 v252, v252, v28
    v_mul_f32 v253, v253, v28
    v_mul_f32 v254, v254, v28
    v_mul_f32 v255, v255, v28
    v_accvgpr_write_b32 a96, v252
    v_accvgpr_write_b32 a97, v253
    v_accvgpr_write_b32 a98, v254
    v_accvgpr_write_b32 a99, v255
    v_accvgpr_read_b32 v252, a112
    v_accvgpr_read_b32 v253, a113
    v_accvgpr_read_b32 v254, a114
    v_accvgpr_read_b32 v255, a115
    v_mul_f32 v252, v252, v28
    v_mul_f32 v253, v253, v28
    v_mul_f32 v254, v254, v28
    v_mul_f32 v255, v255, v28
    v_accvgpr_write_b32 a112, v252
    v_accvgpr_write_b32 a113, v253
    v_accvgpr_write_b32 a114, v254
    v_accvgpr_write_b32 a115, v255
    v_max3_f32 v248, v136, v137, v138
    v_max3_f32 v249, v139, v140, v141
    v_max3_f32 v248, v248, v142, v143
    v_max3_f32 v248, v248, v249, v25
    v_mov_b32 v249, v248
    s_nop 1
    v_permlane16_swap_b32 v248, v249
    s_nop 0
    v_max_f32 v248, v248, v249
    v_mov_b32 v249, v248
    s_nop 1
    v_permlane32_swap_b32 v248, v249
    s_nop 0
    v_max_f32 v248, v248, v249
    v_sub_f32 v249, v25, v248
    v_exp_f32 v29, v249
    v_mov_b32 v25, v248
    v_sub_f32 v136, v136, v248
    v_sub_f32 v137, v137, v248
    v_sub_f32 v138, v138, v248
    v_sub_f32 v139, v139, v248
    v_sub_f32 v140, v140, v248
    v_sub_f32 v141, v141, v248
    v_sub_f32 v142, v142, v248
    v_sub_f32 v143, v143, v248
    v_exp_f32 v136, v136
    v_exp_f32 v137, v137
    v_exp_f32 v138, v138
    v_exp_f32 v139, v139
    v_exp_f32 v140, v140
    v_exp_f32 v141, v141
    v_exp_f32 v142, v142
    v_exp_f32 v143, v143
    v_mul_f32 v9, v9, v29
    v_add_f32 v9, v9, v136
    v_add_f32 v9, v9, v137
    v_add_f32 v9, v9, v138
    v_add_f32 v9, v9, v139
    v_add_f32 v9, v9, v140
    v_add_f32 v9, v9, v141
    v_add_f32 v9, v9, v142
    v_add_f32 v9, v9, v143
    v_cvt_pk_bf16_f32 v136, v136, v137
    v_cvt_pk_bf16_f32 v137, v138, v139
    v_cvt_pk_bf16_f32 v138, v140, v141
    v_cvt_pk_bf16_f32 v139, v142, v143
    v_accvgpr_read_b32 v252, a4
    v_accvgpr_read_b32 v253, a5
    v_accvgpr_read_b32 v254, a6
    v_accvgpr_read_b32 v255, a7
    v_mul_f32 v252, v252, v29
    v_mul_f32 v253, v253, v29
    v_mul_f32 v254, v254, v29
    v_mul_f32 v255, v255, v29
    v_accvgpr_write_b32 a4, v252
    v_accvgpr_write_b32 a5, v253
    v_accvgpr_write_b32 a6, v254
    v_accvgpr_write_b32 a7, v255
    v_accvgpr_read_b32 v252, a20
    v_accvgpr_read_b32 v253, a21
    v_accvgpr_read_b32 v254, a22
    v_accvgpr_read_b32 v255, a23
    v_mul_f32 v252, v252, v29
    v_mul_f32 v253, v253, v29
    v_mul_f32 v254, v254, v29
    v_mul_f32 v255, v255, v29
    v_accvgpr_write_b32 a20, v252
    v_accvgpr_write_b32 a21, v253
    v_accvgpr_write_b32 a22, v254
    v_accvgpr_write_b32 a23, v255
    v_accvgpr_read_b32 v252, a36
    v_accvgpr_read_b32 v253, a37
    v_accvgpr_read_b32 v254, a38
    v_accvgpr_read_b32 v255, a39
    v_mul_f32 v252, v252, v29
    v_mul_f32 v253, v253, v29
    v_mul_f32 v254, v254, v29
    v_mul_f32 v255, v255, v29
    v_accvgpr_write_b32 a36, v252
    v_accvgpr_write_b32 a37, v253
    v_accvgpr_write_b32 a38, v254
    v_accvgpr_write_b32 a39, v255
    v_accvgpr_read_b32 v252, a52
    v_accvgpr_read_b32 v253, a53
    v_accvgpr_read_b32 v254, a54
    v_accvgpr_read_b32 v255, a55
    v_mul_f32 v252, v252, v29
    v_mul_f32 v253, v253, v29
    v_mul_f32 v254, v254, v29
    v_mul_f32 v255, v255, v29
    v_accvgpr_write_b32 a52, v252
    v_accvgpr_write_b32 a53, v253
    v_accvgpr_write_b32 a54, v254
    v_accvgpr_write_b32 a55, v255
    v_accvgpr_read_b32 v252, a68
    v_accvgpr_read_b32 v253, a69
    v_accvgpr_read_b32 v254, a70
    v_accvgpr_read_b32 v255, a71
    v_mul_f32 v252, v252, v29
    v_mul_f32 v253, v253, v29
    v_mul_f32 v254, v254, v29
    v_mul_f32 v255, v255, v29
    v_accvgpr_write_b32 a68, v252
    v_accvgpr_write_b32 a69, v253
    v_accvgpr_write_b32 a70, v254
    v_accvgpr_write_b32 a71, v255
    v_accvgpr_read_b32 v252, a84
    v_accvgpr_read_b32 v253, a85
    v_accvgpr_read_b32 v254, a86
    v_accvgpr_read_b32 v255, a87
    v_mul_f32 v252, v252, v29
    v_mul_f32 v253, v253, v29
    v_mul_f32 v254, v254, v29
    v_mul_f32 v255, v255, v29
    v_accvgpr_write_b32 a84, v252
    v_accvgpr_write_b32 a85, v253
    v_accvgpr_write_b32 a86, v254
    v_accvgpr_write_b32 a87, v255
    v_accvgpr_read_b32 v252, a100
    v_accvgpr_read_b32 v253, a101
    v_accvgpr_read_b32 v254, a102
    v_accvgpr_read_b32 v255, a103
    v_mul_f32 v252, v252, v29
    v_mul_f32 v253, v253, v29
    v_mul_f32 v254, v254, v29
    v_mul_f32 v255, v255, v29
    v_accvgpr_write_b32 a100, v252
    v_accvgpr_write_b32 a101, v253
    v_accvgpr_write_b32 a102, v254
    v_accvgpr_write_b32 a103, v255
    v_accvgpr_read_b32 v252, a116
    v_accvgpr_read_b32 v253, a117
    v_accvgpr_read_b32 v254, a118
    v_accvgpr_read_b32 v255, a119
    v_mul_f32 v252, v252, v29
    v_mul_f32 v253, v253, v29
    v_mul_f32 v254, v254, v29
    v_mul_f32 v255, v255, v29
    v_accvgpr_write_b32 a116, v252
    v_accvgpr_write_b32 a117, v253
    v_accvgpr_write_b32 a118, v254
    v_accvgpr_write_b32 a119, v255
    v_max3_f32 v248, v144, v145, v146
    v_max3_f32 v249, v147, v148, v149
    v_max3_f32 v248, v248, v150, v151
    v_max3_f32 v248, v248, v249, v26
    v_mov_b32 v249, v248
    s_nop 1
    v_permlane16_swap_b32 v248, v249
    s_nop 0
    v_max_f32 v248, v248, v249
    v_mov_b32 v249, v248
    s_nop 1
    v_permlane32_swap_b32 v248, v249
    s_nop 0
    v_max_f32 v248, v248, v249
    v_sub_f32 v249, v26, v248
    v_exp_f32 v30, v249
    v_mov_b32 v26, v248
    v_sub_f32 v144, v144, v248
    v_sub_f32 v145, v145, v248
    v_sub_f32 v146, v146, v248
    v_sub_f32 v147, v147, v248
    v_sub_f32 v148, v148, v248
    v_sub_f32 v149, v149, v248
    v_sub_f32 v150, v150, v248
    v_sub_f32 v151, v151, v248
    v_exp_f32 v144, v144
    v_exp_f32 v145, v145
    v_exp_f32 v146, v146
    v_exp_f32 v147, v147
    v_exp_f32 v148, v148
    v_exp_f32 v149, v149
    v_exp_f32 v150, v150
    v_exp_f32 v151, v151
    v_mul_f32 v10, v10, v30
    v_add_f32 v10, v10, v144
    v_add_f32 v10, v10, v145
    v_add_f32 v10, v10, v146
    v_add_f32 v10, v10, v147
    v_add_f32 v10, v10, v148
    v_add_f32 v10, v10, v149
    v_add_f32 v10, v10, v150
    v_add_f32 v10, v10, v151
    v_cvt_pk_bf16_f32 v144, v144, v145
    v_cvt_pk_bf16_f32 v145, v146, v147
    v_cvt_pk_bf16_f32 v146, v148, v149
    v_cvt_pk_bf16_f32 v147, v150, v151
    v_accvgpr_read_b32 v252, a8
    v_accvgpr_read_b32 v253, a9
    v_accvgpr_read_b32 v254, a10
    v_accvgpr_read_b32 v255, a11
    v_mul_f32 v252, v252, v30
    v_mul_f32 v253, v253, v30
    v_mul_f32 v254, v254, v30
    v_mul_f32 v255, v255, v30
    v_accvgpr_write_b32 a8, v252
    v_accvgpr_write_b32 a9, v253
    v_accvgpr_write_b32 a10, v254
    v_accvgpr_write_b32 a11, v255
    v_accvgpr_read_b32 v252, a24
    v_accvgpr_read_b32 v253, a25
    v_accvgpr_read_b32 v254, a26
    v_accvgpr_read_b32 v255, a27
    v_mul_f32 v252, v252, v30
    v_mul_f32 v253, v253, v30
    v_mul_f32 v254, v254, v30
    v_mul_f32 v255, v255, v30
    v_accvgpr_write_b32 a24, v252
    v_accvgpr_write_b32 a25, v253
    v_accvgpr_write_b32 a26, v254
    v_accvgpr_write_b32 a27, v255
    v_accvgpr_read_b32 v252, a40
    v_accvgpr_read_b32 v253, a41
    v_accvgpr_read_b32 v254, a42
    v_accvgpr_read_b32 v255, a43
    v_mul_f32 v252, v252, v30
    v_mul_f32 v253, v253, v30
    v_mul_f32 v254, v254, v30
    v_mul_f32 v255, v255, v30
    v_accvgpr_write_b32 a40, v252
    v_accvgpr_write_b32 a41, v253
    v_accvgpr_write_b32 a42, v254
    v_accvgpr_write_b32 a43, v255
    v_accvgpr_read_b32 v252, a56
    v_accvgpr_read_b32 v253, a57
    v_accvgpr_read_b32 v254, a58
    v_accvgpr_read_b32 v255, a59
    v_mul_f32 v252, v252, v30
    v_mul_f32 v253, v253, v30
    v_mul_f32 v254, v254, v30
    v_mul_f32 v255, v255, v30
    v_accvgpr_write_b32 a56, v252
    v_accvgpr_write_b32 a57, v253
    v_accvgpr_write_b32 a58, v254
    v_accvgpr_write_b32 a59, v255
    v_accvgpr_read_b32 v252, a72
    v_accvgpr_read_b32 v253, a73
    v_accvgpr_read_b32 v254, a74
    v_accvgpr_read_b32 v255, a75
    v_mul_f32 v252, v252, v30
    v_mul_f32 v253, v253, v30
    v_mul_f32 v254, v254, v30
    v_mul_f32 v255, v255, v30
    v_accvgpr_write_b32 a72, v252
    v_accvgpr_write_b32 a73, v253
    v_accvgpr_write_b32 a74, v254
    v_accvgpr_write_b32 a75, v255
    v_accvgpr_read_b32 v252, a88
    v_accvgpr_read_b32 v253, a89
    v_accvgpr_read_b32 v254, a90
    v_accvgpr_read_b32 v255, a91
    v_mul_f32 v252, v252, v30
    v_mul_f32 v253, v253, v30
    v_mul_f32 v254, v254, v30
    v_mul_f32 v255, v255, v30
    v_accvgpr_write_b32 a88, v252
    v_accvgpr_write_b32 a89, v253
    v_accvgpr_write_b32 a90, v254
    v_accvgpr_write_b32 a91, v255
    v_accvgpr_read_b32 v252, a104
    v_accvgpr_read_b32 v253, a105
    v_accvgpr_read_b32 v254, a106
    v_accvgpr_read_b32 v255, a107
    v_mul_f32 v252, v252, v30
    v_mul_f32 v253, v253, v30
    v_mul_f32 v254, v254, v30
    v_mul_f32 v255, v255, v30
    v_accvgpr_write_b32 a104, v252
    v_accvgpr_write_b32 a105, v253
    v_accvgpr_write_b32 a106, v254
    v_accvgpr_write_b32 a107, v255
    v_accvgpr_read_b32 v252, a120
    v_accvgpr_read_b32 v253, a121
    v_accvgpr_read_b32 v254, a122
    v_accvgpr_read_b32 v255, a123
    v_mul_f32 v252, v252, v30
    v_mul_f32 v253, v253, v30
    v_mul_f32 v254, v254, v30
    v_mul_f32 v255, v255, v30
    v_accvgpr_write_b32 a120, v252
    v_accvgpr_write_b32 a121, v253
    v_accvgpr_write_b32 a122, v254
    v_accvgpr_write_b32 a123, v255
    v_max3_f32 v248, v152, v153, v154
    v_max3_f32 v249, v155, v156, v157
    v_max3_f32 v248, v248, v158, v159
    v_max3_f32 v248, v248, v249, v27
    v_mov_b32 v249, v248
    s_nop 1
    v_permlane16_swap_b32 v248, v249
    s_nop 0
    v_max_f32 v248, v248, v249
    v_mov_b32 v249, v248
    s_nop 1
    v_permlane32_swap_b32 v248, v249
    s_nop 0
    v_max_f32 v248, v248, v249
    v_sub_f32 v249, v27, v248
    v_exp_f32 v31, v249
    v_mov_b32 v27, v248
    v_sub_f32 v152, v152, v248
    v_sub_f32 v153, v153, v248
    v_sub_f32 v154, v154, v248
    v_sub_f32 v155, v155, v248
    v_sub_f32 v156, v156, v248
    v_sub_f32 v157, v157, v248
    v_sub_f32 v158, v158, v248
    v_sub_f32 v159, v159, v248
    v_exp_f32 v152, v152
    v_exp_f32 v153, v153
    v_exp_f32 v154, v154
    v_exp_f32 v155, v155
    v_exp_f32 v156, v156
    v_exp_f32 v157, v157
    v_exp_f32 v158, v158
    v_exp_f32 v159, v159
    v_mul_f32 v11, v11, v31
    v_add_f32 v11, v11, v152
    v_add_f32 v11, v11, v153
    v_add_f32 v11, v11, v154
    v_add_f32 v11, v11, v155
    v_add_f32 v11, v11, v156
    v_add_f32 v11, v11, v157
    v_add_f32 v11, v11, v158
    v_add_f32 v11, v11, v159
    v_cvt_pk_bf16_f32 v152, v152, v153
    v_cvt_pk_bf16_f32 v153, v154, v155
    v_cvt_pk_bf16_f32 v154, v156, v157
    v_cvt_pk_bf16_f32 v155, v158, v159
    v_accvgpr_read_b32 v252, a12
    v_accvgpr_read_b32 v253, a13
    v_accvgpr_read_b32 v254, a14
    v_accvgpr_read_b32 v255, a15
    v_mul_f32 v252, v252, v31
    v_mul_f32 v253, v253, v31
    v_mul_f32 v254, v254, v31
    v_mul_f32 v255, v255, v31
    v_accvgpr_write_b32 a12, v252
    v_accvgpr_write_b32 a13, v253
    v_accvgpr_write_b32 a14, v254
    v_accvgpr_write_b32 a15, v255
    v_accvgpr_read_b32 v252, a28
    v_accvgpr_read_b32 v253, a29
    v_accvgpr_read_b32 v254, a30
    v_accvgpr_read_b32 v255, a31
    v_mul_f32 v252, v252, v31
    v_mul_f32 v253, v253, v31
    v_mul_f32 v254, v254, v31
    v_mul_f32 v255, v255, v31
    v_accvgpr_write_b32 a28, v252
    v_accvgpr_write_b32 a29, v253
    v_accvgpr_write_b32 a30, v254
    v_accvgpr_write_b32 a31, v255
    v_accvgpr_read_b32 v252, a44
    v_accvgpr_read_b32 v253, a45
    v_accvgpr_read_b32 v254, a46
    v_accvgpr_read_b32 v255, a47
    v_mul_f32 v252, v252, v31
    v_mul_f32 v253, v253, v31
    v_mul_f32 v254, v254, v31
    v_mul_f32 v255, v255, v31
    v_accvgpr_write_b32 a44, v252
    v_accvgpr_write_b32 a45, v253
    v_accvgpr_write_b32 a46, v254
    v_accvgpr_write_b32 a47, v255
    v_accvgpr_read_b32 v252, a60
    v_accvgpr_read_b32 v253, a61
    v_accvgpr_read_b32 v254, a62
    v_accvgpr_read_b32 v255, a63
    v_mul_f32 v252, v252, v31
    v_mul_f32 v253, v253, v31
    v_mul_f32 v254, v254, v31
    v_mul_f32 v255, v255, v31
    v_accvgpr_write_b32 a60, v252
    v_accvgpr_write_b32 a61, v253
    v_accvgpr_write_b32 a62, v254
    v_accvgpr_write_b32 a63, v255
    v_accvgpr_read_b32 v252, a76
    v_accvgpr_read_b32 v253, a77
    v_accvgpr_read_b32 v254, a78
    v_accvgpr_read_b32 v255, a79
    v_mul_f32 v252, v252, v31
    v_mul_f32 v253, v253, v31
    v_mul_f32 v254, v254, v31
    v_mul_f32 v255, v255, v31
    v_accvgpr_write_b32 a76, v252
    v_accvgpr_write_b32 a77, v253
    v_accvgpr_write_b32 a78, v254
    v_accvgpr_write_b32 a79, v255
    v_accvgpr_read_b32 v252, a92
    v_accvgpr_read_b32 v253, a93
    v_accvgpr_read_b32 v254, a94
    v_accvgpr_read_b32 v255, a95
    v_mul_f32 v252, v252, v31
    v_mul_f32 v253, v253, v31
    v_mul_f32 v254, v254, v31
    v_mul_f32 v255, v255, v31
    v_accvgpr_write_b32 a92, v252
    v_accvgpr_write_b32 a93, v253
    v_accvgpr_write_b32 a94, v254
    v_accvgpr_write_b32 a95, v255
    v_accvgpr_read_b32 v252, a108
    v_accvgpr_read_b32 v253, a109
    v_accvgpr_read_b32 v254, a110
    v_accvgpr_read_b32 v255, a111
    v_mul_f32 v252, v252, v31
    v_mul_f32 v253, v253, v31
    v_mul_f32 v254, v254, v31
    v_mul_f32 v255, v255, v31
    v_accvgpr_write_b32 a108, v252
    v_accvgpr_write_b32 a109, v253
    v_accvgpr_write_b32 a110, v254
    v_accvgpr_write_b32 a111, v255
    v_accvgpr_read_b32 v252, a124
    v_accvgpr_read_b32 v253, a125
    v_accvgpr_read_b32 v254, a126
    v_accvgpr_read_b32 v255, a127
    v_mul_f32 v252, v252, v31
    v_mul_f32 v253, v253, v31
    v_mul_f32 v254, v254, v31
    v_mul_f32 v255, v255, v31
    v_accvgpr_write_b32 a124, v252
    v_accvgpr_write_b32 a125, v253
    v_accvgpr_write_b32 a126, v254
    v_accvgpr_write_b32 a127, v255
    s_nop 1
    v_mfma_f32_16x16x32_bf16 a[0:3], a[128:131], v[128:131], a[0:3]
    v_mfma_f32_16x16x32_bf16 a[16:19], a[132:135], v[128:131], a[16:19]
    v_mfma_f32_16x16x32_bf16 a[32:35], a[136:139], v[128:131], a[32:35]
    v_mfma_f32_16x16x32_bf16 a[48:51], a[140:143], v[128:131], a[48:51]
    v_mfma_f32_16x16x32_bf16 a[64:67], a[144:147], v[128:131], a[64:67]
    v_mfma_f32_16x16x32_bf16 a[80:83], a[148:151], v[128:131], a[80:83]
    v_mfma_f32_16x16x32_bf16 a[96:99], a[152:155], v[128:131], a[96:99]
    v_mfma_f32_16x16x32_bf16 a[112:115], a[156:159], v[128:131], a[112:115]
    v_mfma_f32_16x16x32_bf16 a[4:7], a[128:131], v[136:139], a[4:7]
    v_mfma_f32_16x16x32_bf16 a[20:23], a[132:135], v[136:139], a[20:23]
    v_mfma_f32_16x16x32_bf16 a[36:39], a[136:139], v[136:139], a[36:39]
    v_mfma_f32_16x16x32_bf16 a[52:55], a[140:143], v[136:139], a[52:55]
    v_mfma_f32_16x16x32_bf16 a[68:71], a[144:147], v[136:139], a[68:71]
    v_mfma_f32_16x16x32_bf16 a[84:87], a[148:151], v[136:139], a[84:87]
    v_mfma_f32_16x16x32_bf16 a[100:103], a[152:155], v[136:139], a[100:103]
    v_mfma_f32_16x16x32_bf16 a[116:119], a[156:159], v[136:139], a[116:119]
    v_mfma_f32_16x16x32_bf16 a[8:11], a[128:131], v[144:147], a[8:11]
    v_mfma_f32_16x16x32_bf16 a[24:27], a[132:135], v[144:147], a[24:27]
    v_mfma_f32_16x16x32_bf16 a[40:43], a[136:139], v[144:147], a[40:43]
    v_mfma_f32_16x16x32_bf16 a[56:59], a[140:143], v[144:147], a[56:59]
    v_mfma_f32_16x16x32_bf16 a[72:75], a[144:147], v[144:147], a[72:75]
    v_mfma_f32_16x16x32_bf16 a[88:91], a[148:151], v[144:147], a[88:91]
    v_mfma_f32_16x16x32_bf16 a[104:107], a[152:155], v[144:147], a[104:107]
    v_mfma_f32_16x16x32_bf16 a[120:123], a[156:159], v[144:147], a[120:123]
    v_mfma_f32_16x16x32_bf16 a[12:15], a[128:131], v[152:155], a[12:15]
    v_mfma_f32_16x16x32_bf16 a[28:31], a[132:135], v[152:155], a[28:31]
    v_mfma_f32_16x16x32_bf16 a[44:47], a[136:139], v[152:155], a[44:47]
    v_mfma_f32_16x16x32_bf16 a[60:63], a[140:143], v[152:155], a[60:63]
    v_mfma_f32_16x16x32_bf16 a[76:79], a[144:147], v[152:155], a[76:79]
    v_mfma_f32_16x16x32_bf16 a[92:95], a[148:151], v[152:155], a[92:95]
    v_mfma_f32_16x16x32_bf16 a[108:111], a[152:155], v[152:155], a[108:111]
    v_mfma_f32_16x16x32_bf16 a[124:127], a[156:159], v[152:155], a[124:127]
    s_nop 7
    ds_read_b128 a[160:163], v20 offset:57344
    ds_read_b128 a[164:167], v20 offset:61440
    ds_read_b128 a[168:171], v21 offset:57344
    ds_read_b128 a[172:175], v21 offset:61440
    ds_read_b128 a[176:179], v22 offset:57344
    ds_read_b128 a[180:183], v22 offset:61440
    ds_read_b128 a[184:187], v23 offset:57344
    ds_read_b128 a[188:191], v23 offset:61440
    ds_read_b64_tr_b16 a[128:129], v32 offset:8192
    ds_read_b64_tr_b16 a[130:131], v32 offset:12288
    ds_read_b64_tr_b16 a[132:133], v33 offset:8192
    ds_read_b64_tr_b16 a[134:135], v33 offset:12288
    ds_read_b64_tr_b16 a[136:137], v34 offset:8192
    ds_read_b64_tr_b16 a[138:139], v34 offset:12288
    ds_read_b64_tr_b16 a[140:141], v35 offset:8192
    ds_read_b64_tr_b16 a[142:143], v35 offset:12288
    ds_read_b64_tr_b16 a[144:145], v36 offset:8192
    ds_read_b64_tr_b16 a[146:147], v36 offset:12288
    ds_read_b64_tr_b16 a[148:149], v37 offset:8192
    ds_read_b64_tr_b16 a[150:151], v37 offset:12288
    ds_read_b64_tr_b16 a[152:153], v38 offset:8192
    ds_read_b64_tr_b16 a[154:155], v38 offset:12288
    ds_read_b64_tr_b16 a[156:157], v39 offset:8192
    ds_read_b64_tr_b16 a[158:159], v39 offset:12288
    s_waitcnt lgkmcnt(0)
    v_mfma_f32_16x16x32_bf16 v[160:163], a[160:163], v[64:67], 0
    v_mfma_f32_16x16x32_bf16 v[160:163], a[168:171], v[68:71], v[160:163]
    v_mfma_f32_16x16x32_bf16 v[160:163], a[176:179], v[72:75], v[160:163]
    v_mfma_f32_16x16x32_bf16 v[160:163], a[184:187], v[76:79], v[160:163]
    v_mfma_f32_16x16x32_bf16 v[168:171], a[160:163], v[80:83], 0
    v_mfma_f32_16x16x32_bf16 v[168:171], a[168:171], v[84:87], v[168:171]
    v_mfma_f32_16x16x32_bf16 v[168:171], a[176:179], v[88:91], v[168:171]
    v_mfma_f32_16x16x32_bf16 v[168:171], a[184:187], v[92:95], v[168:171]
    v_mfma_f32_16x16x32_bf16 v[176:179], a[160:163], v[96:99], 0
    v_mfma_f32_16x16x32_bf16 v[176:179], a[168:171], v[100:103], v[176:179]
    v_mfma_f32_16x16x32_bf16 v[176:179], a[176:179], v[104:107], v[176:179]
    v_mfma_f32_16x16x32_bf16 v[176:179], a[184:187], v[108:111], v[176:179]
    v_mfma_f32_16x16x32_bf16 v[184:187], a[160:163], v[112:115], 0
    v_mfma_f32_16x16x32_bf16 v[184:187], a[168:171], v[116:119], v[184:187]
    v_mfma_f32_16x16x32_bf16 v[184:187], a[176:179], v[120:123], v[184:187]
    v_mfma_f32_16x16x32_bf16 v[184:187], a[184:187], v[124:127], v[184:187]
    v_mfma_f32_16x16x32_bf16 v[164:167], a[164:167], v[64:67], 0
    v_mfma_f32_16x16x32_bf16 v[164:167], a[172:175], v[68:71], v[164:167]
    v_mfma_f32_16x16x32_bf16 v[164:167], a[180:183], v[72:75], v[164:167]
    v_mfma_f32_16x16x32_bf16 v[164:167], a[188:191], v[76:79], v[164:167]
    v_mfma_f32_16x16x32_bf16 v[172:175], a[164:167], v[80:83], 0
    v_mfma_f32_16x16x32_bf16 v[172:175], a[172:175], v[84:87], v[172:175]
    v_mfma_f32_16x16x32_bf16 v[172:175], a[180:183], v[88:91], v[172:175]
    v_mfma_f32_16x16x32_bf16 v[172:175], a[188:191], v[92:95], v[172:175]
    v_mfma_f32_16x16x32_bf16 v[180:183], a[164:167], v[96:99], 0
    v_mfma_f32_16x16x32_bf16 v[180:183], a[172:175], v[100:103], v[180:183]
    v_mfma_f32_16x16x32_bf16 v[180:183], a[180:183], v[104:107], v[180:183]
    v_mfma_f32_16x16x32_bf16 v[180:183], a[188:191], v[108:111], v[180:183]
    v_mfma_f32_16x16x32_bf16 v[188:191], a[164:167], v[112:115], 0
    v_mfma_f32_16x16x32_bf16 v[188:191], a[172:175], v[116:119], v[188:191]
    v_mfma_f32_16x16x32_bf16 v[188:191], a[180:183], v[120:123], v[188:191]
    v_mfma_f32_16x16x32_bf16 v[188:191], a[188:191], v[124:127], v[188:191]
    s_nop 7
    v_max3_f32 v248, v160, v161, v162
    v_max3_f32 v249, v163, v164, v165
    v_max3_f32 v248, v248, v166, v167
    v_max3_f32 v248, v248, v249, v24
    v_mov_b32 v249, v248
    s_nop 1
    v_permlane16_swap_b32 v248, v249
    s_nop 0
    v_max_f32 v248, v248, v249
    v_mov_b32 v249, v248
    s_nop 1
    v_permlane32_swap_b32 v248, v249
    s_nop 0
    v_max_f32 v248, v248, v249
    v_sub_f32 v249, v24, v248
    v_exp_f32 v28, v249
    v_mov_b32 v24, v248
    v_sub_f32 v160, v160, v248
    v_sub_f32 v161, v161, v248
    v_sub_f32 v162, v162, v248
    v_sub_f32 v163, v163, v248
    v_sub_f32 v164, v164, v248
    v_sub_f32 v165, v165, v248
    v_sub_f32 v166, v166, v248
    v_sub_f32 v167, v167, v248
    v_exp_f32 v160, v160
    v_exp_f32 v161, v161
    v_exp_f32 v162, v162
    v_exp_f32 v163, v163
    v_exp_f32 v164, v164
    v_exp_f32 v165, v165
    v_exp_f32 v166, v166
    v_exp_f32 v167, v167
    v_mul_f32 v8, v8, v28
    v_add_f32 v8, v8, v160
    v_add_f32 v8, v8, v161
    v_add_f32 v8, v8, v162
    v_add_f32 v8, v8, v163
    v_add_f32 v8, v8, v164
    v_add_f32 v8, v8, v165
    v_add_f32 v8, v8, v166
    v_add_f32 v8, v8, v167
    v_cvt_pk_bf16_f32 v160, v160, v161
    v_cvt_pk_bf16_f32 v161, v162, v163
    v_cvt_pk_bf16_f32 v162, v164, v165
    v_cvt_pk_bf16_f32 v163, v166, v167
    v_accvgpr_read_b32 v252, a0
    v_accvgpr_read_b32 v253, a1
    v_accvgpr_read_b32 v254, a2
    v_accvgpr_read_b32 v255, a3
    v_mul_f32 v252, v252, v28
    v_mul_f32 v253, v253, v28
    v_mul_f32 v254, v254, v28
    v_mul_f32 v255, v255, v28
    v_accvgpr_write_b32 a0, v252
    v_accvgpr_write_b32 a1, v253
    v_accvgpr_write_b32 a2, v254
    v_accvgpr_write_b32 a3, v255
    v_accvgpr_read_b32 v252, a16
    v_accvgpr_read_b32 v253, a17
    v_accvgpr_read_b32 v254, a18
    v_accvgpr_read_b32 v255, a19
    v_mul_f32 v252, v252, v28
    v_mul_f32 v253, v253, v28
    v_mul_f32 v254, v254, v28
    v_mul_f32 v255, v255, v28
    v_accvgpr_write_b32 a16, v252
    v_accvgpr_write_b32 a17, v253
    v_accvgpr_write_b32 a18, v254
    v_accvgpr_write_b32 a19, v255
    v_accvgpr_read_b32 v252, a32
    v_accvgpr_read_b32 v253, a33
    v_accvgpr_read_b32 v254, a34
    v_accvgpr_read_b32 v255, a35
    v_mul_f32 v252, v252, v28
    v_mul_f32 v253, v253, v28
    v_mul_f32 v254, v254, v28
    v_mul_f32 v255, v255, v28
    v_accvgpr_write_b32 a32, v252
    v_accvgpr_write_b32 a33, v253
    v_accvgpr_write_b32 a34, v254
    v_accvgpr_write_b32 a35, v255
    v_accvgpr_read_b32 v252, a48
    v_accvgpr_read_b32 v253, a49
    v_accvgpr_read_b32 v254, a50
    v_accvgpr_read_b32 v255, a51
    v_mul_f32 v252, v252, v28
    v_mul_f32 v253, v253, v28
    v_mul_f32 v254, v254, v28
    v_mul_f32 v255, v255, v28
    v_accvgpr_write_b32 a48, v252
    v_accvgpr_write_b32 a49, v253
    v_accvgpr_write_b32 a50, v254
    v_accvgpr_write_b32 a51, v255
    v_accvgpr_read_b32 v252, a64
    v_accvgpr_read_b32 v253, a65
    v_accvgpr_read_b32 v254, a66
    v_accvgpr_read_b32 v255, a67
    v_mul_f32 v252, v252, v28
    v_mul_f32 v253, v253, v28
    v_mul_f32 v254, v254, v28
    v_mul_f32 v255, v255, v28
    v_accvgpr_write_b32 a64, v252
    v_accvgpr_write_b32 a65, v253
    v_accvgpr_write_b32 a66, v254
    v_accvgpr_write_b32 a67, v255
    v_accvgpr_read_b32 v252, a80
    v_accvgpr_read_b32 v253, a81
    v_accvgpr_read_b32 v254, a82
    v_accvgpr_read_b32 v255, a83
    v_mul_f32 v252, v252, v28
    v_mul_f32 v253, v253, v28
    v_mul_f32 v254, v254, v28
    v_mul_f32 v255, v255, v28
    v_accvgpr_write_b32 a80, v252
    v_accvgpr_write_b32 a81, v253
    v_accvgpr_write_b32 a82, v254
    v_accvgpr_write_b32 a83, v255
    v_accvgpr_read_b32 v252, a96
    v_accvgpr_read_b32 v253, a97
    v_accvgpr_read_b32 v254, a98
    v_accvgpr_read_b32 v255, a99
    v_mul_f32 v252, v252, v28
    v_mul_f32 v253, v253, v28
    v_mul_f32 v254, v254, v28
    v_mul_f32 v255, v255, v28
    v_accvgpr_write_b32 a96, v252
    v_accvgpr_write_b32 a97, v253
    v_accvgpr_write_b32 a98, v254
    v_accvgpr_write_b32 a99, v255
    v_accvgpr_read_b32 v252, a112
    v_accvgpr_read_b32 v253, a113
    v_accvgpr_read_b32 v254, a114
    v_accvgpr_read_b32 v255, a115
    v_mul_f32 v252, v252, v28
    v_mul_f32 v253, v253, v28
    v_mul_f32 v254, v254, v28
    v_mul_f32 v255, v255, v28
    v_accvgpr_write_b32 a112, v252
    v_accvgpr_write_b32 a113, v253
    v_accvgpr_write_b32 a114, v254
    v_accvgpr_write_b32 a115, v255
    v_max3_f32 v248, v168, v169, v170
    v_max3_f32 v249, v171, v172, v173
    v_max3_f32 v248, v248, v174, v175
    v_max3_f32 v248, v248, v249, v25
    v_mov_b32 v249, v248
    s_nop 1
    v_permlane16_swap_b32 v248, v249
    s_nop 0
    v_max_f32 v248, v248, v249
    v_mov_b32 v249, v248
    s_nop 1
    v_permlane32_swap_b32 v248, v249
    s_nop 0
    v_max_f32 v248, v248, v249
    v_sub_f32 v249, v25, v248
    v_exp_f32 v29, v249
    v_mov_b32 v25, v248
    v_sub_f32 v168, v168, v248
    v_sub_f32 v169, v169, v248
    v_sub_f32 v170, v170, v248
    v_sub_f32 v171, v171, v248
    v_sub_f32 v172, v172, v248
    v_sub_f32 v173, v173, v248
    v_sub_f32 v174, v174, v248
    v_sub_f32 v175, v175, v248
    v_exp_f32 v168, v168
    v_exp_f32 v169, v169
    v_exp_f32 v170, v170
    v_exp_f32 v171, v171
    v_exp_f32 v172, v172
    v_exp_f32 v173, v173
    v_exp_f32 v174, v174
    v_exp_f32 v175, v175
    v_mul_f32 v9, v9, v29
    v_add_f32 v9, v9, v168
    v_add_f32 v9, v9, v169
    v_add_f32 v9, v9, v170
    v_add_f32 v9, v9, v171
    v_add_f32 v9, v9, v172
    v_add_f32 v9, v9, v173
    v_add_f32 v9, v9, v174
    v_add_f32 v9, v9, v175
    v_cvt_pk_bf16_f32 v168, v168, v169
    v_cvt_pk_bf16_f32 v169, v170, v171
    v_cvt_pk_bf16_f32 v170, v172, v173
    v_cvt_pk_bf16_f32 v171, v174, v175
    v_accvgpr_read_b32 v252, a4
    v_accvgpr_read_b32 v253, a5
    v_accvgpr_read_b32 v254, a6
    v_accvgpr_read_b32 v255, a7
    v_mul_f32 v252, v252, v29
    v_mul_f32 v253, v253, v29
    v_mul_f32 v254, v254, v29
    v_mul_f32 v255, v255, v29
    v_accvgpr_write_b32 a4, v252
    v_accvgpr_write_b32 a5, v253
    v_accvgpr_write_b32 a6, v254
    v_accvgpr_write_b32 a7, v255
    v_accvgpr_read_b32 v252, a20
    v_accvgpr_read_b32 v253, a21
    v_accvgpr_read_b32 v254, a22
    v_accvgpr_read_b32 v255, a23
    v_mul_f32 v252, v252, v29
    v_mul_f32 v253, v253, v29
    v_mul_f32 v254, v254, v29
    v_mul_f32 v255, v255, v29
    v_accvgpr_write_b32 a20, v252
    v_accvgpr_write_b32 a21, v253
    v_accvgpr_write_b32 a22, v254
    v_accvgpr_write_b32 a23, v255
    v_accvgpr_read_b32 v252, a36
    v_accvgpr_read_b32 v253, a37
    v_accvgpr_read_b32 v254, a38
    v_accvgpr_read_b32 v255, a39
    v_mul_f32 v252, v252, v29
    v_mul_f32 v253, v253, v29
    v_mul_f32 v254, v254, v29
    v_mul_f32 v255, v255, v29
    v_accvgpr_write_b32 a36, v252
    v_accvgpr_write_b32 a37, v253
    v_accvgpr_write_b32 a38, v254
    v_accvgpr_write_b32 a39, v255
    v_accvgpr_read_b32 v252, a52
    v_accvgpr_read_b32 v253, a53
    v_accvgpr_read_b32 v254, a54
    v_accvgpr_read_b32 v255, a55
    v_mul_f32 v252, v252, v29
    v_mul_f32 v253, v253, v29
    v_mul_f32 v254, v254, v29
    v_mul_f32 v255, v255, v29
    v_accvgpr_write_b32 a52, v252
    v_accvgpr_write_b32 a53, v253
    v_accvgpr_write_b32 a54, v254
    v_accvgpr_write_b32 a55, v255
    v_accvgpr_read_b32 v252, a68
    v_accvgpr_read_b32 v253, a69
    v_accvgpr_read_b32 v254, a70
    v_accvgpr_read_b32 v255, a71
    v_mul_f32 v252, v252, v29
    v_mul_f32 v253, v253, v29
    v_mul_f32 v254, v254, v29
    v_mul_f32 v255, v255, v29
    v_accvgpr_write_b32 a68, v252
    v_accvgpr_write_b32 a69, v253
    v_accvgpr_write_b32 a70, v254
    v_accvgpr_write_b32 a71, v255
    v_accvgpr_read_b32 v252, a84
    v_accvgpr_read_b32 v253, a85
    v_accvgpr_read_b32 v254, a86
    v_accvgpr_read_b32 v255, a87
    v_mul_f32 v252, v252, v29
    v_mul_f32 v253, v253, v29
    v_mul_f32 v254, v254, v29
    v_mul_f32 v255, v255, v29
    v_accvgpr_write_b32 a84, v252
    v_accvgpr_write_b32 a85, v253
    v_accvgpr_write_b32 a86, v254
    v_accvgpr_write_b32 a87, v255
    v_accvgpr_read_b32 v252, a100
    v_accvgpr_read_b32 v253, a101
    v_accvgpr_read_b32 v254, a102
    v_accvgpr_read_b32 v255, a103
    v_mul_f32 v252, v252, v29
    v_mul_f32 v253, v253, v29
    v_mul_f32 v254, v254, v29
    v_mul_f32 v255, v255, v29
    v_accvgpr_write_b32 a100, v252
    v_accvgpr_write_b32 a101, v253
    v_accvgpr_write_b32 a102, v254
    v_accvgpr_write_b32 a103, v255
    v_accvgpr_read_b32 v252, a116
    v_accvgpr_read_b32 v253, a117
    v_accvgpr_read_b32 v254, a118
    v_accvgpr_read_b32 v255, a119
    v_mul_f32 v252, v252, v29
    v_mul_f32 v253, v253, v29
    v_mul_f32 v254, v254, v29
    v_mul_f32 v255, v255, v29
    v_accvgpr_write_b32 a116, v252
    v_accvgpr_write_b32 a117, v253
    v_accvgpr_write_b32 a118, v254
    v_accvgpr_write_b32 a119, v255
    v_max3_f32 v248, v176, v177, v178
    v_max3_f32 v249, v179, v180, v181
    v_max3_f32 v248, v248, v182, v183
    v_max3_f32 v248, v248, v249, v26
    v_mov_b32 v249, v248
    s_nop 1
    v_permlane16_swap_b32 v248, v249
    s_nop 0
    v_max_f32 v248, v248, v249
    v_mov_b32 v249, v248
    s_nop 1
    v_permlane32_swap_b32 v248, v249
    s_nop 0
    v_max_f32 v248, v248, v249
    v_sub_f32 v249, v26, v248
    v_exp_f32 v30, v249
    v_mov_b32 v26, v248
    v_sub_f32 v176, v176, v248
    v_sub_f32 v177, v177, v248
    v_sub_f32 v178, v178, v248
    v_sub_f32 v179, v179, v248
    v_sub_f32 v180, v180, v248
    v_sub_f32 v181, v181, v248
    v_sub_f32 v182, v182, v248
    v_sub_f32 v183, v183, v248
    v_exp_f32 v176, v176
    v_exp_f32 v177, v177
    v_exp_f32 v178, v178
    v_exp_f32 v179, v179
    v_exp_f32 v180, v180
    v_exp_f32 v181, v181
    v_exp_f32 v182, v182
    v_exp_f32 v183, v183
    v_mul_f32 v10, v10, v30
    v_add_f32 v10, v10, v176
    v_add_f32 v10, v10, v177
    v_add_f32 v10, v10, v178
    v_add_f32 v10, v10, v179
    v_add_f32 v10, v10, v180
    v_add_f32 v10, v10, v181
    v_add_f32 v10, v10, v182
    v_add_f32 v10, v10, v183
    v_cvt_pk_bf16_f32 v176, v176, v177
    v_cvt_pk_bf16_f32 v177, v178, v179
    v_cvt_pk_bf16_f32 v178, v180, v181
    v_cvt_pk_bf16_f32 v179, v182, v183
    v_accvgpr_read_b32 v252, a8
    v_accvgpr_read_b32 v253, a9
    v_accvgpr_read_b32 v254, a10
    v_accvgpr_read_b32 v255, a11
    v_mul_f32 v252, v252, v30
    v_mul_f32 v253, v253, v30
    v_mul_f32 v254, v254, v30
    v_mul_f32 v255, v255, v30
    v_accvgpr_write_b32 a8, v252
    v_accvgpr_write_b32 a9, v253
    v_accvgpr_write_b32 a10, v254
    v_accvgpr_write_b32 a11, v255
    v_accvgpr_read_b32 v252, a24
    v_accvgpr_read_b32 v253, a25
    v_accvgpr_read_b32 v254, a26
    v_accvgpr_read_b32 v255, a27
    v_mul_f32 v252, v252, v30
    v_mul_f32 v253, v253, v30
    v_mul_f32 v254, v254, v30
    v_mul_f32 v255, v255, v30
    v_accvgpr_write_b32 a24, v252
    v_accvgpr_write_b32 a25, v253
    v_accvgpr_write_b32 a26, v254
    v_accvgpr_write_b32 a27, v255
    v_accvgpr_read_b32 v252, a40
    v_accvgpr_read_b32 v253, a41
    v_accvgpr_read_b32 v254, a42
    v_accvgpr_read_b32 v255, a43
    v_mul_f32 v252, v252, v30
    v_mul_f32 v253, v253, v30
    v_mul_f32 v254, v254, v30
    v_mul_f32 v255, v255, v30
    v_accvgpr_write_b32 a40, v252
    v_accvgpr_write_b32 a41, v253
    v_accvgpr_write_b32 a42, v254
    v_accvgpr_write_b32 a43, v255
    v_accvgpr_read_b32 v252, a56
    v_accvgpr_read_b32 v253, a57
    v_accvgpr_read_b32 v254, a58
    v_accvgpr_read_b32 v255, a59
    v_mul_f32 v252, v252, v30
    v_mul_f32 v253, v253, v30
    v_mul_f32 v254, v254, v30
    v_mul_f32 v255, v255, v30
    v_accvgpr_write_b32 a56, v252
    v_accvgpr_write_b32 a57, v253
    v_accvgpr_write_b32 a58, v254
    v_accvgpr_write_b32 a59, v255
    v_accvgpr_read_b32 v252, a72
    v_accvgpr_read_b32 v253, a73
    v_accvgpr_read_b32 v254, a74
    v_accvgpr_read_b32 v255, a75
    v_mul_f32 v252, v252, v30
    v_mul_f32 v253, v253, v30
    v_mul_f32 v254, v254, v30
    v_mul_f32 v255, v255, v30
    v_accvgpr_write_b32 a72, v252
    v_accvgpr_write_b32 a73, v253
    v_accvgpr_write_b32 a74, v254
    v_accvgpr_write_b32 a75, v255
    v_accvgpr_read_b32 v252, a88
    v_accvgpr_read_b32 v253, a89
    v_accvgpr_read_b32 v254, a90
    v_accvgpr_read_b32 v255, a91
    v_mul_f32 v252, v252, v30
    v_mul_f32 v253, v253, v30
    v_mul_f32 v254, v254, v30
    v_mul_f32 v255, v255, v30
    v_accvgpr_write_b32 a88, v252
    v_accvgpr_write_b32 a89, v253
    v_accvgpr_write_b32 a90, v254
    v_accvgpr_write_b32 a91, v255
    v_accvgpr_read_b32 v252, a104
    v_accvgpr_read_b32 v253, a105
    v_accvgpr_read_b32 v254, a106
    v_accvgpr_read_b32 v255, a107
    v_mul_f32 v252, v252, v30
    v_mul_f32 v253, v253, v30
    v_mul_f32 v254, v254, v30
    v_mul_f32 v255, v255, v30
    v_accvgpr_write_b32 a104, v252
    v_accvgpr_write_b32 a105, v253
    v_accvgpr_write_b32 a106, v254
    v_accvgpr_write_b32 a107, v255
    v_accvgpr_read_b32 v252, a120
    v_accvgpr_read_b32 v253, a121
    v_accvgpr_read_b32 v254, a122
    v_accvgpr_read_b32 v255, a123
    v_mul_f32 v252, v252, v30
    v_mul_f32 v253, v253, v30
    v_mul_f32 v254, v254, v30
    v_mul_f32 v255, v255, v30
    v_accvgpr_write_b32 a120, v252
    v_accvgpr_write_b32 a121, v253
    v_accvgpr_write_b32 a122, v254
    v_accvgpr_write_b32 a123, v255
    v_max3_f32 v248, v184, v185, v186
    v_max3_f32 v249, v187, v188, v189
    v_max3_f32 v248, v248, v190, v191
    v_max3_f32 v248, v248, v249, v27
    v_mov_b32 v249, v248
    s_nop 1
    v_permlane16_swap_b32 v248, v249
    s_nop 0
    v_max_f32 v248, v248, v249
    v_mov_b32 v249, v248
    s_nop 1
    v_permlane32_swap_b32 v248, v249
    s_nop 0
    v_max_f32 v248, v248, v249
    v_sub_f32 v249, v27, v248
    v_exp_f32 v31, v249
    v_mov_b32 v27, v248
    v_sub_f32 v184, v184, v248
    v_sub_f32 v185, v185, v248
    v_sub_f32 v186, v186, v248
    v_sub_f32 v187, v187, v248
    v_sub_f32 v188, v188, v248
    v_sub_f32 v189, v189, v248
    v_sub_f32 v190, v190, v248
    v_sub_f32 v191, v191, v248
    v_exp_f32 v184, v184
    v_exp_f32 v185, v185
    v_exp_f32 v186, v186
    v_exp_f32 v187, v187
    v_exp_f32 v188, v188
    v_exp_f32 v189, v189
    v_exp_f32 v190, v190
    v_exp_f32 v191, v191
    v_mul_f32 v11, v11, v31
    v_add_f32 v11, v11, v184
    v_add_f32 v11, v11, v185
    v_add_f32 v11, v11, v186
    v_add_f32 v11, v11, v187
    v_add_f32 v11, v11, v188
    v_add_f32 v11, v11, v189
    v_add_f32 v11, v11, v190
    v_add_f32 v11, v11, v191
    v_cvt_pk_bf16_f32 v184, v184, v185
    v_cvt_pk_bf16_f32 v185, v186, v187
    v_cvt_pk_bf16_f32 v186, v188, v189
    v_cvt_pk_bf16_f32 v187, v190, v191
    v_accvgpr_read_b32 v252, a12
    v_accvgpr_read_b32 v253, a13
    v_accvgpr_read_b32 v254, a14
    v_accvgpr_read_b32 v255, a15
    v_mul_f32 v252, v252, v31
    v_mul_f32 v253, v253, v31
    v_mul_f32 v254, v254, v31
    v_mul_f32 v255, v255, v31
    v_accvgpr_write_b32 a12, v252
    v_accvgpr_write_b32 a13, v253
    v_accvgpr_write_b32 a14, v254
    v_accvgpr_write_b32 a15, v255
    v_accvgpr_read_b32 v252, a28
    v_accvgpr_read_b32 v253, a29
    v_accvgpr_read_b32 v254, a30
    v_accvgpr_read_b32 v255, a31
    v_mul_f32 v252, v252, v31
    v_mul_f32 v253, v253, v31
    v_mul_f32 v254, v254, v31
    v_mul_f32 v255, v255, v31
    v_accvgpr_write_b32 a28, v252
    v_accvgpr_write_b32 a29, v253
    v_accvgpr_write_b32 a30, v254
    v_accvgpr_write_b32 a31, v255
    v_accvgpr_read_b32 v252, a44
    v_accvgpr_read_b32 v253, a45
    v_accvgpr_read_b32 v254, a46
    v_accvgpr_read_b32 v255, a47
    v_mul_f32 v252, v252, v31
    v_mul_f32 v253, v253, v31
    v_mul_f32 v254, v254, v31
    v_mul_f32 v255, v255, v31
    v_accvgpr_write_b32 a44, v252
    v_accvgpr_write_b32 a45, v253
    v_accvgpr_write_b32 a46, v254
    v_accvgpr_write_b32 a47, v255
    v_accvgpr_read_b32 v252, a60
    v_accvgpr_read_b32 v253, a61
    v_accvgpr_read_b32 v254, a62
    v_accvgpr_read_b32 v255, a63
    v_mul_f32 v252, v252, v31
    v_mul_f32 v253, v253, v31
    v_mul_f32 v254, v254, v31
    v_mul_f32 v255, v255, v31
    v_accvgpr_write_b32 a60, v252
    v_accvgpr_write_b32 a61, v253
    v_accvgpr_write_b32 a62, v254
    v_accvgpr_write_b32 a63, v255
    v_accvgpr_read_b32 v252, a76
    v_accvgpr_read_b32 v253, a77
    v_accvgpr_read_b32 v254, a78
    v_accvgpr_read_b32 v255, a79
    v_mul_f32 v252, v252, v31
    v_mul_f32 v253, v253, v31
    v_mul_f32 v254, v254, v31
    v_mul_f32 v255, v255, v31
    v_accvgpr_write_b32 a76, v252
    v_accvgpr_write_b32 a77, v253
    v_accvgpr_write_b32 a78, v254
    v_accvgpr_write_b32 a79, v255
    v_accvgpr_read_b32 v252, a92
    v_accvgpr_read_b32 v253, a93
    v_accvgpr_read_b32 v254, a94
    v_accvgpr_read_b32 v255, a95
    v_mul_f32 v252, v252, v31
    v_mul_f32 v253, v253, v31
    v_mul_f32 v254, v254, v31
    v_mul_f32 v255, v255, v31
    v_accvgpr_write_b32 a92, v252
    v_accvgpr_write_b32 a93, v253
    v_accvgpr_write_b32 a94, v254
    v_accvgpr_write_b32 a95, v255
    v_accvgpr_read_b32 v252, a108
    v_accvgpr_read_b32 v253, a109
    v_accvgpr_read_b32 v254, a110
    v_accvgpr_read_b32 v255, a111
    v_mul_f32 v252, v252, v31
    v_mul_f32 v253, v253, v31
    v_mul_f32 v254, v254, v31
    v_mul_f32 v255, v255, v31
    v_accvgpr_write_b32 a108, v252
    v_accvgpr_write_b32 a109, v253
    v_accvgpr_write_b32 a110, v254
    v_accvgpr_write_b32 a111, v255
    v_accvgpr_read_b32 v252, a124
    v_accvgpr_read_b32 v253, a125
    v_accvgpr_read_b32 v254, a126
    v_accvgpr_read_b32 v255, a127
    v_mul_f32 v252, v252, v31
    v_mul_f32 v253, v253, v31
    v_mul_f32 v254, v254, v31
    v_mul_f32 v255, v255, v31
    v_accvgpr_write_b32 a124, v252
    v_accvgpr_write_b32 a125, v253
    v_accvgpr_write_b32 a126, v254
    v_accvgpr_write_b32 a127, v255
    s_nop 1
    v_mfma_f32_16x16x32_bf16 a[0:3], a[128:131], v[160:163], a[0:3]
    v_mfma_f32_16x16x32_bf16 a[16:19], a[132:135], v[160:163], a[16:19]
    v_mfma_f32_16x16x32_bf16 a[32:35], a[136:139], v[160:163], a[32:35]
    v_mfma_f32_16x16x32_bf16 a[48:51], a[140:143], v[160:163], a[48:51]
    v_mfma_f32_16x16x32_bf16 a[64:67], a[144:147], v[160:163], a[64:67]
    v_mfma_f32_16x16x32_bf16 a[80:83], a[148:151], v[160:163], a[80:83]
    v_mfma_f32_16x16x32_bf16 a[96:99], a[152:155], v[160:163], a[96:99]
    v_mfma_f32_16x16x32_bf16 a[112:115], a[156:159], v[160:163], a[112:115]
    v_mfma_f32_16x16x32_bf16 a[4:7], a[128:131], v[168:171], a[4:7]
    v_mfma_f32_16x16x32_bf16 a[20:23], a[132:135], v[168:171], a[20:23]
    v_mfma_f32_16x16x32_bf16 a[36:39], a[136:139], v[168:171], a[36:39]
    v_mfma_f32_16x16x32_bf16 a[52:55], a[140:143], v[168:171], a[52:55]
    v_mfma_f32_16x16x32_bf16 a[68:71], a[144:147], v[168:171], a[68:71]
    v_mfma_f32_16x16x32_bf16 a[84:87], a[148:151], v[168:171], a[84:87]
    v_mfma_f32_16x16x32_bf16 a[100:103], a[152:155], v[168:171], a[100:103]
    v_mfma_f32_16x16x32_bf16 a[116:119], a[156:159], v[168:171], a[116:119]
    v_mfma_f32_16x16x32_bf16 a[8:11], a[128:131], v[176:179], a[8:11]
    v_mfma_f32_16x16x32_bf16 a[24:27], a[132:135], v[176:179], a[24:27]
    v_mfma_f32_16x16x32_bf16 a[40:43], a[136:139], v[176:179], a[40:43]
    v_mfma_f32_16x16x32_bf16 a[56:59], a[140:143], v[176:179], a[56:59]
    v_mfma_f32_16x16x32_bf16 a[72:75], a[144:147], v[176:179], a[72:75]
    v_mfma_f32_16x16x32_bf16 a[88:91], a[148:151], v[176:179], a[88:91]
    v_mfma_f32_16x16x32_bf16 a[104:107], a[152:155], v[176:179], a[104:107]
    v_mfma_f32_16x16x32_bf16 a[120:123], a[156:159], v[176:179], a[120:123]
    v_mfma_f32_16x16x32_bf16 a[12:15], a[128:131], v[184:187], a[12:15]
    v_mfma_f32_16x16x32_bf16 a[28:31], a[132:135], v[184:187], a[28:31]
    v_mfma_f32_16x16x32_bf16 a[44:47], a[136:139], v[184:187], a[44:47]
    v_mfma_f32_16x16x32_bf16 a[60:63], a[140:143], v[184:187], a[60:63]
    v_mfma_f32_16x16x32_bf16 a[76:79], a[144:147], v[184:187], a[76:79]
    v_mfma_f32_16x16x32_bf16 a[92:95], a[148:151], v[184:187], a[92:95]
    v_mfma_f32_16x16x32_bf16 a[108:111], a[152:155], v[184:187], a[108:111]
    v_mfma_f32_16x16x32_bf16 a[124:127], a[156:159], v[184:187], a[124:127]
    s_nop 7
    s_add_u32 s88, s88, 16384
    s_cmp_lt_u32 s88, 0x80000
    s_cbranch_scc1 L_slowloop
    v_mov_b32 v12, v8
    v_mov_b32 v13, v9
    v_mov_b32 v14, v10
    v_mov_b32 v15, v11
    s_nop 1
    v_permlane16_swap_b32 v8, v12
    v_permlane16_swap_b32 v9, v13
    v_permlane16_swap_b32 v10, v14
    v_permlane16_swap_b32 v11, v15
    v_add_f32 v8, v8, v12
    v_mov_b32 v12, v8
    v_add_f32 v9, v9, v13
    v_mov_b32 v13, v9
    v_add_f32 v10, v10, v14
    v_mov_b32 v14, v10
    v_add_f32 v11, v11, v15
    v_mov_b32 v15, v11
    s_nop 1
    v_permlane32_swap_b32 v8, v12
    v_permlane32_swap_b32 v9, v13
    v_permlane32_swap_b32 v10, v14
    v_permlane32_swap_b32 v11, v15
    v_add_f32 v8, v8, v12
    v_mov_b32 v12, v8
    v_add_f32 v9, v9, v13
    v_mov_b32 v13, v9
    v_add_f32 v10, v10, v14
    v_mov_b32 v14, v10
    v_add_f32 v11, v11, v15
    v_mov_b32 v15, v11
    s_barrier
    s_cmp_eq_u32 s95, 2
    s_mov_b32 s88, s0
    s_cselect_b32 s81, s1, 0x40000000
    s_cmp_eq_u32 s95, 3
    s_cselect_b32 s89, 0x40000000, s1
    buffer_load_dwordx2 v[24:25], v51, s[60:63], s81 offen offset:0
    buffer_load_dwordx2 v[26:27], v51, s[60:63], s81 offen offset:32
    buffer_load_dwordx2 v[28:29], v51, s[60:63], s81 offen offset:64
    buffer_load_dwordx2 v[30:31], v51, s[60:63], s81 offen offset:96
    s_add_u32 m0, s90, 65536
    s_nop 0
    buffer_load_dwordx4 v41, s[44:47], s89 offen offset:0 lds
    buffer_load_dwordx4 v42, s[44:47], s89 offen offset:1024 lds
    buffer_load_dwordx4 v43, s[44:47], s89 offen offset:2048 lds
    buffer_load_dwordx4 v44, s[44:47], s89 offen offset:3072 lds
    s_add_u32 s89, s89, s31
    s_cmp_lg_u32 s95, 2
    s_cbranch_scc1 L_oma_4
    s_add_u32 m0, s90, 0
    s_nop 0
    buffer_load_dwordx4 v40, s[72:75], s88 offen offset:0 sc1 lds
    buffer_load_dwordx4 v40, s[72:75], s88 offen offset:1024 sc1 lds
    buffer_load_dwordx4 v40, s[72:75], s88 offen offset:2048 sc1 lds
    buffer_load_dwordx4 v40, s[72:75], s88 offen offset:3072 sc1 lds
    s_add_u32 s88, s88, s30
L_oma_4:
    s_add_u32 m0, s90, 81920
    s_nop 0
    buffer_load_dwordx4 v41, s[44:47], s89 offen offset:0 lds
    buffer_load_dwordx4 v42, s[44:47], s89 offen offset:1024 lds
    buffer_load_dwordx4 v43, s[44:47], s89 offen offset:2048 lds
    buffer_load_dwordx4 v44, s[44:47], s89 offen offset:3072 lds
    s_add_u32 s89, s89, s31
    s_cmp_lg_u32 s95, 2
    s_cbranch_scc1 L_omb_5
    s_add_u32 m0, s90, 16384
    s_nop 0
    buffer_load_dwordx4 v40, s[72:75], s88 offen offset:0 sc1 lds
    buffer_load_dwordx4 v40, s[72:75], s88 offen offset:1024 sc1 lds
    buffer_load_dwordx4 v40, s[72:75], s88 offen offset:2048 sc1 lds
    buffer_load_dwordx4 v40, s[72:75], s88 offen offset:3072 sc1 lds
    s_add_u32 s88, s88, s30
L_omb_5:
    s_cmp_lg_u32 s95, 2
    s_cbranch_scc1 L_omc_6
    s_add_u32 m0, s90, 98304
    s_nop 0
    buffer_load_dwordx4 v41, s[44:47], s89 offen offset:0 lds
    buffer_load_dwordx4 v42, s[44:47], s89 offen offset:1024 lds
    buffer_load_dwordx4 v43, s[44:47], s89 offen offset:2048 lds
    buffer_load_dwordx4 v44, s[44:47], s89 offen offset:3072 lds
    s_add_u32 s89, s89, s31
    s_add_u32 m0, s90, 32768
    s_nop 0
    buffer_load_dwordx4 v40, s[72:75], s88 offen offset:0 sc1 lds
    buffer_load_dwordx4 v40, s[72:75], s88 offen offset:1024 sc1 lds
    buffer_load_dwordx4 v40, s[72:75], s88 offen offset:2048 sc1 lds
    buffer_load_dwordx4 v40, s[72:75], s88 offen offset:3072 sc1 lds
    s_add_u32 s88, s88, s30
L_omc_6:
    s_cmp_lg_u32 s95, 2
    s_cbranch_scc1 L_omd_7
    s_add_u32 m0, s90, 114688
    s_nop 0
    buffer_load_dwordx4 v41, s[44:47], s89 offen offset:0 lds
    buffer_load_dwordx4 v42, s[44:47], s89 offen offset:1024 lds
    buffer_load_dwordx4 v43, s[44:47], s89 offen offset:2048 lds
    buffer_load_dwordx4 v44, s[44:47], s89 offen offset:3072 lds
    s_add_u32 s89, s89, s31
    s_add_u32 m0, s90, 49152
    s_nop 0
    buffer_load_dwordx4 v40, s[72:75], s88 offen offset:0 sc1 lds
    buffer_load_dwordx4 v40, s[72:75], s88 offen offset:1024 sc1 lds
    buffer_load_dwordx4 v40, s[72:75], s88 offen offset:2048 sc1 lds
    buffer_load_dwordx4 v40, s[72:75], s88 offen offset:3072 sc1 lds
    s_add_u32 s88, s88, s30
L_omd_7:
    s_branch L_epi
L_end2:
L_end:
    s_endpgm
L_codeend:

.section .rodata,"a"
.p2align 6
.amdhsa_kernel recurrent_scan__gqa_block_cached__mixer_token_mlp__prompt_kernel
  .amdhsa_next_free_vgpr 512
  .amdhsa_next_free_sgpr 102
  .amdhsa_accum_offset 256
  .amdhsa_group_segment_fixed_size 0
  .amdhsa_kernarg_size 104
  .amdhsa_user_sgpr_count 2
  .amdhsa_user_sgpr_kernarg_segment_ptr 1
  .amdhsa_system_sgpr_workgroup_id_x 1
  .amdhsa_float_denorm_mode_32 3
.end_amdhsa_kernel
```
